```python
import torch

def _softmax(x, axis=-1):
    return torch.softmax(x, dim=axis)
def _gelu(x):
    return torch.nn.functional.gelu(x, approximate="tanh")
def _silu(x):
    return torch.nn.functional.silu(x)
def _sigmoid(x):
    return torch.sigmoid(x)
def _layernorm(x, axis=-1, eps=1e-5):
    m = x.mean(dim=axis, keepdim=True)
    v = x.var(dim=axis, keepdim=True, unbiased=False)
    return (x - m) / torch.sqrt(v + eps)
def _scatter_add(tgt, idx, src, axis=0):
    return tgt.clone().index_add_(axis, idx, src)
def _segment_sum(src, seg, n):
    out = torch.zeros((n,) + src.shape[1:], dtype=src.dtype)
    return out.index_add_(0, seg, src)
def _pad(x, pw):
    flat = tuple(v for pair in reversed(pw) for v in pair)
    return torch.nn.functional.pad(x, flat)

kernel_name = 'concat_heads__mha_block_cached__mha_block_cached__near_ridge'

def setup_inputs():

    _w = (lambda a: (lambda t: t.to(torch.bfloat16) if t.is_floating_point() else t)(torch.as_tensor(a)))
    def _A_setup():
        B, Sq, D = 8, 128, 448
        H, Sk, Dh = 16, 1024, 256
        return {
            "x": _w((lambda *s: torch.randn(*s, dtype=torch.bfloat16) * 0.8)(B, Sq, D)),
            "k_cache": _w((lambda *s: torch.randn(*s, dtype=torch.bfloat16) * 0.8)(B, H, Sk, Dh)),
            "v_cache": _w((lambda *s: torch.randn(*s, dtype=torch.bfloat16) * 0.05)(B, H, Sk, Dh)),
            "wq": _w((lambda *s: torch.randn(*s, dtype=torch.bfloat16) * 0.8)(D, H * Dh) * (D ** -0.5)),
            "wo": _w((lambda *s: torch.randn(*s, dtype=torch.bfloat16) * 0.05)(H * Dh, D) * ((H * Dh) ** -0.5)),
        }
    _A_in = _A_setup()

    def _B_setup():
        B, Sq, D = 8, 128, 448
        H, Sk, Dh = 16, 1024, 256
        return {
            "x": _w((lambda *s: torch.randn(*s, dtype=torch.bfloat16) * 0.8)(B, Sq, D)),
            "k_cache": _w((lambda *s: torch.randn(*s, dtype=torch.bfloat16) * 0.8)(B, H, Sk, Dh)),
            "v_cache": _w((lambda *s: torch.randn(*s, dtype=torch.bfloat16) * 0.05)(B, H, Sk, Dh)),
            "wq": _w((lambda *s: torch.randn(*s, dtype=torch.bfloat16) * 0.8)(D, H * Dh) * (D ** -0.5)),
            "wo": _w((lambda *s: torch.randn(*s, dtype=torch.bfloat16) * 0.05)(H * Dh, D) * ((H * Dh) ** -0.5)),
        }
    _B_in = _B_setup()

    return {
        "A_x": _A_in["x"],
        "A_k_cache": _A_in["k_cache"],
        "A_v_cache": _A_in["v_cache"],
        "A_wq": _A_in["wq"],
        "A_wo": _A_in["wo"],
        "B_x": _B_in["x"],
        "B_k_cache": _B_in["k_cache"],
        "B_v_cache": _B_in["v_cache"],
        "B_wq": _B_in["wq"],
        "B_wo": _B_in["wo"],
    }

def reference(A_x, A_k_cache, A_v_cache, A_wq, A_wo, B_x, B_k_cache, B_v_cache, B_wq, B_wo):
    def _A_ref(x, k_cache, v_cache, wq, wo):
        B, Sq, D = x.shape
        H, Dh = 16, 256
        q = (lambda x, *d: x.permute(*d))((x @ wq).reshape(B, Sq, H, Dh), 0, 2, 1, 3)
        scores = torch.einsum("bhqd,bhkd->bhqk", q, k_cache) * (Dh ** -0.5)
        p = _softmax(scores, axis=-1)
        o = torch.einsum("bhqk,bhkd->bhqd", p, v_cache)
        return (lambda x, *d: x.permute(*d))(o, 0, 2, 1, 3).reshape(B, Sq, H * Dh) @ wo

    def _B_ref(x, k_cache, v_cache, wq, wo):
        B, Sq, D = x.shape
        H, Dh = 16, 256
        q = (lambda x, *d: x.permute(*d))((x @ wq).reshape(B, Sq, H, Dh), 0, 2, 1, 3)
        scores = torch.einsum("bhqd,bhkd->bhqk", q, k_cache) * (Dh ** -0.5)
        p = _softmax(scores, axis=-1)
        o = torch.einsum("bhqk,bhkd->bhqd", p, v_cache)
        return (lambda x, *d: x.permute(*d))(o, 0, 2, 1, 3).reshape(B, Sq, H * Dh) @ wo

    a = _A_ref(A_x, A_k_cache, A_v_cache, A_wq, A_wo)
    b = _B_ref(B_x, B_k_cache, B_v_cache, B_wq, B_wo)
    return torch.concatenate([a, b], axis=-1)
```

```asm
; @launch grid=(256,1,1) block=(256,1,1) lds=163840
.amdgcn_target "amdgcn-amd-amdhsa--gfx950"
.text
.globl concat_heads__mha_block_cached__mha_block_cached__near_ridge_kernel
.p2align 8
.type concat_heads__mha_block_cached__mha_block_cached__near_ridge_kernel,@function
concat_heads__mha_block_cached__mha_block_cached__near_ridge_kernel:
s_load_dwordx16 s[36:51], s[0:1], 0
s_load_dwordx8 s[52:59], s[0:1], 64
s_load_dwordx2 s[60:61], s[0:1], 96
s_cmp_lt_u32 s2, 256
s_cbranch_scc1 L_go
s_endpgm
L_go:
v_lshrrev_b32 v162, 6, v0
v_and_b32 v220, 63, v0
s_and_b32 s3, s2, 7
s_lshr_b32 s4, s2, 3
v_readfirstlane_b32 s32, v162
s_bfe_u32 s5, s3, 0x10001
s_lshr_b32 s6, s3, 1
s_and_b32 s6, s6, 2
s_and_b32 s3, s3, 1
s_or_b32 s6, s6, s3
s_lshl_b32 s6, s6, 2
s_and_b32 s34, s4, 3
s_or_b32 s6, s6, s34
s_lshr_b32 s7, s4, 2
s_lshl_b32 s34, s34, 1
s_add_u32 s34, s34, s7
s_cmp_ge_u32 s34, 7
s_cselect_b32 s35, 7, 0
s_sub_u32 s64, s34, s35
s_add_u32 s65, s64, 1
s_cmp_eq_u32 s65, 7
s_cselect_b32 s65, 0, s65
s_add_u32 s66, s65, 1
s_cmp_eq_u32 s66, 7
s_cselect_b32 s66, 0, s66
s_lshl_b32 s33, s32, 12
v_lshrrev_b32 v156, 5, v220
v_and_b32 v159, 31, v220
v_lshrrev_b32 v158, 4, v220
v_and_b32 v160, 7, v220
v_lshrrev_b32 v161, 3, v220
s_lshl_b32 s34, s32, 5
v_add_u32 v164, s34, v161
v_mul_u32_u24 v164, 896, v164
v_xor_b32 v162, v158, v160
v_lshl_add_u32 v144, v162, 4, v164
v_xor_b32 v162, 4, v162
v_lshl_add_u32 v145, v162, 4, v164
v_add_u32 v146, 12288, v144
v_add_u32 v147, 18432, v145
v_add_u32 v145, 6144, v145
s_and_b32 s34, s32, 1
s_lshl_b32 s34, s34, 17
s_lshr_b32 s35, s32, 1
s_lshl_b32 s35, s35, 15
s_add_u32 s34, s34, s35
v_lshlrev_b32 v162, 1, v156
v_xor_b32 v162, v162, v159
v_lshlrev_b32 v162, 4, v162
v_lshl_add_u32 v163, v156, 13, v162
v_add_u32 v163, s34, v163
v_xor_b32 v148, 0, v163
v_xor_b32 v149, 64, v163
v_add_u32 v149, 15360, v149
v_xor_b32 v150, 128, v163
v_add_u32 v150, 63488, v150
v_xor_b32 v151, 192, v163
v_add_u32 v151, 78848, v151
s_waitcnt lgkmcnt(0)
s_cmp_eq_u32 s5, 0
s_cselect_b64 s[36:37], s[36:37], s[46:47]
s_cselect_b64 s[38:39], s[38:39], s[48:49]
s_cselect_b64 s[40:41], s[40:41], s[50:51]
s_cselect_b64 s[42:43], s[42:43], s[52:53]
s_cselect_b64 s[44:45], s[44:45], s[54:55]
s_mul_i32 s34, s7, 114688
s_add_u32 s16, s36, s34
s_addc_u32 s17, s37, 0
s_mov_b32 s18, 114688
s_mov_b32 s19, 0x20000
s_lshl_b32 s34, s6, 9
s_add_u32 s20, s42, s34
s_addc_u32 s21, s43, 0
s_mov_b32 s22, 3662336
s_mov_b32 s23, 0x20000
s_add_u32 m0, s33, 131072
s_lshl_b32 s34, s64, 7
buffer_load_dwordx4 v144, s[16:19], s34 offen offset:0  lds
buffer_load_dwordx4 v145, s[16:19], s34 offen offset:1024  lds
buffer_load_dwordx4 v146, s[16:19], s34 offen offset:2048  lds
buffer_load_dwordx4 v147, s[16:19], s34 offen offset:3072  lds
s_add_u32 m0, s33, 0
s_lshl_b32 s34, s64, 19
buffer_load_dwordx4 v148, s[20:23], s34 offen offset:0  lds
buffer_load_dwordx4 v149, s[20:23], s34 offen offset:1024  lds
buffer_load_dwordx4 v150, s[20:23], s34 offen offset:2048  lds
buffer_load_dwordx4 v151, s[20:23], s34 offen offset:3072  lds
s_add_u32 m0, s33, 147456
s_lshl_b32 s34, s65, 7
buffer_load_dwordx4 v144, s[16:19], s34 offen offset:0  lds
buffer_load_dwordx4 v145, s[16:19], s34 offen offset:1024  lds
buffer_load_dwordx4 v146, s[16:19], s34 offen offset:2048  lds
buffer_load_dwordx4 v147, s[16:19], s34 offen offset:3072  lds
s_add_u32 m0, s33, 16384
s_lshl_b32 s34, s64, 19
s_add_u32 s34, s34, 262144
buffer_load_dwordx4 v148, s[20:23], s34 offen offset:0  lds
buffer_load_dwordx4 v149, s[20:23], s34 offen offset:1024  lds
buffer_load_dwordx4 v150, s[20:23], s34 offen offset:2048  lds
buffer_load_dwordx4 v151, s[20:23], s34 offen offset:3072  lds
s_add_u32 s67, s66, 1
s_cmp_eq_u32 s67, 7
s_cselect_b32 s67, 0, s67
s_add_u32 s68, s67, 1
s_cmp_eq_u32 s68, 7
s_cselect_b32 s68, 0, s68
s_add_u32 s69, s68, 1
s_cmp_eq_u32 s69, 7
s_cselect_b32 s69, 0, s69
s_add_u32 s70, s69, 1
s_cmp_eq_u32 s70, 7
s_cselect_b32 s70, 0, s70
s_lshl_b32 s34, s7, 4
s_add_u32 s34, s34, s6
s_lshl_b32 s34, s34, 19
s_add_u32 s8, s38, s34
s_addc_u32 s9, s39, 0
s_mov_b32 s10, 524288
s_mov_b32 s11, 0x20000
s_add_u32 s12, s40, s34
s_addc_u32 s13, s41, 0
s_mov_b32 s14, 524288
s_mov_b32 s15, 0x20000
s_lshl_b32 s35, s32, 14
v_lshl_add_u32 v163, v156, 9, v162
v_add_u32 v163, s35, v163
v_xor_b32 v192, 0, v163
v_xor_b32 v193, 64, v163
v_add_u32 v193, 7168, v193
v_xor_b32 v194, 128, v163
v_add_u32 v194, 2048, v194
v_xor_b32 v195, 192, v163
v_add_u32 v195, 9216, v195
s_and_b32 s34, s32, 1
s_lshl_b32 s34, s34, 3
v_xor_b32 v162, v156, v159
v_xor_b32 v162, s34, v162
v_lshlrev_b32 v162, 4, v162
v_lshl_add_u32 v163, v156, 9, v162
v_add_u32 v163, s35, v163
v_xor_b32 v188, 0, v163
v_xor_b32 v189, 32, v163
v_add_u32 v189, 7168, v189
v_xor_b32 v190, 64, v163
v_add_u32 v190, 2048, v190
v_xor_b32 v191, 96, v163
v_add_u32 v191, 9216, v191
s_getpc_b64 s[52:53]
L_pc:
s_lshl_b32 s34, s4, 12
s_lshl_b32 s35, s32, 10
s_add_u32 s34, s34, s35
v_lshl_add_u32 v162, v160, 7, s34
v_min_u32 v162, L_codeend-L_pc-4, v162
global_load_dword v221, v162, s[52:53]
s_cmp_eq_u32 s7, 7
s_cselect_b32 s72, 0, s7
s_mov_b32 s72, 0
s_add_u32 s73, s72, 1
s_cmp_eq_u32 s73, 7
s_cselect_b32 s73, 0, s73
s_add_u32 s74, s73, 1
s_cmp_eq_u32 s74, 7
s_cselect_b32 s74, 0, s74
s_add_u32 s75, s74, 1
s_cmp_eq_u32 s75, 7
s_cselect_b32 s75, 0, s75
s_add_u32 s76, s75, 1
s_cmp_eq_u32 s76, 7
s_cselect_b32 s76, 0, s76
s_add_u32 s77, s76, 1
s_cmp_eq_u32 s77, 7
s_cselect_b32 s77, 0, s77
s_add_u32 s78, s77, 1
s_cmp_eq_u32 s78, 7
s_cselect_b32 s78, 0, s78
s_mov_b32 s80, 0x41000000
s_mul_i32 s34, s6, 229376
s_add_u32 s24, s44, s34
s_addc_u32 s25, s45, 0
s_mov_b32 s26, 229376
s_mov_b32 s27, 0x20000
s_lshl_b32 s62, s5, 3
s_add_u32 s62, s62, s7
s_mul_i32 s34, s62, 1835008
s_mul_i32 s35, s6, 7168
s_add_u32 s35, s34, s35
s_add_u32 s28, s60, s35
s_addc_u32 s29, s61, 0
s_mov_b32 s30, 1727488
s_mov_b32 s31, 0x20000
s_mul_i32 s35, s6, 114688
s_add_u32 s35, s34, s35
s_add_u32 s36, s60, s35
s_addc_u32 s37, s61, 0
s_mov_b32 s38, 114688
s_mov_b32 s39, 0x20000
s_lshl_b32 s35, s62, 15
s_add_u32 s35, s35, 29360128
s_add_u32 s40, s60, s35
s_addc_u32 s41, s61, 0
s_mov_b32 s42, 32768
s_mov_b32 s43, 0x20000
s_lshl_b32 s35, s62, 4
s_add_u32 s44, s58, s35
s_addc_u32 s45, s59, 0
s_mov_b32 s46, 4
s_mov_b32 s47, 0x20000
s_mov_b32 s48, s56
s_mov_b32 s49, s57
s_mov_b32 s50, 1835008
s_mov_b32 s51, 0x20000
s_lshl_b32 s34, s32, 13
s_lshl_b32 s35, s6, 9
s_add_u32 s34, s34, s35
v_lshl_add_u32 v253, v220, 3, s34
v_lshl_add_u32 v222, v159, 2, s34
v_lshl_add_u32 v222, v156, 15, v222
v_mov_b32 v229, 0
v_mov_b32 v228, 0
v_and_b32 v157, 15, v220
v_lshrrev_b32 v162, 2, v220
v_and_b32 v163, 7, v162
v_lshlrev_b32 v163, 5, v163
v_lshl_add_u32 v163, v162, 9, v163
v_and_b32 v225, 3, v220
v_lshl_add_u32 v163, v225, 3, v163
v_xor_b32 v128, 0, v163
v_add_u32 v180, 0x10000, v128
v_add_u32 v136, 0x20000, v128
v_xor_b32 v129, 32, v163
v_add_u32 v181, 0x10000, v129
v_add_u32 v137, 0x20000, v129
v_xor_b32 v130, 64, v163
v_add_u32 v182, 0x10000, v130
v_add_u32 v138, 0x20000, v130
v_xor_b32 v131, 96, v163
v_add_u32 v183, 0x10000, v131
v_add_u32 v139, 0x20000, v131
v_xor_b32 v132, 128, v163
v_add_u32 v184, 0x10000, v132
v_add_u32 v140, 0x20000, v132
v_xor_b32 v133, 160, v163
v_add_u32 v185, 0x10000, v133
v_add_u32 v141, 0x20000, v133
v_xor_b32 v134, 192, v163
v_add_u32 v186, 0x10000, v134
v_add_u32 v142, 0x20000, v134
v_xor_b32 v135, 224, v163
v_add_u32 v187, 0x10000, v135
v_add_u32 v143, 0x20000, v135
v_bfe_u32 v163, v220, 3, 2
v_lshlrev_b32 v163, 5, v163
v_lshl_add_u32 v163, v162, 7, v163
v_lshl_add_u32 v163, v225, 3, v163
s_lshl_b32 s34, s32, 5
v_xor_b32 v200, s34, v163
s_add_u32 s34, s32, 0
s_and_b32 s34, s34, 3
s_mul_i32 s52, s34, 458752
s_lshl_b32 s92, s34, 7
s_lshl_b32 s34, s34, 14
v_lshl_add_u32 v219, v220, 4, s34
s_add_u32 s34, s32, 1
s_and_b32 s34, s34, 3
s_mul_i32 s53, s34, 458752
s_lshl_b32 s93, s34, 7
s_lshl_b32 s34, s34, 14
v_lshl_add_u32 v201, v220, 4, s34
s_add_u32 s34, s32, 2
s_and_b32 s34, s34, 3
s_mul_i32 s54, s34, 458752
s_lshl_b32 s94, s34, 7
s_lshl_b32 s34, s34, 14
v_lshl_add_u32 v202, v220, 4, s34
s_add_u32 s34, s32, 3
s_and_b32 s34, s34, 3
s_mul_i32 s55, s34, 458752
s_lshl_b32 s95, s34, 7
s_lshl_b32 s34, s34, 14
v_lshl_add_u32 v203, v220, 4, s34
v_lshrrev_b32 v162, 1, v157
v_xor_b32 v162, v162, v158
v_lshlrev_b32 v162, 4, v162
v_lshl_add_u32 v162, v157, 7, v162
v_add_u32 v152, s33, v162
v_xor_b32 v153, 64, v152
v_bfe_u32 v162, v220, 4, 1
v_lshl_add_u32 v162, v162, 1, v156
v_xor_b32 v162, v162, v157
v_lshlrev_b32 v162, 4, v162
v_lshl_add_u32 v162, v157, 9, v162
v_xor_b32 v176, 0, v162
v_xor_b32 v177, 64, v162
v_xor_b32 v178, 128, v162
v_xor_b32 v179, 192, v162
v_lshl_add_u32 v252, v220, 4, s33
v_lshlrev_b32 v162, 1, v158
v_xor_b32 v162, v162, v160
v_lshl_add_u32 v196, v162, 4, v164
v_add_u32 v197, 6144, v196
v_add_u32 v198, 12288, v196
v_add_u32 v199, 18432, v196
v_bfe_u32 v163, v220, 2, 2
v_mul_u32_u24 v162, 114688, v163
v_lshl_add_u32 v162, v158, 6, v162
v_lshl_add_u32 v162, v225, 4, v162
s_lshl_b32 s34, s32, 8
v_add_u32 v218, s34, v162
s_lshl_b32 s34, s32, 13
s_lshr_b32 s35, s6, 2
s_lshl_b32 s35, s35, 7
s_add_u32 s34, s34, s35
v_lshl_add_u32 v223, v157, 9, s34
v_mul_u32_u24 v224, 7168, v158
v_lshl_add_u32 v224, v157, 4, v224
s_lshl_b32 s34, s32, 8
v_add_u32 v224, s34, v224
s_lshl_b32 s34, s7, 7
s_lshr_b32 s35, s6, 2
s_lshl_b32 s35, s35, 5
s_add_u32 s34, s34, s35
s_and_b32 s35, s6, 3
s_lshl_b32 s35, s35, 2
s_add_u32 s34, s34, s35
s_mul_i32 s34, s34, 1792
s_mul_i32 s35, s5, 896
s_add_u32 s34, s34, s35
s_lshl_b32 s35, s32, 5
s_add_u32 s34, s34, s35
v_lshl_add_u32 v225, v158, 4, v225
v_mul_u32_u24 v225, 1792, v225
v_lshl_add_u32 v225, v163, 3, v225
v_lshl_add_u32 v225, v156, 30, v225
v_add_u32 v225, s34, v225
v_and_b32 v163, 1, v220
v_lshlrev_b32 v163, 4, v163
v_mov_b32 v162, 0x3f80
v_lshlrev_b32 v162, v163, v162
v_lshrrev_b32 v163, 1, v157
v_cmp_eq_u32 vcc, 0, v163
s_nop 1
v_cndmask_b32 v204, v228, v162, vcc
v_cmp_eq_u32 vcc, 1, v163
s_nop 1
v_cndmask_b32 v205, v228, v162, vcc
v_cmp_eq_u32 vcc, 2, v163
s_nop 1
v_cndmask_b32 v206, v228, v162, vcc
v_cmp_eq_u32 vcc, 3, v163
s_nop 1
v_cndmask_b32 v207, v228, v162, vcc
v_mov_b32 v162, 0x3f803f80
v_accvgpr_write_b32 a232, v162
v_accvgpr_write_b32 a233, v162
v_accvgpr_write_b32 a234, v162
v_accvgpr_write_b32 a235, v162
v_mov_b32 v232, 0x3db8aa3b
v_mov_b32 v233, 0x3db8aa3b
v_mov_b32 v226, 1
s_lshl_b32 s35, s32, 8
v_lshl_add_u32 v227, v220, 2, s35
v_add_u32 v152, 131072, v152
v_add_u32 v153, 131072, v153
s_waitcnt vmcnt(9)
s_barrier
ds_read_b128 a[4:7], v152 offset:2048
ds_read_b128 a[0:3], v152 offset:0
ds_read_b64_tr_b16 a[192:193], v128 offset:0
ds_read_b64_tr_b16 a[194:195], v128 offset:8192
ds_read_b64_tr_b16 a[196:197], v129 offset:0
ds_read_b64_tr_b16 a[198:199], v129 offset:8192
ds_read_b64_tr_b16 a[200:201], v130 offset:0
ds_read_b64_tr_b16 a[202:203], v130 offset:8192
ds_read_b64_tr_b16 a[204:205], v131 offset:0
ds_read_b64_tr_b16 a[206:207], v131 offset:8192
ds_read_b128 a[8:11], v153 offset:0
ds_read_b64_tr_b16 a[208:209], v132 offset:0
ds_read_b64_tr_b16 a[210:211], v132 offset:8192
ds_read_b64_tr_b16 a[212:213], v133 offset:0
ds_read_b64_tr_b16 a[214:215], v133 offset:8192
s_waitcnt lgkmcnt(9)
v_mfma_f32_16x16x32_bf16 v[0:3], a[192:195], a[0:3], 0
ds_read_b64_tr_b16 a[216:217], v134 offset:0
v_mfma_f32_16x16x32_bf16 v[8:11], a[192:195], a[4:7], 0
ds_read_b64_tr_b16 a[218:219], v134 offset:8192
s_add_u32 m0, s33, 32768
s_lshl_b32 s34, s65, 19
buffer_load_dwordx4 v148, s[20:23], s34 offen offset:0  lds
v_mfma_f32_16x16x32_bf16 v[4:7], a[196:199], a[0:3], 0
ds_read_b64_tr_b16 a[220:221], v135 offset:0
v_mfma_f32_16x16x32_bf16 v[12:15], a[196:199], a[4:7], 0
ds_read_b64_tr_b16 a[222:223], v135 offset:8192
buffer_load_dwordx4 v149, s[20:23], s34 offen offset:1024  lds
s_waitcnt lgkmcnt(9)
v_mfma_f32_16x16x32_bf16 v[16:19], a[200:203], a[0:3], 0
ds_read_b128 a[12:15], v153 offset:2048
ds_read_b64_tr_b16 a[192:193], v128 offset:256
v_mfma_f32_16x16x32_bf16 v[24:27], a[200:203], a[4:7], 0
ds_read_b64_tr_b16 a[194:195], v128 offset:8448
buffer_load_dwordx4 v150, s[20:23], s34 offen offset:2048  lds
v_mfma_f32_16x16x32_bf16 v[20:23], a[204:207], a[0:3], 0
ds_read_b64_tr_b16 a[196:197], v129 offset:256
v_mfma_f32_16x16x32_bf16 v[28:31], a[204:207], a[4:7], 0
ds_read_b64_tr_b16 a[198:199], v129 offset:8448
buffer_load_dwordx4 v151, s[20:23], s34 offen offset:3072  lds
s_waitcnt lgkmcnt(9)
v_mfma_f32_16x16x32_bf16 v[32:35], a[208:211], a[0:3], 0
ds_read_b64_tr_b16 a[200:201], v130 offset:256
v_mfma_f32_16x16x32_bf16 v[40:43], a[208:211], a[4:7], 0
ds_read_b64_tr_b16 a[202:203], v130 offset:8448
s_add_u32 m0, s33, 49152
s_lshl_b32 s34, s65, 19
s_add_u32 s34, s34, 262144
buffer_load_dwordx4 v148, s[20:23], s34 offen offset:0  lds
v_mfma_f32_16x16x32_bf16 v[36:39], a[212:215], a[0:3], 0
ds_read_b64_tr_b16 a[204:205], v131 offset:256
v_mfma_f32_16x16x32_bf16 v[44:47], a[212:215], a[4:7], 0
ds_read_b64_tr_b16 a[206:207], v131 offset:8448
buffer_load_dwordx4 v149, s[20:23], s34 offen offset:1024  lds
s_waitcnt lgkmcnt(9)
v_mfma_f32_16x16x32_bf16 v[48:51], a[216:219], a[0:3], 0
ds_read_b64_tr_b16 a[208:209], v132 offset:256
v_mfma_f32_16x16x32_bf16 v[56:59], a[216:219], a[4:7], 0
ds_read_b64_tr_b16 a[210:211], v132 offset:8448
buffer_load_dwordx4 v150, s[20:23], s34 offen offset:2048  lds
v_mfma_f32_16x16x32_bf16 v[52:55], a[220:223], a[0:3], 0
ds_read_b64_tr_b16 a[212:213], v133 offset:256
v_mfma_f32_16x16x32_bf16 v[60:63], a[220:223], a[4:7], 0
ds_read_b64_tr_b16 a[214:215], v133 offset:8448
buffer_load_dwordx4 v151, s[20:23], s34 offen offset:3072  lds
s_waitcnt lgkmcnt(8)
v_mfma_f32_16x16x32_bf16 v[64:67], a[192:195], a[0:3], 0
ds_read_b64_tr_b16 a[216:217], v134 offset:256
v_mfma_f32_16x16x32_bf16 v[72:75], a[192:195], a[4:7], 0
ds_read_b64_tr_b16 a[218:219], v134 offset:8448
s_add_u32 m0, s33, 65536
s_lshl_b32 s34, s66, 7
buffer_load_dwordx4 v144, s[16:19], s34 offen offset:0  lds
v_mfma_f32_16x16x32_bf16 v[68:71], a[196:199], a[0:3], 0
ds_read_b64_tr_b16 a[220:221], v135 offset:256
v_mfma_f32_16x16x32_bf16 v[76:79], a[196:199], a[4:7], 0
ds_read_b64_tr_b16 a[222:223], v135 offset:8448
buffer_load_dwordx4 v145, s[16:19], s34 offen offset:1024  lds
s_waitcnt lgkmcnt(8)
v_mfma_f32_16x16x32_bf16 v[80:83], a[200:203], a[0:3], 0
s_waitcnt vmcnt(11)
s_barrier
ds_read_b64_tr_b16 a[192:193], v128 offset:16384
v_mfma_f32_16x16x32_bf16 v[88:91], a[200:203], a[4:7], 0
ds_read_b64_tr_b16 a[194:195], v128 offset:24576
buffer_load_dwordx4 v146, s[16:19], s34 offen offset:2048  lds
v_mfma_f32_16x16x32_bf16 v[84:87], a[204:207], a[0:3], 0
ds_read_b64_tr_b16 a[196:197], v129 offset:16384
v_mfma_f32_16x16x32_bf16 v[92:95], a[204:207], a[4:7], 0
ds_read_b64_tr_b16 a[198:199], v129 offset:24576
buffer_load_dwordx4 v147, s[16:19], s34 offen offset:3072  lds
s_waitcnt lgkmcnt(8)
v_mfma_f32_16x16x32_bf16 v[96:99], a[208:211], a[0:3], 0
ds_read_b64_tr_b16 a[200:201], v130 offset:16384
v_mfma_f32_16x16x32_bf16 v[104:107], a[208:211], a[4:7], 0
ds_read_b64_tr_b16 a[202:203], v130 offset:24576
s_add_u32 m0, s33, 81920
s_lshl_b32 s34, s66, 19
buffer_load_dwordx4 v148, s[20:23], s34 offen offset:0  lds
v_mfma_f32_16x16x32_bf16 v[100:103], a[212:215], a[0:3], 0
ds_read_b64_tr_b16 a[204:205], v131 offset:16384
v_mfma_f32_16x16x32_bf16 v[108:111], a[212:215], a[4:7], 0
ds_read_b64_tr_b16 a[206:207], v131 offset:24576
buffer_load_dwordx4 v149, s[20:23], s34 offen offset:1024  lds
s_waitcnt lgkmcnt(8)
v_mfma_f32_16x16x32_bf16 v[112:115], a[216:219], a[0:3], 0
ds_read_b64_tr_b16 a[208:209], v132 offset:16384
v_mfma_f32_16x16x32_bf16 v[120:123], a[216:219], a[4:7], 0
ds_read_b64_tr_b16 a[210:211], v132 offset:24576
buffer_load_dwordx4 v150, s[20:23], s34 offen offset:2048  lds
v_mfma_f32_16x16x32_bf16 v[116:119], a[220:223], a[0:3], 0
ds_read_b64_tr_b16 a[212:213], v133 offset:16384
v_mfma_f32_16x16x32_bf16 v[124:127], a[220:223], a[4:7], 0
ds_read_b64_tr_b16 a[214:215], v133 offset:24576
buffer_load_dwordx4 v151, s[20:23], s34 offen offset:3072  lds
s_waitcnt lgkmcnt(8)
v_mfma_f32_16x16x32_bf16 v[0:3], a[192:195], a[8:11], v[0:3]
ds_read_b64_tr_b16 a[216:217], v134 offset:16384
v_mfma_f32_16x16x32_bf16 v[8:11], a[192:195], a[12:15], v[8:11]
ds_read_b64_tr_b16 a[218:219], v134 offset:24576
v_mfma_f32_16x16x32_bf16 v[4:7], a[196:199], a[8:11], v[4:7]
ds_read_b64_tr_b16 a[220:221], v135 offset:16384
v_mfma_f32_16x16x32_bf16 v[12:15], a[196:199], a[12:15], v[12:15]
ds_read_b64_tr_b16 a[222:223], v135 offset:24576
s_waitcnt lgkmcnt(8)
v_mfma_f32_16x16x32_bf16 v[16:19], a[200:203], a[8:11], v[16:19]
ds_read_b64_tr_b16 a[192:193], v128 offset:16640
v_mfma_f32_16x16x32_bf16 v[24:27], a[200:203], a[12:15], v[24:27]
ds_read_b64_tr_b16 a[194:195], v128 offset:24832
v_mfma_f32_16x16x32_bf16 v[20:23], a[204:207], a[8:11], v[20:23]
ds_read_b64_tr_b16 a[196:197], v129 offset:16640
v_mfma_f32_16x16x32_bf16 v[28:31], a[204:207], a[12:15], v[28:31]
ds_read_b64_tr_b16 a[198:199], v129 offset:24832
s_waitcnt lgkmcnt(8)
v_mfma_f32_16x16x32_bf16 v[32:35], a[208:211], a[8:11], v[32:35]
ds_read_b64_tr_b16 a[200:201], v130 offset:16640
v_mfma_f32_16x16x32_bf16 v[40:43], a[208:211], a[12:15], v[40:43]
ds_read_b64_tr_b16 a[202:203], v130 offset:24832
v_mfma_f32_16x16x32_bf16 v[36:39], a[212:215], a[8:11], v[36:39]
ds_read_b64_tr_b16 a[204:205], v131 offset:16640
v_mfma_f32_16x16x32_bf16 v[44:47], a[212:215], a[12:15], v[44:47]
ds_read_b64_tr_b16 a[206:207], v131 offset:24832
s_waitcnt lgkmcnt(8)
v_mfma_f32_16x16x32_bf16 v[48:51], a[216:219], a[8:11], v[48:51]
ds_read_b64_tr_b16 a[208:209], v132 offset:16640
v_mfma_f32_16x16x32_bf16 v[56:59], a[216:219], a[12:15], v[56:59]
ds_read_b64_tr_b16 a[210:211], v132 offset:24832
v_mfma_f32_16x16x32_bf16 v[52:55], a[220:223], a[8:11], v[52:55]
ds_read_b64_tr_b16 a[212:213], v133 offset:16640
v_mfma_f32_16x16x32_bf16 v[60:63], a[220:223], a[12:15], v[60:63]
ds_read_b64_tr_b16 a[214:215], v133 offset:24832
s_waitcnt lgkmcnt(8)
v_mfma_f32_16x16x32_bf16 v[64:67], a[192:195], a[8:11], v[64:67]
ds_read_b64_tr_b16 a[216:217], v134 offset:16640
v_mfma_f32_16x16x32_bf16 v[72:75], a[192:195], a[12:15], v[72:75]
ds_read_b64_tr_b16 a[218:219], v134 offset:24832
s_add_u32 m0, s33, 98304
s_lshl_b32 s34, s66, 19
s_add_u32 s34, s34, 262144
buffer_load_dwordx4 v148, s[20:23], s34 offen offset:0  lds
v_mfma_f32_16x16x32_bf16 v[68:71], a[196:199], a[8:11], v[68:71]
ds_read_b64_tr_b16 a[220:221], v135 offset:16640
v_mfma_f32_16x16x32_bf16 v[76:79], a[196:199], a[12:15], v[76:79]
ds_read_b64_tr_b16 a[222:223], v135 offset:24832
buffer_load_dwordx4 v149, s[20:23], s34 offen offset:1024  lds
s_waitcnt lgkmcnt(8)
v_mfma_f32_16x16x32_bf16 v[80:83], a[200:203], a[8:11], v[80:83]
s_waitcnt vmcnt(14)
s_barrier
buffer_store_dwordx2 v[228:229], v253, s[40:43], 0 offen sc1
ds_read_b128 a[20:23], v152 offset:18432
ds_read_b128 a[16:19], v152 offset:16384
v_mfma_f32_16x16x32_bf16 v[88:91], a[200:203], a[12:15], v[88:91]
ds_read_b64_tr_b16 a[192:193], v128 offset:32768
ds_read_b64_tr_b16 a[194:195], v128 offset:40960
buffer_load_dwordx4 v150, s[20:23], s34 offen offset:2048  lds
v_mfma_f32_16x16x32_bf16 v[84:87], a[204:207], a[8:11], v[84:87]
ds_read_b64_tr_b16 a[196:197], v129 offset:32768
v_mfma_f32_16x16x32_bf16 v[92:95], a[204:207], a[12:15], v[92:95]
ds_read_b64_tr_b16 a[198:199], v129 offset:40960
buffer_load_dwordx4 v151, s[20:23], s34 offen offset:3072  lds
s_waitcnt lgkmcnt(10)
v_mfma_f32_16x16x32_bf16 v[96:99], a[208:211], a[8:11], v[96:99]
ds_read_b64_tr_b16 a[200:201], v130 offset:32768
v_mfma_f32_16x16x32_bf16 v[104:107], a[208:211], a[12:15], v[104:107]
ds_read_b64_tr_b16 a[202:203], v130 offset:40960
s_mov_b32 s34, 3072
buffer_load_dwordx4 a[32:35], v188, s[8:11], s34 offen offset:0 nt
v_mfma_f32_16x16x32_bf16 v[100:103], a[212:215], a[8:11], v[100:103]
ds_read_b64_tr_b16 a[204:205], v131 offset:32768
v_mfma_f32_16x16x32_bf16 v[108:111], a[212:215], a[12:15], v[108:111]
ds_read_b64_tr_b16 a[206:207], v131 offset:40960
s_mov_b32 s34, 2048
buffer_load_dwordx4 a[36:39], v189, s[8:11], s34 offen offset:1024 nt
s_waitcnt lgkmcnt(10)
v_mfma_f32_16x16x32_bf16 v[112:115], a[216:219], a[8:11], v[112:115]
ds_read_b128 a[24:27], v153 offset:16384
ds_read_b64_tr_b16 a[208:209], v132 offset:32768
v_mfma_f32_16x16x32_bf16 v[120:123], a[216:219], a[12:15], v[120:123]
ds_read_b64_tr_b16 a[210:211], v132 offset:40960
s_mov_b32 s34, 1024
buffer_load_dwordx4 a[40:43], v190, s[8:11], s34 offen offset:2048 nt
v_mfma_f32_16x16x32_bf16 v[116:119], a[220:223], a[8:11], v[116:119]
ds_read_b64_tr_b16 a[212:213], v133 offset:32768
v_mfma_f32_16x16x32_bf16 v[124:127], a[220:223], a[12:15], v[124:127]
ds_read_b64_tr_b16 a[214:215], v133 offset:40960
s_mov_b32 s34, 0
buffer_load_dwordx4 a[44:47], v191, s[8:11], s34 offen offset:3072 nt
s_waitcnt lgkmcnt(9)
v_mfma_f32_16x16x32_bf16 v[0:3], a[192:195], a[16:19], v[0:3]
ds_read_b64_tr_b16 a[216:217], v134 offset:32768
v_mfma_f32_16x16x32_bf16 v[8:11], a[192:195], a[20:23], v[8:11]
ds_read_b64_tr_b16 a[218:219], v134 offset:40960
v_mfma_f32_16x16x32_bf16 v[4:7], a[196:199], a[16:19], v[4:7]
ds_read_b64_tr_b16 a[220:221], v135 offset:32768
v_mfma_f32_16x16x32_bf16 v[12:15], a[196:199], a[20:23], v[12:15]
ds_read_b64_tr_b16 a[222:223], v135 offset:40960
s_waitcnt lgkmcnt(9)
v_mfma_f32_16x16x32_bf16 v[16:19], a[200:203], a[16:19], v[16:19]
ds_read_b128 a[28:31], v153 offset:18432
ds_read_b64_tr_b16 a[192:193], v128 offset:33024
v_mfma_f32_16x16x32_bf16 v[24:27], a[200:203], a[20:23], v[24:27]
ds_read_b64_tr_b16 a[194:195], v128 offset:41216
v_mfma_f32_16x16x32_bf16 v[20:23], a[204:207], a[16:19], v[20:23]
ds_read_b64_tr_b16 a[196:197], v129 offset:33024
v_mfma_f32_16x16x32_bf16 v[28:31], a[204:207], a[20:23], v[28:31]
ds_read_b64_tr_b16 a[198:199], v129 offset:41216
s_waitcnt lgkmcnt(9)
v_mfma_f32_16x16x32_bf16 v[32:35], a[208:211], a[16:19], v[32:35]
ds_read_b64_tr_b16 a[200:201], v130 offset:33024
v_mfma_f32_16x16x32_bf16 v[40:43], a[208:211], a[20:23], v[40:43]
ds_read_b64_tr_b16 a[202:203], v130 offset:41216
v_mfma_f32_16x16x32_bf16 v[36:39], a[212:215], a[16:19], v[36:39]
ds_read_b64_tr_b16 a[204:205], v131 offset:33024
v_mfma_f32_16x16x32_bf16 v[44:47], a[212:215], a[20:23], v[44:47]
ds_read_b64_tr_b16 a[206:207], v131 offset:41216
s_waitcnt lgkmcnt(9)
v_mfma_f32_16x16x32_bf16 v[48:51], a[216:219], a[16:19], v[48:51]
ds_read_b64_tr_b16 a[208:209], v132 offset:33024
v_mfma_f32_16x16x32_bf16 v[56:59], a[216:219], a[20:23], v[56:59]
ds_read_b64_tr_b16 a[210:211], v132 offset:41216
v_mfma_f32_16x16x32_bf16 v[52:55], a[220:223], a[16:19], v[52:55]
ds_read_b64_tr_b16 a[212:213], v133 offset:33024
v_mfma_f32_16x16x32_bf16 v[60:63], a[220:223], a[20:23], v[60:63]
ds_read_b64_tr_b16 a[214:215], v133 offset:41216
s_waitcnt lgkmcnt(8)
v_mfma_f32_16x16x32_bf16 v[64:67], a[192:195], a[16:19], v[64:67]
ds_read_b64_tr_b16 a[216:217], v134 offset:33024
v_mfma_f32_16x16x32_bf16 v[72:75], a[192:195], a[20:23], v[72:75]
ds_read_b64_tr_b16 a[218:219], v134 offset:41216
s_add_u32 m0, s33, 131072
s_lshl_b32 s34, s67, 7
buffer_load_dwordx4 v144, s[16:19], s34 offen offset:0  lds
v_mfma_f32_16x16x32_bf16 v[68:71], a[196:199], a[16:19], v[68:71]
ds_read_b64_tr_b16 a[220:221], v135 offset:33024
v_mfma_f32_16x16x32_bf16 v[76:79], a[196:199], a[20:23], v[76:79]
ds_read_b64_tr_b16 a[222:223], v135 offset:41216
buffer_load_dwordx4 v145, s[16:19], s34 offen offset:1024  lds
s_waitcnt lgkmcnt(8)
v_mfma_f32_16x16x32_bf16 v[80:83], a[200:203], a[16:19], v[80:83]
s_waitcnt vmcnt(19)
s_barrier
ds_read_b64_tr_b16 a[192:193], v128 offset:49152
v_mfma_f32_16x16x32_bf16 v[88:91], a[200:203], a[20:23], v[88:91]
ds_read_b64_tr_b16 a[194:195], v128 offset:57344
buffer_load_dwordx4 v146, s[16:19], s34 offen offset:2048  lds
v_mfma_f32_16x16x32_bf16 v[84:87], a[204:207], a[16:19], v[84:87]
ds_read_b64_tr_b16 a[196:197], v129 offset:49152
v_mfma_f32_16x16x32_bf16 v[92:95], a[204:207], a[20:23], v[92:95]
ds_read_b64_tr_b16 a[198:199], v129 offset:57344
buffer_load_dwordx4 v147, s[16:19], s34 offen offset:3072  lds
s_waitcnt lgkmcnt(8)
v_mfma_f32_16x16x32_bf16 v[96:99], a[208:211], a[16:19], v[96:99]
ds_read_b64_tr_b16 a[200:201], v130 offset:49152
v_mfma_f32_16x16x32_bf16 v[104:107], a[208:211], a[20:23], v[104:107]
ds_read_b64_tr_b16 a[202:203], v130 offset:57344
s_add_u32 m0, s33, 0
s_lshl_b32 s34, s67, 19
buffer_load_dwordx4 v148, s[20:23], s34 offen offset:0  lds
v_mfma_f32_16x16x32_bf16 v[100:103], a[212:215], a[16:19], v[100:103]
ds_read_b64_tr_b16 a[204:205], v131 offset:49152
v_mfma_f32_16x16x32_bf16 v[108:111], a[212:215], a[20:23], v[108:111]
ds_read_b64_tr_b16 a[206:207], v131 offset:57344
buffer_load_dwordx4 v149, s[20:23], s34 offen offset:1024  lds
s_waitcnt lgkmcnt(8)
v_mfma_f32_16x16x32_bf16 v[112:115], a[216:219], a[16:19], v[112:115]
ds_read_b64_tr_b16 a[208:209], v132 offset:49152
v_mfma_f32_16x16x32_bf16 v[120:123], a[216:219], a[20:23], v[120:123]
ds_read_b64_tr_b16 a[210:211], v132 offset:57344
buffer_load_dwordx4 v150, s[20:23], s34 offen offset:2048  lds
v_mfma_f32_16x16x32_bf16 v[116:119], a[220:223], a[16:19], v[116:119]
ds_read_b64_tr_b16 a[212:213], v133 offset:49152
v_mfma_f32_16x16x32_bf16 v[124:127], a[220:223], a[20:23], v[124:127]
ds_read_b64_tr_b16 a[214:215], v133 offset:57344
buffer_load_dwordx4 v151, s[20:23], s34 offen offset:3072  lds
s_waitcnt lgkmcnt(8)
v_mfma_f32_16x16x32_bf16 v[0:3], a[192:195], a[24:27], v[0:3]
ds_read_b64_tr_b16 a[216:217], v134 offset:49152
v_mfma_f32_16x16x32_bf16 v[8:11], a[192:195], a[28:31], v[8:11]
ds_read_b64_tr_b16 a[218:219], v134 offset:57344
s_mov_b32 s34, 2048
buffer_load_dwordx4 a[48:51], v192, s[12:15], s34 offen offset:0 nt
v_mfma_f32_16x16x32_bf16 v[4:7], a[196:199], a[24:27], v[4:7]
ds_read_b64_tr_b16 a[220:221], v135 offset:49152
v_mfma_f32_16x16x32_bf16 v[12:15], a[196:199], a[28:31], v[12:15]
ds_read_b64_tr_b16 a[222:223], v135 offset:57344
s_mov_b32 s34, 3072
buffer_load_dwordx4 a[52:55], v193, s[12:15], s34 offen offset:1024 nt
s_waitcnt lgkmcnt(8)
v_mfma_f32_16x16x32_bf16 v[16:19], a[200:203], a[24:27], v[16:19]
ds_read_b64_tr_b16 a[192:193], v128 offset:49408
v_mfma_f32_16x16x32_bf16 v[24:27], a[200:203], a[28:31], v[24:27]
ds_read_b64_tr_b16 a[194:195], v128 offset:57600
s_mov_b32 s34, 0
buffer_load_dwordx4 a[56:59], v194, s[12:15], s34 offen offset:2048 nt
v_mfma_f32_16x16x32_bf16 v[20:23], a[204:207], a[24:27], v[20:23]
ds_read_b64_tr_b16 a[196:197], v129 offset:49408
v_mfma_f32_16x16x32_bf16 v[28:31], a[204:207], a[28:31], v[28:31]
ds_read_b64_tr_b16 a[198:199], v129 offset:57600
s_mov_b32 s34, 1024
buffer_load_dwordx4 a[60:63], v195, s[12:15], s34 offen offset:3072 nt
s_waitcnt lgkmcnt(8)
v_mfma_f32_16x16x32_bf16 v[32:35], a[208:211], a[24:27], v[32:35]
ds_read_b64_tr_b16 a[200:201], v130 offset:49408
v_mfma_f32_16x16x32_bf16 v[40:43], a[208:211], a[28:31], v[40:43]
ds_read_b64_tr_b16 a[202:203], v130 offset:57600
v_mfma_f32_16x16x32_bf16 v[36:39], a[212:215], a[24:27], v[36:39]
ds_read_b64_tr_b16 a[204:205], v131 offset:49408
v_mfma_f32_16x16x32_bf16 v[44:47], a[212:215], a[28:31], v[44:47]
ds_read_b64_tr_b16 a[206:207], v131 offset:57600
s_waitcnt lgkmcnt(8)
v_mfma_f32_16x16x32_bf16 v[48:51], a[216:219], a[24:27], v[48:51]
ds_read_b64_tr_b16 a[208:209], v132 offset:49408
v_mfma_f32_16x16x32_bf16 v[56:59], a[216:219], a[28:31], v[56:59]
ds_read_b64_tr_b16 a[210:211], v132 offset:57600
v_mfma_f32_16x16x32_bf16 v[52:55], a[220:223], a[24:27], v[52:55]
ds_read_b64_tr_b16 a[212:213], v133 offset:49408
v_mfma_f32_16x16x32_bf16 v[60:63], a[220:223], a[28:31], v[60:63]
ds_read_b64_tr_b16 a[214:215], v133 offset:57600
s_waitcnt lgkmcnt(8)
v_mfma_f32_16x16x32_bf16 v[64:67], a[192:195], a[24:27], v[64:67]
ds_read_b64_tr_b16 a[216:217], v134 offset:49408
v_mfma_f32_16x16x32_bf16 v[72:75], a[192:195], a[28:31], v[72:75]
ds_read_b64_tr_b16 a[218:219], v134 offset:57600
s_add_u32 m0, s33, 16384
s_lshl_b32 s34, s67, 19
s_add_u32 s34, s34, 262144
buffer_load_dwordx4 v148, s[20:23], s34 offen offset:0  lds
v_mfma_f32_16x16x32_bf16 v[68:71], a[196:199], a[24:27], v[68:71]
ds_read_b64_tr_b16 a[220:221], v135 offset:49408
v_mfma_f32_16x16x32_bf16 v[76:79], a[196:199], a[28:31], v[76:79]
ds_read_b64_tr_b16 a[222:223], v135 offset:57600
buffer_load_dwordx4 v149, s[20:23], s34 offen offset:1024  lds
s_waitcnt lgkmcnt(8)
v_mfma_f32_16x16x32_bf16 v[80:83], a[200:203], a[24:27], v[80:83]
v_subrev_u32 v152, 65536, v152
v_subrev_u32 v153, 65536, v153
s_waitcnt vmcnt(23)
s_barrier
ds_read_b128 a[4:7], v152 offset:2048
ds_read_b128 a[0:3], v152 offset:0
v_mfma_f32_16x16x32_bf16 v[88:91], a[200:203], a[28:31], v[88:91]
ds_read_b64_tr_b16 a[192:193], v180 offset:16384
ds_read_b64_tr_b16 a[194:195], v180 offset:24576
buffer_load_dwordx4 v150, s[20:23], s34 offen offset:2048  lds
v_mfma_f32_16x16x32_bf16 v[84:87], a[204:207], a[24:27], v[84:87]
ds_read_b64_tr_b16 a[196:197], v181 offset:16384
v_mfma_f32_16x16x32_bf16 v[92:95], a[204:207], a[28:31], v[92:95]
ds_read_b64_tr_b16 a[198:199], v181 offset:24576
buffer_load_dwordx4 v151, s[20:23], s34 offen offset:3072  lds
s_waitcnt lgkmcnt(10)
v_mfma_f32_16x16x32_bf16 v[96:99], a[208:211], a[24:27], v[96:99]
ds_read_b64_tr_b16 a[200:201], v182 offset:16384
v_mfma_f32_16x16x32_bf16 v[104:107], a[208:211], a[28:31], v[104:107]
ds_read_b64_tr_b16 a[202:203], v182 offset:24576
v_mfma_f32_16x16x32_bf16 v[100:103], a[212:215], a[24:27], v[100:103]
ds_read_b64_tr_b16 a[204:205], v183 offset:16384
v_mfma_f32_16x16x32_bf16 v[108:111], a[212:215], a[28:31], v[108:111]
ds_read_b64_tr_b16 a[206:207], v183 offset:24576
s_waitcnt lgkmcnt(10)
v_mfma_f32_16x16x32_bf16 v[112:115], a[216:219], a[24:27], v[112:115]
ds_read_b128 a[8:11], v153 offset:0
ds_read_b64_tr_b16 a[208:209], v184 offset:16384
v_mfma_f32_16x16x32_bf16 v[120:123], a[216:219], a[28:31], v[120:123]
ds_read_b64_tr_b16 a[210:211], v184 offset:24576
v_mfma_f32_16x16x32_bf16 v[116:119], a[220:223], a[24:27], v[116:119]
ds_read_b64_tr_b16 a[212:213], v185 offset:16384
v_mfma_f32_16x16x32_bf16 v[124:127], a[220:223], a[28:31], v[124:127]
ds_read_b64_tr_b16 a[214:215], v185 offset:24576
s_waitcnt lgkmcnt(9)
v_mfma_f32_16x16x32_bf16 v[0:3], a[192:195], a[0:3], v[0:3]
ds_read_b64_tr_b16 a[216:217], v186 offset:16384
v_mfma_f32_16x16x32_bf16 v[8:11], a[192:195], a[4:7], v[8:11]
ds_read_b64_tr_b16 a[218:219], v186 offset:24576
v_mfma_f32_16x16x32_bf16 v[4:7], a[196:199], a[0:3], v[4:7]
ds_read_b64_tr_b16 a[220:221], v187 offset:16384
v_mfma_f32_16x16x32_bf16 v[12:15], a[196:199], a[4:7], v[12:15]
ds_read_b64_tr_b16 a[222:223], v187 offset:24576
s_waitcnt lgkmcnt(9)
v_mfma_f32_16x16x32_bf16 v[16:19], a[200:203], a[0:3], v[16:19]
ds_read_b128 a[12:15], v153 offset:2048
ds_read_b64_tr_b16 a[192:193], v180 offset:16640
v_mfma_f32_16x16x32_bf16 v[24:27], a[200:203], a[4:7], v[24:27]
ds_read_b64_tr_b16 a[194:195], v180 offset:24832
v_mfma_f32_16x16x32_bf16 v[20:23], a[204:207], a[0:3], v[20:23]
ds_read_b64_tr_b16 a[196:197], v181 offset:16640
v_mfma_f32_16x16x32_bf16 v[28:31], a[204:207], a[4:7], v[28:31]
ds_read_b64_tr_b16 a[198:199], v181 offset:24832
s_waitcnt lgkmcnt(9)
v_mfma_f32_16x16x32_bf16 v[32:35], a[208:211], a[0:3], v[32:35]
ds_read_b64_tr_b16 a[200:201], v182 offset:16640
v_mfma_f32_16x16x32_bf16 v[40:43], a[208:211], a[4:7], v[40:43]
ds_read_b64_tr_b16 a[202:203], v182 offset:24832
v_mfma_f32_16x16x32_bf16 v[36:39], a[212:215], a[0:3], v[36:39]
ds_read_b64_tr_b16 a[204:205], v183 offset:16640
v_mfma_f32_16x16x32_bf16 v[44:47], a[212:215], a[4:7], v[44:47]
ds_read_b64_tr_b16 a[206:207], v183 offset:24832
s_waitcnt lgkmcnt(9)
v_mfma_f32_16x16x32_bf16 v[48:51], a[216:219], a[0:3], v[48:51]
ds_read_b64_tr_b16 a[208:209], v184 offset:16640
v_mfma_f32_16x16x32_bf16 v[56:59], a[216:219], a[4:7], v[56:59]
ds_read_b64_tr_b16 a[210:211], v184 offset:24832
v_mfma_f32_16x16x32_bf16 v[52:55], a[220:223], a[0:3], v[52:55]
ds_read_b64_tr_b16 a[212:213], v185 offset:16640
v_mfma_f32_16x16x32_bf16 v[60:63], a[220:223], a[4:7], v[60:63]
ds_read_b64_tr_b16 a[214:215], v185 offset:24832
s_waitcnt lgkmcnt(8)
v_mfma_f32_16x16x32_bf16 v[64:67], a[192:195], a[0:3], v[64:67]
ds_read_b64_tr_b16 a[216:217], v186 offset:16640
v_mfma_f32_16x16x32_bf16 v[72:75], a[192:195], a[4:7], v[72:75]
ds_read_b64_tr_b16 a[218:219], v186 offset:24832
s_add_u32 m0, s33, 147456
s_lshl_b32 s34, s68, 7
buffer_load_dwordx4 v144, s[16:19], s34 offen offset:0  lds
v_mfma_f32_16x16x32_bf16 v[68:71], a[196:199], a[0:3], v[68:71]
ds_read_b64_tr_b16 a[220:221], v187 offset:16640
v_mfma_f32_16x16x32_bf16 v[76:79], a[196:199], a[4:7], v[76:79]
ds_read_b64_tr_b16 a[222:223], v187 offset:24832
buffer_load_dwordx4 v145, s[16:19], s34 offen offset:1024  lds
s_waitcnt lgkmcnt(8)
v_mfma_f32_16x16x32_bf16 v[80:83], a[200:203], a[0:3], v[80:83]
s_waitcnt vmcnt(22)
s_barrier
ds_read_b64_tr_b16 a[192:193], v180 offset:32768
v_mfma_f32_16x16x32_bf16 v[88:91], a[200:203], a[4:7], v[88:91]
ds_read_b64_tr_b16 a[194:195], v180 offset:40960
buffer_load_dwordx4 v146, s[16:19], s34 offen offset:2048  lds
v_mfma_f32_16x16x32_bf16 v[84:87], a[204:207], a[0:3], v[84:87]
ds_read_b64_tr_b16 a[196:197], v181 offset:32768
v_mfma_f32_16x16x32_bf16 v[92:95], a[204:207], a[4:7], v[92:95]
ds_read_b64_tr_b16 a[198:199], v181 offset:40960
buffer_load_dwordx4 v147, s[16:19], s34 offen offset:3072  lds
s_waitcnt lgkmcnt(8)
v_mfma_f32_16x16x32_bf16 v[96:99], a[208:211], a[0:3], v[96:99]
ds_read_b64_tr_b16 a[200:201], v182 offset:32768
v_mfma_f32_16x16x32_bf16 v[104:107], a[208:211], a[4:7], v[104:107]
ds_read_b64_tr_b16 a[202:203], v182 offset:40960
s_add_u32 m0, s33, 32768
s_lshl_b32 s34, s68, 19
buffer_load_dwordx4 v148, s[20:23], s34 offen offset:0  lds
v_mfma_f32_16x16x32_bf16 v[100:103], a[212:215], a[0:3], v[100:103]
ds_read_b64_tr_b16 a[204:205], v183 offset:32768
v_mfma_f32_16x16x32_bf16 v[108:111], a[212:215], a[4:7], v[108:111]
ds_read_b64_tr_b16 a[206:207], v183 offset:40960
buffer_load_dwordx4 v149, s[20:23], s34 offen offset:1024  lds
s_waitcnt lgkmcnt(8)
v_mfma_f32_16x16x32_bf16 v[112:115], a[216:219], a[0:3], v[112:115]
ds_read_b64_tr_b16 a[208:209], v184 offset:32768
v_mfma_f32_16x16x32_bf16 v[120:123], a[216:219], a[4:7], v[120:123]
ds_read_b64_tr_b16 a[210:211], v184 offset:40960
buffer_load_dwordx4 v150, s[20:23], s34 offen offset:2048  lds
v_mfma_f32_16x16x32_bf16 v[116:119], a[220:223], a[0:3], v[116:119]
ds_read_b64_tr_b16 a[212:213], v185 offset:32768
v_mfma_f32_16x16x32_bf16 v[124:127], a[220:223], a[4:7], v[124:127]
ds_read_b64_tr_b16 a[214:215], v185 offset:40960
buffer_load_dwordx4 v151, s[20:23], s34 offen offset:3072  lds
s_waitcnt lgkmcnt(8)
v_mfma_f32_16x16x32_bf16 v[0:3], a[192:195], a[8:11], v[0:3]
ds_read_b64_tr_b16 a[216:217], v186 offset:32768
v_mfma_f32_16x16x32_bf16 v[8:11], a[192:195], a[12:15], v[8:11]
ds_read_b64_tr_b16 a[218:219], v186 offset:40960
s_mov_b32 s34, 65536
buffer_load_dwordx4 a[64:67], v188, s[8:11], s34 offen offset:0 nt
v_mfma_f32_16x16x32_bf16 v[4:7], a[196:199], a[8:11], v[4:7]
ds_read_b64_tr_b16 a[220:221], v187 offset:32768
v_mfma_f32_16x16x32_bf16 v[12:15], a[196:199], a[12:15], v[12:15]
ds_read_b64_tr_b16 a[222:223], v187 offset:40960
s_mov_b32 s34, 66560
buffer_load_dwordx4 a[68:71], v189, s[8:11], s34 offen offset:1024 nt
s_waitcnt lgkmcnt(8)
v_mfma_f32_16x16x32_bf16 v[16:19], a[200:203], a[8:11], v[16:19]
ds_read_b64_tr_b16 a[192:193], v180 offset:33024
v_mfma_f32_16x16x32_bf16 v[24:27], a[200:203], a[12:15], v[24:27]
ds_read_b64_tr_b16 a[194:195], v180 offset:41216
s_mov_b32 s34, 67584
buffer_load_dwordx4 a[72:75], v190, s[8:11], s34 offen offset:2048 nt
v_mfma_f32_16x16x32_bf16 v[20:23], a[204:207], a[8:11], v[20:23]
ds_read_b64_tr_b16 a[196:197], v181 offset:33024
v_mfma_f32_16x16x32_bf16 v[28:31], a[204:207], a[12:15], v[28:31]
ds_read_b64_tr_b16 a[198:199], v181 offset:41216
s_mov_b32 s34, 68608
buffer_load_dwordx4 a[76:79], v191, s[8:11], s34 offen offset:3072 nt
s_waitcnt lgkmcnt(8)
v_mfma_f32_16x16x32_bf16 v[32:35], a[208:211], a[8:11], v[32:35]
ds_read_b64_tr_b16 a[200:201], v182 offset:33024
v_mfma_f32_16x16x32_bf16 v[40:43], a[208:211], a[12:15], v[40:43]
ds_read_b64_tr_b16 a[202:203], v182 offset:41216
v_mfma_f32_16x16x32_bf16 v[36:39], a[212:215], a[8:11], v[36:39]
ds_read_b64_tr_b16 a[204:205], v183 offset:33024
v_mfma_f32_16x16x32_bf16 v[44:47], a[212:215], a[12:15], v[44:47]
ds_read_b64_tr_b16 a[206:207], v183 offset:41216
s_waitcnt lgkmcnt(8)
v_mfma_f32_16x16x32_bf16 v[48:51], a[216:219], a[8:11], v[48:51]
ds_read_b64_tr_b16 a[208:209], v184 offset:33024
v_mfma_f32_16x16x32_bf16 v[56:59], a[216:219], a[12:15], v[56:59]
ds_read_b64_tr_b16 a[210:211], v184 offset:41216
v_mfma_f32_16x16x32_bf16 v[52:55], a[220:223], a[8:11], v[52:55]
ds_read_b64_tr_b16 a[212:213], v185 offset:33024
v_mfma_f32_16x16x32_bf16 v[60:63], a[220:223], a[12:15], v[60:63]
ds_read_b64_tr_b16 a[214:215], v185 offset:41216
s_waitcnt lgkmcnt(8)
v_mfma_f32_16x16x32_bf16 v[64:67], a[192:195], a[8:11], v[64:67]
ds_read_b64_tr_b16 a[216:217], v186 offset:33024
v_mfma_f32_16x16x32_bf16 v[72:75], a[192:195], a[12:15], v[72:75]
ds_read_b64_tr_b16 a[218:219], v186 offset:41216
s_add_u32 m0, s33, 49152
s_lshl_b32 s34, s68, 19
s_add_u32 s34, s34, 262144
buffer_load_dwordx4 v148, s[20:23], s34 offen offset:0  lds
v_mfma_f32_16x16x32_bf16 v[68:71], a[196:199], a[8:11], v[68:71]
ds_read_b64_tr_b16 a[220:221], v187 offset:33024
v_mfma_f32_16x16x32_bf16 v[76:79], a[196:199], a[12:15], v[76:79]
ds_read_b64_tr_b16 a[222:223], v187 offset:41216
buffer_load_dwordx4 v149, s[20:23], s34 offen offset:1024  lds
s_waitcnt lgkmcnt(8)
v_mfma_f32_16x16x32_bf16 v[80:83], a[200:203], a[8:11], v[80:83]
v_add_u32 v152, 65536, v152
v_add_u32 v153, 65536, v153
s_waitcnt vmcnt(22)
s_barrier
buffer_atomic_add v226, v227, s[44:47], 0 offen sc1
ds_read_b128 a[20:23], v152 offset:2048
ds_read_b128 a[16:19], v152 offset:0
v_mfma_f32_16x16x32_bf16 v[88:91], a[200:203], a[12:15], v[88:91]
ds_read_b64_tr_b16 a[192:193], v128 offset:0
ds_read_b64_tr_b16 a[194:195], v128 offset:8192
buffer_load_dwordx4 v150, s[20:23], s34 offen offset:2048  lds
v_mfma_f32_16x16x32_bf16 v[84:87], a[204:207], a[8:11], v[84:87]
ds_read_b64_tr_b16 a[196:197], v129 offset:0
v_mfma_f32_16x16x32_bf16 v[92:95], a[204:207], a[12:15], v[92:95]
ds_read_b64_tr_b16 a[198:199], v129 offset:8192
buffer_load_dwordx4 v151, s[20:23], s34 offen offset:3072  lds
s_waitcnt lgkmcnt(10)
v_mfma_f32_16x16x32_bf16 v[96:99], a[208:211], a[8:11], v[96:99]
ds_read_b64_tr_b16 a[200:201], v130 offset:0
v_mfma_f32_16x16x32_bf16 v[104:107], a[208:211], a[12:15], v[104:107]
ds_read_b64_tr_b16 a[202:203], v130 offset:8192
v_mfma_f32_16x16x32_bf16 v[100:103], a[212:215], a[8:11], v[100:103]
ds_read_b64_tr_b16 a[204:205], v131 offset:0
v_mfma_f32_16x16x32_bf16 v[108:111], a[212:215], a[12:15], v[108:111]
ds_read_b64_tr_b16 a[206:207], v131 offset:8192
s_waitcnt lgkmcnt(10)
v_mfma_f32_16x16x32_bf16 v[112:115], a[216:219], a[8:11], v[112:115]
ds_read_b128 a[24:27], v153 offset:0
ds_read_b64_tr_b16 a[208:209], v132 offset:0
v_mfma_f32_16x16x32_bf16 v[120:123], a[216:219], a[12:15], v[120:123]
ds_read_b64_tr_b16 a[210:211], v132 offset:8192
v_mfma_f32_16x16x32_bf16 v[116:119], a[220:223], a[8:11], v[116:119]
ds_read_b64_tr_b16 a[212:213], v133 offset:0
v_mfma_f32_16x16x32_bf16 v[124:127], a[220:223], a[12:15], v[124:127]
ds_read_b64_tr_b16 a[214:215], v133 offset:8192
s_waitcnt lgkmcnt(9)
v_mfma_f32_16x16x32_bf16 v[0:3], a[192:195], a[16:19], v[0:3]
ds_read_b64_tr_b16 a[216:217], v134 offset:0
v_mfma_f32_16x16x32_bf16 v[8:11], a[192:195], a[20:23], v[8:11]
ds_read_b64_tr_b16 a[218:219], v134 offset:8192
s_mov_b32 s34, 3072
buffer_load_dwordx4 a[80:83], v192, s[12:15], s34 offen offset:0 nt
v_mfma_f32_16x16x32_bf16 v[4:7], a[196:199], a[16:19], v[4:7]
ds_read_b64_tr_b16 a[220:221], v135 offset:0
v_mfma_f32_16x16x32_bf16 v[12:15], a[196:199], a[20:23], v[12:15]
ds_read_b64_tr_b16 a[222:223], v135 offset:8192
s_mov_b32 s34, 2048
buffer_load_dwordx4 a[84:87], v193, s[12:15], s34 offen offset:1024 nt
s_waitcnt lgkmcnt(9)
v_mfma_f32_16x16x32_bf16 v[16:19], a[200:203], a[16:19], v[16:19]
ds_read_b128 a[28:31], v153 offset:2048
ds_read_b64_tr_b16 a[192:193], v128 offset:256
v_mfma_f32_16x16x32_bf16 v[24:27], a[200:203], a[20:23], v[24:27]
ds_read_b64_tr_b16 a[194:195], v128 offset:8448
s_mov_b32 s34, 1024
buffer_load_dwordx4 a[88:91], v194, s[12:15], s34 offen offset:2048 nt
v_mfma_f32_16x16x32_bf16 v[20:23], a[204:207], a[16:19], v[20:23]
ds_read_b64_tr_b16 a[196:197], v129 offset:256
v_mfma_f32_16x16x32_bf16 v[28:31], a[204:207], a[20:23], v[28:31]
ds_read_b64_tr_b16 a[198:199], v129 offset:8448
s_mov_b32 s34, 0
buffer_load_dwordx4 a[92:95], v195, s[12:15], s34 offen offset:3072 nt
s_waitcnt lgkmcnt(9)
v_mfma_f32_16x16x32_bf16 v[32:35], a[208:211], a[16:19], v[32:35]
ds_read_b64_tr_b16 a[200:201], v130 offset:256
v_mfma_f32_16x16x32_bf16 v[40:43], a[208:211], a[20:23], v[40:43]
ds_read_b64_tr_b16 a[202:203], v130 offset:8448
v_mfma_f32_16x16x32_bf16 v[36:39], a[212:215], a[16:19], v[36:39]
ds_read_b64_tr_b16 a[204:205], v131 offset:256
v_mfma_f32_16x16x32_bf16 v[44:47], a[212:215], a[20:23], v[44:47]
ds_read_b64_tr_b16 a[206:207], v131 offset:8448
s_waitcnt lgkmcnt(9)
v_mfma_f32_16x16x32_bf16 v[48:51], a[216:219], a[16:19], v[48:51]
ds_read_b64_tr_b16 a[208:209], v132 offset:256
v_mfma_f32_16x16x32_bf16 v[56:59], a[216:219], a[20:23], v[56:59]
ds_read_b64_tr_b16 a[210:211], v132 offset:8448
v_mfma_f32_16x16x32_bf16 v[52:55], a[220:223], a[16:19], v[52:55]
ds_read_b64_tr_b16 a[212:213], v133 offset:256
v_mfma_f32_16x16x32_bf16 v[60:63], a[220:223], a[20:23], v[60:63]
ds_read_b64_tr_b16 a[214:215], v133 offset:8448
s_waitcnt lgkmcnt(8)
v_mfma_f32_16x16x32_bf16 v[64:67], a[192:195], a[16:19], v[64:67]
ds_read_b64_tr_b16 a[216:217], v134 offset:256
v_mfma_f32_16x16x32_bf16 v[72:75], a[192:195], a[20:23], v[72:75]
ds_read_b64_tr_b16 a[218:219], v134 offset:8448
s_add_u32 m0, s33, 65536
s_lshl_b32 s34, s69, 7
buffer_load_dwordx4 v144, s[16:19], s34 offen offset:0  lds
v_mfma_f32_16x16x32_bf16 v[68:71], a[196:199], a[16:19], v[68:71]
ds_read_b64_tr_b16 a[220:221], v135 offset:256
v_mfma_f32_16x16x32_bf16 v[76:79], a[196:199], a[20:23], v[76:79]
ds_read_b64_tr_b16 a[222:223], v135 offset:8448
buffer_load_dwordx4 v145, s[16:19], s34 offen offset:1024  lds
s_waitcnt lgkmcnt(8)
v_mfma_f32_16x16x32_bf16 v[80:83], a[200:203], a[16:19], v[80:83]
s_waitcnt vmcnt(23)
s_barrier
ds_read_b64_tr_b16 a[192:193], v128 offset:16384
v_mfma_f32_16x16x32_bf16 v[88:91], a[200:203], a[20:23], v[88:91]
ds_read_b64_tr_b16 a[194:195], v128 offset:24576
buffer_load_dwordx4 v146, s[16:19], s34 offen offset:2048  lds
v_mfma_f32_16x16x32_bf16 v[84:87], a[204:207], a[16:19], v[84:87]
ds_read_b64_tr_b16 a[196:197], v129 offset:16384
v_mfma_f32_16x16x32_bf16 v[92:95], a[204:207], a[20:23], v[92:95]
ds_read_b64_tr_b16 a[198:199], v129 offset:24576
buffer_load_dwordx4 v147, s[16:19], s34 offen offset:3072  lds
s_waitcnt lgkmcnt(8)
v_mfma_f32_16x16x32_bf16 v[96:99], a[208:211], a[16:19], v[96:99]
ds_read_b64_tr_b16 a[200:201], v130 offset:16384
v_mfma_f32_16x16x32_bf16 v[104:107], a[208:211], a[20:23], v[104:107]
ds_read_b64_tr_b16 a[202:203], v130 offset:24576
s_add_u32 m0, s33, 81920
s_lshl_b32 s34, s69, 19
buffer_load_dwordx4 v148, s[20:23], s34 offen offset:0  lds
v_mfma_f32_16x16x32_bf16 v[100:103], a[212:215], a[16:19], v[100:103]
ds_read_b64_tr_b16 a[204:205], v131 offset:16384
v_mfma_f32_16x16x32_bf16 v[108:111], a[212:215], a[20:23], v[108:111]
ds_read_b64_tr_b16 a[206:207], v131 offset:24576
buffer_load_dwordx4 v149, s[20:23], s34 offen offset:1024  lds
s_waitcnt lgkmcnt(8)
v_mfma_f32_16x16x32_bf16 v[112:115], a[216:219], a[16:19], v[112:115]
ds_read_b64_tr_b16 a[208:209], v132 offset:16384
v_mfma_f32_16x16x32_bf16 v[120:123], a[216:219], a[20:23], v[120:123]
ds_read_b64_tr_b16 a[210:211], v132 offset:24576
buffer_load_dwordx4 v150, s[20:23], s34 offen offset:2048  lds
v_mfma_f32_16x16x32_bf16 v[116:119], a[220:223], a[16:19], v[116:119]
ds_read_b64_tr_b16 a[212:213], v133 offset:16384
v_mfma_f32_16x16x32_bf16 v[124:127], a[220:223], a[20:23], v[124:127]
ds_read_b64_tr_b16 a[214:215], v133 offset:24576
buffer_load_dwordx4 v151, s[20:23], s34 offen offset:3072  lds
s_waitcnt lgkmcnt(8)
v_mfma_f32_16x16x32_bf16 v[0:3], a[192:195], a[24:27], v[0:3]
ds_read_b64_tr_b16 a[216:217], v134 offset:16384
v_mfma_f32_16x16x32_bf16 v[8:11], a[192:195], a[28:31], v[8:11]
ds_read_b64_tr_b16 a[218:219], v134 offset:24576
v_mfma_f32_16x16x32_bf16 v[4:7], a[196:199], a[24:27], v[4:7]
ds_read_b64_tr_b16 a[220:221], v135 offset:16384
v_mfma_f32_16x16x32_bf16 v[12:15], a[196:199], a[28:31], v[12:15]
ds_read_b64_tr_b16 a[222:223], v135 offset:24576
s_waitcnt lgkmcnt(8)
v_mfma_f32_16x16x32_bf16 v[16:19], a[200:203], a[24:27], v[16:19]
ds_read_b64_tr_b16 a[192:193], v128 offset:16640
v_mfma_f32_16x16x32_bf16 v[24:27], a[200:203], a[28:31], v[24:27]
ds_read_b64_tr_b16 a[194:195], v128 offset:24832
v_mfma_f32_16x16x32_bf16 v[20:23], a[204:207], a[24:27], v[20:23]
ds_read_b64_tr_b16 a[196:197], v129 offset:16640
v_mfma_f32_16x16x32_bf16 v[28:31], a[204:207], a[28:31], v[28:31]
ds_read_b64_tr_b16 a[198:199], v129 offset:24832
s_waitcnt lgkmcnt(8)
v_mfma_f32_16x16x32_bf16 v[32:35], a[208:211], a[24:27], v[32:35]
ds_read_b64_tr_b16 a[200:201], v130 offset:16640
v_mfma_f32_16x16x32_bf16 v[40:43], a[208:211], a[28:31], v[40:43]
ds_read_b64_tr_b16 a[202:203], v130 offset:24832
v_mfma_f32_16x16x32_bf16 v[36:39], a[212:215], a[24:27], v[36:39]
ds_read_b64_tr_b16 a[204:205], v131 offset:16640
v_mfma_f32_16x16x32_bf16 v[44:47], a[212:215], a[28:31], v[44:47]
ds_read_b64_tr_b16 a[206:207], v131 offset:24832
s_waitcnt lgkmcnt(8)
v_mfma_f32_16x16x32_bf16 v[48:51], a[216:219], a[24:27], v[48:51]
ds_read_b64_tr_b16 a[208:209], v132 offset:16640
v_mfma_f32_16x16x32_bf16 v[56:59], a[216:219], a[28:31], v[56:59]
ds_read_b64_tr_b16 a[210:211], v132 offset:24832
v_mfma_f32_16x16x32_bf16 v[52:55], a[220:223], a[24:27], v[52:55]
ds_read_b64_tr_b16 a[212:213], v133 offset:16640
v_mfma_f32_16x16x32_bf16 v[60:63], a[220:223], a[28:31], v[60:63]
ds_read_b64_tr_b16 a[214:215], v133 offset:24832
s_waitcnt lgkmcnt(8)
v_mfma_f32_16x16x32_bf16 v[64:67], a[192:195], a[24:27], v[64:67]
ds_read_b64_tr_b16 a[216:217], v134 offset:16640
v_mfma_f32_16x16x32_bf16 v[72:75], a[192:195], a[28:31], v[72:75]
ds_read_b64_tr_b16 a[218:219], v134 offset:24832
s_add_u32 m0, s33, 98304
s_lshl_b32 s34, s69, 19
s_add_u32 s34, s34, 262144
buffer_load_dwordx4 v148, s[20:23], s34 offen offset:0  lds
v_mfma_f32_16x16x32_bf16 v[68:71], a[196:199], a[24:27], v[68:71]
ds_read_b64_tr_b16 a[220:221], v135 offset:16640
v_mfma_f32_16x16x32_bf16 v[76:79], a[196:199], a[28:31], v[76:79]
ds_read_b64_tr_b16 a[222:223], v135 offset:24832
buffer_load_dwordx4 v149, s[20:23], s34 offen offset:1024  lds
s_waitcnt lgkmcnt(8)
v_mfma_f32_16x16x32_bf16 v[80:83], a[200:203], a[24:27], v[80:83]
s_waitcnt vmcnt(23)
s_barrier
ds_read_b128 a[4:7], v152 offset:18432
ds_read_b128 a[0:3], v152 offset:16384
v_mfma_f32_16x16x32_bf16 v[88:91], a[200:203], a[28:31], v[88:91]
ds_read_b64_tr_b16 a[192:193], v128 offset:32768
ds_read_b64_tr_b16 a[194:195], v128 offset:40960
buffer_load_dwordx4 v150, s[20:23], s34 offen offset:2048  lds
v_mfma_f32_16x16x32_bf16 v[84:87], a[204:207], a[24:27], v[84:87]
ds_read_b64_tr_b16 a[196:197], v129 offset:32768
v_mfma_f32_16x16x32_bf16 v[92:95], a[204:207], a[28:31], v[92:95]
ds_read_b64_tr_b16 a[198:199], v129 offset:40960
buffer_load_dwordx4 v151, s[20:23], s34 offen offset:3072  lds
s_waitcnt lgkmcnt(10)
v_mfma_f32_16x16x32_bf16 v[96:99], a[208:211], a[24:27], v[96:99]
ds_read_b64_tr_b16 a[200:201], v130 offset:32768
v_mfma_f32_16x16x32_bf16 v[104:107], a[208:211], a[28:31], v[104:107]
ds_read_b64_tr_b16 a[202:203], v130 offset:40960
s_add_u32 m0, s33, 0
s_mov_b32 s34, 0
buffer_load_dwordx4 v188, s[8:11], s34 offen offset:0 nt lds
v_mfma_f32_16x16x32_bf16 v[100:103], a[212:215], a[24:27], v[100:103]
ds_read_b64_tr_b16 a[204:205], v131 offset:32768
v_mfma_f32_16x16x32_bf16 v[108:111], a[212:215], a[28:31], v[108:111]
ds_read_b64_tr_b16 a[206:207], v131 offset:40960
s_mov_b32 s34, 1024
buffer_load_dwordx4 v189, s[8:11], s34 offen offset:1024 nt lds
s_waitcnt lgkmcnt(10)
v_mfma_f32_16x16x32_bf16 v[112:115], a[216:219], a[24:27], v[112:115]
ds_read_b128 a[8:11], v153 offset:16384
ds_read_b64_tr_b16 a[208:209], v132 offset:32768
v_mfma_f32_16x16x32_bf16 v[120:123], a[216:219], a[28:31], v[120:123]
ds_read_b64_tr_b16 a[210:211], v132 offset:40960
s_mov_b32 s34, 2048
buffer_load_dwordx4 v190, s[8:11], s34 offen offset:2048 nt lds
v_mfma_f32_16x16x32_bf16 v[116:119], a[220:223], a[24:27], v[116:119]
ds_read_b64_tr_b16 a[212:213], v133 offset:32768
v_mfma_f32_16x16x32_bf16 v[124:127], a[220:223], a[28:31], v[124:127]
ds_read_b64_tr_b16 a[214:215], v133 offset:40960
s_mov_b32 s34, 3072
buffer_load_dwordx4 v191, s[8:11], s34 offen offset:3072 nt lds
s_waitcnt lgkmcnt(9)
v_mfma_f32_16x16x32_bf16 v[0:3], a[192:195], a[0:3], v[0:3]
ds_read_b64_tr_b16 a[216:217], v134 offset:32768
v_mfma_f32_16x16x32_bf16 v[8:11], a[192:195], a[4:7], v[8:11]
ds_read_b64_tr_b16 a[218:219], v134 offset:40960
v_mfma_f32_16x16x32_bf16 v[4:7], a[196:199], a[0:3], v[4:7]
ds_read_b64_tr_b16 a[220:221], v135 offset:32768
v_mfma_f32_16x16x32_bf16 v[12:15], a[196:199], a[4:7], v[12:15]
ds_read_b64_tr_b16 a[222:223], v135 offset:40960
s_waitcnt lgkmcnt(9)
v_mfma_f32_16x16x32_bf16 v[16:19], a[200:203], a[0:3], v[16:19]
ds_read_b128 a[12:15], v153 offset:18432
ds_read_b64_tr_b16 a[192:193], v128 offset:33024
v_mfma_f32_16x16x32_bf16 v[24:27], a[200:203], a[4:7], v[24:27]
ds_read_b64_tr_b16 a[194:195], v128 offset:41216
v_mfma_f32_16x16x32_bf16 v[20:23], a[204:207], a[0:3], v[20:23]
ds_read_b64_tr_b16 a[196:197], v129 offset:33024
v_mfma_f32_16x16x32_bf16 v[28:31], a[204:207], a[4:7], v[28:31]
ds_read_b64_tr_b16 a[198:199], v129 offset:41216
s_waitcnt lgkmcnt(9)
v_mfma_f32_16x16x32_bf16 v[32:35], a[208:211], a[0:3], v[32:35]
ds_read_b64_tr_b16 a[200:201], v130 offset:33024
v_mfma_f32_16x16x32_bf16 v[40:43], a[208:211], a[4:7], v[40:43]
ds_read_b64_tr_b16 a[202:203], v130 offset:41216
v_mfma_f32_16x16x32_bf16 v[36:39], a[212:215], a[0:3], v[36:39]
ds_read_b64_tr_b16 a[204:205], v131 offset:33024
v_mfma_f32_16x16x32_bf16 v[44:47], a[212:215], a[4:7], v[44:47]
ds_read_b64_tr_b16 a[206:207], v131 offset:41216
s_waitcnt lgkmcnt(9)
v_mfma_f32_16x16x32_bf16 v[48:51], a[216:219], a[0:3], v[48:51]
ds_read_b64_tr_b16 a[208:209], v132 offset:33024
v_mfma_f32_16x16x32_bf16 v[56:59], a[216:219], a[4:7], v[56:59]
ds_read_b64_tr_b16 a[210:211], v132 offset:41216
v_mfma_f32_16x16x32_bf16 v[52:55], a[220:223], a[0:3], v[52:55]
ds_read_b64_tr_b16 a[212:213], v133 offset:33024
v_mfma_f32_16x16x32_bf16 v[60:63], a[220:223], a[4:7], v[60:63]
ds_read_b64_tr_b16 a[214:215], v133 offset:41216
s_waitcnt lgkmcnt(8)
v_mfma_f32_16x16x32_bf16 v[64:67], a[192:195], a[0:3], v[64:67]
ds_read_b64_tr_b16 a[216:217], v134 offset:33024
v_mfma_f32_16x16x32_bf16 v[72:75], a[192:195], a[4:7], v[72:75]
ds_read_b64_tr_b16 a[218:219], v134 offset:41216
s_add_u32 m0, s33, 131072
s_lshl_b32 s34, s70, 7
buffer_load_dwordx4 v144, s[16:19], s34 offen offset:0  lds
v_mfma_f32_16x16x32_bf16 v[68:71], a[196:199], a[0:3], v[68:71]
ds_read_b64_tr_b16 a[220:221], v135 offset:33024
v_mfma_f32_16x16x32_bf16 v[76:79], a[196:199], a[4:7], v[76:79]
ds_read_b64_tr_b16 a[222:223], v135 offset:41216
buffer_load_dwordx4 v145, s[16:19], s34 offen offset:1024  lds
s_waitcnt lgkmcnt(8)
v_mfma_f32_16x16x32_bf16 v[80:83], a[200:203], a[0:3], v[80:83]
s_waitcnt vmcnt(22)
s_barrier
ds_read_b64_tr_b16 a[192:193], v128 offset:49152
v_mfma_f32_16x16x32_bf16 v[88:91], a[200:203], a[4:7], v[88:91]
ds_read_b64_tr_b16 a[194:195], v128 offset:57344
buffer_load_dwordx4 v146, s[16:19], s34 offen offset:2048  lds
v_mfma_f32_16x16x32_bf16 v[84:87], a[204:207], a[0:3], v[84:87]
ds_read_b64_tr_b16 a[196:197], v129 offset:49152
v_mfma_f32_16x16x32_bf16 v[92:95], a[204:207], a[4:7], v[92:95]
ds_read_b64_tr_b16 a[198:199], v129 offset:57344
buffer_load_dwordx4 v147, s[16:19], s34 offen offset:3072  lds
s_waitcnt lgkmcnt(8)
v_mfma_f32_16x16x32_bf16 v[96:99], a[208:211], a[0:3], v[96:99]
ds_read_b64_tr_b16 a[200:201], v130 offset:49152
v_mfma_f32_16x16x32_bf16 v[104:107], a[208:211], a[4:7], v[104:107]
ds_read_b64_tr_b16 a[202:203], v130 offset:57344
s_add_u32 m0, s33, 16384
s_lshl_b32 s34, s70, 19
buffer_load_dwordx4 v148, s[20:23], s34 offen offset:0  lds
v_mfma_f32_16x16x32_bf16 v[100:103], a[212:215], a[0:3], v[100:103]
ds_read_b64_tr_b16 a[204:205], v131 offset:49152
v_mfma_f32_16x16x32_bf16 v[108:111], a[212:215], a[4:7], v[108:111]
ds_read_b64_tr_b16 a[206:207], v131 offset:57344
buffer_load_dwordx4 v149, s[20:23], s34 offen offset:1024  lds
s_waitcnt lgkmcnt(8)
v_mfma_f32_16x16x32_bf16 v[112:115], a[216:219], a[0:3], v[112:115]
ds_read_b64_tr_b16 a[208:209], v132 offset:49152
v_mfma_f32_16x16x32_bf16 v[120:123], a[216:219], a[4:7], v[120:123]
ds_read_b64_tr_b16 a[210:211], v132 offset:57344
buffer_load_dwordx4 v150, s[20:23], s34 offen offset:2048  lds
v_mfma_f32_16x16x32_bf16 v[116:119], a[220:223], a[0:3], v[116:119]
ds_read_b64_tr_b16 a[212:213], v133 offset:49152
v_mfma_f32_16x16x32_bf16 v[124:127], a[220:223], a[4:7], v[124:127]
ds_read_b64_tr_b16 a[214:215], v133 offset:57344
buffer_load_dwordx4 v151, s[20:23], s34 offen offset:3072  lds
s_waitcnt lgkmcnt(8)
v_mfma_f32_16x16x32_bf16 v[0:3], a[192:195], a[8:11], v[0:3]
ds_read_b64_tr_b16 a[216:217], v134 offset:49152
v_mfma_f32_16x16x32_bf16 v[8:11], a[192:195], a[12:15], v[8:11]
ds_read_b64_tr_b16 a[218:219], v134 offset:57344
s_add_u32 m0, s33, 114688
s_mov_b32 s34, 1024
buffer_load_dwordx4 v188, s[8:11], s34 offen offset:0 nt lds
v_mfma_f32_16x16x32_bf16 v[4:7], a[196:199], a[8:11], v[4:7]
ds_read_b64_tr_b16 a[220:221], v135 offset:49152
v_mfma_f32_16x16x32_bf16 v[12:15], a[196:199], a[12:15], v[12:15]
ds_read_b64_tr_b16 a[222:223], v135 offset:57344
s_mov_b32 s34, 0
buffer_load_dwordx4 v189, s[8:11], s34 offen offset:1024 nt lds
s_waitcnt lgkmcnt(8)
v_mfma_f32_16x16x32_bf16 v[16:19], a[200:203], a[8:11], v[16:19]
ds_read_b64_tr_b16 a[192:193], v128 offset:49408
v_mfma_f32_16x16x32_bf16 v[24:27], a[200:203], a[12:15], v[24:27]
ds_read_b64_tr_b16 a[194:195], v128 offset:57600
s_mov_b32 s34, 3072
buffer_load_dwordx4 v190, s[8:11], s34 offen offset:2048 nt lds
v_mfma_f32_16x16x32_bf16 v[20:23], a[204:207], a[8:11], v[20:23]
ds_read_b64_tr_b16 a[196:197], v129 offset:49408
v_mfma_f32_16x16x32_bf16 v[28:31], a[204:207], a[12:15], v[28:31]
ds_read_b64_tr_b16 a[198:199], v129 offset:57600
s_mov_b32 s34, 2048
buffer_load_dwordx4 v191, s[8:11], s34 offen offset:3072 nt lds
s_waitcnt lgkmcnt(8)
v_mfma_f32_16x16x32_bf16 v[32:35], a[208:211], a[8:11], v[32:35]
ds_read_b64_tr_b16 a[200:201], v130 offset:49408
v_mfma_f32_16x16x32_bf16 v[40:43], a[208:211], a[12:15], v[40:43]
ds_read_b64_tr_b16 a[202:203], v130 offset:57600
v_mfma_f32_16x16x32_bf16 v[36:39], a[212:215], a[8:11], v[36:39]
ds_read_b64_tr_b16 a[204:205], v131 offset:49408
v_mfma_f32_16x16x32_bf16 v[44:47], a[212:215], a[12:15], v[44:47]
ds_read_b64_tr_b16 a[206:207], v131 offset:57600
s_waitcnt lgkmcnt(8)
v_mfma_f32_16x16x32_bf16 v[48:51], a[216:219], a[8:11], v[48:51]
ds_read_b64_tr_b16 a[208:209], v132 offset:49408
v_mfma_f32_16x16x32_bf16 v[56:59], a[216:219], a[12:15], v[56:59]
ds_read_b64_tr_b16 a[210:211], v132 offset:57600
v_mfma_f32_16x16x32_bf16 v[52:55], a[220:223], a[8:11], v[52:55]
ds_read_b64_tr_b16 a[212:213], v133 offset:49408
v_mfma_f32_16x16x32_bf16 v[60:63], a[220:223], a[12:15], v[60:63]
ds_read_b64_tr_b16 a[214:215], v133 offset:57600
s_waitcnt lgkmcnt(8)
v_mfma_f32_16x16x32_bf16 v[64:67], a[192:195], a[8:11], v[64:67]
ds_read_b64_tr_b16 a[216:217], v134 offset:49408
v_mfma_f32_16x16x32_bf16 v[72:75], a[192:195], a[12:15], v[72:75]
ds_read_b64_tr_b16 a[218:219], v134 offset:57600
s_add_u32 m0, s33, 147456
s_lshl_b32 s34, s70, 19
s_add_u32 s34, s34, 262144
buffer_load_dwordx4 v148, s[20:23], s34 offen offset:0  lds
v_mfma_f32_16x16x32_bf16 v[68:71], a[196:199], a[8:11], v[68:71]
ds_read_b64_tr_b16 a[220:221], v135 offset:49408
v_mfma_f32_16x16x32_bf16 v[76:79], a[196:199], a[12:15], v[76:79]
ds_read_b64_tr_b16 a[222:223], v135 offset:57600
buffer_load_dwordx4 v149, s[20:23], s34 offen offset:1024  lds
s_waitcnt lgkmcnt(8)
v_mfma_f32_16x16x32_bf16 v[80:83], a[200:203], a[8:11], v[80:83]
v_subrev_u32 v152, 65536, v152
v_subrev_u32 v153, 65536, v153
s_waitcnt vmcnt(22)
s_barrier
ds_read_b128 a[20:23], v152 offset:2048
ds_read_b128 a[16:19], v152 offset:0
v_mfma_f32_16x16x32_bf16 v[88:91], a[200:203], a[12:15], v[88:91]
ds_read_b64_tr_b16 a[192:193], v180 offset:16384
ds_read_b64_tr_b16 a[194:195], v180 offset:24576
buffer_load_dwordx4 v150, s[20:23], s34 offen offset:2048  lds
v_mfma_f32_16x16x32_bf16 v[84:87], a[204:207], a[8:11], v[84:87]
ds_read_b64_tr_b16 a[196:197], v181 offset:16384
v_mfma_f32_16x16x32_bf16 v[92:95], a[204:207], a[12:15], v[92:95]
ds_read_b64_tr_b16 a[198:199], v181 offset:24576
buffer_load_dwordx4 v151, s[20:23], s34 offen offset:3072  lds
s_waitcnt lgkmcnt(10)
v_mfma_f32_16x16x32_bf16 v[96:99], a[208:211], a[8:11], v[96:99]
ds_read_b64_tr_b16 a[200:201], v182 offset:16384
v_mfma_f32_16x16x32_bf16 v[104:107], a[208:211], a[12:15], v[104:107]
ds_read_b64_tr_b16 a[202:203], v182 offset:24576
v_mfma_f32_16x16x32_bf16 v[100:103], a[212:215], a[8:11], v[100:103]
ds_read_b64_tr_b16 a[204:205], v183 offset:16384
v_mfma_f32_16x16x32_bf16 v[108:111], a[212:215], a[12:15], v[108:111]
ds_read_b64_tr_b16 a[206:207], v183 offset:24576
s_waitcnt lgkmcnt(10)
v_mfma_f32_16x16x32_bf16 v[112:115], a[216:219], a[8:11], v[112:115]
ds_read_b128 a[24:27], v153 offset:0
ds_read_b64_tr_b16 a[208:209], v184 offset:16384
v_mfma_f32_16x16x32_bf16 v[120:123], a[216:219], a[12:15], v[120:123]
ds_read_b64_tr_b16 a[210:211], v184 offset:24576
v_mfma_f32_16x16x32_bf16 v[116:119], a[220:223], a[8:11], v[116:119]
ds_read_b64_tr_b16 a[212:213], v185 offset:16384
v_mfma_f32_16x16x32_bf16 v[124:127], a[220:223], a[12:15], v[124:127]
ds_read_b64_tr_b16 a[214:215], v185 offset:24576
s_waitcnt lgkmcnt(9)
v_mfma_f32_16x16x32_bf16 v[0:3], a[192:195], a[16:19], v[0:3]
ds_read_b64_tr_b16 a[216:217], v186 offset:16384
v_mfma_f32_16x16x32_bf16 v[8:11], a[192:195], a[20:23], v[8:11]
ds_read_b64_tr_b16 a[218:219], v186 offset:24576
v_mfma_f32_16x16x32_bf16 v[4:7], a[196:199], a[16:19], v[4:7]
ds_read_b64_tr_b16 a[220:221], v187 offset:16384
v_mfma_f32_16x16x32_bf16 v[12:15], a[196:199], a[20:23], v[12:15]
ds_read_b64_tr_b16 a[222:223], v187 offset:24576
s_waitcnt lgkmcnt(9)
v_mfma_f32_16x16x32_bf16 v[16:19], a[200:203], a[16:19], v[16:19]
ds_read_b128 a[28:31], v153 offset:2048
ds_read_b64_tr_b16 a[192:193], v180 offset:16640
v_mfma_f32_16x16x32_bf16 v[24:27], a[200:203], a[20:23], v[24:27]
ds_read_b64_tr_b16 a[194:195], v180 offset:24832
v_mfma_f32_16x16x32_bf16 v[20:23], a[204:207], a[16:19], v[20:23]
ds_read_b64_tr_b16 a[196:197], v181 offset:16640
v_mfma_f32_16x16x32_bf16 v[28:31], a[204:207], a[20:23], v[28:31]
ds_read_b64_tr_b16 a[198:199], v181 offset:24832
s_waitcnt lgkmcnt(9)
v_mfma_f32_16x16x32_bf16 v[32:35], a[208:211], a[16:19], v[32:35]
ds_read_b64_tr_b16 a[200:201], v182 offset:16640
v_mfma_f32_16x16x32_bf16 v[40:43], a[208:211], a[20:23], v[40:43]
ds_read_b64_tr_b16 a[202:203], v182 offset:24832
v_mfma_f32_16x16x32_bf16 v[36:39], a[212:215], a[16:19], v[36:39]
ds_read_b64_tr_b16 a[204:205], v183 offset:16640
v_mfma_f32_16x16x32_bf16 v[44:47], a[212:215], a[20:23], v[44:47]
ds_read_b64_tr_b16 a[206:207], v183 offset:24832
s_waitcnt lgkmcnt(9)
v_mfma_f32_16x16x32_bf16 v[48:51], a[216:219], a[16:19], v[48:51]
ds_read_b64_tr_b16 a[208:209], v184 offset:16640
v_mfma_f32_16x16x32_bf16 v[56:59], a[216:219], a[20:23], v[56:59]
ds_read_b64_tr_b16 a[210:211], v184 offset:24832
v_mfma_f32_16x16x32_bf16 v[52:55], a[220:223], a[16:19], v[52:55]
ds_read_b64_tr_b16 a[212:213], v185 offset:16640
v_mfma_f32_16x16x32_bf16 v[60:63], a[220:223], a[20:23], v[60:63]
ds_read_b64_tr_b16 a[214:215], v185 offset:24832
s_waitcnt lgkmcnt(8)
v_mfma_f32_16x16x32_bf16 v[64:67], a[192:195], a[16:19], v[64:67]
ds_read_b64_tr_b16 a[216:217], v186 offset:16640
v_mfma_f32_16x16x32_bf16 v[72:75], a[192:195], a[20:23], v[72:75]
ds_read_b64_tr_b16 a[218:219], v186 offset:24832
s_add_u32 m0, s33, 32768
s_mov_b32 s34, 0
buffer_load_dwordx4 v192, s[12:15], s34 offen offset:0 nt lds
v_mfma_f32_16x16x32_bf16 v[68:71], a[196:199], a[16:19], v[68:71]
ds_read_b64_tr_b16 a[220:221], v187 offset:16640
v_mfma_f32_16x16x32_bf16 v[76:79], a[196:199], a[20:23], v[76:79]
ds_read_b64_tr_b16 a[222:223], v187 offset:24832
s_mov_b32 s34, 1024
buffer_load_dwordx4 v193, s[12:15], s34 offen offset:1024 nt lds
s_waitcnt lgkmcnt(8)
v_mfma_f32_16x16x32_bf16 v[80:83], a[200:203], a[16:19], v[80:83]
s_waitcnt vmcnt(22)
s_barrier
ds_read_b64_tr_b16 a[192:193], v180 offset:32768
v_mfma_f32_16x16x32_bf16 v[88:91], a[200:203], a[20:23], v[88:91]
ds_read_b64_tr_b16 a[194:195], v180 offset:40960
s_mov_b32 s34, 2048
buffer_load_dwordx4 v194, s[12:15], s34 offen offset:2048 nt lds
v_mfma_f32_16x16x32_bf16 v[84:87], a[204:207], a[16:19], v[84:87]
ds_read_b64_tr_b16 a[196:197], v181 offset:32768
v_mfma_f32_16x16x32_bf16 v[92:95], a[204:207], a[20:23], v[92:95]
ds_read_b64_tr_b16 a[198:199], v181 offset:40960
s_mov_b32 s34, 3072
buffer_load_dwordx4 v195, s[12:15], s34 offen offset:3072 nt lds
s_waitcnt lgkmcnt(8)
v_mfma_f32_16x16x32_bf16 v[96:99], a[208:211], a[16:19], v[96:99]
ds_read_b64_tr_b16 a[200:201], v182 offset:32768
v_mfma_f32_16x16x32_bf16 v[104:107], a[208:211], a[20:23], v[104:107]
ds_read_b64_tr_b16 a[202:203], v182 offset:40960
v_mfma_f32_16x16x32_bf16 v[100:103], a[212:215], a[16:19], v[100:103]
ds_read_b64_tr_b16 a[204:205], v183 offset:32768
v_mfma_f32_16x16x32_bf16 v[108:111], a[212:215], a[20:23], v[108:111]
ds_read_b64_tr_b16 a[206:207], v183 offset:40960
s_waitcnt lgkmcnt(8)
v_mfma_f32_16x16x32_bf16 v[112:115], a[216:219], a[16:19], v[112:115]
ds_read_b64_tr_b16 a[208:209], v184 offset:32768
v_mfma_f32_16x16x32_bf16 v[120:123], a[216:219], a[20:23], v[120:123]
ds_read_b64_tr_b16 a[210:211], v184 offset:40960
v_mfma_f32_16x16x32_bf16 v[116:119], a[220:223], a[16:19], v[116:119]
ds_read_b64_tr_b16 a[212:213], v185 offset:32768
v_mfma_f32_16x16x32_bf16 v[124:127], a[220:223], a[20:23], v[124:127]
ds_read_b64_tr_b16 a[214:215], v185 offset:40960
s_waitcnt lgkmcnt(8)
v_mfma_f32_16x16x32_bf16 v[0:3], a[192:195], a[24:27], v[0:3]
ds_read_b64_tr_b16 a[216:217], v186 offset:32768
v_mfma_f32_16x16x32_bf16 v[8:11], a[192:195], a[28:31], v[8:11]
ds_read_b64_tr_b16 a[218:219], v186 offset:40960
v_mfma_f32_16x16x32_bf16 v[4:7], a[196:199], a[24:27], v[4:7]
ds_read_b64_tr_b16 a[220:221], v187 offset:32768
v_mfma_f32_16x16x32_bf16 v[12:15], a[196:199], a[28:31], v[12:15]
ds_read_b64_tr_b16 a[222:223], v187 offset:40960
s_waitcnt lgkmcnt(8)
v_mfma_f32_16x16x32_bf16 v[16:19], a[200:203], a[24:27], v[16:19]
ds_read_b64_tr_b16 a[192:193], v180 offset:33024
v_mfma_f32_16x16x32_bf16 v[24:27], a[200:203], a[28:31], v[24:27]
ds_read_b64_tr_b16 a[194:195], v180 offset:41216
v_mfma_f32_16x16x32_bf16 v[20:23], a[204:207], a[24:27], v[20:23]
ds_read_b64_tr_b16 a[196:197], v181 offset:33024
v_mfma_f32_16x16x32_bf16 v[28:31], a[204:207], a[28:31], v[28:31]
ds_read_b64_tr_b16 a[198:199], v181 offset:41216
s_waitcnt lgkmcnt(8)
v_mfma_f32_16x16x32_bf16 v[32:35], a[208:211], a[24:27], v[32:35]
ds_read_b64_tr_b16 a[200:201], v182 offset:33024
v_mfma_f32_16x16x32_bf16 v[40:43], a[208:211], a[28:31], v[40:43]
ds_read_b64_tr_b16 a[202:203], v182 offset:41216
v_mfma_f32_16x16x32_bf16 v[36:39], a[212:215], a[24:27], v[36:39]
ds_read_b64_tr_b16 a[204:205], v183 offset:33024
v_mfma_f32_16x16x32_bf16 v[44:47], a[212:215], a[28:31], v[44:47]
ds_read_b64_tr_b16 a[206:207], v183 offset:41216
s_waitcnt lgkmcnt(8)
v_mfma_f32_16x16x32_bf16 v[48:51], a[216:219], a[24:27], v[48:51]
ds_read_b64_tr_b16 a[208:209], v184 offset:33024
v_mfma_f32_16x16x32_bf16 v[56:59], a[216:219], a[28:31], v[56:59]
ds_read_b64_tr_b16 a[210:211], v184 offset:41216
v_mfma_f32_16x16x32_bf16 v[52:55], a[220:223], a[24:27], v[52:55]
ds_read_b64_tr_b16 a[212:213], v185 offset:33024
v_mfma_f32_16x16x32_bf16 v[60:63], a[220:223], a[28:31], v[60:63]
ds_read_b64_tr_b16 a[214:215], v185 offset:41216
s_waitcnt lgkmcnt(8)
v_mfma_f32_16x16x32_bf16 v[64:67], a[192:195], a[24:27], v[64:67]
ds_read_b64_tr_b16 a[216:217], v186 offset:33024
v_mfma_f32_16x16x32_bf16 v[72:75], a[192:195], a[28:31], v[72:75]
ds_read_b64_tr_b16 a[218:219], v186 offset:41216
v_mfma_f32_16x16x32_bf16 v[68:71], a[196:199], a[24:27], v[68:71]
ds_read_b64_tr_b16 a[220:221], v187 offset:33024
v_mfma_f32_16x16x32_bf16 v[76:79], a[196:199], a[28:31], v[76:79]
ds_read_b64_tr_b16 a[222:223], v187 offset:41216
s_waitcnt lgkmcnt(8)
v_mfma_f32_16x16x32_bf16 v[80:83], a[200:203], a[24:27], v[80:83]
v_add_u32 v152, 65536, v152
v_add_u32 v153, 65536, v153
s_waitcnt vmcnt(12)
s_barrier
ds_read_b128 a[4:7], v152 offset:2048
ds_read_b128 a[0:3], v152 offset:0
v_mfma_f32_16x16x32_bf16 v[88:91], a[200:203], a[28:31], v[88:91]
ds_read_b64_tr_b16 a[192:193], v128 offset:16384
ds_read_b64_tr_b16 a[194:195], v128 offset:24576
v_mfma_f32_16x16x32_bf16 v[84:87], a[204:207], a[24:27], v[84:87]
ds_read_b64_tr_b16 a[196:197], v129 offset:16384
v_mfma_f32_16x16x32_bf16 v[92:95], a[204:207], a[28:31], v[92:95]
ds_read_b64_tr_b16 a[198:199], v129 offset:24576
s_waitcnt lgkmcnt(10)
v_mfma_f32_16x16x32_bf16 v[96:99], a[208:211], a[24:27], v[96:99]
ds_read_b64_tr_b16 a[200:201], v130 offset:16384
v_mfma_f32_16x16x32_bf16 v[104:107], a[208:211], a[28:31], v[104:107]
ds_read_b64_tr_b16 a[202:203], v130 offset:24576
v_mfma_f32_16x16x32_bf16 v[100:103], a[212:215], a[24:27], v[100:103]
ds_read_b64_tr_b16 a[204:205], v131 offset:16384
v_mfma_f32_16x16x32_bf16 v[108:111], a[212:215], a[28:31], v[108:111]
ds_read_b64_tr_b16 a[206:207], v131 offset:24576
s_waitcnt lgkmcnt(10)
v_mfma_f32_16x16x32_bf16 v[112:115], a[216:219], a[24:27], v[112:115]
ds_read_b128 a[8:11], v153 offset:0
ds_read_b64_tr_b16 a[208:209], v132 offset:16384
v_mfma_f32_16x16x32_bf16 v[120:123], a[216:219], a[28:31], v[120:123]
ds_read_b64_tr_b16 a[210:211], v132 offset:24576
v_mfma_f32_16x16x32_bf16 v[116:119], a[220:223], a[24:27], v[116:119]
ds_read_b64_tr_b16 a[212:213], v133 offset:16384
v_mfma_f32_16x16x32_bf16 v[124:127], a[220:223], a[28:31], v[124:127]
ds_read_b64_tr_b16 a[214:215], v133 offset:24576
s_waitcnt lgkmcnt(9)
v_mfma_f32_16x16x32_bf16 v[0:3], a[192:195], a[0:3], v[0:3]
ds_read_b64_tr_b16 a[216:217], v134 offset:16384
v_mfma_f32_16x16x32_bf16 v[8:11], a[192:195], a[4:7], v[8:11]
ds_read_b64_tr_b16 a[218:219], v134 offset:24576
s_add_u32 m0, s33, 49152
s_mov_b32 s34, 2048
buffer_load_dwordx4 v188, s[8:11], s34 offen offset:0 nt lds
v_mfma_f32_16x16x32_bf16 v[4:7], a[196:199], a[0:3], v[4:7]
ds_read_b64_tr_b16 a[220:221], v135 offset:16384
v_mfma_f32_16x16x32_bf16 v[12:15], a[196:199], a[4:7], v[12:15]
ds_read_b64_tr_b16 a[222:223], v135 offset:24576
s_mov_b32 s34, 3072
buffer_load_dwordx4 v189, s[8:11], s34 offen offset:1024 nt lds
s_waitcnt lgkmcnt(9)
v_mfma_f32_16x16x32_bf16 v[16:19], a[200:203], a[0:3], v[16:19]
ds_read_b128 a[12:15], v153 offset:2048
ds_read_b64_tr_b16 a[192:193], v128 offset:16640
v_mfma_f32_16x16x32_bf16 v[24:27], a[200:203], a[4:7], v[24:27]
ds_read_b64_tr_b16 a[194:195], v128 offset:24832
s_mov_b32 s34, 0
buffer_load_dwordx4 v190, s[8:11], s34 offen offset:2048 nt lds
v_mfma_f32_16x16x32_bf16 v[20:23], a[204:207], a[0:3], v[20:23]
ds_read_b64_tr_b16 a[196:197], v129 offset:16640
v_mfma_f32_16x16x32_bf16 v[28:31], a[204:207], a[4:7], v[28:31]
ds_read_b64_tr_b16 a[198:199], v129 offset:24832
s_mov_b32 s34, 1024
buffer_load_dwordx4 v191, s[8:11], s34 offen offset:3072 nt lds
s_waitcnt lgkmcnt(9)
v_mfma_f32_16x16x32_bf16 v[32:35], a[208:211], a[0:3], v[32:35]
ds_read_b64_tr_b16 a[200:201], v130 offset:16640
v_mfma_f32_16x16x32_bf16 v[40:43], a[208:211], a[4:7], v[40:43]
ds_read_b64_tr_b16 a[202:203], v130 offset:24832
v_mfma_f32_16x16x32_bf16 v[36:39], a[212:215], a[0:3], v[36:39]
ds_read_b64_tr_b16 a[204:205], v131 offset:16640
v_mfma_f32_16x16x32_bf16 v[44:47], a[212:215], a[4:7], v[44:47]
ds_read_b64_tr_b16 a[206:207], v131 offset:24832
s_waitcnt lgkmcnt(9)
v_mfma_f32_16x16x32_bf16 v[48:51], a[216:219], a[0:3], v[48:51]
ds_read_b64_tr_b16 a[208:209], v132 offset:16640
v_mfma_f32_16x16x32_bf16 v[56:59], a[216:219], a[4:7], v[56:59]
ds_read_b64_tr_b16 a[210:211], v132 offset:24832
v_mfma_f32_16x16x32_bf16 v[52:55], a[220:223], a[0:3], v[52:55]
ds_read_b64_tr_b16 a[212:213], v133 offset:16640
v_mfma_f32_16x16x32_bf16 v[60:63], a[220:223], a[4:7], v[60:63]
ds_read_b64_tr_b16 a[214:215], v133 offset:24832
s_waitcnt lgkmcnt(8)
v_mfma_f32_16x16x32_bf16 v[64:67], a[192:195], a[0:3], v[64:67]
ds_read_b64_tr_b16 a[216:217], v134 offset:16640
v_mfma_f32_16x16x32_bf16 v[72:75], a[192:195], a[4:7], v[72:75]
ds_read_b64_tr_b16 a[218:219], v134 offset:24832
v_mfma_f32_16x16x32_bf16 v[68:71], a[196:199], a[0:3], v[68:71]
ds_read_b64_tr_b16 a[220:221], v135 offset:16640
v_mfma_f32_16x16x32_bf16 v[76:79], a[196:199], a[4:7], v[76:79]
ds_read_b64_tr_b16 a[222:223], v135 offset:24832
s_waitcnt lgkmcnt(8)
v_mfma_f32_16x16x32_bf16 v[80:83], a[200:203], a[0:3], v[80:83]
s_waitcnt vmcnt(8)
s_barrier
ds_read_b64_tr_b16 a[192:193], v136 offset:16384
v_mfma_f32_16x16x32_bf16 v[88:91], a[200:203], a[4:7], v[88:91]
ds_read_b64_tr_b16 a[194:195], v136 offset:24576
v_mfma_f32_16x16x32_bf16 v[84:87], a[204:207], a[0:3], v[84:87]
ds_read_b64_tr_b16 a[196:197], v137 offset:16384
v_mfma_f32_16x16x32_bf16 v[92:95], a[204:207], a[4:7], v[92:95]
ds_read_b64_tr_b16 a[198:199], v137 offset:24576
s_waitcnt lgkmcnt(8)
v_mfma_f32_16x16x32_bf16 v[96:99], a[208:211], a[0:3], v[96:99]
ds_read_b64_tr_b16 a[200:201], v138 offset:16384
v_mfma_f32_16x16x32_bf16 v[104:107], a[208:211], a[4:7], v[104:107]
ds_read_b64_tr_b16 a[202:203], v138 offset:24576
v_mfma_f32_16x16x32_bf16 v[100:103], a[212:215], a[0:3], v[100:103]
ds_read_b64_tr_b16 a[204:205], v139 offset:16384
v_mfma_f32_16x16x32_bf16 v[108:111], a[212:215], a[4:7], v[108:111]
ds_read_b64_tr_b16 a[206:207], v139 offset:24576
s_waitcnt lgkmcnt(8)
v_mfma_f32_16x16x32_bf16 v[112:115], a[216:219], a[0:3], v[112:115]
ds_read_b64_tr_b16 a[208:209], v140 offset:16384
v_mfma_f32_16x16x32_bf16 v[120:123], a[216:219], a[4:7], v[120:123]
ds_read_b64_tr_b16 a[210:211], v140 offset:24576
v_mfma_f32_16x16x32_bf16 v[116:119], a[220:223], a[0:3], v[116:119]
ds_read_b64_tr_b16 a[212:213], v141 offset:16384
v_mfma_f32_16x16x32_bf16 v[124:127], a[220:223], a[4:7], v[124:127]
ds_read_b64_tr_b16 a[214:215], v141 offset:24576
s_waitcnt lgkmcnt(8)
v_mfma_f32_16x16x32_bf16 v[0:3], a[192:195], a[8:11], v[0:3]
ds_read_b64_tr_b16 a[216:217], v142 offset:16384
v_mfma_f32_16x16x32_bf16 v[8:11], a[192:195], a[12:15], v[8:11]
ds_read_b64_tr_b16 a[218:219], v142 offset:24576
v_mfma_f32_16x16x32_bf16 v[4:7], a[196:199], a[8:11], v[4:7]
ds_read_b64_tr_b16 a[220:221], v143 offset:16384
v_mfma_f32_16x16x32_bf16 v[12:15], a[196:199], a[12:15], v[12:15]
ds_read_b64_tr_b16 a[222:223], v143 offset:24576
s_waitcnt lgkmcnt(8)
v_mfma_f32_16x16x32_bf16 v[16:19], a[200:203], a[8:11], v[16:19]
ds_read_b64_tr_b16 a[192:193], v136 offset:16640
v_mfma_f32_16x16x32_bf16 v[24:27], a[200:203], a[12:15], v[24:27]
ds_read_b64_tr_b16 a[194:195], v136 offset:24832
v_mfma_f32_16x16x32_bf16 v[20:23], a[204:207], a[8:11], v[20:23]
ds_read_b64_tr_b16 a[196:197], v137 offset:16640
v_mfma_f32_16x16x32_bf16 v[28:31], a[204:207], a[12:15], v[28:31]
ds_read_b64_tr_b16 a[198:199], v137 offset:24832
s_waitcnt lgkmcnt(8)
v_mfma_f32_16x16x32_bf16 v[32:35], a[208:211], a[8:11], v[32:35]
ds_read_b64_tr_b16 a[200:201], v138 offset:16640
v_mul_f32 v0, v232, v0
v_mul_f32 v1, v232, v1
v_mul_f32 v2, v232, v2
v_mul_f32 v3, v232, v3
v_mul_f32 v4, v232, v4
v_mul_f32 v5, v232, v5
v_mul_f32 v6, v232, v6
v_mul_f32 v7, v232, v7
v_cvt_pk_bf16_f32 v208, v0, v1
v_cvt_pk_bf16_f32 v209, v2, v3
v_cvt_pk_bf16_f32 v210, v4, v5
v_cvt_pk_bf16_f32 v211, v6, v7
v_mfma_f32_16x16x32_bf16 v[40:43], a[208:211], a[12:15], v[40:43]
ds_read_b64_tr_b16 a[202:203], v138 offset:24832
v_mul_f32 v8, v232, v8
v_mul_f32 v9, v232, v9
v_mul_f32 v10, v232, v10
v_mul_f32 v11, v232, v11
v_mul_f32 v12, v232, v12
v_mul_f32 v13, v232, v13
v_mul_f32 v14, v232, v14
v_mul_f32 v15, v232, v15
v_cvt_pk_bf16_f32 v212, v8, v9
v_cvt_pk_bf16_f32 v213, v10, v11
v_cvt_pk_bf16_f32 v214, v12, v13
v_cvt_pk_bf16_f32 v215, v14, v15
v_mfma_f32_16x16x32_bf16 v[36:39], a[212:215], a[8:11], v[36:39]
ds_read_b64_tr_b16 a[204:205], v139 offset:16640
s_nop 0
v_permlane16_swap_b32 v208, v210
v_permlane16_swap_b32 v209, v211
v_permlane16_swap_b32 v212, v214
v_permlane16_swap_b32 v213, v215
v_accvgpr_write_b32 a128, v208
v_accvgpr_write_b32 a129, v209
v_mfma_f32_16x16x32_bf16 v[44:47], a[212:215], a[12:15], v[44:47]
ds_read_b64_tr_b16 a[206:207], v139 offset:24832
v_accvgpr_write_b32 a130, v210
v_accvgpr_write_b32 a131, v211
v_accvgpr_write_b32 a132, v212
v_accvgpr_write_b32 a133, v213
v_accvgpr_write_b32 a134, v214
v_accvgpr_write_b32 a135, v215
s_waitcnt lgkmcnt(8)
v_mfma_f32_16x16x32_bf16 v[48:51], a[216:219], a[8:11], v[48:51]
ds_read_b64_tr_b16 a[208:209], v140 offset:16640
v_mul_f32 v16, v232, v16
v_mul_f32 v17, v232, v17
v_mul_f32 v18, v232, v18
v_mul_f32 v19, v232, v19
v_mul_f32 v20, v232, v20
v_mul_f32 v21, v232, v21
v_mul_f32 v22, v232, v22
v_mul_f32 v23, v232, v23
v_cvt_pk_bf16_f32 v208, v16, v17
v_cvt_pk_bf16_f32 v209, v18, v19
v_cvt_pk_bf16_f32 v210, v20, v21
v_cvt_pk_bf16_f32 v211, v22, v23
v_mfma_f32_16x16x32_bf16 v[56:59], a[216:219], a[12:15], v[56:59]
ds_read_b64_tr_b16 a[210:211], v140 offset:24832
v_mul_f32 v24, v232, v24
v_mul_f32 v25, v232, v25
v_mul_f32 v26, v232, v26
v_mul_f32 v27, v232, v27
v_mul_f32 v28, v232, v28
v_mul_f32 v29, v232, v29
v_mul_f32 v30, v232, v30
v_mul_f32 v31, v232, v31
v_cvt_pk_bf16_f32 v212, v24, v25
v_cvt_pk_bf16_f32 v213, v26, v27
v_cvt_pk_bf16_f32 v214, v28, v29
v_cvt_pk_bf16_f32 v215, v30, v31
v_mfma_f32_16x16x32_bf16 v[52:55], a[220:223], a[8:11], v[52:55]
ds_read_b64_tr_b16 a[212:213], v141 offset:16640
s_nop 0
v_permlane16_swap_b32 v208, v210
v_permlane16_swap_b32 v209, v211
v_permlane16_swap_b32 v212, v214
v_permlane16_swap_b32 v213, v215
v_accvgpr_write_b32 a136, v208
v_accvgpr_write_b32 a137, v209
v_mfma_f32_16x16x32_bf16 v[60:63], a[220:223], a[12:15], v[60:63]
ds_read_b64_tr_b16 a[214:215], v141 offset:24832
v_accvgpr_write_b32 a138, v210
v_accvgpr_write_b32 a139, v211
v_accvgpr_write_b32 a140, v212
v_accvgpr_write_b32 a141, v213
v_accvgpr_write_b32 a142, v214
v_accvgpr_write_b32 a143, v215
s_waitcnt lgkmcnt(8)
v_mfma_f32_16x16x32_bf16 v[64:67], a[192:195], a[8:11], v[64:67]
ds_read_b64_tr_b16 a[216:217], v142 offset:16640
v_mul_f32 v32, v232, v32
v_mul_f32 v33, v232, v33
v_mul_f32 v34, v232, v34
v_mul_f32 v35, v232, v35
v_mul_f32 v36, v232, v36
v_mul_f32 v37, v232, v37
v_mul_f32 v38, v232, v38
v_mul_f32 v39, v232, v39
v_cvt_pk_bf16_f32 v208, v32, v33
v_cvt_pk_bf16_f32 v209, v34, v35
v_cvt_pk_bf16_f32 v210, v36, v37
v_cvt_pk_bf16_f32 v211, v38, v39
v_mfma_f32_16x16x32_bf16 v[72:75], a[192:195], a[12:15], v[72:75]
ds_read_b64_tr_b16 a[218:219], v142 offset:24832
v_mul_f32 v40, v232, v40
v_mul_f32 v41, v232, v41
v_mul_f32 v42, v232, v42
v_mul_f32 v43, v232, v43
v_mul_f32 v44, v232, v44
v_mul_f32 v45, v232, v45
v_mul_f32 v46, v232, v46
v_mul_f32 v47, v232, v47
v_cvt_pk_bf16_f32 v212, v40, v41
v_cvt_pk_bf16_f32 v213, v42, v43
v_cvt_pk_bf16_f32 v214, v44, v45
v_cvt_pk_bf16_f32 v215, v46, v47
s_add_u32 m0, s33, 65536
s_mov_b32 s34, 1024
buffer_load_dwordx4 v192, s[12:15], s34 offen offset:0 nt lds
v_mfma_f32_16x16x32_bf16 v[68:71], a[196:199], a[8:11], v[68:71]
ds_read_b64_tr_b16 a[220:221], v143 offset:16640
s_nop 0
v_permlane16_swap_b32 v208, v210
v_permlane16_swap_b32 v209, v211
v_permlane16_swap_b32 v212, v214
v_permlane16_swap_b32 v213, v215
v_accvgpr_write_b32 a144, v208
v_accvgpr_write_b32 a145, v209
v_mfma_f32_16x16x32_bf16 v[76:79], a[196:199], a[12:15], v[76:79]
ds_read_b64_tr_b16 a[222:223], v143 offset:24832
v_accvgpr_write_b32 a146, v210
v_accvgpr_write_b32 a147, v211
v_accvgpr_write_b32 a148, v212
v_accvgpr_write_b32 a149, v213
v_accvgpr_write_b32 a150, v214
v_accvgpr_write_b32 a151, v215
s_mov_b32 s34, 0
buffer_load_dwordx4 v193, s[12:15], s34 offen offset:1024 nt lds
s_waitcnt lgkmcnt(8)
v_mfma_f32_16x16x32_bf16 v[80:83], a[200:203], a[8:11], v[80:83]
s_barrier
ds_read_b128 a[192:195], v176 offset:0
v_mul_f32 v48, v232, v48
v_mul_f32 v49, v232, v49
v_mul_f32 v50, v232, v50
v_mul_f32 v51, v232, v51
v_mul_f32 v52, v232, v52
v_mul_f32 v53, v232, v53
v_mul_f32 v54, v232, v54
v_mul_f32 v55, v232, v55
v_cvt_pk_bf16_f32 v208, v48, v49
v_cvt_pk_bf16_f32 v209, v50, v51
v_cvt_pk_bf16_f32 v210, v52, v53
v_cvt_pk_bf16_f32 v211, v54, v55
v_mfma_f32_16x16x32_bf16 v[88:91], a[200:203], a[12:15], v[88:91]
v_mul_f32 v56, v232, v56
v_mul_f32 v57, v232, v57
v_mul_f32 v58, v232, v58
v_mul_f32 v59, v232, v59
v_mul_f32 v60, v232, v60
v_mul_f32 v61, v232, v61
v_mul_f32 v62, v232, v62
v_mul_f32 v63, v232, v63
v_cvt_pk_bf16_f32 v212, v56, v57
v_cvt_pk_bf16_f32 v213, v58, v59
v_cvt_pk_bf16_f32 v214, v60, v61
v_cvt_pk_bf16_f32 v215, v62, v63
s_mov_b32 s34, 3072
buffer_load_dwordx4 v194, s[12:15], s34 offen offset:2048 nt lds
v_mfma_f32_16x16x32_bf16 v[84:87], a[204:207], a[8:11], v[84:87]
ds_read_b128 a[196:199], v176 offset:8192
s_nop 0
v_permlane16_swap_b32 v208, v210
v_permlane16_swap_b32 v209, v211
v_permlane16_swap_b32 v212, v214
v_permlane16_swap_b32 v213, v215
v_accvgpr_write_b32 a152, v208
v_mfma_f32_16x16x32_bf16 v[92:95], a[204:207], a[12:15], v[92:95]
v_accvgpr_write_b32 a153, v209
v_accvgpr_write_b32 a154, v210
v_accvgpr_write_b32 a155, v211
v_accvgpr_write_b32 a156, v212
v_accvgpr_write_b32 a157, v213
v_accvgpr_write_b32 a158, v214
v_accvgpr_write_b32 a159, v215
s_mov_b32 s34, 2048
buffer_load_dwordx4 v195, s[12:15], s34 offen offset:3072 nt lds
s_waitcnt lgkmcnt(6)
v_mfma_f32_16x16x32_bf16 v[96:99], a[208:211], a[8:11], v[96:99]
ds_read_b128 a[200:203], v177 offset:0
v_mul_f32 v64, v232, v64
v_mul_f32 v65, v232, v65
v_mul_f32 v66, v232, v66
v_mul_f32 v67, v232, v67
v_mul_f32 v68, v232, v68
v_mul_f32 v69, v232, v69
v_mul_f32 v70, v232, v70
v_mul_f32 v71, v232, v71
v_cvt_pk_bf16_f32 v208, v64, v65
v_cvt_pk_bf16_f32 v209, v66, v67
v_cvt_pk_bf16_f32 v210, v68, v69
v_cvt_pk_bf16_f32 v211, v70, v71
v_mfma_f32_16x16x32_bf16 v[104:107], a[208:211], a[12:15], v[104:107]
v_mul_f32 v72, v232, v72
v_mul_f32 v73, v232, v73
v_mul_f32 v74, v232, v74
v_mul_f32 v75, v232, v75
v_mul_f32 v76, v232, v76
v_mul_f32 v77, v232, v77
v_mul_f32 v78, v232, v78
v_mul_f32 v79, v232, v79
v_cvt_pk_bf16_f32 v212, v72, v73
v_cvt_pk_bf16_f32 v213, v74, v75
v_cvt_pk_bf16_f32 v214, v76, v77
v_cvt_pk_bf16_f32 v215, v78, v79
s_waitcnt vmcnt(4)
s_add_u32 m0, s33, 16384
s_mov_b32 s34, 66560
buffer_load_dwordx4 v188, s[8:11], s34 offen offset:0 nt lds
v_mfma_f32_16x16x32_bf16 v[100:103], a[212:215], a[8:11], v[100:103]
ds_read_b128 a[204:207], v177 offset:8192
s_nop 0
v_permlane16_swap_b32 v208, v210
v_permlane16_swap_b32 v209, v211
v_permlane16_swap_b32 v212, v214
v_permlane16_swap_b32 v213, v215
v_accvgpr_write_b32 a160, v208
v_mfma_f32_16x16x32_bf16 v[108:111], a[212:215], a[12:15], v[108:111]
v_accvgpr_write_b32 a161, v209
v_accvgpr_write_b32 a162, v210
v_accvgpr_write_b32 a163, v211
v_accvgpr_write_b32 a164, v212
v_accvgpr_write_b32 a165, v213
v_accvgpr_write_b32 a166, v214
v_accvgpr_write_b32 a167, v215
s_waitcnt lgkmcnt(4)
v_mfma_f32_16x16x32_bf16 v[112:115], a[216:219], a[8:11], v[112:115]
ds_read_b128 a[208:211], v178 offset:0
v_mul_f32 v80, v232, v80
v_mul_f32 v81, v232, v81
v_mul_f32 v82, v232, v82
v_mul_f32 v83, v232, v83
v_mul_f32 v84, v232, v84
v_mul_f32 v85, v232, v85
v_mul_f32 v86, v232, v86
v_mul_f32 v87, v232, v87
v_cvt_pk_bf16_f32 v208, v80, v81
v_cvt_pk_bf16_f32 v209, v82, v83
v_cvt_pk_bf16_f32 v210, v84, v85
v_cvt_pk_bf16_f32 v211, v86, v87
v_mfma_f32_16x16x32_bf16 v[120:123], a[216:219], a[12:15], v[120:123]
v_mul_f32 v88, v232, v88
v_mul_f32 v89, v232, v89
v_mul_f32 v90, v232, v90
v_mul_f32 v91, v232, v91
v_mul_f32 v92, v232, v92
v_mul_f32 v93, v232, v93
v_mul_f32 v94, v232, v94
v_mul_f32 v95, v232, v95
v_cvt_pk_bf16_f32 v212, v88, v89
v_cvt_pk_bf16_f32 v213, v90, v91
v_cvt_pk_bf16_f32 v214, v92, v93
v_cvt_pk_bf16_f32 v215, v94, v95
v_mfma_f32_16x16x32_bf16 v[116:119], a[220:223], a[8:11], v[116:119]
ds_read_b128 a[212:215], v178 offset:8192
s_nop 0
v_permlane16_swap_b32 v208, v210
v_permlane16_swap_b32 v209, v211
v_permlane16_swap_b32 v212, v214
v_permlane16_swap_b32 v213, v215
v_accvgpr_write_b32 a168, v208
v_mfma_f32_16x16x32_bf16 v[124:127], a[220:223], a[12:15], v[124:127]
v_accvgpr_write_b32 a169, v209
v_accvgpr_write_b32 a170, v210
v_accvgpr_write_b32 a171, v211
v_accvgpr_write_b32 a172, v212
v_accvgpr_write_b32 a173, v213
v_accvgpr_write_b32 a174, v214
v_accvgpr_write_b32 a175, v215
s_waitcnt vmcnt(4)
s_mov_b32 s34, 65536
buffer_load_dwordx4 v189, s[8:11], s34 offen offset:1024 nt lds
s_waitcnt lgkmcnt(4)
v_mfma_f32_16x16x32_bf16 v[128:131], a[192:195], a[128:131], 0
ds_read_b128 a[216:219], v179 offset:0
v_mul_f32 v96, v232, v96
v_mul_f32 v97, v232, v97
v_mul_f32 v98, v232, v98
v_mul_f32 v99, v232, v99
v_mul_f32 v100, v232, v100
v_mul_f32 v101, v232, v101
v_mul_f32 v102, v232, v102
v_mul_f32 v103, v232, v103
v_cvt_pk_bf16_f32 v208, v96, v97
v_cvt_pk_bf16_f32 v209, v98, v99
v_cvt_pk_bf16_f32 v210, v100, v101
v_cvt_pk_bf16_f32 v211, v102, v103
v_mfma_f32_16x16x32_bf16 v[136:139], a[192:195], a[132:135], 0
v_mul_f32 v104, v232, v104
v_mul_f32 v105, v232, v105
v_mul_f32 v106, v232, v106
v_mul_f32 v107, v232, v107
v_mul_f32 v108, v232, v108
v_mul_f32 v109, v232, v109
v_mul_f32 v110, v232, v110
v_mul_f32 v111, v232, v111
v_cvt_pk_bf16_f32 v212, v104, v105
v_cvt_pk_bf16_f32 v213, v106, v107
v_cvt_pk_bf16_f32 v214, v108, v109
v_cvt_pk_bf16_f32 v215, v110, v111
v_mfma_f32_16x16x32_bf16 v[132:135], a[196:199], a[128:131], 0
ds_read_b128 a[220:223], v179 offset:8192
s_nop 0
v_permlane16_swap_b32 v208, v210
v_permlane16_swap_b32 v209, v211
v_permlane16_swap_b32 v212, v214
v_permlane16_swap_b32 v213, v215
v_accvgpr_write_b32 a176, v208
v_mfma_f32_16x16x32_bf16 v[140:143], a[196:199], a[132:135], 0
v_accvgpr_write_b32 a177, v209
v_accvgpr_write_b32 a178, v210
v_accvgpr_write_b32 a179, v211
v_accvgpr_write_b32 a180, v212
v_accvgpr_write_b32 a181, v213
v_accvgpr_write_b32 a182, v214
v_accvgpr_write_b32 a183, v215
s_waitcnt lgkmcnt(4)
v_mfma_f32_16x16x32_bf16 v[128:131], a[200:203], a[136:139], v[128:131]
ds_read_b128 a[192:195], v176 offset:256
v_mul_f32 v112, v232, v112
v_mul_f32 v113, v232, v113
v_mul_f32 v114, v232, v114
v_mul_f32 v115, v232, v115
v_mul_f32 v116, v232, v116
v_mul_f32 v117, v232, v117
v_mul_f32 v118, v232, v118
v_mul_f32 v119, v232, v119
v_cvt_pk_bf16_f32 v208, v112, v113
v_cvt_pk_bf16_f32 v209, v114, v115
v_cvt_pk_bf16_f32 v210, v116, v117
v_cvt_pk_bf16_f32 v211, v118, v119
v_mfma_f32_16x16x32_bf16 v[136:139], a[200:203], a[140:143], v[136:139]
v_mul_f32 v120, v232, v120
v_mul_f32 v121, v232, v121
v_mul_f32 v122, v232, v122
v_mul_f32 v123, v232, v123
v_mul_f32 v124, v232, v124
v_mul_f32 v125, v232, v125
v_mul_f32 v126, v232, v126
v_mul_f32 v127, v232, v127
v_cvt_pk_bf16_f32 v212, v120, v121
v_cvt_pk_bf16_f32 v213, v122, v123
v_cvt_pk_bf16_f32 v214, v124, v125
v_cvt_pk_bf16_f32 v215, v126, v127
v_mfma_f32_16x16x32_bf16 v[132:135], a[204:207], a[136:139], v[132:135]
ds_read_b128 a[196:199], v176 offset:8448
s_nop 0
v_permlane16_swap_b32 v208, v210
v_permlane16_swap_b32 v209, v211
v_permlane16_swap_b32 v212, v214
v_permlane16_swap_b32 v213, v215
v_accvgpr_write_b32 a184, v208
v_mfma_f32_16x16x32_bf16 v[140:143], a[204:207], a[140:143], v[140:143]
v_accvgpr_write_b32 a185, v209
v_accvgpr_write_b32 a186, v210
v_accvgpr_write_b32 a187, v211
v_accvgpr_write_b32 a188, v212
v_accvgpr_write_b32 a189, v213
v_accvgpr_write_b32 a190, v214
v_accvgpr_write_b32 a191, v215
s_waitcnt lgkmcnt(4)
v_mfma_f32_16x16x32_bf16 v[128:131], a[208:211], a[144:147], v[128:131]
ds_read_b128 a[200:203], v177 offset:256
v_mfma_f32_16x16x32_bf16 v[136:139], a[208:211], a[148:151], v[136:139]
s_waitcnt vmcnt(4)
s_mov_b32 s34, 68608
buffer_load_dwordx4 v190, s[8:11], s34 offen offset:2048 nt lds
v_mfma_f32_16x16x32_bf16 v[132:135], a[212:215], a[144:147], v[132:135]
ds_read_b128 a[204:207], v177 offset:8448
v_mfma_f32_16x16x32_bf16 v[140:143], a[212:215], a[148:151], v[140:143]
s_waitcnt lgkmcnt(4)
v_mfma_f32_16x16x32_bf16 v[128:131], a[216:219], a[152:155], v[128:131]
ds_read_b128 a[208:211], v178 offset:256
v_mfma_f32_16x16x32_bf16 v[136:139], a[216:219], a[156:159], v[136:139]
v_mfma_f32_16x16x32_bf16 v[132:135], a[220:223], a[152:155], v[132:135]
ds_read_b128 a[212:215], v178 offset:8448
v_mfma_f32_16x16x32_bf16 v[140:143], a[220:223], a[156:159], v[140:143]
s_waitcnt lgkmcnt(4)
v_mfma_f32_16x16x32_bf16 v[128:131], a[192:195], a[160:163], v[128:131]
ds_read_b128 a[216:219], v179 offset:256
v_mfma_f32_16x16x32_bf16 v[136:139], a[192:195], a[164:167], v[136:139]
s_waitcnt vmcnt(4)
s_mov_b32 s34, 67584
buffer_load_dwordx4 v191, s[8:11], s34 offen offset:3072 nt lds
v_mfma_f32_16x16x32_bf16 v[132:135], a[196:199], a[160:163], v[132:135]
ds_read_b128 a[220:223], v179 offset:8448
v_mfma_f32_16x16x32_bf16 v[140:143], a[196:199], a[164:167], v[140:143]
s_waitcnt lgkmcnt(4)
v_mfma_f32_16x16x32_bf16 v[128:131], a[200:203], a[168:171], v[128:131]
v_add_u32 v176, 65536, v176
v_add_u32 v177, 65536, v177
v_add_u32 v178, 65536, v178
v_add_u32 v179, 65536, v179
s_waitcnt lgkmcnt(0)
s_barrier
ds_read_b128 a[192:195], v176 offset:49152
v_mfma_f32_16x16x32_bf16 v[136:139], a[200:203], a[172:175], v[136:139]
v_mfma_f32_16x16x32_bf16 v[132:135], a[204:207], a[168:171], v[132:135]
ds_read_b128 a[196:199], v176 offset:57344
v_mfma_f32_16x16x32_bf16 v[140:143], a[204:207], a[172:175], v[140:143]
s_waitcnt lgkmcnt(4)
v_mfma_f32_16x16x32_bf16 v[128:131], a[208:211], a[176:179], v[128:131]
ds_read_b128 a[200:203], v177 offset:49152
v_mfma_f32_16x16x32_bf16 v[136:139], a[208:211], a[180:183], v[136:139]
v_mfma_f32_16x16x32_bf16 v[132:135], a[212:215], a[176:179], v[132:135]
ds_read_b128 a[204:207], v177 offset:57344
v_mfma_f32_16x16x32_bf16 v[140:143], a[212:215], a[180:183], v[140:143]
s_waitcnt vmcnt(4)
s_add_u32 m0, s33, 0
s_mov_b32 s34, 65536
buffer_load_dwordx4 v192, s[12:15], s34 offen offset:0 nt lds
s_waitcnt lgkmcnt(4)
v_mfma_f32_16x16x32_bf16 v[128:131], a[216:219], a[184:187], v[128:131]
ds_read_b128 a[208:211], v178 offset:49152
v_mfma_f32_16x16x32_bf16 v[136:139], a[216:219], a[188:191], v[136:139]
v_mfma_f32_16x16x32_bf16 v[132:135], a[220:223], a[184:187], v[132:135]
ds_read_b128 a[212:215], v178 offset:57344
v_mfma_f32_16x16x32_bf16 v[140:143], a[220:223], a[188:191], v[140:143]
s_nop 7
v_max3_f32 v208, v128, v129, v130
v_max3_f32 v209, v136, v137, v138
v_max3_f32 v208, v208, v131, v132
v_max3_f32 v209, v209, v139, v140
v_max3_f32 v208, v208, v133, v134
v_max3_f32 v209, v209, v141, v142
v_max_f32 v208, v208, v135
v_max_f32 v209, v209, v143
v_mov_b32 v212, v208
v_mov_b32 v213, v209
s_nop 1
v_permlane16_swap_b32 v208, v212
v_permlane16_swap_b32 v209, v213
v_max_f32 v208, v208, v212
v_max_f32 v209, v209, v213
v_mov_b32 v212, v208
v_mov_b32 v213, v209
s_nop 1
v_permlane32_swap_b32 v208, v212
v_permlane32_swap_b32 v209, v213
v_max_f32 v208, v208, v212
v_max_f32 v209, v209, v213
v_sub_f32 v168, 0, v208
v_sub_f32 v169, 0, v208
v_sub_f32 v170, 0, v208
v_sub_f32 v171, 0, v208
v_sub_f32 v172, 0, v209
v_sub_f32 v173, 0, v209
v_sub_f32 v174, 0, v209
v_sub_f32 v175, 0, v209
v_sub_f32 v128, v128, v208
v_sub_f32 v129, v129, v208
v_sub_f32 v130, v130, v208
v_sub_f32 v131, v131, v208
v_sub_f32 v132, v132, v208
v_sub_f32 v133, v133, v208
v_sub_f32 v134, v134, v208
v_sub_f32 v135, v135, v208
v_sub_f32 v136, v136, v209
v_sub_f32 v137, v137, v209
v_sub_f32 v138, v138, v209
v_sub_f32 v139, v139, v209
v_sub_f32 v140, v140, v209
v_sub_f32 v141, v141, v209
v_sub_f32 v142, v142, v209
v_sub_f32 v143, v143, v209
s_waitcnt lgkmcnt(4)
v_mfma_f32_16x16x32_bf16 v[144:147], a[192:195], a[128:131], v[168:171]
ds_read_b128 a[216:219], v179 offset:49152
v_exp_f32 v128, v128
v_mfma_f32_16x16x32_bf16 v[152:155], a[192:195], a[132:135], v[172:175]
v_exp_f32 v129, v129
v_mfma_f32_16x16x32_bf16 v[148:151], a[196:199], a[128:131], v[168:171]
ds_read_b128 a[220:223], v179 offset:57344
v_exp_f32 v130, v130
v_mfma_f32_16x16x32_bf16 v[156:159], a[196:199], a[132:135], v[172:175]
v_cvt_pk_bf16_f32 v160, v128, v129
s_waitcnt vmcnt(4)
s_mov_b32 s34, 66560
buffer_load_dwordx4 v193, s[12:15], s34 offen offset:1024 nt lds
s_waitcnt lgkmcnt(4)
v_mfma_f32_16x16x32_bf16 v[144:147], a[200:203], a[136:139], v[144:147]
ds_read_b128 a[192:195], v176 offset:49408
v_mfma_f32_16x16x32_bf16 v[152:155], a[200:203], a[140:143], v[152:155]
v_exp_f32 v131, v131
v_mfma_f32_16x16x32_bf16 v[148:151], a[204:207], a[136:139], v[148:151]
ds_read_b128 a[196:199], v176 offset:57600
v_exp_f32 v132, v132
v_mfma_f32_16x16x32_bf16 v[156:159], a[204:207], a[140:143], v[156:159]
v_cvt_pk_bf16_f32 v161, v130, v131
s_waitcnt lgkmcnt(4)
v_mfma_f32_16x16x32_bf16 v[144:147], a[208:211], a[144:147], v[144:147]
ds_read_b128 a[200:203], v177 offset:49408
v_mfma_f32_16x16x32_bf16 v[152:155], a[208:211], a[148:151], v[152:155]
v_exp_f32 v133, v133
v_mfma_f32_16x16x32_bf16 v[148:151], a[212:215], a[144:147], v[148:151]
ds_read_b128 a[204:207], v177 offset:57600
v_exp_f32 v134, v134
v_mfma_f32_16x16x32_bf16 v[156:159], a[212:215], a[148:151], v[156:159]
v_cvt_pk_bf16_f32 v162, v132, v133
s_waitcnt lgkmcnt(4)
v_mfma_f32_16x16x32_bf16 v[144:147], a[216:219], a[152:155], v[144:147]
ds_read_b128 a[208:211], v178 offset:49408
v_mfma_f32_16x16x32_bf16 v[152:155], a[216:219], a[156:159], v[152:155]
v_exp_f32 v135, v135
s_waitcnt vmcnt(4)
s_mov_b32 s34, 67584
buffer_load_dwordx4 v194, s[12:15], s34 offen offset:2048 nt lds
v_mfma_f32_16x16x32_bf16 v[148:151], a[220:223], a[152:155], v[148:151]
ds_read_b128 a[212:215], v178 offset:57600
v_exp_f32 v136, v136
v_mfma_f32_16x16x32_bf16 v[156:159], a[220:223], a[156:159], v[156:159]
v_cvt_pk_bf16_f32 v163, v134, v135
s_waitcnt lgkmcnt(4)
v_mfma_f32_16x16x32_bf16 v[144:147], a[192:195], a[160:163], v[144:147]
ds_read_b128 a[216:219], v179 offset:49408
v_mfma_f32_16x16x32_bf16 v[152:155], a[192:195], a[164:167], v[152:155]
v_exp_f32 v137, v137
v_mfma_f32_16x16x32_bf16 v[148:151], a[196:199], a[160:163], v[148:151]
ds_read_b128 a[220:223], v179 offset:57600
v_exp_f32 v138, v138
v_mfma_f32_16x16x32_bf16 v[156:159], a[196:199], a[164:167], v[156:159]
v_cvt_pk_bf16_f32 v164, v136, v137
s_waitcnt lgkmcnt(4)
v_mfma_f32_16x16x32_bf16 v[144:147], a[200:203], a[168:171], v[144:147]
v_subrev_u32 v180, 65536, v180
v_subrev_u32 v181, 65536, v181
v_subrev_u32 v182, 65536, v182
v_subrev_u32 v183, 65536, v183
v_subrev_u32 v184, 65536, v184
v_subrev_u32 v185, 65536, v185
v_subrev_u32 v186, 65536, v186
v_subrev_u32 v187, 65536, v187
s_waitcnt lgkmcnt(0)
s_barrier
ds_read_b64_tr_b16 a[192:193], v180 offset:32768
v_exp_f32 v139, v139
v_mfma_f32_16x16x32_bf16 v[152:155], a[200:203], a[172:175], v[152:155]
ds_read_b64_tr_b16 a[194:195], v180 offset:40960
s_waitcnt vmcnt(4)
s_mov_b32 s34, 68608
buffer_load_dwordx4 v195, s[12:15], s34 offen offset:3072 nt lds
v_mfma_f32_16x16x32_bf16 v[148:151], a[204:207], a[168:171], v[148:151]
ds_read_b64_tr_b16 a[196:197], v181 offset:32768
v_exp_f32 v140, v140
v_mfma_f32_16x16x32_bf16 v[156:159], a[204:207], a[172:175], v[156:159]
ds_read_b64_tr_b16 a[198:199], v181 offset:40960
v_cvt_pk_bf16_f32 v165, v138, v139
s_waitcnt lgkmcnt(6)
v_mfma_f32_16x16x32_bf16 v[144:147], a[208:211], a[176:179], v[144:147]
ds_read_b64_tr_b16 a[200:201], v182 offset:32768
v_exp_f32 v141, v141
v_mfma_f32_16x16x32_bf16 v[152:155], a[208:211], a[180:183], v[152:155]
ds_read_b64_tr_b16 a[202:203], v182 offset:40960
v_mfma_f32_16x16x32_bf16 v[148:151], a[212:215], a[176:179], v[148:151]
ds_read_b64_tr_b16 a[204:205], v183 offset:32768
v_exp_f32 v142, v142
v_mfma_f32_16x16x32_bf16 v[156:159], a[212:215], a[180:183], v[156:159]
ds_read_b64_tr_b16 a[206:207], v183 offset:40960
v_cvt_pk_bf16_f32 v166, v140, v141
s_waitcnt lgkmcnt(8)
v_mfma_f32_16x16x32_bf16 v[144:147], a[216:219], a[184:187], v[144:147]
ds_read_b64_tr_b16 a[208:209], v184 offset:32768
v_exp_f32 v143, v143
v_mfma_f32_16x16x32_bf16 v[152:155], a[216:219], a[188:191], v[152:155]
ds_read_b64_tr_b16 a[210:211], v184 offset:40960
v_mfma_f32_16x16x32_bf16 v[148:151], a[220:223], a[184:187], v[148:151]
ds_read_b64_tr_b16 a[212:213], v185 offset:32768
v_cvt_pk_bf16_f32 v167, v142, v143
v_mfma_f32_16x16x32_bf16 v[156:159], a[220:223], a[188:191], v[156:159]
ds_read_b64_tr_b16 a[214:215], v185 offset:40960
s_waitcnt vmcnt(4)
s_add_u32 m0, s33, 81920
s_mov_b32 s34, 67584
buffer_load_dwordx4 v188, s[8:11], s34 offen offset:0 nt lds
s_nop 0
s_waitcnt lgkmcnt(8)
v_mfma_f32_16x16x32_bf16 v[0:3], a[192:195], v[160:163], 0
ds_read_b64_tr_b16 a[216:217], v186 offset:32768
v_mfma_f32_16x16x32_bf16 v[8:11], a[192:195], v[164:167], 0
ds_read_b64_tr_b16 a[218:219], v186 offset:40960
v_mfma_f32_16x16x32_bf16 a[224:227], a[232:235], v[160:163], 0
v_mfma_f32_16x16x32_bf16 v[4:7], a[196:199], v[160:163], 0
ds_read_b64_tr_b16 a[220:221], v187 offset:32768
v_mfma_f32_16x16x32_bf16 v[12:15], a[196:199], v[164:167], 0
ds_read_b64_tr_b16 a[222:223], v187 offset:40960
v_mfma_f32_16x16x32_bf16 a[228:231], a[232:235], v[164:167], 0
s_waitcnt lgkmcnt(8)
v_mfma_f32_16x16x32_bf16 v[16:19], a[200:203], v[160:163], 0
ds_read_b64_tr_b16 a[192:193], v180 offset:33024
v_mfma_f32_16x16x32_bf16 v[24:27], a[200:203], v[164:167], 0
ds_read_b64_tr_b16 a[194:195], v180 offset:41216
v_mfma_f32_16x16x32_bf16 v[20:23], a[204:207], v[160:163], 0
ds_read_b64_tr_b16 a[196:197], v181 offset:33024
v_mfma_f32_16x16x32_bf16 v[28:31], a[204:207], v[164:167], 0
ds_read_b64_tr_b16 a[198:199], v181 offset:41216
s_waitcnt vmcnt(4)
s_mov_b32 s34, 68608
buffer_load_dwordx4 v189, s[8:11], s34 offen offset:1024 nt lds
s_waitcnt lgkmcnt(8)
v_mfma_f32_16x16x32_bf16 v[32:35], a[208:211], v[160:163], 0
ds_read_b64_tr_b16 a[200:201], v182 offset:33024
v_max3_f32 v208, v144, v145, v146
v_mfma_f32_16x16x32_bf16 v[40:43], a[208:211], v[164:167], 0
ds_read_b64_tr_b16 a[202:203], v182 offset:41216
v_mfma_f32_16x16x32_bf16 v[36:39], a[212:215], v[160:163], 0
ds_read_b64_tr_b16 a[204:205], v183 offset:33024
v_max3_f32 v209, v152, v153, v154
v_mfma_f32_16x16x32_bf16 v[44:47], a[212:215], v[164:167], 0
ds_read_b64_tr_b16 a[206:207], v183 offset:41216
s_waitcnt lgkmcnt(8)
v_mfma_f32_16x16x32_bf16 v[48:51], a[216:219], v[160:163], 0
ds_read_b64_tr_b16 a[208:209], v184 offset:33024
v_max3_f32 v208, v208, v147, v148
v_mfma_f32_16x16x32_bf16 v[56:59], a[216:219], v[164:167], 0
ds_read_b64_tr_b16 a[210:211], v184 offset:41216
v_mfma_f32_16x16x32_bf16 v[52:55], a[220:223], v[160:163], 0
ds_read_b64_tr_b16 a[212:213], v185 offset:33024
v_max3_f32 v209, v209, v155, v156
v_mfma_f32_16x16x32_bf16 v[60:63], a[220:223], v[164:167], 0
ds_read_b64_tr_b16 a[214:215], v185 offset:41216
s_waitcnt lgkmcnt(8)
v_mfma_f32_16x16x32_bf16 v[64:67], a[192:195], v[160:163], 0
ds_read_b64_tr_b16 a[216:217], v186 offset:33024
v_max3_f32 v208, v208, v149, v150
v_mfma_f32_16x16x32_bf16 v[72:75], a[192:195], v[164:167], 0
ds_read_b64_tr_b16 a[218:219], v186 offset:41216
s_waitcnt vmcnt(4)
s_mov_b32 s34, 65536
buffer_load_dwordx4 v190, s[8:11], s34 offen offset:2048 nt lds
v_mfma_f32_16x16x32_bf16 v[68:71], a[196:199], v[160:163], 0
ds_read_b64_tr_b16 a[220:221], v187 offset:33024
v_max3_f32 v209, v209, v157, v158
v_mfma_f32_16x16x32_bf16 v[76:79], a[196:199], v[164:167], 0
ds_read_b64_tr_b16 a[222:223], v187 offset:41216
s_waitcnt lgkmcnt(8)
v_mfma_f32_16x16x32_bf16 v[80:83], a[200:203], v[160:163], 0
v_subrev_u32 v176, 65536, v176
v_subrev_u32 v177, 65536, v177
v_subrev_u32 v178, 65536, v178
v_subrev_u32 v179, 65536, v179
s_waitcnt lgkmcnt(0)
s_barrier
ds_read_b128 a[192:195], v176 offset:49152
v_mfma_f32_16x16x32_bf16 v[88:91], a[200:203], v[164:167], 0
v_max_f32 v208, v208, v151
v_mfma_f32_16x16x32_bf16 v[84:87], a[204:207], v[160:163], 0
ds_read_b128 a[196:199], v176 offset:57344
v_mfma_f32_16x16x32_bf16 v[92:95], a[204:207], v[164:167], 0
v_max_f32 v209, v209, v159
s_waitcnt lgkmcnt(6)
v_mfma_f32_16x16x32_bf16 v[96:99], a[208:211], v[160:163], 0
ds_read_b128 a[200:203], v177 offset:49152
v_mfma_f32_16x16x32_bf16 v[104:107], a[208:211], v[164:167], 0
v_max_f32 v210, v208, v209
s_waitcnt vmcnt(4)
s_mov_b32 s34, 66560
buffer_load_dwordx4 v191, s[8:11], s34 offen offset:3072 nt lds
v_mfma_f32_16x16x32_bf16 v[100:103], a[212:215], v[160:163], 0
ds_read_b128 a[204:207], v177 offset:57344
v_mfma_f32_16x16x32_bf16 v[108:111], a[212:215], v[164:167], 0
v_cmp_lt_f32 vcc, s80, v210
s_waitcnt lgkmcnt(4)
v_mfma_f32_16x16x32_bf16 v[112:115], a[216:219], v[160:163], 0
ds_read_b128 a[208:211], v178 offset:49152
v_mfma_f32_16x16x32_bf16 v[120:123], a[216:219], v[164:167], 0
v_mfma_f32_16x16x32_bf16 v[116:119], a[220:223], v[160:163], 0
ds_read_b128 a[212:215], v178 offset:57344
v_mfma_f32_16x16x32_bf16 v[124:127], a[220:223], v[164:167], 0
s_cbranch_vccz L_nors1
s_call_b64 s[82:83], L_rescale
L_nors1:
s_waitcnt lgkmcnt(4)
v_mfma_f32_16x16x32_bf16 v[128:131], a[192:195], a[128:131], v[168:171]
ds_read_b128 a[216:219], v179 offset:49152
v_exp_f32 v144, v144
v_mfma_f32_16x16x32_bf16 v[136:139], a[192:195], a[132:135], v[172:175]
v_exp_f32 v145, v145
s_lshl_b32 s64, s72, 10
s_lshl_b32 s65, s73, 10
s_lshl_b32 s66, s74, 10
s_lshl_b32 s67, s75, 10
s_lshl_b32 s68, s76, 10
s_lshl_b32 s69, s77, 10
s_lshl_b32 s70, s78, 10
v_mfma_f32_16x16x32_bf16 v[132:135], a[196:199], a[128:131], v[168:171]
ds_read_b128 a[220:223], v179 offset:57344
v_exp_f32 v146, v146
v_mfma_f32_16x16x32_bf16 v[140:143], a[196:199], a[132:135], v[172:175]
v_cvt_pk_bf16_f32 v160, v144, v145
s_waitcnt vmcnt(4)
s_add_u32 m0, s33, 32768
s_mov_b32 s34, 66560
buffer_load_dwordx4 v192, s[12:15], s34 offen offset:0 nt lds
s_waitcnt lgkmcnt(4)
v_mfma_f32_16x16x32_bf16 v[128:131], a[200:203], a[136:139], v[128:131]
ds_read_b128 a[192:195], v176 offset:49408
v_mfma_f32_16x16x32_bf16 v[136:139], a[200:203], a[140:143], v[136:139]
v_exp_f32 v147, v147
v_mfma_f32_16x16x32_bf16 v[132:135], a[204:207], a[136:139], v[132:135]
ds_read_b128 a[196:199], v176 offset:57600
v_exp_f32 v148, v148
v_mfma_f32_16x16x32_bf16 v[140:143], a[204:207], a[140:143], v[140:143]
v_cvt_pk_bf16_f32 v161, v146, v147
s_waitcnt lgkmcnt(4)
v_mfma_f32_16x16x32_bf16 v[128:131], a[208:211], a[144:147], v[128:131]
ds_read_b128 a[200:203], v177 offset:49408
v_mfma_f32_16x16x32_bf16 v[136:139], a[208:211], a[148:151], v[136:139]
v_exp_f32 v149, v149
v_mfma_f32_16x16x32_bf16 v[132:135], a[212:215], a[144:147], v[132:135]
ds_read_b128 a[204:207], v177 offset:57600
v_exp_f32 v150, v150
v_mfma_f32_16x16x32_bf16 v[140:143], a[212:215], a[148:151], v[140:143]
v_cvt_pk_bf16_f32 v162, v148, v149
s_waitcnt vmcnt(4)
s_mov_b32 s34, 65536
buffer_load_dwordx4 v193, s[12:15], s34 offen offset:1024 nt lds
s_waitcnt lgkmcnt(4)
v_mfma_f32_16x16x32_bf16 v[128:131], a[216:219], a[152:155], v[128:131]
ds_read_b128 a[208:211], v178 offset:49408
v_mfma_f32_16x16x32_bf16 v[136:139], a[216:219], a[156:159], v[136:139]
v_exp_f32 v151, v151
v_mfma_f32_16x16x32_bf16 v[132:135], a[220:223], a[152:155], v[132:135]
ds_read_b128 a[212:215], v178 offset:57600
v_exp_f32 v152, v152
v_mfma_f32_16x16x32_bf16 v[140:143], a[220:223], a[156:159], v[140:143]
v_cvt_pk_bf16_f32 v163, v150, v151
s_waitcnt lgkmcnt(4)
v_mfma_f32_16x16x32_bf16 v[128:131], a[192:195], a[160:163], v[128:131]
ds_read_b128 a[216:219], v179 offset:49408
v_mfma_f32_16x16x32_bf16 v[136:139], a[192:195], a[164:167], v[136:139]
v_exp_f32 v153, v153
v_mfma_f32_16x16x32_bf16 v[132:135], a[196:199], a[160:163], v[132:135]
ds_read_b128 a[220:223], v179 offset:57600
v_exp_f32 v154, v154
v_mfma_f32_16x16x32_bf16 v[140:143], a[196:199], a[164:167], v[140:143]
v_cvt_pk_bf16_f32 v164, v152, v153
s_waitcnt lgkmcnt(4)
v_mfma_f32_16x16x32_bf16 v[128:131], a[200:203], a[168:171], v[128:131]
v_add_u32 v180, 65536, v180
v_add_u32 v181, 65536, v181
v_add_u32 v182, 65536, v182
v_add_u32 v183, 65536, v183
v_add_u32 v184, 65536, v184
v_add_u32 v185, 65536, v185
v_add_u32 v186, 65536, v186
v_add_u32 v187, 65536, v187
s_waitcnt lgkmcnt(0)
s_barrier
ds_read_b64_tr_b16 a[192:193], v180 offset:0
v_exp_f32 v155, v155
v_mfma_f32_16x16x32_bf16 v[136:139], a[200:203], a[172:175], v[136:139]
ds_read_b64_tr_b16 a[194:195], v180 offset:8192
s_waitcnt vmcnt(4)
s_mov_b32 s34, 68608
buffer_load_dwordx4 v194, s[12:15], s34 offen offset:2048 nt lds
v_mfma_f32_16x16x32_bf16 v[132:135], a[204:207], a[168:171], v[132:135]
ds_write_b128 v252, a[32:35] offset:49152
ds_read_b64_tr_b16 a[196:197], v181 offset:0
v_exp_f32 v156, v156
v_mfma_f32_16x16x32_bf16 v[140:143], a[204:207], a[172:175], v[140:143]
ds_read_b64_tr_b16 a[198:199], v181 offset:8192
v_cvt_pk_bf16_f32 v165, v154, v155
s_waitcnt lgkmcnt(7)
v_mfma_f32_16x16x32_bf16 v[128:131], a[208:211], a[176:179], v[128:131]
ds_read_b64_tr_b16 a[200:201], v182 offset:0
v_exp_f32 v157, v157
v_mfma_f32_16x16x32_bf16 v[136:139], a[208:211], a[180:183], v[136:139]
ds_read_b64_tr_b16 a[202:203], v182 offset:8192
v_mfma_f32_16x16x32_bf16 v[132:135], a[212:215], a[176:179], v[132:135]
ds_write_b128 v252, a[36:39] offset:50176
ds_read_b64_tr_b16 a[204:205], v183 offset:0
v_exp_f32 v158, v158
v_mfma_f32_16x16x32_bf16 v[140:143], a[212:215], a[180:183], v[140:143]
ds_read_b64_tr_b16 a[206:207], v183 offset:8192
v_cvt_pk_bf16_f32 v166, v156, v157
s_waitcnt lgkmcnt(10)
v_mfma_f32_16x16x32_bf16 v[128:131], a[216:219], a[184:187], v[128:131]
ds_read_b64_tr_b16 a[208:209], v184 offset:0
v_exp_f32 v159, v159
v_mfma_f32_16x16x32_bf16 v[136:139], a[216:219], a[188:191], v[136:139]
ds_read_b64_tr_b16 a[210:211], v184 offset:8192
s_waitcnt vmcnt(4)
s_mov_b32 s34, 67584
buffer_load_dwordx4 v195, s[12:15], s34 offen offset:3072 nt lds
v_mfma_f32_16x16x32_bf16 v[132:135], a[220:223], a[184:187], v[132:135]
ds_write_b128 v252, a[40:43] offset:51200
ds_read_b64_tr_b16 a[212:213], v185 offset:0
v_mfma_f32_16x16x32_bf16 v[140:143], a[220:223], a[188:191], v[140:143]
ds_read_b64_tr_b16 a[214:215], v185 offset:8192
v_cvt_pk_bf16_f32 v167, v158, v159
s_nop 0
s_waitcnt lgkmcnt(10)
v_mfma_f32_16x16x32_bf16 v[0:3], a[192:195], v[160:163], v[0:3]
ds_read_b64_tr_b16 a[216:217], v186 offset:0
v_mfma_f32_16x16x32_bf16 v[8:11], a[192:195], v[164:167], v[8:11]
ds_read_b64_tr_b16 a[218:219], v186 offset:8192
v_mfma_f32_16x16x32_bf16 a[224:227], a[232:235], v[160:163], a[224:227]
v_mfma_f32_16x16x32_bf16 v[4:7], a[196:199], v[160:163], v[4:7]
ds_write_b128 v252, a[44:47] offset:52224
ds_read_b64_tr_b16 a[220:221], v187 offset:0
v_mfma_f32_16x16x32_bf16 v[12:15], a[196:199], v[164:167], v[12:15]
ds_read_b64_tr_b16 a[222:223], v187 offset:8192
v_mfma_f32_16x16x32_bf16 a[228:231], a[232:235], v[164:167], a[228:231]
s_waitcnt lgkmcnt(10)
v_mfma_f32_16x16x32_bf16 v[16:19], a[200:203], v[160:163], v[16:19]
ds_read_b64_tr_b16 a[192:193], v180 offset:256
v_mfma_f32_16x16x32_bf16 v[24:27], a[200:203], v[164:167], v[24:27]
ds_read_b64_tr_b16 a[194:195], v180 offset:8448
v_mfma_f32_16x16x32_bf16 v[20:23], a[204:207], v[160:163], v[20:23]
ds_read_b64_tr_b16 a[196:197], v181 offset:256
v_mfma_f32_16x16x32_bf16 v[28:31], a[204:207], v[164:167], v[28:31]
ds_read_b64_tr_b16 a[198:199], v181 offset:8448
s_waitcnt vmcnt(4)
s_add_u32 m0, s33, 98304
s_mov_b32 s34, 68608
buffer_load_dwordx4 v188, s[8:11], s34 offen offset:0 nt lds
s_waitcnt lgkmcnt(9)
v_mfma_f32_16x16x32_bf16 v[32:35], a[208:211], v[160:163], v[32:35]
ds_read_b64_tr_b16 a[200:201], v182 offset:256
v_max3_f32 v208, v128, v129, v130
v_mfma_f32_16x16x32_bf16 v[40:43], a[208:211], v[164:167], v[40:43]
ds_read_b64_tr_b16 a[202:203], v182 offset:8448
v_mfma_f32_16x16x32_bf16 v[36:39], a[212:215], v[160:163], v[36:39]
ds_read_b64_tr_b16 a[204:205], v183 offset:256
v_max3_f32 v209, v136, v137, v138
v_mfma_f32_16x16x32_bf16 v[44:47], a[212:215], v[164:167], v[44:47]
ds_read_b64_tr_b16 a[206:207], v183 offset:8448
s_waitcnt lgkmcnt(8)
v_mfma_f32_16x16x32_bf16 v[48:51], a[216:219], v[160:163], v[48:51]
ds_read_b64_tr_b16 a[208:209], v184 offset:256
v_max3_f32 v208, v208, v131, v132
v_mfma_f32_16x16x32_bf16 v[56:59], a[216:219], v[164:167], v[56:59]
ds_read_b64_tr_b16 a[210:211], v184 offset:8448
v_mfma_f32_16x16x32_bf16 v[52:55], a[220:223], v[160:163], v[52:55]
ds_read_b64_tr_b16 a[212:213], v185 offset:256
v_max3_f32 v209, v209, v139, v140
v_mfma_f32_16x16x32_bf16 v[60:63], a[220:223], v[164:167], v[60:63]
ds_read_b64_tr_b16 a[214:215], v185 offset:8448
s_waitcnt vmcnt(4)
s_mov_b32 s34, 67584
buffer_load_dwordx4 v189, s[8:11], s34 offen offset:1024 nt lds
s_waitcnt lgkmcnt(8)
v_mfma_f32_16x16x32_bf16 v[64:67], a[192:195], v[160:163], v[64:67]
ds_read_b64_tr_b16 a[216:217], v186 offset:256
v_max3_f32 v208, v208, v133, v134
v_mfma_f32_16x16x32_bf16 v[72:75], a[192:195], v[164:167], v[72:75]
ds_read_b64_tr_b16 a[218:219], v186 offset:8448
v_mfma_f32_16x16x32_bf16 v[68:71], a[196:199], v[160:163], v[68:71]
ds_read_b64_tr_b16 a[220:221], v187 offset:256
v_max3_f32 v209, v209, v141, v142
v_mfma_f32_16x16x32_bf16 v[76:79], a[196:199], v[164:167], v[76:79]
ds_read_b64_tr_b16 a[222:223], v187 offset:8448
s_waitcnt lgkmcnt(8)
v_mfma_f32_16x16x32_bf16 v[80:83], a[200:203], v[160:163], v[80:83]
s_waitcnt lgkmcnt(0)
s_barrier
v_add_u32 v252, 65536, v252
ds_read_b128 a[192:195], v176 offset:49152
v_mfma_f32_16x16x32_bf16 v[88:91], a[200:203], v[164:167], v[88:91]
v_max_f32 v208, v208, v135
v_mfma_f32_16x16x32_bf16 v[84:87], a[204:207], v[160:163], v[84:87]
ds_write_b128 v252, a[48:51] offset:0
v_max_f32 v209, v209, v143
v_mfma_f32_16x16x32_bf16 v[92:95], a[204:207], v[164:167], v[92:95]
ds_read_b128 a[196:199], v176 offset:57344
s_waitcnt lgkmcnt(7)
v_mfma_f32_16x16x32_bf16 v[96:99], a[208:211], v[160:163], v[96:99]
ds_read_b128 a[200:203], v177 offset:49152
v_mfma_f32_16x16x32_bf16 v[104:107], a[208:211], v[164:167], v[104:107]
v_max_f32 v210, v208, v209
s_waitcnt vmcnt(4)
s_mov_b32 s34, 66560
buffer_load_dwordx4 v190, s[8:11], s34 offen offset:2048 nt lds
v_mfma_f32_16x16x32_bf16 v[100:103], a[212:215], v[160:163], v[100:103]
ds_write_b128 v252, a[52:55] offset:1024
v_cmp_lt_f32 vcc, s80, v210
v_mfma_f32_16x16x32_bf16 v[108:111], a[212:215], v[164:167], v[108:111]
ds_read_b128 a[204:207], v177 offset:57344
s_waitcnt lgkmcnt(6)
v_mfma_f32_16x16x32_bf16 v[112:115], a[216:219], v[160:163], v[112:115]
ds_read_b128 a[208:211], v178 offset:49152
v_mfma_f32_16x16x32_bf16 v[120:123], a[216:219], v[164:167], v[120:123]
v_mfma_f32_16x16x32_bf16 v[116:119], a[220:223], v[160:163], v[116:119]
ds_write_b128 v252, a[56:59] offset:2048
v_mfma_f32_16x16x32_bf16 v[124:127], a[220:223], v[164:167], v[124:127]
ds_read_b128 a[212:215], v178 offset:57344
s_cbranch_vccz L_nors2
s_call_b64 s[82:83], L_rescale
L_nors2:
s_waitcnt lgkmcnt(6)
v_mfma_f32_16x16x32_bf16 v[144:147], a[192:195], a[128:131], v[168:171]
ds_read_b128 a[216:219], v179 offset:49152
v_exp_f32 v128, v128
v_mfma_f32_16x16x32_bf16 v[152:155], a[192:195], a[132:135], v[172:175]
v_exp_f32 v129, v129
s_waitcnt vmcnt(4)
s_mov_b32 s34, 65536
buffer_load_dwordx4 v191, s[8:11], s34 offen offset:3072 nt lds
v_mfma_f32_16x16x32_bf16 v[148:151], a[196:199], a[128:131], v[168:171]
ds_write_b128 v252, a[60:63] offset:3072
v_exp_f32 v130, v130
v_mfma_f32_16x16x32_bf16 v[156:159], a[196:199], a[132:135], v[172:175]
ds_read_b128 a[220:223], v179 offset:57344
v_cvt_pk_bf16_f32 v160, v128, v129
s_waitcnt lgkmcnt(6)
v_mfma_f32_16x16x32_bf16 v[144:147], a[200:203], a[136:139], v[144:147]
ds_read_b128 a[192:195], v176 offset:49408
v_mfma_f32_16x16x32_bf16 v[152:155], a[200:203], a[140:143], v[152:155]
v_exp_f32 v131, v131
v_mfma_f32_16x16x32_bf16 v[148:151], a[204:207], a[136:139], v[148:151]
ds_read_b128 a[196:199], v176 offset:57600
v_exp_f32 v132, v132
v_mfma_f32_16x16x32_bf16 v[156:159], a[204:207], a[140:143], v[156:159]
v_cvt_pk_bf16_f32 v161, v130, v131
s_waitcnt lgkmcnt(5)
v_mfma_f32_16x16x32_bf16 v[144:147], a[208:211], a[144:147], v[144:147]
ds_read_b128 a[200:203], v177 offset:49408
v_mfma_f32_16x16x32_bf16 v[152:155], a[208:211], a[148:151], v[152:155]
v_exp_f32 v133, v133
v_mfma_f32_16x16x32_bf16 v[148:151], a[212:215], a[144:147], v[148:151]
ds_read_b128 a[204:207], v177 offset:57600
v_exp_f32 v134, v134
v_mfma_f32_16x16x32_bf16 v[156:159], a[212:215], a[148:151], v[156:159]
v_cvt_pk_bf16_f32 v162, v132, v133
s_waitcnt vmcnt(4)
s_add_u32 m0, s33, 114688
s_mov_b32 s34, 67584
buffer_load_dwordx4 v192, s[12:15], s34 offen offset:0 nt lds
s_waitcnt lgkmcnt(4)
v_mfma_f32_16x16x32_bf16 v[144:147], a[216:219], a[152:155], v[144:147]
ds_read_b128 a[208:211], v178 offset:49408
v_mfma_f32_16x16x32_bf16 v[152:155], a[216:219], a[156:159], v[152:155]
v_exp_f32 v135, v135
v_mfma_f32_16x16x32_bf16 v[148:151], a[220:223], a[152:155], v[148:151]
ds_read_b128 a[212:215], v178 offset:57600
v_exp_f32 v136, v136
v_mfma_f32_16x16x32_bf16 v[156:159], a[220:223], a[156:159], v[156:159]
v_cvt_pk_bf16_f32 v163, v134, v135
s_waitcnt lgkmcnt(4)
v_mfma_f32_16x16x32_bf16 v[144:147], a[192:195], a[160:163], v[144:147]
ds_read_b128 a[216:219], v179 offset:49408
v_mfma_f32_16x16x32_bf16 v[152:155], a[192:195], a[164:167], v[152:155]
v_exp_f32 v137, v137
v_mfma_f32_16x16x32_bf16 v[148:151], a[196:199], a[160:163], v[148:151]
ds_read_b128 a[220:223], v179 offset:57600
v_exp_f32 v138, v138
v_mfma_f32_16x16x32_bf16 v[156:159], a[196:199], a[164:167], v[156:159]
v_cvt_pk_bf16_f32 v164, v136, v137
s_waitcnt vmcnt(4)
s_mov_b32 s34, 68608
buffer_load_dwordx4 v193, s[12:15], s34 offen offset:1024 nt lds
s_waitcnt lgkmcnt(4)
v_mfma_f32_16x16x32_bf16 v[144:147], a[200:203], a[168:171], v[144:147]
s_waitcnt lgkmcnt(0)
s_barrier
v_subrev_u32 v252, 65536, v252
ds_read_b64_tr_b16 a[192:193], v180 offset:0
v_exp_f32 v139, v139
v_mfma_f32_16x16x32_bf16 v[152:155], a[200:203], a[172:175], v[152:155]
ds_read_b64_tr_b16 a[194:195], v180 offset:8192
v_mfma_f32_16x16x32_bf16 v[148:151], a[204:207], a[168:171], v[148:151]
ds_write_b128 v252, a[64:67] offset:49152
ds_read_b64_tr_b16 a[196:197], v181 offset:0
v_exp_f32 v140, v140
v_mfma_f32_16x16x32_bf16 v[156:159], a[204:207], a[172:175], v[156:159]
ds_read_b64_tr_b16 a[198:199], v181 offset:8192
v_cvt_pk_bf16_f32 v165, v138, v139
s_waitcnt lgkmcnt(7)
v_mfma_f32_16x16x32_bf16 v[144:147], a[208:211], a[176:179], v[144:147]
ds_read_b64_tr_b16 a[200:201], v182 offset:0
v_exp_f32 v141, v141
v_mfma_f32_16x16x32_bf16 v[152:155], a[208:211], a[180:183], v[152:155]
ds_read_b64_tr_b16 a[202:203], v182 offset:8192
v_mfma_f32_16x16x32_bf16 v[148:151], a[212:215], a[176:179], v[148:151]
ds_write_b128 v252, a[68:71] offset:50176
ds_read_b64_tr_b16 a[204:205], v183 offset:0
v_exp_f32 v142, v142
v_mfma_f32_16x16x32_bf16 v[156:159], a[212:215], a[180:183], v[156:159]
ds_read_b64_tr_b16 a[206:207], v183 offset:8192
v_cvt_pk_bf16_f32 v166, v140, v141
s_waitcnt lgkmcnt(10)
v_mfma_f32_16x16x32_bf16 v[144:147], a[216:219], a[184:187], v[144:147]
ds_read_b64_tr_b16 a[208:209], v184 offset:0
v_exp_f32 v143, v143
v_mfma_f32_16x16x32_bf16 v[152:155], a[216:219], a[188:191], v[152:155]
ds_read_b64_tr_b16 a[210:211], v184 offset:8192
s_waitcnt vmcnt(4)
s_mov_b32 s34, 65536
buffer_load_dwordx4 v194, s[12:15], s34 offen offset:2048 nt lds
v_mfma_f32_16x16x32_bf16 v[148:151], a[220:223], a[184:187], v[148:151]
ds_write_b128 v252, a[72:75] offset:51200
ds_read_b64_tr_b16 a[212:213], v185 offset:0
v_mfma_f32_16x16x32_bf16 v[156:159], a[220:223], a[188:191], v[156:159]
ds_read_b64_tr_b16 a[214:215], v185 offset:8192
v_cvt_pk_bf16_f32 v167, v142, v143
s_nop 0
s_waitcnt lgkmcnt(10)
v_mfma_f32_16x16x32_bf16 v[0:3], a[192:195], v[160:163], v[0:3]
ds_read_b64_tr_b16 a[216:217], v186 offset:0
v_mfma_f32_16x16x32_bf16 v[8:11], a[192:195], v[164:167], v[8:11]
ds_read_b64_tr_b16 a[218:219], v186 offset:8192
v_mfma_f32_16x16x32_bf16 a[224:227], a[232:235], v[160:163], a[224:227]
v_mfma_f32_16x16x32_bf16 v[4:7], a[196:199], v[160:163], v[4:7]
ds_write_b128 v252, a[76:79] offset:52224
ds_read_b64_tr_b16 a[220:221], v187 offset:0
v_mfma_f32_16x16x32_bf16 v[12:15], a[196:199], v[164:167], v[12:15]
ds_read_b64_tr_b16 a[222:223], v187 offset:8192
v_mfma_f32_16x16x32_bf16 a[228:231], a[232:235], v[164:167], a[228:231]
s_waitcnt lgkmcnt(10)
v_mfma_f32_16x16x32_bf16 v[16:19], a[200:203], v[160:163], v[16:19]
ds_read_b64_tr_b16 a[192:193], v180 offset:256
v_mfma_f32_16x16x32_bf16 v[24:27], a[200:203], v[164:167], v[24:27]
ds_read_b64_tr_b16 a[194:195], v180 offset:8448
s_waitcnt vmcnt(4)
s_mov_b32 s34, 66560
buffer_load_dwordx4 v195, s[12:15], s34 offen offset:3072 nt lds
v_mfma_f32_16x16x32_bf16 v[20:23], a[204:207], v[160:163], v[20:23]
ds_read_b64_tr_b16 a[196:197], v181 offset:256
v_mfma_f32_16x16x32_bf16 v[28:31], a[204:207], v[164:167], v[28:31]
ds_read_b64_tr_b16 a[198:199], v181 offset:8448
s_waitcnt lgkmcnt(9)
v_mfma_f32_16x16x32_bf16 v[32:35], a[208:211], v[160:163], v[32:35]
ds_read_b64_tr_b16 a[200:201], v182 offset:256
v_max3_f32 v208, v144, v145, v146
v_mfma_f32_16x16x32_bf16 v[40:43], a[208:211], v[164:167], v[40:43]
ds_read_b64_tr_b16 a[202:203], v182 offset:8448
v_mfma_f32_16x16x32_bf16 v[36:39], a[212:215], v[160:163], v[36:39]
ds_read_b64_tr_b16 a[204:205], v183 offset:256
v_max3_f32 v209, v152, v153, v154
v_mfma_f32_16x16x32_bf16 v[44:47], a[212:215], v[164:167], v[44:47]
ds_read_b64_tr_b16 a[206:207], v183 offset:8448
s_waitcnt lgkmcnt(8)
v_mfma_f32_16x16x32_bf16 v[48:51], a[216:219], v[160:163], v[48:51]
ds_read_b64_tr_b16 a[208:209], v184 offset:256
v_max3_f32 v208, v208, v147, v148
v_mfma_f32_16x16x32_bf16 v[56:59], a[216:219], v[164:167], v[56:59]
ds_read_b64_tr_b16 a[210:211], v184 offset:8448
v_mfma_f32_16x16x32_bf16 v[52:55], a[220:223], v[160:163], v[52:55]
ds_read_b64_tr_b16 a[212:213], v185 offset:256
v_max3_f32 v209, v209, v155, v156
v_mfma_f32_16x16x32_bf16 v[60:63], a[220:223], v[164:167], v[60:63]
ds_read_b64_tr_b16 a[214:215], v185 offset:8448
s_waitcnt vmcnt(4)
s_add_u32 m0, s33, 131072
s_mov_b32 s34, 131072
buffer_load_dwordx4 v188, s[8:11], s34 offen offset:0 nt lds
s_waitcnt lgkmcnt(8)
v_mfma_f32_16x16x32_bf16 v[64:67], a[192:195], v[160:163], v[64:67]
ds_read_b64_tr_b16 a[216:217], v186 offset:256
v_max3_f32 v208, v208, v149, v150
v_mfma_f32_16x16x32_bf16 v[72:75], a[192:195], v[164:167], v[72:75]
ds_read_b64_tr_b16 a[218:219], v186 offset:8448
v_mfma_f32_16x16x32_bf16 v[68:71], a[196:199], v[160:163], v[68:71]
ds_read_b64_tr_b16 a[220:221], v187 offset:256
v_max3_f32 v209, v209, v157, v158
v_mfma_f32_16x16x32_bf16 v[76:79], a[196:199], v[164:167], v[76:79]
ds_read_b64_tr_b16 a[222:223], v187 offset:8448
s_waitcnt lgkmcnt(8)
v_mfma_f32_16x16x32_bf16 v[80:83], a[200:203], v[160:163], v[80:83]
s_waitcnt lgkmcnt(0)
s_barrier
v_add_u32 v252, 65536, v252
ds_read_b128 a[192:195], v176 offset:49152
v_mfma_f32_16x16x32_bf16 v[88:91], a[200:203], v[164:167], v[88:91]
v_max_f32 v208, v208, v151
v_mfma_f32_16x16x32_bf16 v[84:87], a[204:207], v[160:163], v[84:87]
ds_write_b128 v252, a[80:83] offset:0
v_max_f32 v209, v209, v159
v_mfma_f32_16x16x32_bf16 v[92:95], a[204:207], v[164:167], v[92:95]
ds_read_b128 a[196:199], v176 offset:57344
s_waitcnt vmcnt(4)
s_mov_b32 s34, 132096
buffer_load_dwordx4 v189, s[8:11], s34 offen offset:1024 nt lds
s_waitcnt lgkmcnt(7)
v_mfma_f32_16x16x32_bf16 v[96:99], a[208:211], v[160:163], v[96:99]
ds_read_b128 a[200:203], v177 offset:49152
v_mfma_f32_16x16x32_bf16 v[104:107], a[208:211], v[164:167], v[104:107]
v_max_f32 v210, v208, v209
v_mfma_f32_16x16x32_bf16 v[100:103], a[212:215], v[160:163], v[100:103]
ds_write_b128 v252, a[84:87] offset:1024
v_cmp_lt_f32 vcc, s80, v210
v_mfma_f32_16x16x32_bf16 v[108:111], a[212:215], v[164:167], v[108:111]
ds_read_b128 a[204:207], v177 offset:57344
s_waitcnt lgkmcnt(6)
v_mfma_f32_16x16x32_bf16 v[112:115], a[216:219], v[160:163], v[112:115]
ds_read_b128 a[208:211], v178 offset:49152
v_mfma_f32_16x16x32_bf16 v[120:123], a[216:219], v[164:167], v[120:123]
v_mfma_f32_16x16x32_bf16 v[116:119], a[220:223], v[160:163], v[116:119]
ds_write_b128 v252, a[88:91] offset:2048
v_mfma_f32_16x16x32_bf16 v[124:127], a[220:223], v[164:167], v[124:127]
ds_read_b128 a[212:215], v178 offset:57344
s_cbranch_vccz L_nors3
s_call_b64 s[82:83], L_rescale
L_nors3:
s_waitcnt lgkmcnt(6)
v_mfma_f32_16x16x32_bf16 v[128:131], a[192:195], a[128:131], v[168:171]
ds_read_b128 a[216:219], v179 offset:49152
v_exp_f32 v144, v144
v_mfma_f32_16x16x32_bf16 v[136:139], a[192:195], a[132:135], v[172:175]
v_exp_f32 v145, v145
s_waitcnt vmcnt(4)
s_mov_b32 s34, 133120
buffer_load_dwordx4 v190, s[8:11], s34 offen offset:2048 nt lds
v_mfma_f32_16x16x32_bf16 v[132:135], a[196:199], a[128:131], v[168:171]
ds_write_b128 v252, a[92:95] offset:3072
v_exp_f32 v146, v146
v_mfma_f32_16x16x32_bf16 v[140:143], a[196:199], a[132:135], v[172:175]
ds_read_b128 a[220:223], v179 offset:57344
v_cvt_pk_bf16_f32 v160, v144, v145
s_waitcnt lgkmcnt(6)
v_mfma_f32_16x16x32_bf16 v[128:131], a[200:203], a[136:139], v[128:131]
ds_read_b128 a[192:195], v176 offset:49408
v_mfma_f32_16x16x32_bf16 v[136:139], a[200:203], a[140:143], v[136:139]
v_exp_f32 v147, v147
v_mfma_f32_16x16x32_bf16 v[132:135], a[204:207], a[136:139], v[132:135]
ds_read_b128 a[196:199], v176 offset:57600
v_exp_f32 v148, v148
v_mfma_f32_16x16x32_bf16 v[140:143], a[204:207], a[140:143], v[140:143]
v_cvt_pk_bf16_f32 v161, v146, v147
s_waitcnt lgkmcnt(5)
v_mfma_f32_16x16x32_bf16 v[128:131], a[208:211], a[144:147], v[128:131]
ds_read_b128 a[200:203], v177 offset:49408
v_mfma_f32_16x16x32_bf16 v[136:139], a[208:211], a[148:151], v[136:139]
v_exp_f32 v149, v149
s_waitcnt vmcnt(4)
s_mov_b32 s34, 134144
buffer_load_dwordx4 v191, s[8:11], s34 offen offset:3072 nt lds
v_mfma_f32_16x16x32_bf16 v[132:135], a[212:215], a[144:147], v[132:135]
ds_read_b128 a[204:207], v177 offset:57600
v_exp_f32 v150, v150
v_mfma_f32_16x16x32_bf16 v[140:143], a[212:215], a[148:151], v[140:143]
v_cvt_pk_bf16_f32 v162, v148, v149
s_waitcnt lgkmcnt(4)
v_mfma_f32_16x16x32_bf16 v[128:131], a[216:219], a[152:155], v[128:131]
ds_read_b128 a[208:211], v178 offset:49408
v_mfma_f32_16x16x32_bf16 v[136:139], a[216:219], a[156:159], v[136:139]
v_exp_f32 v151, v151
v_mfma_f32_16x16x32_bf16 v[132:135], a[220:223], a[152:155], v[132:135]
ds_read_b128 a[212:215], v178 offset:57600
v_exp_f32 v152, v152
v_mfma_f32_16x16x32_bf16 v[140:143], a[220:223], a[156:159], v[140:143]
v_cvt_pk_bf16_f32 v163, v150, v151
s_waitcnt lgkmcnt(4)
v_mfma_f32_16x16x32_bf16 v[128:131], a[192:195], a[160:163], v[128:131]
ds_read_b128 a[216:219], v179 offset:49408
v_mfma_f32_16x16x32_bf16 v[136:139], a[192:195], a[164:167], v[136:139]
v_exp_f32 v153, v153
v_mfma_f32_16x16x32_bf16 v[132:135], a[196:199], a[160:163], v[132:135]
ds_read_b128 a[220:223], v179 offset:57600
v_exp_f32 v154, v154
v_mfma_f32_16x16x32_bf16 v[140:143], a[196:199], a[164:167], v[140:143]
v_cvt_pk_bf16_f32 v164, v152, v153
s_waitcnt vmcnt(4)
s_add_u32 m0, s33, 147456
s_mov_b32 s34, 68608
buffer_load_dwordx4 v192, s[12:15], s34 offen offset:0 nt lds
s_waitcnt lgkmcnt(4)
v_mfma_f32_16x16x32_bf16 v[128:131], a[200:203], a[168:171], v[128:131]
s_waitcnt lgkmcnt(0)
s_barrier
ds_read_b64_tr_b16 a[192:193], v180 offset:0
v_exp_f32 v155, v155
v_mfma_f32_16x16x32_bf16 v[136:139], a[200:203], a[172:175], v[136:139]
ds_read_b64_tr_b16 a[194:195], v180 offset:8192
v_mfma_f32_16x16x32_bf16 v[132:135], a[204:207], a[168:171], v[132:135]
ds_read_b64_tr_b16 a[196:197], v181 offset:0
v_exp_f32 v156, v156
v_mfma_f32_16x16x32_bf16 v[140:143], a[204:207], a[172:175], v[140:143]
ds_read_b64_tr_b16 a[198:199], v181 offset:8192
v_cvt_pk_bf16_f32 v165, v154, v155
s_waitcnt lgkmcnt(6)
v_mfma_f32_16x16x32_bf16 v[128:131], a[208:211], a[176:179], v[128:131]
ds_read_b64_tr_b16 a[200:201], v182 offset:0
v_exp_f32 v157, v157
v_mfma_f32_16x16x32_bf16 v[136:139], a[208:211], a[180:183], v[136:139]
ds_read_b64_tr_b16 a[202:203], v182 offset:8192
v_mfma_f32_16x16x32_bf16 v[132:135], a[212:215], a[176:179], v[132:135]
ds_read_b64_tr_b16 a[204:205], v183 offset:0
v_exp_f32 v158, v158
v_mfma_f32_16x16x32_bf16 v[140:143], a[212:215], a[180:183], v[140:143]
ds_read_b64_tr_b16 a[206:207], v183 offset:8192
v_cvt_pk_bf16_f32 v166, v156, v157
s_waitcnt vmcnt(4)
s_mov_b32 s34, 67584
buffer_load_dwordx4 v193, s[12:15], s34 offen offset:1024 nt lds
s_waitcnt lgkmcnt(8)
v_mfma_f32_16x16x32_bf16 v[128:131], a[216:219], a[184:187], v[128:131]
ds_read_b64_tr_b16 a[208:209], v184 offset:0
v_exp_f32 v159, v159
v_mfma_f32_16x16x32_bf16 v[136:139], a[216:219], a[188:191], v[136:139]
ds_read_b64_tr_b16 a[210:211], v184 offset:8192
v_mfma_f32_16x16x32_bf16 v[132:135], a[220:223], a[184:187], v[132:135]
ds_read_b64_tr_b16 a[212:213], v185 offset:0
v_cvt_pk_bf16_f32 v167, v158, v159
v_mfma_f32_16x16x32_bf16 v[140:143], a[220:223], a[188:191], v[140:143]
ds_read_b64_tr_b16 a[214:215], v185 offset:8192
s_nop 0
s_waitcnt lgkmcnt(8)
v_mfma_f32_16x16x32_bf16 v[0:3], a[192:195], v[160:163], v[0:3]
ds_read_b64_tr_b16 a[216:217], v186 offset:0
v_mfma_f32_16x16x32_bf16 v[8:11], a[192:195], v[164:167], v[8:11]
ds_read_b64_tr_b16 a[218:219], v186 offset:8192
v_mfma_f32_16x16x32_bf16 a[224:227], a[232:235], v[160:163], a[224:227]
v_mfma_f32_16x16x32_bf16 v[4:7], a[196:199], v[160:163], v[4:7]
ds_read_b64_tr_b16 a[220:221], v187 offset:0
v_mfma_f32_16x16x32_bf16 v[12:15], a[196:199], v[164:167], v[12:15]
ds_read_b64_tr_b16 a[222:223], v187 offset:8192
v_mfma_f32_16x16x32_bf16 a[228:231], a[232:235], v[164:167], a[228:231]
s_waitcnt lgkmcnt(8)
v_mfma_f32_16x16x32_bf16 v[16:19], a[200:203], v[160:163], v[16:19]
ds_read_b64_tr_b16 a[192:193], v180 offset:256
v_mfma_f32_16x16x32_bf16 v[24:27], a[200:203], v[164:167], v[24:27]
ds_read_b64_tr_b16 a[194:195], v180 offset:8448
s_waitcnt vmcnt(4)
s_mov_b32 s34, 66560
buffer_load_dwordx4 v194, s[12:15], s34 offen offset:2048 nt lds
v_mfma_f32_16x16x32_bf16 v[20:23], a[204:207], v[160:163], v[20:23]
ds_read_b64_tr_b16 a[196:197], v181 offset:256
v_mfma_f32_16x16x32_bf16 v[28:31], a[204:207], v[164:167], v[28:31]
ds_read_b64_tr_b16 a[198:199], v181 offset:8448
s_waitcnt lgkmcnt(8)
v_mfma_f32_16x16x32_bf16 v[32:35], a[208:211], v[160:163], v[32:35]
ds_read_b64_tr_b16 a[200:201], v182 offset:256
v_max3_f32 v208, v128, v129, v130
v_mfma_f32_16x16x32_bf16 v[40:43], a[208:211], v[164:167], v[40:43]
ds_read_b64_tr_b16 a[202:203], v182 offset:8448
v_mfma_f32_16x16x32_bf16 v[36:39], a[212:215], v[160:163], v[36:39]
ds_read_b64_tr_b16 a[204:205], v183 offset:256
v_max3_f32 v209, v136, v137, v138
v_mfma_f32_16x16x32_bf16 v[44:47], a[212:215], v[164:167], v[44:47]
ds_read_b64_tr_b16 a[206:207], v183 offset:8448
s_waitcnt lgkmcnt(8)
v_mfma_f32_16x16x32_bf16 v[48:51], a[216:219], v[160:163], v[48:51]
ds_read_b64_tr_b16 a[208:209], v184 offset:256
v_max3_f32 v208, v208, v131, v132
v_mfma_f32_16x16x32_bf16 v[56:59], a[216:219], v[164:167], v[56:59]
ds_read_b64_tr_b16 a[210:211], v184 offset:8448
s_waitcnt vmcnt(4)
s_mov_b32 s34, 65536
buffer_load_dwordx4 v195, s[12:15], s34 offen offset:3072 nt lds
v_mfma_f32_16x16x32_bf16 v[52:55], a[220:223], v[160:163], v[52:55]
ds_read_b64_tr_b16 a[212:213], v185 offset:256
v_max3_f32 v209, v209, v139, v140
v_mfma_f32_16x16x32_bf16 v[60:63], a[220:223], v[164:167], v[60:63]
ds_read_b64_tr_b16 a[214:215], v185 offset:8448
s_waitcnt lgkmcnt(8)
v_mfma_f32_16x16x32_bf16 v[64:67], a[192:195], v[160:163], v[64:67]
ds_read_b64_tr_b16 a[216:217], v186 offset:256
v_max3_f32 v208, v208, v133, v134
v_mfma_f32_16x16x32_bf16 v[72:75], a[192:195], v[164:167], v[72:75]
ds_read_b64_tr_b16 a[218:219], v186 offset:8448
v_mfma_f32_16x16x32_bf16 v[68:71], a[196:199], v[160:163], v[68:71]
ds_read_b64_tr_b16 a[220:221], v187 offset:256
v_max3_f32 v209, v209, v141, v142
v_mfma_f32_16x16x32_bf16 v[76:79], a[196:199], v[164:167], v[76:79]
ds_read_b64_tr_b16 a[222:223], v187 offset:8448
s_waitcnt lgkmcnt(8)
v_mfma_f32_16x16x32_bf16 v[80:83], a[200:203], v[160:163], v[80:83]
s_waitcnt lgkmcnt(0)
s_barrier
ds_read_b128 a[192:195], v176 offset:16384
v_mfma_f32_16x16x32_bf16 v[88:91], a[200:203], v[164:167], v[88:91]
v_max_f32 v208, v208, v135
v_mfma_f32_16x16x32_bf16 v[84:87], a[204:207], v[160:163], v[84:87]
ds_read_b128 a[196:199], v176 offset:24576
v_mfma_f32_16x16x32_bf16 v[92:95], a[204:207], v[164:167], v[92:95]
v_max_f32 v209, v209, v143
s_waitcnt vmcnt(4)
s_add_u32 m0, s33, 49152
s_mov_b32 s34, 132096
buffer_load_dwordx4 v188, s[8:11], s34 offen offset:0 nt lds
s_waitcnt lgkmcnt(6)
v_mfma_f32_16x16x32_bf16 v[96:99], a[208:211], v[160:163], v[96:99]
ds_read_b128 a[200:203], v177 offset:16384
v_mfma_f32_16x16x32_bf16 v[104:107], a[208:211], v[164:167], v[104:107]
v_max_f32 v210, v208, v209
s_add_u32 m0, s33, 65536
s_lshl_b32 s71, s72, 7
buffer_load_dwordx4 v196, s[24:27], s71 offen offset:0  lds
v_mfma_f32_16x16x32_bf16 v[100:103], a[212:215], v[160:163], v[100:103]
ds_read_b128 a[204:207], v177 offset:24576
v_mfma_f32_16x16x32_bf16 v[108:111], a[212:215], v[164:167], v[108:111]
v_cmp_lt_f32 vcc, s80, v210
s_waitcnt lgkmcnt(4)
v_mfma_f32_16x16x32_bf16 v[112:115], a[216:219], v[160:163], v[112:115]
ds_read_b128 a[208:211], v178 offset:16384
v_mfma_f32_16x16x32_bf16 v[120:123], a[216:219], v[164:167], v[120:123]
v_mfma_f32_16x16x32_bf16 v[116:119], a[220:223], v[160:163], v[116:119]
ds_read_b128 a[212:215], v178 offset:24576
v_mfma_f32_16x16x32_bf16 v[124:127], a[220:223], v[164:167], v[124:127]
s_waitcnt vmcnt(5)
s_add_u32 m0, s33, 49152
s_mov_b32 s34, 131072
buffer_load_dwordx4 v189, s[8:11], s34 offen offset:1024 nt lds
s_cbranch_vccz L_nors4
s_call_b64 s[82:83], L_rescale
L_nors4:
s_waitcnt lgkmcnt(4)
v_mfma_f32_16x16x32_bf16 v[144:147], a[192:195], a[128:131], v[168:171]
ds_read_b128 a[216:219], v179 offset:16384
v_exp_f32 v128, v128
v_mfma_f32_16x16x32_bf16 v[152:155], a[192:195], a[132:135], v[172:175]
v_exp_f32 v129, v129
v_mfma_f32_16x16x32_bf16 v[148:151], a[196:199], a[128:131], v[168:171]
ds_read_b128 a[220:223], v179 offset:24576
v_exp_f32 v130, v130
v_mfma_f32_16x16x32_bf16 v[156:159], a[196:199], a[132:135], v[172:175]
v_cvt_pk_bf16_f32 v160, v128, v129
s_waitcnt lgkmcnt(4)
v_mfma_f32_16x16x32_bf16 v[144:147], a[200:203], a[136:139], v[144:147]
ds_read_b128 a[192:195], v176 offset:16640
v_mfma_f32_16x16x32_bf16 v[152:155], a[200:203], a[140:143], v[152:155]
v_exp_f32 v131, v131
v_mfma_f32_16x16x32_bf16 v[148:151], a[204:207], a[136:139], v[148:151]
ds_read_b128 a[196:199], v176 offset:24832
v_exp_f32 v132, v132
v_mfma_f32_16x16x32_bf16 v[156:159], a[204:207], a[140:143], v[156:159]
v_cvt_pk_bf16_f32 v161, v130, v131
s_waitcnt lgkmcnt(4)
v_mfma_f32_16x16x32_bf16 v[144:147], a[208:211], a[144:147], v[144:147]
ds_read_b128 a[200:203], v177 offset:16640
v_mfma_f32_16x16x32_bf16 v[152:155], a[208:211], a[148:151], v[152:155]
v_exp_f32 v133, v133
s_waitcnt vmcnt(5)
s_mov_b32 s34, 134144
buffer_load_dwordx4 v190, s[8:11], s34 offen offset:2048 nt lds
v_mfma_f32_16x16x32_bf16 v[148:151], a[212:215], a[144:147], v[148:151]
ds_read_b128 a[204:207], v177 offset:24832
v_exp_f32 v134, v134
v_mfma_f32_16x16x32_bf16 v[156:159], a[212:215], a[148:151], v[156:159]
v_cvt_pk_bf16_f32 v162, v132, v133
s_waitcnt lgkmcnt(4)
v_mfma_f32_16x16x32_bf16 v[144:147], a[216:219], a[152:155], v[144:147]
ds_read_b128 a[208:211], v178 offset:16640
v_mfma_f32_16x16x32_bf16 v[152:155], a[216:219], a[156:159], v[152:155]
v_exp_f32 v135, v135
v_mfma_f32_16x16x32_bf16 v[148:151], a[220:223], a[152:155], v[148:151]
ds_read_b128 a[212:215], v178 offset:24832
v_exp_f32 v136, v136
v_mfma_f32_16x16x32_bf16 v[156:159], a[220:223], a[156:159], v[156:159]
v_cvt_pk_bf16_f32 v163, v134, v135
s_waitcnt lgkmcnt(4)
v_mfma_f32_16x16x32_bf16 v[144:147], a[192:195], a[160:163], v[144:147]
ds_read_b128 a[216:219], v179 offset:16640
v_mfma_f32_16x16x32_bf16 v[152:155], a[192:195], a[164:167], v[152:155]
v_exp_f32 v137, v137
s_waitcnt vmcnt(5)
s_mov_b32 s34, 133120
buffer_load_dwordx4 v191, s[8:11], s34 offen offset:3072 nt lds
s_add_u32 m0, s33, 65536
s_lshl_b32 s71, s72, 7
buffer_load_dwordx4 v197, s[24:27], s71 offen offset:1024  lds
v_mfma_f32_16x16x32_bf16 v[148:151], a[196:199], a[160:163], v[148:151]
ds_read_b128 a[220:223], v179 offset:24832
v_exp_f32 v138, v138
v_mfma_f32_16x16x32_bf16 v[156:159], a[196:199], a[164:167], v[156:159]
v_cvt_pk_bf16_f32 v164, v136, v137
s_waitcnt lgkmcnt(4)
v_mfma_f32_16x16x32_bf16 v[144:147], a[200:203], a[168:171], v[144:147]
v_subrev_u32 v180, 65536, v180
v_subrev_u32 v181, 65536, v181
v_subrev_u32 v182, 65536, v182
v_subrev_u32 v183, 65536, v183
v_subrev_u32 v184, 65536, v184
v_subrev_u32 v185, 65536, v185
v_subrev_u32 v186, 65536, v186
v_subrev_u32 v187, 65536, v187
s_waitcnt lgkmcnt(0)
s_barrier
ds_read_b64_tr_b16 a[192:193], v180 offset:0
v_exp_f32 v139, v139
v_mfma_f32_16x16x32_bf16 v[152:155], a[200:203], a[172:175], v[152:155]
ds_read_b64_tr_b16 a[194:195], v180 offset:8192
v_mfma_f32_16x16x32_bf16 v[148:151], a[204:207], a[168:171], v[148:151]
ds_read_b64_tr_b16 a[196:197], v181 offset:0
v_exp_f32 v140, v140
v_mfma_f32_16x16x32_bf16 v[156:159], a[204:207], a[172:175], v[156:159]
ds_read_b64_tr_b16 a[198:199], v181 offset:8192
v_cvt_pk_bf16_f32 v165, v138, v139
s_waitcnt lgkmcnt(6)
v_mfma_f32_16x16x32_bf16 v[144:147], a[208:211], a[176:179], v[144:147]
ds_read_b64_tr_b16 a[200:201], v182 offset:0
v_exp_f32 v141, v141
v_mfma_f32_16x16x32_bf16 v[152:155], a[208:211], a[180:183], v[152:155]
ds_read_b64_tr_b16 a[202:203], v182 offset:8192
v_mfma_f32_16x16x32_bf16 v[148:151], a[212:215], a[176:179], v[148:151]
ds_read_b64_tr_b16 a[204:205], v183 offset:0
v_exp_f32 v142, v142
v_mfma_f32_16x16x32_bf16 v[156:159], a[212:215], a[180:183], v[156:159]
ds_read_b64_tr_b16 a[206:207], v183 offset:8192
v_cvt_pk_bf16_f32 v166, v140, v141
s_waitcnt vmcnt(6)
s_add_u32 m0, s33, 16384
s_mov_b32 s34, 131072
buffer_load_dwordx4 v192, s[12:15], s34 offen offset:0 nt lds
s_waitcnt lgkmcnt(8)
v_mfma_f32_16x16x32_bf16 v[144:147], a[216:219], a[184:187], v[144:147]
ds_read_b64_tr_b16 a[208:209], v184 offset:0
v_exp_f32 v143, v143
v_mfma_f32_16x16x32_bf16 v[152:155], a[216:219], a[188:191], v[152:155]
ds_read_b64_tr_b16 a[210:211], v184 offset:8192
v_mfma_f32_16x16x32_bf16 v[148:151], a[220:223], a[184:187], v[148:151]
ds_read_b64_tr_b16 a[212:213], v185 offset:0
v_cvt_pk_bf16_f32 v167, v142, v143
v_mfma_f32_16x16x32_bf16 v[156:159], a[220:223], a[188:191], v[156:159]
ds_read_b64_tr_b16 a[214:215], v185 offset:8192
s_nop 0
s_waitcnt lgkmcnt(8)
v_mfma_f32_16x16x32_bf16 v[0:3], a[192:195], v[160:163], v[0:3]
ds_read_b64_tr_b16 a[216:217], v186 offset:0
v_mfma_f32_16x16x32_bf16 v[8:11], a[192:195], v[164:167], v[8:11]
ds_read_b64_tr_b16 a[218:219], v186 offset:8192
v_mfma_f32_16x16x32_bf16 a[224:227], a[232:235], v[160:163], a[224:227]
v_mfma_f32_16x16x32_bf16 v[4:7], a[196:199], v[160:163], v[4:7]
ds_read_b64_tr_b16 a[220:221], v187 offset:0
v_mfma_f32_16x16x32_bf16 v[12:15], a[196:199], v[164:167], v[12:15]
ds_read_b64_tr_b16 a[222:223], v187 offset:8192
s_waitcnt vmcnt(6)
s_mov_b32 s34, 132096
buffer_load_dwordx4 v193, s[12:15], s34 offen offset:1024 nt lds
v_mfma_f32_16x16x32_bf16 a[228:231], a[232:235], v[164:167], a[228:231]
s_waitcnt lgkmcnt(8)
v_mfma_f32_16x16x32_bf16 v[16:19], a[200:203], v[160:163], v[16:19]
ds_read_b64_tr_b16 a[192:193], v180 offset:256
v_mfma_f32_16x16x32_bf16 v[24:27], a[200:203], v[164:167], v[24:27]
ds_read_b64_tr_b16 a[194:195], v180 offset:8448
v_mfma_f32_16x16x32_bf16 v[20:23], a[204:207], v[160:163], v[20:23]
ds_read_b64_tr_b16 a[196:197], v181 offset:256
v_mfma_f32_16x16x32_bf16 v[28:31], a[204:207], v[164:167], v[28:31]
ds_read_b64_tr_b16 a[198:199], v181 offset:8448
s_waitcnt lgkmcnt(8)
v_mfma_f32_16x16x32_bf16 v[32:35], a[208:211], v[160:163], v[32:35]
ds_read_b64_tr_b16 a[200:201], v182 offset:256
v_max3_f32 v208, v144, v145, v146
v_mfma_f32_16x16x32_bf16 v[40:43], a[208:211], v[164:167], v[40:43]
ds_read_b64_tr_b16 a[202:203], v182 offset:8448
s_add_u32 m0, s33, 65536
s_lshl_b32 s71, s72, 7
buffer_load_dwordx4 v198, s[24:27], s71 offen offset:2048  lds
v_mfma_f32_16x16x32_bf16 v[36:39], a[212:215], v[160:163], v[36:39]
ds_read_b64_tr_b16 a[204:205], v183 offset:256
v_max3_f32 v209, v152, v153, v154
v_mfma_f32_16x16x32_bf16 v[44:47], a[212:215], v[164:167], v[44:47]
ds_read_b64_tr_b16 a[206:207], v183 offset:8448
s_waitcnt lgkmcnt(8)
v_mfma_f32_16x16x32_bf16 v[48:51], a[216:219], v[160:163], v[48:51]
ds_read_b64_tr_b16 a[208:209], v184 offset:256
v_max3_f32 v208, v208, v147, v148
v_mfma_f32_16x16x32_bf16 v[56:59], a[216:219], v[164:167], v[56:59]
ds_read_b64_tr_b16 a[210:211], v184 offset:8448
s_waitcnt vmcnt(6)
s_add_u32 m0, s33, 16384
s_mov_b32 s34, 133120
buffer_load_dwordx4 v194, s[12:15], s34 offen offset:2048 nt lds
v_mfma_f32_16x16x32_bf16 v[52:55], a[220:223], v[160:163], v[52:55]
ds_read_b64_tr_b16 a[212:213], v185 offset:256
v_max3_f32 v209, v209, v155, v156
v_mfma_f32_16x16x32_bf16 v[60:63], a[220:223], v[164:167], v[60:63]
ds_read_b64_tr_b16 a[214:215], v185 offset:8448
s_waitcnt lgkmcnt(8)
v_mfma_f32_16x16x32_bf16 v[64:67], a[192:195], v[160:163], v[64:67]
ds_read_b64_tr_b16 a[216:217], v186 offset:256
v_max3_f32 v208, v208, v149, v150
v_mfma_f32_16x16x32_bf16 v[72:75], a[192:195], v[164:167], v[72:75]
ds_read_b64_tr_b16 a[218:219], v186 offset:8448
v_mfma_f32_16x16x32_bf16 v[68:71], a[196:199], v[160:163], v[68:71]
ds_read_b64_tr_b16 a[220:221], v187 offset:256
v_max3_f32 v209, v209, v157, v158
v_mfma_f32_16x16x32_bf16 v[76:79], a[196:199], v[164:167], v[76:79]
ds_read_b64_tr_b16 a[222:223], v187 offset:8448
s_waitcnt lgkmcnt(8)
v_mfma_f32_16x16x32_bf16 v[80:83], a[200:203], v[160:163], v[80:83]
v_add_u32 v176, 65536, v176
v_add_u32 v177, 65536, v177
v_add_u32 v178, 65536, v178
v_add_u32 v179, 65536, v179
s_waitcnt lgkmcnt(0)
s_barrier
ds_read_b128 a[192:195], v176 offset:16384
v_mfma_f32_16x16x32_bf16 v[88:91], a[200:203], v[164:167], v[88:91]
v_max_f32 v208, v208, v151
s_waitcnt vmcnt(6)
s_mov_b32 s34, 134144
buffer_load_dwordx4 v195, s[12:15], s34 offen offset:3072 nt lds
v_mfma_f32_16x16x32_bf16 v[84:87], a[204:207], v[160:163], v[84:87]
ds_read_b128 a[196:199], v176 offset:24576
v_mfma_f32_16x16x32_bf16 v[92:95], a[204:207], v[164:167], v[92:95]
v_max_f32 v209, v209, v159
s_waitcnt lgkmcnt(6)
v_mfma_f32_16x16x32_bf16 v[96:99], a[208:211], v[160:163], v[96:99]
ds_read_b128 a[200:203], v177 offset:16384
v_mfma_f32_16x16x32_bf16 v[104:107], a[208:211], v[164:167], v[104:107]
v_max_f32 v210, v208, v209
v_mfma_f32_16x16x32_bf16 v[100:103], a[212:215], v[160:163], v[100:103]
ds_read_b128 a[204:207], v177 offset:24576
v_mfma_f32_16x16x32_bf16 v[108:111], a[212:215], v[164:167], v[108:111]
v_cmp_lt_f32 vcc, s80, v210
s_waitcnt lgkmcnt(4)
v_mfma_f32_16x16x32_bf16 v[112:115], a[216:219], v[160:163], v[112:115]
ds_read_b128 a[208:211], v178 offset:16384
v_mfma_f32_16x16x32_bf16 v[120:123], a[216:219], v[164:167], v[120:123]
v_mfma_f32_16x16x32_bf16 v[116:119], a[220:223], v[160:163], v[116:119]
ds_read_b128 a[212:215], v178 offset:24576
v_mfma_f32_16x16x32_bf16 v[124:127], a[220:223], v[164:167], v[124:127]
s_waitcnt vmcnt(6)
s_add_u32 m0, s33, 0
s_mov_b32 s34, 133120
buffer_load_dwordx4 v188, s[8:11], s34 offen offset:0 nt lds
s_cbranch_vccz L_nors5
s_call_b64 s[82:83], L_rescale
L_nors5:
s_waitcnt lgkmcnt(4)
v_mfma_f32_16x16x32_bf16 v[128:131], a[192:195], a[128:131], v[168:171]
ds_read_b128 a[216:219], v179 offset:16384
v_exp_f32 v144, v144
v_mfma_f32_16x16x32_bf16 v[136:139], a[192:195], a[132:135], v[172:175]
v_exp_f32 v145, v145
s_add_u32 m0, s33, 65536
s_lshl_b32 s71, s72, 7
buffer_load_dwordx4 v199, s[24:27], s71 offen offset:3072  lds
v_mfma_f32_16x16x32_bf16 v[132:135], a[196:199], a[128:131], v[168:171]
ds_read_b128 a[220:223], v179 offset:24576
v_exp_f32 v146, v146
v_mfma_f32_16x16x32_bf16 v[140:143], a[196:199], a[132:135], v[172:175]
v_cvt_pk_bf16_f32 v160, v144, v145
s_waitcnt lgkmcnt(4)
v_mfma_f32_16x16x32_bf16 v[128:131], a[200:203], a[136:139], v[128:131]
ds_read_b128 a[192:195], v176 offset:16640
v_mfma_f32_16x16x32_bf16 v[136:139], a[200:203], a[140:143], v[136:139]
v_exp_f32 v147, v147
v_mfma_f32_16x16x32_bf16 v[132:135], a[204:207], a[136:139], v[132:135]
ds_read_b128 a[196:199], v176 offset:24832
v_exp_f32 v148, v148
v_mfma_f32_16x16x32_bf16 v[140:143], a[204:207], a[140:143], v[140:143]
v_cvt_pk_bf16_f32 v161, v146, v147
s_waitcnt vmcnt(6)
s_add_u32 m0, s33, 0
s_mov_b32 s34, 134144
buffer_load_dwordx4 v189, s[8:11], s34 offen offset:1024 nt lds
s_waitcnt lgkmcnt(4)
v_mfma_f32_16x16x32_bf16 v[128:131], a[208:211], a[144:147], v[128:131]
ds_read_b128 a[200:203], v177 offset:16640
v_mfma_f32_16x16x32_bf16 v[136:139], a[208:211], a[148:151], v[136:139]
v_exp_f32 v149, v149
v_mfma_f32_16x16x32_bf16 v[132:135], a[212:215], a[144:147], v[132:135]
ds_read_b128 a[204:207], v177 offset:24832
v_exp_f32 v150, v150
v_mfma_f32_16x16x32_bf16 v[140:143], a[212:215], a[148:151], v[140:143]
v_cvt_pk_bf16_f32 v162, v148, v149
s_waitcnt lgkmcnt(4)
v_mfma_f32_16x16x32_bf16 v[128:131], a[216:219], a[152:155], v[128:131]
ds_read_b128 a[208:211], v178 offset:16640
v_mfma_f32_16x16x32_bf16 v[136:139], a[216:219], a[156:159], v[136:139]
v_exp_f32 v151, v151
v_mfma_f32_16x16x32_bf16 v[132:135], a[220:223], a[152:155], v[132:135]
ds_read_b128 a[212:215], v178 offset:24832
v_exp_f32 v152, v152
v_mfma_f32_16x16x32_bf16 v[140:143], a[220:223], a[156:159], v[140:143]
v_cvt_pk_bf16_f32 v163, v150, v151
s_waitcnt lgkmcnt(4)
v_mfma_f32_16x16x32_bf16 v[128:131], a[192:195], a[160:163], v[128:131]
ds_read_b128 a[216:219], v179 offset:16640
v_mfma_f32_16x16x32_bf16 v[136:139], a[192:195], a[164:167], v[136:139]
v_exp_f32 v153, v153
s_waitcnt vmcnt(6)
s_mov_b32 s34, 131072
buffer_load_dwordx4 v190, s[8:11], s34 offen offset:2048 nt lds
v_mfma_f32_16x16x32_bf16 v[132:135], a[196:199], a[160:163], v[132:135]
ds_read_b128 a[220:223], v179 offset:24832
v_exp_f32 v154, v154
v_mfma_f32_16x16x32_bf16 v[140:143], a[196:199], a[164:167], v[140:143]
v_cvt_pk_bf16_f32 v164, v152, v153
s_waitcnt lgkmcnt(4)
v_mfma_f32_16x16x32_bf16 v[128:131], a[200:203], a[168:171], v[128:131]
s_waitcnt lgkmcnt(0)
s_barrier
ds_read_b64_tr_b16 a[192:193], v180 offset:32768
v_exp_f32 v155, v155
v_mfma_f32_16x16x32_bf16 v[136:139], a[200:203], a[172:175], v[136:139]
ds_read_b64_tr_b16 a[194:195], v180 offset:40960
v_mfma_f32_16x16x32_bf16 v[132:135], a[204:207], a[168:171], v[132:135]
ds_read_b64_tr_b16 a[196:197], v181 offset:32768
v_exp_f32 v156, v156
v_mfma_f32_16x16x32_bf16 v[140:143], a[204:207], a[172:175], v[140:143]
ds_read_b64_tr_b16 a[198:199], v181 offset:40960
v_cvt_pk_bf16_f32 v165, v154, v155
s_waitcnt lgkmcnt(6)
v_mfma_f32_16x16x32_bf16 v[128:131], a[208:211], a[176:179], v[128:131]
ds_read_b64_tr_b16 a[200:201], v182 offset:32768
v_exp_f32 v157, v157
v_mfma_f32_16x16x32_bf16 v[136:139], a[208:211], a[180:183], v[136:139]
ds_read_b64_tr_b16 a[202:203], v182 offset:40960
s_waitcnt vmcnt(5)
s_mov_b32 s34, 132096
buffer_load_dwordx4 v191, s[8:11], s34 offen offset:3072 nt lds
v_mfma_f32_16x16x32_bf16 v[132:135], a[212:215], a[176:179], v[132:135]
ds_read_b64_tr_b16 a[204:205], v183 offset:32768
v_exp_f32 v158, v158
v_mfma_f32_16x16x32_bf16 v[140:143], a[212:215], a[180:183], v[140:143]
ds_read_b64_tr_b16 a[206:207], v183 offset:40960
v_cvt_pk_bf16_f32 v166, v156, v157
s_waitcnt lgkmcnt(8)
v_mfma_f32_16x16x32_bf16 v[128:131], a[216:219], a[184:187], v[128:131]
ds_read_b64_tr_b16 a[208:209], v184 offset:32768
v_exp_f32 v159, v159
v_mfma_f32_16x16x32_bf16 v[136:139], a[216:219], a[188:191], v[136:139]
ds_read_b64_tr_b16 a[210:211], v184 offset:40960
v_mfma_f32_16x16x32_bf16 v[132:135], a[220:223], a[184:187], v[132:135]
ds_read_b64_tr_b16 a[212:213], v185 offset:32768
v_cvt_pk_bf16_f32 v167, v158, v159
v_mfma_f32_16x16x32_bf16 v[140:143], a[220:223], a[188:191], v[140:143]
ds_read_b64_tr_b16 a[214:215], v185 offset:40960
s_nop 0
s_waitcnt lgkmcnt(8)
v_mfma_f32_16x16x32_bf16 v[0:3], a[192:195], v[160:163], v[0:3]
ds_read_b64_tr_b16 a[216:217], v186 offset:32768
v_mfma_f32_16x16x32_bf16 v[8:11], a[192:195], v[164:167], v[8:11]
ds_read_b64_tr_b16 a[218:219], v186 offset:40960
v_mfma_f32_16x16x32_bf16 a[224:227], a[232:235], v[160:163], a[224:227]
v_mfma_f32_16x16x32_bf16 v[4:7], a[196:199], v[160:163], v[4:7]
ds_read_b64_tr_b16 a[220:221], v187 offset:32768
v_mfma_f32_16x16x32_bf16 v[12:15], a[196:199], v[164:167], v[12:15]
ds_read_b64_tr_b16 a[222:223], v187 offset:40960
s_waitcnt vmcnt(5)
s_add_u32 m0, s33, 81920
s_mov_b32 s34, 132096
buffer_load_dwordx4 v192, s[12:15], s34 offen offset:0 nt lds
v_mfma_f32_16x16x32_bf16 a[228:231], a[232:235], v[164:167], a[228:231]
s_waitcnt lgkmcnt(8)
v_mfma_f32_16x16x32_bf16 v[16:19], a[200:203], v[160:163], v[16:19]
ds_read_b64_tr_b16 a[192:193], v180 offset:33024
v_mfma_f32_16x16x32_bf16 v[24:27], a[200:203], v[164:167], v[24:27]
ds_read_b64_tr_b16 a[194:195], v180 offset:41216
v_mfma_f32_16x16x32_bf16 v[20:23], a[204:207], v[160:163], v[20:23]
ds_read_b64_tr_b16 a[196:197], v181 offset:33024
v_mfma_f32_16x16x32_bf16 v[28:31], a[204:207], v[164:167], v[28:31]
ds_read_b64_tr_b16 a[198:199], v181 offset:41216
s_waitcnt lgkmcnt(8)
v_mfma_f32_16x16x32_bf16 v[32:35], a[208:211], v[160:163], v[32:35]
ds_read_b64_tr_b16 a[200:201], v182 offset:33024
v_max3_f32 v208, v128, v129, v130
v_mfma_f32_16x16x32_bf16 v[40:43], a[208:211], v[164:167], v[40:43]
ds_read_b64_tr_b16 a[202:203], v182 offset:41216
v_mfma_f32_16x16x32_bf16 v[36:39], a[212:215], v[160:163], v[36:39]
ds_read_b64_tr_b16 a[204:205], v183 offset:33024
v_max3_f32 v209, v136, v137, v138
v_mfma_f32_16x16x32_bf16 v[44:47], a[212:215], v[164:167], v[44:47]
ds_read_b64_tr_b16 a[206:207], v183 offset:41216
s_waitcnt lgkmcnt(8)
v_mfma_f32_16x16x32_bf16 v[48:51], a[216:219], v[160:163], v[48:51]
ds_read_b64_tr_b16 a[208:209], v184 offset:33024
v_max3_f32 v208, v208, v131, v132
v_mfma_f32_16x16x32_bf16 v[56:59], a[216:219], v[164:167], v[56:59]
ds_read_b64_tr_b16 a[210:211], v184 offset:41216
s_waitcnt vmcnt(5)
s_mov_b32 s34, 131072
buffer_load_dwordx4 v193, s[12:15], s34 offen offset:1024 nt lds
v_mfma_f32_16x16x32_bf16 v[52:55], a[220:223], v[160:163], v[52:55]
ds_read_b64_tr_b16 a[212:213], v185 offset:33024
v_max3_f32 v209, v209, v139, v140
v_mfma_f32_16x16x32_bf16 v[60:63], a[220:223], v[164:167], v[60:63]
ds_read_b64_tr_b16 a[214:215], v185 offset:41216
s_waitcnt lgkmcnt(8)
v_mfma_f32_16x16x32_bf16 v[64:67], a[192:195], v[160:163], v[64:67]
ds_read_b64_tr_b16 a[216:217], v186 offset:33024
v_max3_f32 v208, v208, v133, v134
v_mfma_f32_16x16x32_bf16 v[72:75], a[192:195], v[164:167], v[72:75]
ds_read_b64_tr_b16 a[218:219], v186 offset:41216
v_mfma_f32_16x16x32_bf16 v[68:71], a[196:199], v[160:163], v[68:71]
ds_read_b64_tr_b16 a[220:221], v187 offset:33024
v_max3_f32 v209, v209, v141, v142
v_mfma_f32_16x16x32_bf16 v[76:79], a[196:199], v[164:167], v[76:79]
ds_read_b64_tr_b16 a[222:223], v187 offset:41216
s_waitcnt lgkmcnt(8)
v_mfma_f32_16x16x32_bf16 v[80:83], a[200:203], v[160:163], v[80:83]
s_waitcnt lgkmcnt(0)
s_barrier
ds_read_b128 a[192:195], v176 offset:32768
v_mfma_f32_16x16x32_bf16 v[88:91], a[200:203], v[164:167], v[88:91]
v_max_f32 v208, v208, v135
s_waitcnt vmcnt(4)
s_mov_b32 s34, 134144
buffer_load_dwordx4 v194, s[12:15], s34 offen offset:2048 nt lds
v_mfma_f32_16x16x32_bf16 v[84:87], a[204:207], v[160:163], v[84:87]
ds_read_b128 a[196:199], v176 offset:40960
v_mfma_f32_16x16x32_bf16 v[92:95], a[204:207], v[164:167], v[92:95]
v_max_f32 v209, v209, v143
s_waitcnt lgkmcnt(6)
v_mfma_f32_16x16x32_bf16 v[96:99], a[208:211], v[160:163], v[96:99]
ds_read_b128 a[200:203], v177 offset:32768
v_mfma_f32_16x16x32_bf16 v[104:107], a[208:211], v[164:167], v[104:107]
v_max_f32 v210, v208, v209
v_mfma_f32_16x16x32_bf16 v[100:103], a[212:215], v[160:163], v[100:103]
ds_read_b128 a[204:207], v177 offset:40960
v_mfma_f32_16x16x32_bf16 v[108:111], a[212:215], v[164:167], v[108:111]
v_cmp_lt_f32 vcc, s80, v210
s_waitcnt lgkmcnt(4)
v_mfma_f32_16x16x32_bf16 v[112:115], a[216:219], v[160:163], v[112:115]
ds_read_b128 a[208:211], v178 offset:32768
v_mfma_f32_16x16x32_bf16 v[120:123], a[216:219], v[164:167], v[120:123]
v_mfma_f32_16x16x32_bf16 v[116:119], a[220:223], v[160:163], v[116:119]
ds_read_b128 a[212:215], v178 offset:40960
v_mfma_f32_16x16x32_bf16 v[124:127], a[220:223], v[164:167], v[124:127]
s_waitcnt vmcnt(4)
s_mov_b32 s34, 133120
buffer_load_dwordx4 v195, s[12:15], s34 offen offset:3072 nt lds
s_cbranch_vccz L_nors6
s_call_b64 s[82:83], L_rescale
L_nors6:
s_waitcnt lgkmcnt(4)
v_mfma_f32_16x16x32_bf16 v[144:147], a[192:195], a[128:131], v[168:171]
ds_read_b128 a[216:219], v179 offset:32768
v_exp_f32 v128, v128
v_mfma_f32_16x16x32_bf16 v[152:155], a[192:195], a[132:135], v[172:175]
v_exp_f32 v129, v129
v_mfma_f32_16x16x32_bf16 v[148:151], a[196:199], a[128:131], v[168:171]
ds_read_b128 a[220:223], v179 offset:40960
v_exp_f32 v130, v130
v_mfma_f32_16x16x32_bf16 v[156:159], a[196:199], a[132:135], v[172:175]
v_cvt_pk_bf16_f32 v160, v128, v129
s_waitcnt lgkmcnt(4)
v_mfma_f32_16x16x32_bf16 v[144:147], a[200:203], a[136:139], v[144:147]
ds_read_b128 a[192:195], v176 offset:33024
v_mfma_f32_16x16x32_bf16 v[152:155], a[200:203], a[140:143], v[152:155]
v_exp_f32 v131, v131
v_mfma_f32_16x16x32_bf16 v[148:151], a[204:207], a[136:139], v[148:151]
ds_read_b128 a[196:199], v176 offset:41216
v_exp_f32 v132, v132
v_mfma_f32_16x16x32_bf16 v[156:159], a[204:207], a[140:143], v[156:159]
v_cvt_pk_bf16_f32 v161, v130, v131
s_waitcnt vmcnt(4)
s_add_u32 m0, s33, 32768
s_mov_b32 s34, 134144
buffer_load_dwordx4 v188, s[8:11], s34 offen offset:0 nt lds
s_waitcnt lgkmcnt(4)
v_mfma_f32_16x16x32_bf16 v[144:147], a[208:211], a[144:147], v[144:147]
ds_read_b128 a[200:203], v177 offset:33024
v_mfma_f32_16x16x32_bf16 v[152:155], a[208:211], a[148:151], v[152:155]
v_exp_f32 v133, v133
v_mfma_f32_16x16x32_bf16 v[148:151], a[212:215], a[144:147], v[148:151]
ds_read_b128 a[204:207], v177 offset:41216
v_exp_f32 v134, v134
v_mfma_f32_16x16x32_bf16 v[156:159], a[212:215], a[148:151], v[156:159]
v_cvt_pk_bf16_f32 v162, v132, v133
s_waitcnt lgkmcnt(4)
v_mfma_f32_16x16x32_bf16 v[144:147], a[216:219], a[152:155], v[144:147]
ds_read_b128 a[208:211], v178 offset:33024
v_mfma_f32_16x16x32_bf16 v[152:155], a[216:219], a[156:159], v[152:155]
v_exp_f32 v135, v135
v_mfma_f32_16x16x32_bf16 v[148:151], a[220:223], a[152:155], v[148:151]
ds_read_b128 a[212:215], v178 offset:41216
v_exp_f32 v136, v136
v_mfma_f32_16x16x32_bf16 v[156:159], a[220:223], a[156:159], v[156:159]
v_cvt_pk_bf16_f32 v163, v134, v135
s_waitcnt lgkmcnt(4)
v_mfma_f32_16x16x32_bf16 v[144:147], a[192:195], a[160:163], v[144:147]
ds_read_b128 a[216:219], v179 offset:33024
v_mfma_f32_16x16x32_bf16 v[152:155], a[192:195], a[164:167], v[152:155]
v_exp_f32 v137, v137
s_waitcnt vmcnt(4)
s_mov_b32 s34, 133120
buffer_load_dwordx4 v189, s[8:11], s34 offen offset:1024 nt lds
v_mfma_f32_16x16x32_bf16 v[148:151], a[196:199], a[160:163], v[148:151]
ds_read_b128 a[220:223], v179 offset:41216
v_exp_f32 v138, v138
v_mfma_f32_16x16x32_bf16 v[156:159], a[196:199], a[164:167], v[156:159]
v_cvt_pk_bf16_f32 v164, v136, v137
s_waitcnt lgkmcnt(4)
v_mfma_f32_16x16x32_bf16 v[144:147], a[200:203], a[168:171], v[144:147]
v_add_u32 v180, 65536, v180
v_add_u32 v181, 65536, v181
v_add_u32 v182, 65536, v182
v_add_u32 v183, 65536, v183
v_add_u32 v184, 65536, v184
v_add_u32 v185, 65536, v185
v_add_u32 v186, 65536, v186
v_add_u32 v187, 65536, v187
s_waitcnt lgkmcnt(0)
s_barrier
ds_read_b64_tr_b16 a[192:193], v180 offset:49152
v_exp_f32 v139, v139
v_mfma_f32_16x16x32_bf16 v[152:155], a[200:203], a[172:175], v[152:155]
ds_read_b64_tr_b16 a[194:195], v180 offset:57344
v_mfma_f32_16x16x32_bf16 v[148:151], a[204:207], a[168:171], v[148:151]
ds_read_b64_tr_b16 a[196:197], v181 offset:49152
v_exp_f32 v140, v140
v_mfma_f32_16x16x32_bf16 v[156:159], a[204:207], a[172:175], v[156:159]
ds_read_b64_tr_b16 a[198:199], v181 offset:57344
v_cvt_pk_bf16_f32 v165, v138, v139
s_waitcnt lgkmcnt(6)
v_mfma_f32_16x16x32_bf16 v[144:147], a[208:211], a[176:179], v[144:147]
ds_read_b64_tr_b16 a[200:201], v182 offset:49152
v_exp_f32 v141, v141
v_mfma_f32_16x16x32_bf16 v[152:155], a[208:211], a[180:183], v[152:155]
ds_read_b64_tr_b16 a[202:203], v182 offset:57344
s_waitcnt vmcnt(4)
s_mov_b32 s34, 132096
buffer_load_dwordx4 v190, s[8:11], s34 offen offset:2048 nt lds
v_mfma_f32_16x16x32_bf16 v[148:151], a[212:215], a[176:179], v[148:151]
ds_read_b64_tr_b16 a[204:205], v183 offset:49152
v_exp_f32 v142, v142
v_mfma_f32_16x16x32_bf16 v[156:159], a[212:215], a[180:183], v[156:159]
ds_read_b64_tr_b16 a[206:207], v183 offset:57344
v_cvt_pk_bf16_f32 v166, v140, v141
s_waitcnt lgkmcnt(8)
v_mfma_f32_16x16x32_bf16 v[144:147], a[216:219], a[184:187], v[144:147]
ds_read_b64_tr_b16 a[208:209], v184 offset:49152
v_exp_f32 v143, v143
v_mfma_f32_16x16x32_bf16 v[152:155], a[216:219], a[188:191], v[152:155]
ds_read_b64_tr_b16 a[210:211], v184 offset:57344
v_mfma_f32_16x16x32_bf16 v[148:151], a[220:223], a[184:187], v[148:151]
ds_read_b64_tr_b16 a[212:213], v185 offset:49152
v_cvt_pk_bf16_f32 v167, v142, v143
v_mfma_f32_16x16x32_bf16 v[156:159], a[220:223], a[188:191], v[156:159]
ds_read_b64_tr_b16 a[214:215], v185 offset:57344
s_nop 0
s_waitcnt lgkmcnt(8)
v_mfma_f32_16x16x32_bf16 v[0:3], a[192:195], v[160:163], v[0:3]
ds_read_b64_tr_b16 a[216:217], v186 offset:49152
v_mfma_f32_16x16x32_bf16 v[8:11], a[192:195], v[164:167], v[8:11]
ds_read_b64_tr_b16 a[218:219], v186 offset:57344
v_mfma_f32_16x16x32_bf16 a[224:227], a[232:235], v[160:163], a[224:227]
v_mfma_f32_16x16x32_bf16 v[4:7], a[196:199], v[160:163], v[4:7]
ds_read_b64_tr_b16 a[220:221], v187 offset:49152
v_mfma_f32_16x16x32_bf16 v[12:15], a[196:199], v[164:167], v[12:15]
ds_read_b64_tr_b16 a[222:223], v187 offset:57344
s_waitcnt vmcnt(4)
s_mov_b32 s34, 131072
buffer_load_dwordx4 v191, s[8:11], s34 offen offset:3072 nt lds
v_mfma_f32_16x16x32_bf16 a[228:231], a[232:235], v[164:167], a[228:231]
s_waitcnt lgkmcnt(8)
v_mfma_f32_16x16x32_bf16 v[16:19], a[200:203], v[160:163], v[16:19]
ds_read_b64_tr_b16 a[192:193], v180 offset:49408
v_mfma_f32_16x16x32_bf16 v[24:27], a[200:203], v[164:167], v[24:27]
ds_read_b64_tr_b16 a[194:195], v180 offset:57600
v_mfma_f32_16x16x32_bf16 v[20:23], a[204:207], v[160:163], v[20:23]
ds_read_b64_tr_b16 a[196:197], v181 offset:49408
v_mfma_f32_16x16x32_bf16 v[28:31], a[204:207], v[164:167], v[28:31]
ds_read_b64_tr_b16 a[198:199], v181 offset:57600
s_waitcnt lgkmcnt(8)
v_mfma_f32_16x16x32_bf16 v[32:35], a[208:211], v[160:163], v[32:35]
ds_read_b64_tr_b16 a[200:201], v182 offset:49408
v_max3_f32 v208, v144, v145, v146
v_mfma_f32_16x16x32_bf16 v[40:43], a[208:211], v[164:167], v[40:43]
ds_read_b64_tr_b16 a[202:203], v182 offset:57600
v_mfma_f32_16x16x32_bf16 v[36:39], a[212:215], v[160:163], v[36:39]
ds_read_b64_tr_b16 a[204:205], v183 offset:49408
v_max3_f32 v209, v152, v153, v154
v_mfma_f32_16x16x32_bf16 v[44:47], a[212:215], v[164:167], v[44:47]
ds_read_b64_tr_b16 a[206:207], v183 offset:57600
s_waitcnt vmcnt(4)
s_add_u32 m0, s33, 98304
s_mov_b32 s34, 133120
buffer_load_dwordx4 v192, s[12:15], s34 offen offset:0 nt lds
s_waitcnt lgkmcnt(8)
v_mfma_f32_16x16x32_bf16 v[48:51], a[216:219], v[160:163], v[48:51]
ds_read_b64_tr_b16 a[208:209], v184 offset:49408
v_max3_f32 v208, v208, v147, v148
v_mfma_f32_16x16x32_bf16 v[56:59], a[216:219], v[164:167], v[56:59]
ds_read_b64_tr_b16 a[210:211], v184 offset:57600
v_mfma_f32_16x16x32_bf16 v[52:55], a[220:223], v[160:163], v[52:55]
ds_read_b64_tr_b16 a[212:213], v185 offset:49408
v_max3_f32 v209, v209, v155, v156
v_mfma_f32_16x16x32_bf16 v[60:63], a[220:223], v[164:167], v[60:63]
ds_read_b64_tr_b16 a[214:215], v185 offset:57600
s_waitcnt lgkmcnt(8)
v_mfma_f32_16x16x32_bf16 v[64:67], a[192:195], v[160:163], v[64:67]
ds_read_b64_tr_b16 a[216:217], v186 offset:49408
v_max3_f32 v208, v208, v149, v150
v_mfma_f32_16x16x32_bf16 v[72:75], a[192:195], v[164:167], v[72:75]
ds_read_b64_tr_b16 a[218:219], v186 offset:57600
v_mfma_f32_16x16x32_bf16 v[68:71], a[196:199], v[160:163], v[68:71]
ds_read_b64_tr_b16 a[220:221], v187 offset:49408
v_max3_f32 v209, v209, v157, v158
v_mfma_f32_16x16x32_bf16 v[76:79], a[196:199], v[164:167], v[76:79]
ds_read_b64_tr_b16 a[222:223], v187 offset:57600
s_waitcnt lgkmcnt(8)
v_mfma_f32_16x16x32_bf16 v[80:83], a[200:203], v[160:163], v[80:83]
v_add_u32 v176, 65536, v176
v_add_u32 v177, 65536, v177
v_add_u32 v178, 65536, v178
v_add_u32 v179, 65536, v179
s_waitcnt lgkmcnt(0)
s_barrier
v_add_u32 v200, 65536, v200
ds_read_b128 a[192:195], v176 offset:0
v_mfma_f32_16x16x32_bf16 v[88:91], a[200:203], v[164:167], v[88:91]
v_max_f32 v208, v208, v151
s_waitcnt vmcnt(4)
s_mov_b32 s34, 134144
buffer_load_dwordx4 v193, s[12:15], s34 offen offset:1024 nt lds
v_mfma_f32_16x16x32_bf16 v[84:87], a[204:207], v[160:163], v[84:87]
ds_read_b128 a[196:199], v176 offset:8192
v_mfma_f32_16x16x32_bf16 v[92:95], a[204:207], v[164:167], v[92:95]
v_max_f32 v209, v209, v159
s_waitcnt lgkmcnt(6)
v_mfma_f32_16x16x32_bf16 v[96:99], a[208:211], v[160:163], v[96:99]
ds_read_b128 a[200:203], v177 offset:0
v_max_f32 v210, v208, v209
v_mfma_f32_16x16x32_bf16 v[104:107], a[208:211], v[164:167], v[104:107]
ds_read_b64_tr_b16 a[0:1], v200 offset:0
v_mfma_f32_16x16x32_bf16 v[100:103], a[212:215], v[160:163], v[100:103]
ds_read_b128 a[204:207], v177 offset:8192
v_cmp_lt_f32 vcc, s80, v210
v_mfma_f32_16x16x32_bf16 v[108:111], a[212:215], v[164:167], v[108:111]
ds_read_b64_tr_b16 a[2:3], v200 offset:2048
s_waitcnt lgkmcnt(6)
v_mfma_f32_16x16x32_bf16 v[112:115], a[216:219], v[160:163], v[112:115]
ds_read_b128 a[208:211], v178 offset:0
v_mfma_f32_16x16x32_bf16 v[120:123], a[216:219], v[164:167], v[120:123]
ds_read_b64_tr_b16 a[4:5], v200 offset:4096
s_waitcnt vmcnt(4)
s_mov_b32 s34, 131072
buffer_load_dwordx4 v194, s[12:15], s34 offen offset:2048 nt lds
v_mfma_f32_16x16x32_bf16 v[116:119], a[220:223], v[160:163], v[116:119]
ds_read_b128 a[212:215], v178 offset:8192
v_mfma_f32_16x16x32_bf16 v[124:127], a[220:223], v[164:167], v[124:127]
ds_read_b64_tr_b16 a[6:7], v200 offset:6144
s_cbranch_vccz L_nors7
s_call_b64 s[82:83], L_rescale
L_nors7:
s_waitcnt lgkmcnt(8)
v_mfma_f32_16x16x32_bf16 v[128:131], a[192:195], a[128:131], v[168:171]
ds_read_b128 a[216:219], v179 offset:0
v_exp_f32 v144, v144
v_mfma_f32_16x16x32_bf16 v[136:139], a[192:195], a[132:135], v[172:175]
ds_read_b64_tr_b16 a[8:9], v200 offset:8192
v_exp_f32 v145, v145
v_mfma_f32_16x16x32_bf16 v[132:135], a[196:199], a[128:131], v[168:171]
ds_read_b128 a[220:223], v179 offset:8192
v_exp_f32 v146, v146
v_mfma_f32_16x16x32_bf16 v[140:143], a[196:199], a[132:135], v[172:175]
ds_read_b64_tr_b16 a[10:11], v200 offset:10240
v_cvt_pk_bf16_f32 v160, v144, v145
s_waitcnt lgkmcnt(8)
v_mfma_f32_16x16x32_bf16 v[128:131], a[200:203], a[136:139], v[128:131]
ds_read_b128 a[192:195], v176 offset:256
v_exp_f32 v147, v147
v_mfma_f32_16x16x32_bf16 v[136:139], a[200:203], a[140:143], v[136:139]
ds_read_b64_tr_b16 a[12:13], v200 offset:12288
v_mfma_f32_16x16x32_bf16 v[132:135], a[204:207], a[136:139], v[132:135]
ds_read_b128 a[196:199], v176 offset:8448
v_exp_f32 v148, v148
v_mfma_f32_16x16x32_bf16 v[140:143], a[204:207], a[140:143], v[140:143]
ds_read_b64_tr_b16 a[14:15], v200 offset:14336
v_cvt_pk_bf16_f32 v161, v146, v147
s_waitcnt vmcnt(4)
s_mov_b32 s34, 132096
buffer_load_dwordx4 v195, s[12:15], s34 offen offset:3072 nt lds
s_waitcnt lgkmcnt(8)
v_mfma_f32_16x16x32_bf16 v[128:131], a[208:211], a[144:147], v[128:131]
ds_read_b128 a[200:203], v177 offset:256
v_mfma_f32_16x16x32_bf16 v[136:139], a[208:211], a[148:151], v[136:139]
v_exp_f32 v149, v149
v_mfma_f32_16x16x32_bf16 v[132:135], a[212:215], a[144:147], v[132:135]
ds_read_b128 a[204:207], v177 offset:8448
v_exp_f32 v150, v150
v_mfma_f32_16x16x32_bf16 v[140:143], a[212:215], a[148:151], v[140:143]
v_cvt_pk_bf16_f32 v162, v148, v149
s_waitcnt lgkmcnt(6)
v_mfma_f32_16x16x32_bf16 v[128:131], a[216:219], a[152:155], v[128:131]
ds_read_b128 a[208:211], v178 offset:256
v_mfma_f32_16x16x32_bf16 v[136:139], a[216:219], a[156:159], v[136:139]
v_exp_f32 v151, v151
v_mfma_f32_16x16x32_bf16 v[132:135], a[220:223], a[152:155], v[132:135]
ds_read_b128 a[212:215], v178 offset:8448
v_exp_f32 v152, v152
v_mfma_f32_16x16x32_bf16 v[140:143], a[220:223], a[156:159], v[140:143]
v_cvt_pk_bf16_f32 v163, v150, v151
s_waitcnt vmcnt(4)
s_add_u32 m0, s33, 114688
s_mov_b32 s34, 196608
buffer_load_dwordx4 v188, s[8:11], s34 offen offset:0 nt lds
s_waitcnt lgkmcnt(4)
v_mfma_f32_16x16x32_bf16 v[128:131], a[192:195], a[160:163], v[128:131]
ds_read_b128 a[216:219], v179 offset:256
v_mfma_f32_16x16x32_bf16 v[136:139], a[192:195], a[164:167], v[136:139]
v_exp_f32 v153, v153
v_mfma_f32_16x16x32_bf16 v[132:135], a[196:199], a[160:163], v[132:135]
ds_read_b128 a[220:223], v179 offset:8448
v_exp_f32 v154, v154
v_mfma_f32_16x16x32_bf16 v[140:143], a[196:199], a[164:167], v[140:143]
v_cvt_pk_bf16_f32 v164, v152, v153
s_waitcnt lgkmcnt(4)
v_mfma_f32_16x16x32_bf16 v[128:131], a[200:203], a[168:171], v[128:131]
v_add_u32 v180, 65536, v180
v_add_u32 v181, 65536, v181
v_add_u32 v182, 65536, v182
v_add_u32 v183, 65536, v183
v_add_u32 v184, 65536, v184
v_add_u32 v185, 65536, v185
v_add_u32 v186, 65536, v186
v_add_u32 v187, 65536, v187
s_waitcnt lgkmcnt(0)
s_barrier
ds_read_b64_tr_b16 a[192:193], v180 offset:16384
v_exp_f32 v155, v155
v_mfma_f32_16x16x32_bf16 v[136:139], a[200:203], a[172:175], v[136:139]
ds_read_b64_tr_b16 a[194:195], v180 offset:24576
v_mfma_f32_16x16x32_bf16 v[132:135], a[204:207], a[168:171], v[132:135]
ds_read_b64_tr_b16 a[196:197], v181 offset:16384
v_exp_f32 v156, v156
v_mfma_f32_16x16x32_bf16 v[140:143], a[204:207], a[172:175], v[140:143]
ds_read_b64_tr_b16 a[198:199], v181 offset:24576
v_cvt_pk_bf16_f32 v165, v154, v155
s_waitcnt lgkmcnt(6)
v_mfma_f32_16x16x32_bf16 v[128:131], a[208:211], a[176:179], v[128:131]
ds_read_b64_tr_b16 a[200:201], v182 offset:16384
v_exp_f32 v157, v157
v_mfma_f32_16x16x32_bf16 v[136:139], a[208:211], a[180:183], v[136:139]
ds_read_b64_tr_b16 a[202:203], v182 offset:24576
s_waitcnt vmcnt(4)
s_mov_b32 s34, 197632
buffer_load_dwordx4 v189, s[8:11], s34 offen offset:1024 nt lds
v_mfma_f32_16x16x32_bf16 v[132:135], a[212:215], a[176:179], v[132:135]
ds_read_b64_tr_b16 a[204:205], v183 offset:16384
v_exp_f32 v158, v158
v_mfma_f32_16x16x32_bf16 v[140:143], a[212:215], a[180:183], v[140:143]
ds_read_b64_tr_b16 a[206:207], v183 offset:24576
v_cvt_pk_bf16_f32 v166, v156, v157
s_waitcnt lgkmcnt(8)
v_mfma_f32_16x16x32_bf16 v[128:131], a[216:219], a[184:187], v[128:131]
ds_read_b64_tr_b16 a[208:209], v184 offset:16384
v_exp_f32 v159, v159
v_mfma_f32_16x16x32_bf16 v[136:139], a[216:219], a[188:191], v[136:139]
ds_read_b64_tr_b16 a[210:211], v184 offset:24576
v_mfma_f32_16x16x32_bf16 v[132:135], a[220:223], a[184:187], v[132:135]
ds_read_b64_tr_b16 a[212:213], v185 offset:16384
v_cvt_pk_bf16_f32 v167, v158, v159
v_mfma_f32_16x16x32_bf16 v[140:143], a[220:223], a[188:191], v[140:143]
ds_read_b64_tr_b16 a[214:215], v185 offset:24576
s_nop 0
s_waitcnt lgkmcnt(8)
v_mfma_f32_16x16x32_bf16 v[0:3], a[192:195], v[160:163], v[0:3]
ds_read_b64_tr_b16 a[216:217], v186 offset:16384
v_mfma_f32_16x16x32_bf16 v[8:11], a[192:195], v[164:167], v[8:11]
ds_read_b64_tr_b16 a[218:219], v186 offset:24576
s_waitcnt vmcnt(4)
s_mov_b32 s34, 198656
buffer_load_dwordx4 v190, s[8:11], s34 offen offset:2048 nt lds
v_mfma_f32_16x16x32_bf16 a[224:227], a[232:235], v[160:163], a[224:227]
v_mfma_f32_16x16x32_bf16 v[4:7], a[196:199], v[160:163], v[4:7]
ds_read_b64_tr_b16 a[220:221], v187 offset:16384
v_mfma_f32_16x16x32_bf16 v[12:15], a[196:199], v[164:167], v[12:15]
ds_read_b64_tr_b16 a[222:223], v187 offset:24576
v_mfma_f32_16x16x32_bf16 a[228:231], a[232:235], v[164:167], a[228:231]
s_waitcnt lgkmcnt(8)
v_mfma_f32_16x16x32_bf16 v[16:19], a[200:203], v[160:163], v[16:19]
ds_read_b64_tr_b16 a[192:193], v180 offset:16640
v_mfma_f32_16x16x32_bf16 v[24:27], a[200:203], v[164:167], v[24:27]
ds_read_b64_tr_b16 a[194:195], v180 offset:24832
v_mfma_f32_16x16x32_bf16 v[20:23], a[204:207], v[160:163], v[20:23]
ds_read_b64_tr_b16 a[196:197], v181 offset:16640
v_mfma_f32_16x16x32_bf16 v[28:31], a[204:207], v[164:167], v[28:31]
ds_read_b64_tr_b16 a[198:199], v181 offset:24832
s_waitcnt lgkmcnt(8)
v_mfma_f32_16x16x32_bf16 v[32:35], a[208:211], v[160:163], v[32:35]
ds_read_b64_tr_b16 a[200:201], v182 offset:16640
v_max3_f32 v208, v128, v129, v130
v_mfma_f32_16x16x32_bf16 v[40:43], a[208:211], v[164:167], v[40:43]
ds_read_b64_tr_b16 a[202:203], v182 offset:24832
s_add_u32 m0, s33, 131072
s_lshl_b32 s71, s72, 7
s_add_u32 s71, s71, 114688
buffer_load_dwordx4 v196, s[24:27], s71 offen offset:0  lds
v_mfma_f32_16x16x32_bf16 v[36:39], a[212:215], v[160:163], v[36:39]
ds_read_b64_tr_b16 a[204:205], v183 offset:16640
v_max3_f32 v209, v136, v137, v138
v_mfma_f32_16x16x32_bf16 v[44:47], a[212:215], v[164:167], v[44:47]
ds_read_b64_tr_b16 a[206:207], v183 offset:24832
s_waitcnt vmcnt(5)
s_add_u32 m0, s33, 114688
s_mov_b32 s34, 199680
buffer_load_dwordx4 v191, s[8:11], s34 offen offset:3072 nt lds
s_waitcnt lgkmcnt(8)
v_mfma_f32_16x16x32_bf16 v[48:51], a[216:219], v[160:163], v[48:51]
ds_read_b64_tr_b16 a[208:209], v184 offset:16640
v_max3_f32 v208, v208, v131, v132
v_mfma_f32_16x16x32_bf16 v[56:59], a[216:219], v[164:167], v[56:59]
ds_read_b64_tr_b16 a[210:211], v184 offset:24832
v_mfma_f32_16x16x32_bf16 v[52:55], a[220:223], v[160:163], v[52:55]
ds_read_b64_tr_b16 a[212:213], v185 offset:16640
v_max3_f32 v209, v209, v139, v140
v_mfma_f32_16x16x32_bf16 v[60:63], a[220:223], v[164:167], v[60:63]
ds_read_b64_tr_b16 a[214:215], v185 offset:24832
s_waitcnt lgkmcnt(8)
v_mfma_f32_16x16x32_bf16 v[64:67], a[192:195], v[160:163], v[64:67]
ds_read_b64_tr_b16 a[216:217], v186 offset:16640
v_max3_f32 v208, v208, v133, v134
v_mfma_f32_16x16x32_bf16 v[72:75], a[192:195], v[164:167], v[72:75]
ds_read_b64_tr_b16 a[218:219], v186 offset:24832
v_mfma_f32_16x16x32_bf16 v[68:71], a[196:199], v[160:163], v[68:71]
ds_read_b64_tr_b16 a[220:221], v187 offset:16640
v_max3_f32 v209, v209, v141, v142
v_mfma_f32_16x16x32_bf16 v[76:79], a[196:199], v[164:167], v[76:79]
ds_read_b64_tr_b16 a[222:223], v187 offset:24832
s_waitcnt vmcnt(5)
s_add_u32 m0, s33, 65536
s_mov_b32 s34, 134144
buffer_load_dwordx4 v192, s[12:15], s34 offen offset:0 nt lds
s_waitcnt lgkmcnt(8)
v_mfma_f32_16x16x32_bf16 v[80:83], a[200:203], v[160:163], v[80:83]
v_subrev_u32 v176, 131072, v176
v_subrev_u32 v177, 131072, v177
v_subrev_u32 v178, 131072, v178
v_subrev_u32 v179, 131072, v179
s_waitcnt lgkmcnt(0)
s_barrier
ds_read_b128 a[192:195], v176 offset:49152
v_mfma_f32_16x16x32_bf16 v[88:91], a[200:203], v[164:167], v[88:91]
v_max_f32 v208, v208, v135
v_mfma_f32_16x16x32_bf16 v[84:87], a[204:207], v[160:163], v[84:87]
ds_read_b128 a[196:199], v176 offset:57344
v_mfma_f32_16x16x32_bf16 v[92:95], a[204:207], v[164:167], v[92:95]
v_max_f32 v209, v209, v143
s_waitcnt lgkmcnt(6)
v_mfma_f32_16x16x32_bf16 v[96:99], a[208:211], v[160:163], v[96:99]
ds_read_b128 a[200:203], v177 offset:49152
v_mfma_f32_16x16x32_bf16 v[104:107], a[208:211], v[164:167], v[104:107]
v_max_f32 v210, v208, v209
v_mfma_f32_16x16x32_bf16 v[100:103], a[212:215], v[160:163], v[100:103]
ds_read_b128 a[204:207], v177 offset:57344
v_mfma_f32_16x16x32_bf16 v[108:111], a[212:215], v[164:167], v[108:111]
v_cmp_lt_f32 vcc, s80, v210
s_waitcnt lgkmcnt(4)
v_mfma_f32_16x16x32_bf16 v[112:115], a[216:219], v[160:163], v[112:115]
ds_read_b128 a[208:211], v178 offset:49152
v_mfma_f32_16x16x32_bf16 v[120:123], a[216:219], v[164:167], v[120:123]
s_waitcnt vmcnt(5)
s_mov_b32 s34, 133120
buffer_load_dwordx4 v193, s[12:15], s34 offen offset:1024 nt lds
v_mfma_f32_16x16x32_bf16 v[116:119], a[220:223], v[160:163], v[116:119]
ds_read_b128 a[212:215], v178 offset:57344
v_mfma_f32_16x16x32_bf16 v[124:127], a[220:223], v[164:167], v[124:127]
s_cbranch_vccz L_nors8
s_call_b64 s[82:83], L_rescale
L_nors8:
s_waitcnt lgkmcnt(4)
v_mfma_f32_16x16x32_bf16 v[144:147], a[192:195], a[128:131], v[168:171]
ds_read_b128 a[216:219], v179 offset:49152
v_exp_f32 v128, v128
v_mfma_f32_16x16x32_bf16 v[152:155], a[192:195], a[132:135], v[172:175]
v_exp_f32 v129, v129
s_add_u32 m0, s33, 131072
s_lshl_b32 s71, s72, 7
s_add_u32 s71, s71, 114688
buffer_load_dwordx4 v197, s[24:27], s71 offen offset:1024  lds
v_mfma_f32_16x16x32_bf16 v[148:151], a[196:199], a[128:131], v[168:171]
ds_read_b128 a[220:223], v179 offset:57344
v_exp_f32 v130, v130
v_mfma_f32_16x16x32_bf16 v[156:159], a[196:199], a[132:135], v[172:175]
v_cvt_pk_bf16_f32 v160, v128, v129
s_waitcnt lgkmcnt(4)
v_mfma_f32_16x16x32_bf16 v[144:147], a[200:203], a[136:139], v[144:147]
ds_read_b128 a[192:195], v176 offset:49408
v_mfma_f32_16x16x32_bf16 v[152:155], a[200:203], a[140:143], v[152:155]
v_exp_f32 v131, v131
s_waitcnt vmcnt(6)
s_add_u32 m0, s33, 65536
s_mov_b32 s34, 132096
buffer_load_dwordx4 v194, s[12:15], s34 offen offset:2048 nt lds
v_mfma_f32_16x16x32_bf16 v[148:151], a[204:207], a[136:139], v[148:151]
ds_read_b128 a[196:199], v176 offset:57600
v_exp_f32 v132, v132
v_mfma_f32_16x16x32_bf16 v[156:159], a[204:207], a[140:143], v[156:159]
v_cvt_pk_bf16_f32 v161, v130, v131
s_waitcnt lgkmcnt(4)
v_mfma_f32_16x16x32_bf16 v[144:147], a[208:211], a[144:147], v[144:147]
ds_read_b128 a[200:203], v177 offset:49408
v_mfma_f32_16x16x32_bf16 v[152:155], a[208:211], a[148:151], v[152:155]
v_exp_f32 v133, v133
v_mfma_f32_16x16x32_bf16 v[148:151], a[212:215], a[144:147], v[148:151]
ds_read_b128 a[204:207], v177 offset:57600
v_exp_f32 v134, v134
v_mfma_f32_16x16x32_bf16 v[156:159], a[212:215], a[148:151], v[156:159]
v_cvt_pk_bf16_f32 v162, v132, v133
s_waitcnt lgkmcnt(4)
v_mfma_f32_16x16x32_bf16 v[144:147], a[216:219], a[152:155], v[144:147]
ds_read_b128 a[208:211], v178 offset:49408
v_mfma_f32_16x16x32_bf16 v[152:155], a[216:219], a[156:159], v[152:155]
v_exp_f32 v135, v135
v_mfma_f32_16x16x32_bf16 v[148:151], a[220:223], a[152:155], v[148:151]
ds_read_b128 a[212:215], v178 offset:57600
v_exp_f32 v136, v136
v_mfma_f32_16x16x32_bf16 v[156:159], a[220:223], a[156:159], v[156:159]
v_cvt_pk_bf16_f32 v163, v134, v135
s_waitcnt vmcnt(6)
s_mov_b32 s34, 131072
buffer_load_dwordx4 v195, s[12:15], s34 offen offset:3072 nt lds
s_waitcnt lgkmcnt(4)
v_mfma_f32_16x16x32_bf16 v[144:147], a[192:195], a[160:163], v[144:147]
ds_read_b128 a[216:219], v179 offset:49408
v_mfma_f32_16x16x32_bf16 v[152:155], a[192:195], a[164:167], v[152:155]
v_exp_f32 v137, v137
v_mfma_f32_16x16x32_bf16 v[148:151], a[196:199], a[160:163], v[148:151]
ds_read_b128 a[220:223], v179 offset:57600
v_exp_f32 v138, v138
v_mfma_f32_16x16x32_bf16 v[156:159], a[196:199], a[164:167], v[156:159]
v_cvt_pk_bf16_f32 v164, v136, v137
s_waitcnt lgkmcnt(4)
v_mfma_f32_16x16x32_bf16 v[144:147], a[200:203], a[168:171], v[144:147]
v_subrev_u32 v180, 131072, v180
v_subrev_u32 v181, 131072, v181
v_subrev_u32 v182, 131072, v182
v_subrev_u32 v183, 131072, v183
v_subrev_u32 v184, 131072, v184
v_subrev_u32 v185, 131072, v185
v_subrev_u32 v186, 131072, v186
v_subrev_u32 v187, 131072, v187
s_waitcnt lgkmcnt(0)
s_barrier
ds_read_b64_tr_b16 a[192:193], v180 offset:16384
v_exp_f32 v139, v139
v_mfma_f32_16x16x32_bf16 v[152:155], a[200:203], a[172:175], v[152:155]
ds_read_b64_tr_b16 a[194:195], v180 offset:24576
v_mfma_f32_16x16x32_bf16 v[148:151], a[204:207], a[168:171], v[148:151]
ds_read_b64_tr_b16 a[196:197], v181 offset:16384
v_exp_f32 v140, v140
v_mfma_f32_16x16x32_bf16 v[156:159], a[204:207], a[172:175], v[156:159]
ds_read_b64_tr_b16 a[198:199], v181 offset:24576
v_cvt_pk_bf16_f32 v165, v138, v139
s_waitcnt vmcnt(5)
s_add_u32 m0, s33, 49152
s_mov_b32 s34, 197632
buffer_load_dwordx4 v188, s[8:11], s34 offen offset:0 nt lds
s_waitcnt lgkmcnt(6)
v_mfma_f32_16x16x32_bf16 v[144:147], a[208:211], a[176:179], v[144:147]
ds_read_b64_tr_b16 a[200:201], v182 offset:16384
v_exp_f32 v141, v141
v_mfma_f32_16x16x32_bf16 v[152:155], a[208:211], a[180:183], v[152:155]
ds_read_b64_tr_b16 a[202:203], v182 offset:24576
s_add_u32 m0, s33, 131072
s_lshl_b32 s71, s72, 7
s_add_u32 s71, s71, 114688
buffer_load_dwordx4 v198, s[24:27], s71 offen offset:2048  lds
v_mfma_f32_16x16x32_bf16 v[148:151], a[212:215], a[176:179], v[148:151]
ds_read_b64_tr_b16 a[204:205], v183 offset:16384
v_exp_f32 v142, v142
v_mfma_f32_16x16x32_bf16 v[156:159], a[212:215], a[180:183], v[156:159]
ds_read_b64_tr_b16 a[206:207], v183 offset:24576
v_cvt_pk_bf16_f32 v166, v140, v141
s_waitcnt lgkmcnt(8)
v_mfma_f32_16x16x32_bf16 v[144:147], a[216:219], a[184:187], v[144:147]
ds_read_b64_tr_b16 a[208:209], v184 offset:16384
v_exp_f32 v143, v143
v_mfma_f32_16x16x32_bf16 v[152:155], a[216:219], a[188:191], v[152:155]
ds_read_b64_tr_b16 a[210:211], v184 offset:24576
v_mfma_f32_16x16x32_bf16 v[148:151], a[220:223], a[184:187], v[148:151]
ds_read_b64_tr_b16 a[212:213], v185 offset:16384
v_cvt_pk_bf16_f32 v167, v142, v143
v_mfma_f32_16x16x32_bf16 v[156:159], a[220:223], a[188:191], v[156:159]
ds_read_b64_tr_b16 a[214:215], v185 offset:24576
s_nop 0
s_waitcnt lgkmcnt(8)
v_mfma_f32_16x16x32_bf16 v[0:3], a[192:195], v[160:163], v[0:3]
ds_read_b64_tr_b16 a[216:217], v186 offset:16384
v_mfma_f32_16x16x32_bf16 v[8:11], a[192:195], v[164:167], v[8:11]
ds_read_b64_tr_b16 a[218:219], v186 offset:24576
s_waitcnt vmcnt(6)
s_add_u32 m0, s33, 49152
s_mov_b32 s34, 196608
buffer_load_dwordx4 v189, s[8:11], s34 offen offset:1024 nt lds
v_mfma_f32_16x16x32_bf16 a[224:227], a[232:235], v[160:163], a[224:227]
v_mfma_f32_16x16x32_bf16 v[4:7], a[196:199], v[160:163], v[4:7]
ds_read_b64_tr_b16 a[220:221], v187 offset:16384
v_mfma_f32_16x16x32_bf16 v[12:15], a[196:199], v[164:167], v[12:15]
ds_read_b64_tr_b16 a[222:223], v187 offset:24576
v_mfma_f32_16x16x32_bf16 a[228:231], a[232:235], v[164:167], a[228:231]
s_waitcnt lgkmcnt(8)
v_mfma_f32_16x16x32_bf16 v[16:19], a[200:203], v[160:163], v[16:19]
ds_read_b64_tr_b16 a[192:193], v180 offset:16640
v_mfma_f32_16x16x32_bf16 v[24:27], a[200:203], v[164:167], v[24:27]
ds_read_b64_tr_b16 a[194:195], v180 offset:24832
v_mfma_f32_16x16x32_bf16 v[20:23], a[204:207], v[160:163], v[20:23]
ds_read_b64_tr_b16 a[196:197], v181 offset:16640
v_mfma_f32_16x16x32_bf16 v[28:31], a[204:207], v[164:167], v[28:31]
ds_read_b64_tr_b16 a[198:199], v181 offset:24832
s_waitcnt lgkmcnt(8)
v_mfma_f32_16x16x32_bf16 v[32:35], a[208:211], v[160:163], v[32:35]
ds_read_b64_tr_b16 a[200:201], v182 offset:16640
v_max3_f32 v208, v144, v145, v146
v_mfma_f32_16x16x32_bf16 v[40:43], a[208:211], v[164:167], v[40:43]
ds_read_b64_tr_b16 a[202:203], v182 offset:24832
s_waitcnt vmcnt(6)
s_mov_b32 s34, 199680
buffer_load_dwordx4 v190, s[8:11], s34 offen offset:2048 nt lds
v_mfma_f32_16x16x32_bf16 v[36:39], a[212:215], v[160:163], v[36:39]
ds_read_b64_tr_b16 a[204:205], v183 offset:16640
v_max3_f32 v209, v152, v153, v154
v_mfma_f32_16x16x32_bf16 v[44:47], a[212:215], v[164:167], v[44:47]
ds_read_b64_tr_b16 a[206:207], v183 offset:24832
s_waitcnt lgkmcnt(8)
v_mfma_f32_16x16x32_bf16 v[48:51], a[216:219], v[160:163], v[48:51]
ds_read_b64_tr_b16 a[208:209], v184 offset:16640
v_max3_f32 v208, v208, v147, v148
v_mfma_f32_16x16x32_bf16 v[56:59], a[216:219], v[164:167], v[56:59]
ds_read_b64_tr_b16 a[210:211], v184 offset:24832
v_mfma_f32_16x16x32_bf16 v[52:55], a[220:223], v[160:163], v[52:55]
ds_read_b64_tr_b16 a[212:213], v185 offset:16640
v_max3_f32 v209, v209, v155, v156
v_mfma_f32_16x16x32_bf16 v[60:63], a[220:223], v[164:167], v[60:63]
ds_read_b64_tr_b16 a[214:215], v185 offset:24832
s_waitcnt lgkmcnt(8)
v_mfma_f32_16x16x32_bf16 v[64:67], a[192:195], v[160:163], v[64:67]
ds_read_b64_tr_b16 a[216:217], v186 offset:16640
v_max3_f32 v208, v208, v149, v150
v_mfma_f32_16x16x32_bf16 v[72:75], a[192:195], v[164:167], v[72:75]
ds_read_b64_tr_b16 a[218:219], v186 offset:24832
s_add_u32 m0, s33, 131072
s_lshl_b32 s71, s72, 7
s_add_u32 s71, s71, 114688
buffer_load_dwordx4 v199, s[24:27], s71 offen offset:3072  lds
v_mfma_f32_16x16x32_bf16 v[68:71], a[196:199], v[160:163], v[68:71]
ds_read_b64_tr_b16 a[220:221], v187 offset:16640
v_max3_f32 v209, v209, v157, v158
v_mfma_f32_16x16x32_bf16 v[76:79], a[196:199], v[164:167], v[76:79]
ds_read_b64_tr_b16 a[222:223], v187 offset:24832
s_waitcnt vmcnt(6)
s_add_u32 m0, s33, 49152
s_mov_b32 s34, 198656
buffer_load_dwordx4 v191, s[8:11], s34 offen offset:3072 nt lds
s_waitcnt lgkmcnt(8)
v_mfma_f32_16x16x32_bf16 v[80:83], a[200:203], v[160:163], v[80:83]
s_waitcnt lgkmcnt(0)
s_barrier
ds_read_b128 a[192:195], v176 offset:0
v_mfma_f32_16x16x32_bf16 v[88:91], a[200:203], v[164:167], v[88:91]
v_max_f32 v208, v208, v151
v_mfma_f32_16x16x32_bf16 v[84:87], a[204:207], v[160:163], v[84:87]
ds_read_b128 a[196:199], v176 offset:8192
v_mfma_f32_16x16x32_bf16 v[92:95], a[204:207], v[164:167], v[92:95]
v_max_f32 v209, v209, v159
s_waitcnt lgkmcnt(6)
v_mfma_f32_16x16x32_bf16 v[96:99], a[208:211], v[160:163], v[96:99]
ds_read_b128 a[200:203], v177 offset:0
v_mfma_f32_16x16x32_bf16 v[104:107], a[208:211], v[164:167], v[104:107]
v_max_f32 v210, v208, v209
v_mfma_f32_16x16x32_bf16 v[100:103], a[212:215], v[160:163], v[100:103]
ds_read_b128 a[204:207], v177 offset:8192
v_mfma_f32_16x16x32_bf16 v[108:111], a[212:215], v[164:167], v[108:111]
v_cmp_lt_f32 vcc, s80, v210
s_waitcnt vmcnt(6)
s_add_u32 m0, s33, 16384
s_mov_b32 s34, 196608
buffer_load_dwordx4 v192, s[12:15], s34 offen offset:0 nt lds
s_waitcnt lgkmcnt(4)
v_mfma_f32_16x16x32_bf16 v[112:115], a[216:219], v[160:163], v[112:115]
ds_read_b128 a[208:211], v178 offset:0
v_mfma_f32_16x16x32_bf16 v[120:123], a[216:219], v[164:167], v[120:123]
v_mfma_f32_16x16x32_bf16 v[116:119], a[220:223], v[160:163], v[116:119]
ds_read_b128 a[212:215], v178 offset:8192
v_mfma_f32_16x16x32_bf16 v[124:127], a[220:223], v[164:167], v[124:127]
s_cbranch_vccz L_nors9
s_call_b64 s[82:83], L_rescale
L_nors9:
s_waitcnt lgkmcnt(4)
v_mfma_f32_16x16x32_bf16 v[128:131], a[192:195], a[128:131], v[168:171]
ds_read_b128 a[216:219], v179 offset:0
v_exp_f32 v144, v144
v_mfma_f32_16x16x32_bf16 v[136:139], a[192:195], a[132:135], v[172:175]
v_exp_f32 v145, v145
v_mfma_f32_16x16x32_bf16 v[132:135], a[196:199], a[128:131], v[168:171]
ds_read_b128 a[220:223], v179 offset:8192
v_exp_f32 v146, v146
v_mfma_f32_16x16x32_bf16 v[140:143], a[196:199], a[132:135], v[172:175]
v_cvt_pk_bf16_f32 v160, v144, v145
s_waitcnt lgkmcnt(4)
v_mfma_f32_16x16x32_bf16 v[128:131], a[200:203], a[136:139], v[128:131]
ds_read_b128 a[192:195], v176 offset:256
v_mfma_f32_16x16x32_bf16 v[136:139], a[200:203], a[140:143], v[136:139]
v_exp_f32 v147, v147
s_waitcnt vmcnt(6)
s_mov_b32 s34, 197632
buffer_load_dwordx4 v193, s[12:15], s34 offen offset:1024 nt lds
v_mfma_f32_16x16x32_bf16 v[132:135], a[204:207], a[136:139], v[132:135]
ds_read_b128 a[196:199], v176 offset:8448
v_exp_f32 v148, v148
v_mfma_f32_16x16x32_bf16 v[140:143], a[204:207], a[140:143], v[140:143]
v_cvt_pk_bf16_f32 v161, v146, v147
s_waitcnt lgkmcnt(4)
v_mfma_f32_16x16x32_bf16 v[128:131], a[208:211], a[144:147], v[128:131]
ds_read_b128 a[200:203], v177 offset:256
v_mfma_f32_16x16x32_bf16 v[136:139], a[208:211], a[148:151], v[136:139]
v_exp_f32 v149, v149
s_add_u32 m0, s33, 147456
s_lshl_b32 s71, s73, 7
buffer_load_dwordx4 v196, s[24:27], s71 offen offset:0  lds
v_mfma_f32_16x16x32_bf16 v[132:135], a[212:215], a[144:147], v[132:135]
ds_read_b128 a[204:207], v177 offset:8448
v_exp_f32 v150, v150
v_mfma_f32_16x16x32_bf16 v[140:143], a[212:215], a[148:151], v[140:143]
v_cvt_pk_bf16_f32 v162, v148, v149
s_waitcnt lgkmcnt(4)
v_mfma_f32_16x16x32_bf16 v[128:131], a[216:219], a[152:155], v[128:131]
ds_read_b128 a[208:211], v178 offset:256
v_mfma_f32_16x16x32_bf16 v[136:139], a[216:219], a[156:159], v[136:139]
v_exp_f32 v151, v151
s_waitcnt vmcnt(6)
s_add_u32 m0, s33, 16384
s_mov_b32 s34, 198656
buffer_load_dwordx4 v194, s[12:15], s34 offen offset:2048 nt lds
v_mfma_f32_16x16x32_bf16 v[132:135], a[220:223], a[152:155], v[132:135]
ds_read_b128 a[212:215], v178 offset:8448
v_exp_f32 v152, v152
v_mfma_f32_16x16x32_bf16 v[140:143], a[220:223], a[156:159], v[140:143]
v_cvt_pk_bf16_f32 v163, v150, v151
s_waitcnt lgkmcnt(4)
v_mfma_f32_16x16x32_bf16 v[128:131], a[192:195], a[160:163], v[128:131]
ds_read_b128 a[216:219], v179 offset:256
v_mfma_f32_16x16x32_bf16 v[136:139], a[192:195], a[164:167], v[136:139]
v_exp_f32 v153, v153
v_mfma_f32_16x16x32_bf16 v[132:135], a[196:199], a[160:163], v[132:135]
ds_read_b128 a[220:223], v179 offset:8448
v_exp_f32 v154, v154
v_mfma_f32_16x16x32_bf16 v[140:143], a[196:199], a[164:167], v[140:143]
v_cvt_pk_bf16_f32 v164, v152, v153
s_waitcnt lgkmcnt(4)
v_mfma_f32_16x16x32_bf16 v[128:131], a[200:203], a[168:171], v[128:131]
v_add_u32 v180, 65536, v180
v_add_u32 v181, 65536, v181
v_add_u32 v182, 65536, v182
v_add_u32 v183, 65536, v183
v_add_u32 v184, 65536, v184
v_add_u32 v185, 65536, v185
v_add_u32 v186, 65536, v186
v_add_u32 v187, 65536, v187
s_waitcnt lgkmcnt(0)
s_barrier
ds_read_b64_tr_b16 a[192:193], v180 offset:16384
v_exp_f32 v155, v155
v_mfma_f32_16x16x32_bf16 v[136:139], a[200:203], a[172:175], v[136:139]
ds_read_b64_tr_b16 a[194:195], v180 offset:24576
v_mfma_f32_16x16x32_bf16 v[132:135], a[204:207], a[168:171], v[132:135]
ds_read_b64_tr_b16 a[196:197], v181 offset:16384
v_exp_f32 v156, v156
v_mfma_f32_16x16x32_bf16 v[140:143], a[204:207], a[172:175], v[140:143]
ds_read_b64_tr_b16 a[198:199], v181 offset:24576
v_cvt_pk_bf16_f32 v165, v154, v155
s_waitcnt vmcnt(6)
s_mov_b32 s34, 199680
buffer_load_dwordx4 v195, s[12:15], s34 offen offset:3072 nt lds
s_waitcnt lgkmcnt(6)
v_mfma_f32_16x16x32_bf16 v[128:131], a[208:211], a[176:179], v[128:131]
ds_read_b64_tr_b16 a[200:201], v182 offset:16384
v_exp_f32 v157, v157
v_mfma_f32_16x16x32_bf16 v[136:139], a[208:211], a[180:183], v[136:139]
ds_read_b64_tr_b16 a[202:203], v182 offset:24576
v_mfma_f32_16x16x32_bf16 v[132:135], a[212:215], a[176:179], v[132:135]
ds_read_b64_tr_b16 a[204:205], v183 offset:16384
v_exp_f32 v158, v158
v_mfma_f32_16x16x32_bf16 v[140:143], a[212:215], a[180:183], v[140:143]
ds_read_b64_tr_b16 a[206:207], v183 offset:24576
v_cvt_pk_bf16_f32 v166, v156, v157
s_waitcnt lgkmcnt(8)
v_mfma_f32_16x16x32_bf16 v[128:131], a[216:219], a[184:187], v[128:131]
ds_read_b64_tr_b16 a[208:209], v184 offset:16384
v_exp_f32 v159, v159
v_mfma_f32_16x16x32_bf16 v[136:139], a[216:219], a[188:191], v[136:139]
ds_read_b64_tr_b16 a[210:211], v184 offset:24576
v_mfma_f32_16x16x32_bf16 v[132:135], a[220:223], a[184:187], v[132:135]
ds_read_b64_tr_b16 a[212:213], v185 offset:16384
v_cvt_pk_bf16_f32 v167, v158, v159
v_mfma_f32_16x16x32_bf16 v[140:143], a[220:223], a[188:191], v[140:143]
ds_read_b64_tr_b16 a[214:215], v185 offset:24576
s_waitcnt vmcnt(5)
s_add_u32 m0, s33, 0
s_mov_b32 s34, 198656
buffer_load_dwordx4 v188, s[8:11], s34 offen offset:0 nt lds
s_nop 0
s_waitcnt lgkmcnt(8)
v_mfma_f32_16x16x32_bf16 v[0:3], a[192:195], v[160:163], v[0:3]
ds_read_b64_tr_b16 a[216:217], v186 offset:16384
v_mfma_f32_16x16x32_bf16 v[8:11], a[192:195], v[164:167], v[8:11]
ds_read_b64_tr_b16 a[218:219], v186 offset:24576
s_add_u32 m0, s33, 147456
s_lshl_b32 s71, s73, 7
buffer_load_dwordx4 v197, s[24:27], s71 offen offset:1024  lds
v_mfma_f32_16x16x32_bf16 a[224:227], a[232:235], v[160:163], a[224:227]
v_mfma_f32_16x16x32_bf16 v[4:7], a[196:199], v[160:163], v[4:7]
ds_read_b64_tr_b16 a[220:221], v187 offset:16384
v_mfma_f32_16x16x32_bf16 v[12:15], a[196:199], v[164:167], v[12:15]
ds_read_b64_tr_b16 a[222:223], v187 offset:24576
v_mfma_f32_16x16x32_bf16 a[228:231], a[232:235], v[164:167], a[228:231]
s_waitcnt lgkmcnt(8)
v_mfma_f32_16x16x32_bf16 v[16:19], a[200:203], v[160:163], v[16:19]
ds_read_b64_tr_b16 a[192:193], v180 offset:16640
v_mfma_f32_16x16x32_bf16 v[24:27], a[200:203], v[164:167], v[24:27]
ds_read_b64_tr_b16 a[194:195], v180 offset:24832
v_mfma_f32_16x16x32_bf16 v[20:23], a[204:207], v[160:163], v[20:23]
ds_read_b64_tr_b16 a[196:197], v181 offset:16640
v_mfma_f32_16x16x32_bf16 v[28:31], a[204:207], v[164:167], v[28:31]
ds_read_b64_tr_b16 a[198:199], v181 offset:24832
s_waitcnt lgkmcnt(8)
v_mfma_f32_16x16x32_bf16 v[32:35], a[208:211], v[160:163], v[32:35]
ds_read_b64_tr_b16 a[200:201], v182 offset:16640
v_max3_f32 v208, v128, v129, v130
v_mfma_f32_16x16x32_bf16 v[40:43], a[208:211], v[164:167], v[40:43]
ds_read_b64_tr_b16 a[202:203], v182 offset:24832
s_waitcnt vmcnt(6)
s_add_u32 m0, s33, 0
s_mov_b32 s34, 199680
buffer_load_dwordx4 v189, s[8:11], s34 offen offset:1024 nt lds
v_mfma_f32_16x16x32_bf16 v[36:39], a[212:215], v[160:163], v[36:39]
ds_read_b64_tr_b16 a[204:205], v183 offset:16640
v_max3_f32 v209, v136, v137, v138
v_mfma_f32_16x16x32_bf16 v[44:47], a[212:215], v[164:167], v[44:47]
ds_read_b64_tr_b16 a[206:207], v183 offset:24832
s_waitcnt lgkmcnt(8)
v_mfma_f32_16x16x32_bf16 v[48:51], a[216:219], v[160:163], v[48:51]
ds_read_b64_tr_b16 a[208:209], v184 offset:16640
v_max3_f32 v208, v208, v131, v132
v_mfma_f32_16x16x32_bf16 v[56:59], a[216:219], v[164:167], v[56:59]
ds_read_b64_tr_b16 a[210:211], v184 offset:24832
v_mfma_f32_16x16x32_bf16 v[52:55], a[220:223], v[160:163], v[52:55]
ds_read_b64_tr_b16 a[212:213], v185 offset:16640
v_max3_f32 v209, v209, v139, v140
v_mfma_f32_16x16x32_bf16 v[60:63], a[220:223], v[164:167], v[60:63]
ds_read_b64_tr_b16 a[214:215], v185 offset:24832
s_waitcnt lgkmcnt(8)
v_mfma_f32_16x16x32_bf16 v[64:67], a[192:195], v[160:163], v[64:67]
ds_read_b64_tr_b16 a[216:217], v186 offset:16640
v_max3_f32 v208, v208, v133, v134
v_mfma_f32_16x16x32_bf16 v[72:75], a[192:195], v[164:167], v[72:75]
ds_read_b64_tr_b16 a[218:219], v186 offset:24832
s_waitcnt vmcnt(6)
s_mov_b32 s34, 196608
buffer_load_dwordx4 v190, s[8:11], s34 offen offset:2048 nt lds
v_mfma_f32_16x16x32_bf16 v[68:71], a[196:199], v[160:163], v[68:71]
ds_read_b64_tr_b16 a[220:221], v187 offset:16640
v_max3_f32 v209, v209, v141, v142
v_mfma_f32_16x16x32_bf16 v[76:79], a[196:199], v[164:167], v[76:79]
ds_read_b64_tr_b16 a[222:223], v187 offset:24832
s_waitcnt lgkmcnt(8)
v_mfma_f32_16x16x32_bf16 v[80:83], a[200:203], v[160:163], v[80:83]
s_waitcnt lgkmcnt(0)
s_barrier
v_add_u32 v200, 65536, v200
ds_read_b128 a[192:195], v176 offset:32768
v_mfma_f32_16x16x32_bf16 v[88:91], a[200:203], v[164:167], v[88:91]
v_max_f32 v208, v208, v135
v_mfma_f32_16x16x32_bf16 v[84:87], a[204:207], v[160:163], v[84:87]
ds_read_b128 a[196:199], v176 offset:40960
v_mfma_f32_16x16x32_bf16 v[92:95], a[204:207], v[164:167], v[92:95]
v_max_f32 v209, v209, v143
s_waitcnt lgkmcnt(6)
v_mfma_f32_16x16x32_bf16 v[96:99], a[208:211], v[160:163], v[96:99]
ds_read_b128 a[200:203], v177 offset:32768
v_max_f32 v210, v208, v209
v_mfma_f32_16x16x32_bf16 v[104:107], a[208:211], v[164:167], v[104:107]
ds_read_b64_tr_b16 a[16:17], v200 offset:0
s_add_u32 m0, s33, 147456
s_lshl_b32 s71, s73, 7
buffer_load_dwordx4 v198, s[24:27], s71 offen offset:2048  lds
v_mfma_f32_16x16x32_bf16 v[100:103], a[212:215], v[160:163], v[100:103]
ds_read_b128 a[204:207], v177 offset:40960
v_cmp_lt_f32 vcc, s80, v210
v_mfma_f32_16x16x32_bf16 v[108:111], a[212:215], v[164:167], v[108:111]
ds_read_b64_tr_b16 a[18:19], v200 offset:2048
s_waitcnt vmcnt(6)
s_add_u32 m0, s33, 0
s_mov_b32 s34, 197632
buffer_load_dwordx4 v191, s[8:11], s34 offen offset:3072 nt lds
s_waitcnt lgkmcnt(6)
v_mfma_f32_16x16x32_bf16 v[112:115], a[216:219], v[160:163], v[112:115]
ds_read_b128 a[208:211], v178 offset:32768
v_mfma_f32_16x16x32_bf16 v[120:123], a[216:219], v[164:167], v[120:123]
ds_read_b64_tr_b16 a[20:21], v200 offset:4096
v_mfma_f32_16x16x32_bf16 v[116:119], a[220:223], v[160:163], v[116:119]
ds_read_b128 a[212:215], v178 offset:40960
v_mfma_f32_16x16x32_bf16 v[124:127], a[220:223], v[164:167], v[124:127]
ds_read_b64_tr_b16 a[22:23], v200 offset:6144
s_cbranch_vccz L_nors10
s_call_b64 s[82:83], L_rescale
L_nors10:
s_waitcnt lgkmcnt(8)
v_mfma_f32_16x16x32_bf16 v[144:147], a[192:195], a[128:131], v[168:171]
ds_read_b128 a[216:219], v179 offset:32768
v_exp_f32 v128, v128
v_mfma_f32_16x16x32_bf16 v[152:155], a[192:195], a[132:135], v[172:175]
ds_read_b64_tr_b16 a[24:25], v200 offset:8192
v_exp_f32 v129, v129
v_mfma_f32_16x16x32_bf16 v[148:151], a[196:199], a[128:131], v[168:171]
ds_read_b128 a[220:223], v179 offset:40960
v_exp_f32 v130, v130
v_mfma_f32_16x16x32_bf16 v[156:159], a[196:199], a[132:135], v[172:175]
ds_read_b64_tr_b16 a[26:27], v200 offset:10240
v_cvt_pk_bf16_f32 v160, v128, v129
s_waitcnt vmcnt(6)
s_add_u32 m0, s33, 81920
s_mov_b32 s34, 197632
buffer_load_dwordx4 v192, s[12:15], s34 offen offset:0 nt lds
s_waitcnt lgkmcnt(8)
v_mfma_f32_16x16x32_bf16 v[144:147], a[200:203], a[136:139], v[144:147]
ds_read_b128 a[192:195], v176 offset:33024
v_exp_f32 v131, v131
v_mfma_f32_16x16x32_bf16 v[152:155], a[200:203], a[140:143], v[152:155]
ds_read_b64_tr_b16 a[28:29], v200 offset:12288
v_mfma_f32_16x16x32_bf16 v[148:151], a[204:207], a[136:139], v[148:151]
ds_read_b128 a[196:199], v176 offset:41216
v_exp_f32 v132, v132
v_mfma_f32_16x16x32_bf16 v[156:159], a[204:207], a[140:143], v[156:159]
ds_read_b64_tr_b16 a[30:31], v200 offset:14336
v_cvt_pk_bf16_f32 v161, v130, v131
s_waitcnt lgkmcnt(8)
v_mfma_f32_16x16x32_bf16 v[144:147], a[208:211], a[144:147], v[144:147]
ds_read_b128 a[200:203], v177 offset:33024
v_mfma_f32_16x16x32_bf16 v[152:155], a[208:211], a[148:151], v[152:155]
v_exp_f32 v133, v133
v_mfma_f32_16x16x32_bf16 v[148:151], a[212:215], a[144:147], v[148:151]
ds_read_b128 a[204:207], v177 offset:41216
v_exp_f32 v134, v134
v_mfma_f32_16x16x32_bf16 v[156:159], a[212:215], a[148:151], v[156:159]
v_cvt_pk_bf16_f32 v162, v132, v133
s_waitcnt lgkmcnt(6)
v_mfma_f32_16x16x32_bf16 v[144:147], a[216:219], a[152:155], v[144:147]
ds_read_b128 a[208:211], v178 offset:33024
v_mfma_f32_16x16x32_bf16 v[152:155], a[216:219], a[156:159], v[152:155]
v_exp_f32 v135, v135
s_waitcnt vmcnt(6)
s_mov_b32 s34, 196608
buffer_load_dwordx4 v193, s[12:15], s34 offen offset:1024 nt lds
v_mfma_f32_16x16x32_bf16 v[148:151], a[220:223], a[152:155], v[148:151]
ds_read_b128 a[212:215], v178 offset:41216
v_exp_f32 v136, v136
v_mfma_f32_16x16x32_bf16 v[156:159], a[220:223], a[156:159], v[156:159]
v_cvt_pk_bf16_f32 v163, v134, v135
s_waitcnt lgkmcnt(4)
v_mfma_f32_16x16x32_bf16 v[144:147], a[192:195], a[160:163], v[144:147]
ds_read_b128 a[216:219], v179 offset:33024
v_mfma_f32_16x16x32_bf16 v[152:155], a[192:195], a[164:167], v[152:155]
v_exp_f32 v137, v137
s_add_u32 m0, s33, 147456
s_lshl_b32 s71, s73, 7
buffer_load_dwordx4 v199, s[24:27], s71 offen offset:3072  lds
v_mfma_f32_16x16x32_bf16 v[148:151], a[196:199], a[160:163], v[148:151]
ds_read_b128 a[220:223], v179 offset:41216
v_exp_f32 v138, v138
v_mfma_f32_16x16x32_bf16 v[156:159], a[196:199], a[164:167], v[156:159]
v_cvt_pk_bf16_f32 v164, v136, v137
s_waitcnt lgkmcnt(4)
v_mfma_f32_16x16x32_bf16 v[144:147], a[200:203], a[168:171], v[144:147]
s_waitcnt lgkmcnt(0)
s_barrier
ds_read_b64_tr_b16 a[192:193], v180 offset:32768
v_exp_f32 v139, v139
v_mfma_f32_16x16x32_bf16 v[152:155], a[200:203], a[172:175], v[152:155]
ds_read_b64_tr_b16 a[194:195], v180 offset:40960
s_waitcnt vmcnt(6)
s_add_u32 m0, s33, 81920
s_mov_b32 s34, 199680
buffer_load_dwordx4 v194, s[12:15], s34 offen offset:2048 nt lds
v_mfma_f32_16x16x32_bf16 v[148:151], a[204:207], a[168:171], v[148:151]
ds_read_b64_tr_b16 a[196:197], v181 offset:32768
v_exp_f32 v140, v140
v_mfma_f32_16x16x32_bf16 v[156:159], a[204:207], a[172:175], v[156:159]
ds_read_b64_tr_b16 a[198:199], v181 offset:40960
v_cvt_pk_bf16_f32 v165, v138, v139
s_waitcnt lgkmcnt(6)
v_mfma_f32_16x16x32_bf16 v[144:147], a[208:211], a[176:179], v[144:147]
ds_read_b64_tr_b16 a[200:201], v182 offset:32768
v_exp_f32 v141, v141
v_mfma_f32_16x16x32_bf16 v[152:155], a[208:211], a[180:183], v[152:155]
ds_read_b64_tr_b16 a[202:203], v182 offset:40960
v_mfma_f32_16x16x32_bf16 v[148:151], a[212:215], a[176:179], v[148:151]
ds_read_b64_tr_b16 a[204:205], v183 offset:32768
v_exp_f32 v142, v142
v_mfma_f32_16x16x32_bf16 v[156:159], a[212:215], a[180:183], v[156:159]
ds_read_b64_tr_b16 a[206:207], v183 offset:40960
v_cvt_pk_bf16_f32 v166, v140, v141
s_waitcnt lgkmcnt(8)
v_mfma_f32_16x16x32_bf16 v[144:147], a[216:219], a[184:187], v[144:147]
ds_read_b64_tr_b16 a[208:209], v184 offset:32768
v_exp_f32 v143, v143
v_mfma_f32_16x16x32_bf16 v[152:155], a[216:219], a[188:191], v[152:155]
ds_read_b64_tr_b16 a[210:211], v184 offset:40960
v_mfma_f32_16x16x32_bf16 v[148:151], a[220:223], a[184:187], v[148:151]
ds_read_b64_tr_b16 a[212:213], v185 offset:32768
v_cvt_pk_bf16_f32 v167, v142, v143
v_mfma_f32_16x16x32_bf16 v[156:159], a[220:223], a[188:191], v[156:159]
ds_read_b64_tr_b16 a[214:215], v185 offset:40960
s_waitcnt vmcnt(6)
s_mov_b32 s34, 198656
buffer_load_dwordx4 v195, s[12:15], s34 offen offset:3072 nt lds
s_nop 0
s_waitcnt lgkmcnt(8)
v_mfma_f32_16x16x32_bf16 v[0:3], a[192:195], v[160:163], v[0:3]
ds_read_b64_tr_b16 a[216:217], v186 offset:32768
v_mfma_f32_16x16x32_bf16 v[8:11], a[192:195], v[164:167], v[8:11]
ds_read_b64_tr_b16 a[218:219], v186 offset:40960
v_mfma_f32_16x16x32_bf16 a[224:227], a[232:235], v[160:163], a[224:227]
v_mfma_f32_16x16x32_bf16 v[4:7], a[196:199], v[160:163], v[4:7]
ds_read_b64_tr_b16 a[220:221], v187 offset:32768
v_mfma_f32_16x16x32_bf16 v[12:15], a[196:199], v[164:167], v[12:15]
ds_read_b64_tr_b16 a[222:223], v187 offset:40960
v_mfma_f32_16x16x32_bf16 a[228:231], a[232:235], v[164:167], a[228:231]
s_waitcnt lgkmcnt(8)
v_mfma_f32_16x16x32_bf16 v[16:19], a[200:203], v[160:163], v[16:19]
ds_read_b64_tr_b16 a[192:193], v180 offset:33024
v_mfma_f32_16x16x32_bf16 v[24:27], a[200:203], v[164:167], v[24:27]
ds_read_b64_tr_b16 a[194:195], v180 offset:41216
v_mfma_f32_16x16x32_bf16 v[20:23], a[204:207], v[160:163], v[20:23]
ds_read_b64_tr_b16 a[196:197], v181 offset:33024
v_mfma_f32_16x16x32_bf16 v[28:31], a[204:207], v[164:167], v[28:31]
ds_read_b64_tr_b16 a[198:199], v181 offset:41216
s_waitcnt vmcnt(5)
s_add_u32 m0, s33, 32768
s_mov_b32 s34, 199680
buffer_load_dwordx4 v188, s[8:11], s34 offen offset:0 nt lds
s_waitcnt lgkmcnt(8)
v_mfma_f32_16x16x32_bf16 v[32:35], a[208:211], v[160:163], v[32:35]
ds_read_b64_tr_b16 a[200:201], v182 offset:33024
v_max3_f32 v208, v144, v145, v146
v_mfma_f32_16x16x32_bf16 v[40:43], a[208:211], v[164:167], v[40:43]
ds_read_b64_tr_b16 a[202:203], v182 offset:41216
s_add_u32 m0, s33, 131072
s_lshl_b32 s71, s73, 7
s_add_u32 s71, s71, 114688
buffer_load_dwordx4 v196, s[24:27], s71 offen offset:0  lds
v_mfma_f32_16x16x32_bf16 v[36:39], a[212:215], v[160:163], v[36:39]
ds_read_b64_tr_b16 a[204:205], v183 offset:33024
v_max3_f32 v209, v152, v153, v154
v_mfma_f32_16x16x32_bf16 v[44:47], a[212:215], v[164:167], v[44:47]
ds_read_b64_tr_b16 a[206:207], v183 offset:41216
s_waitcnt lgkmcnt(8)
v_mfma_f32_16x16x32_bf16 v[48:51], a[216:219], v[160:163], v[48:51]
ds_read_b64_tr_b16 a[208:209], v184 offset:33024
v_max3_f32 v208, v208, v147, v148
v_mfma_f32_16x16x32_bf16 v[56:59], a[216:219], v[164:167], v[56:59]
ds_read_b64_tr_b16 a[210:211], v184 offset:41216
v_mfma_f32_16x16x32_bf16 v[52:55], a[220:223], v[160:163], v[52:55]
ds_read_b64_tr_b16 a[212:213], v185 offset:33024
v_max3_f32 v209, v209, v155, v156
v_mfma_f32_16x16x32_bf16 v[60:63], a[220:223], v[164:167], v[60:63]
ds_read_b64_tr_b16 a[214:215], v185 offset:41216
s_waitcnt lgkmcnt(8)
v_mfma_f32_16x16x32_bf16 v[64:67], a[192:195], v[160:163], v[64:67]
ds_read_b64_tr_b16 a[216:217], v186 offset:33024
v_max3_f32 v208, v208, v149, v150
v_mfma_f32_16x16x32_bf16 v[72:75], a[192:195], v[164:167], v[72:75]
ds_read_b64_tr_b16 a[218:219], v186 offset:41216
s_waitcnt vmcnt(6)
s_add_u32 m0, s33, 32768
s_mov_b32 s34, 198656
buffer_load_dwordx4 v189, s[8:11], s34 offen offset:1024 nt lds
v_mfma_f32_16x16x32_bf16 v[68:71], a[196:199], v[160:163], v[68:71]
ds_read_b64_tr_b16 a[220:221], v187 offset:33024
v_max3_f32 v209, v209, v157, v158
v_mfma_f32_16x16x32_bf16 v[76:79], a[196:199], v[164:167], v[76:79]
ds_read_b64_tr_b16 a[222:223], v187 offset:41216
s_waitcnt lgkmcnt(8)
v_mfma_f32_16x16x32_bf16 v[80:83], a[200:203], v[160:163], v[80:83]
v_add_u32 v176, 65536, v176
v_add_u32 v177, 65536, v177
v_add_u32 v178, 65536, v178
v_add_u32 v179, 65536, v179
s_waitcnt lgkmcnt(0)
s_barrier
ds_read_b128 a[192:195], v176 offset:49152
v_mfma_f32_16x16x32_bf16 v[88:91], a[200:203], v[164:167], v[88:91]
v_max_f32 v208, v208, v151
v_mfma_f32_16x16x32_bf16 v[84:87], a[204:207], v[160:163], v[84:87]
ds_read_b128 a[196:199], v176 offset:57344
v_mfma_f32_16x16x32_bf16 v[92:95], a[204:207], v[164:167], v[92:95]
v_max_f32 v209, v209, v159
s_waitcnt lgkmcnt(6)
v_mfma_f32_16x16x32_bf16 v[96:99], a[208:211], v[160:163], v[96:99]
ds_read_b128 a[200:203], v177 offset:49152
v_mfma_f32_16x16x32_bf16 v[104:107], a[208:211], v[164:167], v[104:107]
v_max_f32 v210, v208, v209
s_waitcnt vmcnt(6)
s_mov_b32 s34, 197632
buffer_load_dwordx4 v190, s[8:11], s34 offen offset:2048 nt lds
v_mfma_f32_16x16x32_bf16 v[100:103], a[212:215], v[160:163], v[100:103]
ds_read_b128 a[204:207], v177 offset:57344
v_mfma_f32_16x16x32_bf16 v[108:111], a[212:215], v[164:167], v[108:111]
v_cmp_lt_f32 vcc, s80, v210
s_waitcnt lgkmcnt(4)
v_mfma_f32_16x16x32_bf16 v[112:115], a[216:219], v[160:163], v[112:115]
ds_read_b128 a[208:211], v178 offset:49152
v_mfma_f32_16x16x32_bf16 v[120:123], a[216:219], v[164:167], v[120:123]
v_mfma_f32_16x16x32_bf16 v[116:119], a[220:223], v[160:163], v[116:119]
ds_read_b128 a[212:215], v178 offset:57344
v_mfma_f32_16x16x32_bf16 v[124:127], a[220:223], v[164:167], v[124:127]
s_cbranch_vccz L_nors11
s_call_b64 s[82:83], L_rescale
L_nors11:
s_waitcnt lgkmcnt(4)
v_mfma_f32_16x16x32_bf16 v[128:131], a[192:195], a[128:131], v[168:171]
ds_read_b128 a[216:219], v179 offset:49152
v_exp_f32 v144, v144
v_mfma_f32_16x16x32_bf16 v[136:139], a[192:195], a[132:135], v[172:175]
v_exp_f32 v145, v145
s_add_u32 m0, s33, 131072
s_lshl_b32 s71, s73, 7
s_add_u32 s71, s71, 114688
buffer_load_dwordx4 v197, s[24:27], s71 offen offset:1024  lds
v_mfma_f32_16x16x32_bf16 v[132:135], a[196:199], a[128:131], v[168:171]
ds_read_b128 a[220:223], v179 offset:57344
v_exp_f32 v146, v146
v_mfma_f32_16x16x32_bf16 v[140:143], a[196:199], a[132:135], v[172:175]
v_cvt_pk_bf16_f32 v160, v144, v145
s_waitcnt vmcnt(6)
s_add_u32 m0, s33, 32768
s_mov_b32 s34, 196608
buffer_load_dwordx4 v191, s[8:11], s34 offen offset:3072 nt lds
s_waitcnt lgkmcnt(4)
v_mfma_f32_16x16x32_bf16 v[128:131], a[200:203], a[136:139], v[128:131]
ds_read_b128 a[192:195], v176 offset:49408
v_mfma_f32_16x16x32_bf16 v[136:139], a[200:203], a[140:143], v[136:139]
v_exp_f32 v147, v147
v_mfma_f32_16x16x32_bf16 v[132:135], a[204:207], a[136:139], v[132:135]
ds_read_b128 a[196:199], v176 offset:57600
v_exp_f32 v148, v148
v_mfma_f32_16x16x32_bf16 v[140:143], a[204:207], a[140:143], v[140:143]
v_cvt_pk_bf16_f32 v161, v146, v147
s_waitcnt lgkmcnt(4)
v_mfma_f32_16x16x32_bf16 v[128:131], a[208:211], a[144:147], v[128:131]
ds_read_b128 a[200:203], v177 offset:49408
v_mfma_f32_16x16x32_bf16 v[136:139], a[208:211], a[148:151], v[136:139]
v_exp_f32 v149, v149
v_mfma_f32_16x16x32_bf16 v[132:135], a[212:215], a[144:147], v[132:135]
ds_read_b128 a[204:207], v177 offset:57600
v_exp_f32 v150, v150
v_mfma_f32_16x16x32_bf16 v[140:143], a[212:215], a[148:151], v[140:143]
v_cvt_pk_bf16_f32 v162, v148, v149
s_waitcnt vmcnt(6)
s_add_u32 m0, s33, 98304
s_mov_b32 s34, 198656
buffer_load_dwordx4 v192, s[12:15], s34 offen offset:0 nt lds
s_waitcnt lgkmcnt(4)
v_mfma_f32_16x16x32_bf16 v[128:131], a[216:219], a[152:155], v[128:131]
ds_read_b128 a[208:211], v178 offset:49408
v_mfma_f32_16x16x32_bf16 v[136:139], a[216:219], a[156:159], v[136:139]
v_exp_f32 v151, v151
v_mfma_f32_16x16x32_bf16 v[132:135], a[220:223], a[152:155], v[132:135]
ds_read_b128 a[212:215], v178 offset:57600
v_exp_f32 v152, v152
v_mfma_f32_16x16x32_bf16 v[140:143], a[220:223], a[156:159], v[140:143]
v_cvt_pk_bf16_f32 v163, v150, v151
s_waitcnt lgkmcnt(4)
v_mfma_f32_16x16x32_bf16 v[128:131], a[192:195], a[160:163], v[128:131]
ds_read_b128 a[216:219], v179 offset:49408
v_mfma_f32_16x16x32_bf16 v[136:139], a[192:195], a[164:167], v[136:139]
v_exp_f32 v153, v153
v_mfma_f32_16x16x32_bf16 v[132:135], a[196:199], a[160:163], v[132:135]
ds_read_b128 a[220:223], v179 offset:57600
v_exp_f32 v154, v154
v_mfma_f32_16x16x32_bf16 v[140:143], a[196:199], a[164:167], v[140:143]
v_cvt_pk_bf16_f32 v164, v152, v153
s_waitcnt lgkmcnt(4)
v_mfma_f32_16x16x32_bf16 v[128:131], a[200:203], a[168:171], v[128:131]
s_waitcnt lgkmcnt(0)
s_barrier
ds_read_b64_tr_b16 a[192:193], v180 offset:0
v_exp_f32 v155, v155
v_mfma_f32_16x16x32_bf16 v[136:139], a[200:203], a[172:175], v[136:139]
ds_read_b64_tr_b16 a[194:195], v180 offset:8192
s_waitcnt vmcnt(6)
s_mov_b32 s34, 199680
buffer_load_dwordx4 v193, s[12:15], s34 offen offset:1024 nt lds
v_mfma_f32_16x16x32_bf16 v[132:135], a[204:207], a[168:171], v[132:135]
ds_read_b64_tr_b16 a[196:197], v181 offset:0
v_exp_f32 v156, v156
v_mfma_f32_16x16x32_bf16 v[140:143], a[204:207], a[172:175], v[140:143]
ds_read_b64_tr_b16 a[198:199], v181 offset:8192
v_cvt_pk_bf16_f32 v165, v154, v155
s_waitcnt lgkmcnt(6)
v_mfma_f32_16x16x32_bf16 v[128:131], a[208:211], a[176:179], v[128:131]
ds_read_b64_tr_b16 a[200:201], v182 offset:0
v_exp_f32 v157, v157
v_mfma_f32_16x16x32_bf16 v[136:139], a[208:211], a[180:183], v[136:139]
ds_read_b64_tr_b16 a[202:203], v182 offset:8192
s_add_u32 m0, s33, 131072
s_lshl_b32 s71, s73, 7
s_add_u32 s71, s71, 114688
buffer_load_dwordx4 v198, s[24:27], s71 offen offset:2048  lds
v_mfma_f32_16x16x32_bf16 v[132:135], a[212:215], a[176:179], v[132:135]
ds_read_b64_tr_b16 a[204:205], v183 offset:0
v_exp_f32 v158, v158
v_mfma_f32_16x16x32_bf16 v[140:143], a[212:215], a[180:183], v[140:143]
ds_read_b64_tr_b16 a[206:207], v183 offset:8192
v_cvt_pk_bf16_f32 v166, v156, v157
s_waitcnt lgkmcnt(8)
v_mfma_f32_16x16x32_bf16 v[128:131], a[216:219], a[184:187], v[128:131]
ds_read_b64_tr_b16 a[208:209], v184 offset:0
v_exp_f32 v159, v159
v_mfma_f32_16x16x32_bf16 v[136:139], a[216:219], a[188:191], v[136:139]
ds_read_b64_tr_b16 a[210:211], v184 offset:8192
s_waitcnt vmcnt(6)
s_add_u32 m0, s33, 98304
s_mov_b32 s34, 196608
buffer_load_dwordx4 v194, s[12:15], s34 offen offset:2048 nt lds
v_mfma_f32_16x16x32_bf16 v[132:135], a[220:223], a[184:187], v[132:135]
ds_read_b64_tr_b16 a[212:213], v185 offset:0
v_cvt_pk_bf16_f32 v167, v158, v159
v_mfma_f32_16x16x32_bf16 v[140:143], a[220:223], a[188:191], v[140:143]
ds_read_b64_tr_b16 a[214:215], v185 offset:8192
s_nop 0
s_waitcnt lgkmcnt(8)
v_mfma_f32_16x16x32_bf16 v[0:3], a[192:195], v[160:163], v[0:3]
ds_read_b64_tr_b16 a[216:217], v186 offset:0
v_mfma_f32_16x16x32_bf16 v[8:11], a[192:195], v[164:167], v[8:11]
ds_read_b64_tr_b16 a[218:219], v186 offset:8192
v_mfma_f32_16x16x32_bf16 a[224:227], a[232:235], v[160:163], a[224:227]
v_mfma_f32_16x16x32_bf16 v[4:7], a[196:199], v[160:163], v[4:7]
ds_read_b64_tr_b16 a[220:221], v187 offset:0
v_mfma_f32_16x16x32_bf16 v[12:15], a[196:199], v[164:167], v[12:15]
ds_read_b64_tr_b16 a[222:223], v187 offset:8192
v_mfma_f32_16x16x32_bf16 a[228:231], a[232:235], v[164:167], a[228:231]
s_waitcnt lgkmcnt(8)
v_mfma_f32_16x16x32_bf16 v[16:19], a[200:203], v[160:163], v[16:19]
ds_read_b64_tr_b16 a[192:193], v180 offset:256
v_mfma_f32_16x16x32_bf16 v[24:27], a[200:203], v[164:167], v[24:27]
ds_read_b64_tr_b16 a[194:195], v180 offset:8448
v_mfma_f32_16x16x32_bf16 v[20:23], a[204:207], v[160:163], v[20:23]
ds_read_b64_tr_b16 a[196:197], v181 offset:256
v_mfma_f32_16x16x32_bf16 v[28:31], a[204:207], v[164:167], v[28:31]
ds_read_b64_tr_b16 a[198:199], v181 offset:8448
s_waitcnt vmcnt(6)
s_mov_b32 s34, 197632
buffer_load_dwordx4 v195, s[12:15], s34 offen offset:3072 nt lds
s_waitcnt lgkmcnt(8)
v_mfma_f32_16x16x32_bf16 v[32:35], a[208:211], v[160:163], v[32:35]
ds_read_b64_tr_b16 a[200:201], v182 offset:256
v_max3_f32 v208, v128, v129, v130
v_mfma_f32_16x16x32_bf16 v[40:43], a[208:211], v[164:167], v[40:43]
ds_read_b64_tr_b16 a[202:203], v182 offset:8448
v_mfma_f32_16x16x32_bf16 v[36:39], a[212:215], v[160:163], v[36:39]
ds_read_b64_tr_b16 a[204:205], v183 offset:256
v_max3_f32 v209, v136, v137, v138
v_mfma_f32_16x16x32_bf16 v[44:47], a[212:215], v[164:167], v[44:47]
ds_read_b64_tr_b16 a[206:207], v183 offset:8448
s_waitcnt lgkmcnt(8)
v_mfma_f32_16x16x32_bf16 v[48:51], a[216:219], v[160:163], v[48:51]
ds_read_b64_tr_b16 a[208:209], v184 offset:256
v_max3_f32 v208, v208, v131, v132
v_mfma_f32_16x16x32_bf16 v[56:59], a[216:219], v[164:167], v[56:59]
ds_read_b64_tr_b16 a[210:211], v184 offset:8448
v_mfma_f32_16x16x32_bf16 v[52:55], a[220:223], v[160:163], v[52:55]
ds_read_b64_tr_b16 a[212:213], v185 offset:256
v_max3_f32 v209, v209, v139, v140
v_mfma_f32_16x16x32_bf16 v[60:63], a[220:223], v[164:167], v[60:63]
ds_read_b64_tr_b16 a[214:215], v185 offset:8448
s_waitcnt lgkmcnt(8)
v_mfma_f32_16x16x32_bf16 v[64:67], a[192:195], v[160:163], v[64:67]
ds_read_b64_tr_b16 a[216:217], v186 offset:256
v_max3_f32 v208, v208, v133, v134
v_mfma_f32_16x16x32_bf16 v[72:75], a[192:195], v[164:167], v[72:75]
ds_read_b64_tr_b16 a[218:219], v186 offset:8448
s_waitcnt vmcnt(5)
s_add_u32 m0, s33, 114688
s_mov_b32 s34, 262144
buffer_load_dwordx4 v188, s[8:11], s34 offen offset:0 nt lds
s_add_u32 m0, s33, 131072
s_lshl_b32 s71, s73, 7
s_add_u32 s71, s71, 114688
buffer_load_dwordx4 v199, s[24:27], s71 offen offset:3072  lds
v_mfma_f32_16x16x32_bf16 v[68:71], a[196:199], v[160:163], v[68:71]
ds_read_b64_tr_b16 a[220:221], v187 offset:256
v_max3_f32 v209, v209, v141, v142
v_mfma_f32_16x16x32_bf16 v[76:79], a[196:199], v[164:167], v[76:79]
ds_read_b64_tr_b16 a[222:223], v187 offset:8448
s_waitcnt lgkmcnt(8)
v_mfma_f32_16x16x32_bf16 v[80:83], a[200:203], v[160:163], v[80:83]
v_subrev_u32 v176, 65536, v176
v_subrev_u32 v177, 65536, v177
v_subrev_u32 v178, 65536, v178
v_subrev_u32 v179, 65536, v179
s_waitcnt lgkmcnt(0)
s_barrier
ds_read_b128 a[192:195], v176 offset:49152
v_mfma_f32_16x16x32_bf16 v[88:91], a[200:203], v[164:167], v[88:91]
v_max_f32 v208, v208, v135
v_mfma_f32_16x16x32_bf16 v[84:87], a[204:207], v[160:163], v[84:87]
ds_read_b128 a[196:199], v176 offset:57344
v_mfma_f32_16x16x32_bf16 v[92:95], a[204:207], v[164:167], v[92:95]
v_max_f32 v209, v209, v143
s_waitcnt lgkmcnt(6)
v_mfma_f32_16x16x32_bf16 v[96:99], a[208:211], v[160:163], v[96:99]
ds_read_b128 a[200:203], v177 offset:49152
v_max_f32 v210, v208, v209
v_mfma_f32_16x16x32_bf16 v[104:107], a[208:211], v[164:167], v[104:107]
ds_read_b64_tr_b16 a[32:33], v200 offset:16384
s_waitcnt vmcnt(6)
s_add_u32 m0, s33, 114688
s_mov_b32 s34, 263168
buffer_load_dwordx4 v189, s[8:11], s34 offen offset:1024 nt lds
v_mfma_f32_16x16x32_bf16 v[100:103], a[212:215], v[160:163], v[100:103]
ds_read_b128 a[204:207], v177 offset:57344
v_cmp_lt_f32 vcc, s80, v210
v_mfma_f32_16x16x32_bf16 v[108:111], a[212:215], v[164:167], v[108:111]
ds_read_b64_tr_b16 a[34:35], v200 offset:18432
s_waitcnt lgkmcnt(6)
v_mfma_f32_16x16x32_bf16 v[112:115], a[216:219], v[160:163], v[112:115]
ds_read_b128 a[208:211], v178 offset:49152
v_mfma_f32_16x16x32_bf16 v[120:123], a[216:219], v[164:167], v[120:123]
ds_read_b64_tr_b16 a[36:37], v200 offset:20480
v_mfma_f32_16x16x32_bf16 v[116:119], a[220:223], v[160:163], v[116:119]
ds_read_b128 a[212:215], v178 offset:57344
v_mfma_f32_16x16x32_bf16 v[124:127], a[220:223], v[164:167], v[124:127]
ds_read_b64_tr_b16 a[38:39], v200 offset:22528
s_cbranch_vccz L_nors12
s_call_b64 s[82:83], L_rescale
L_nors12:
s_waitcnt lgkmcnt(8)
v_mfma_f32_16x16x32_bf16 v[144:147], a[192:195], a[128:131], v[168:171]
ds_read_b128 a[216:219], v179 offset:49152
v_exp_f32 v128, v128
v_mfma_f32_16x16x32_bf16 v[152:155], a[192:195], a[132:135], v[172:175]
ds_read_b64_tr_b16 a[40:41], v200 offset:24576
v_exp_f32 v129, v129
v_mfma_f32_16x16x32_bf16 v[148:151], a[196:199], a[128:131], v[168:171]
ds_read_b128 a[220:223], v179 offset:57344
v_exp_f32 v130, v130
v_mfma_f32_16x16x32_bf16 v[156:159], a[196:199], a[132:135], v[172:175]
ds_read_b64_tr_b16 a[42:43], v200 offset:26624
v_cvt_pk_bf16_f32 v160, v128, v129
s_waitcnt vmcnt(6)
s_mov_b32 s34, 264192
buffer_load_dwordx4 v190, s[8:11], s34 offen offset:2048 nt lds
s_waitcnt lgkmcnt(8)
v_mfma_f32_16x16x32_bf16 v[144:147], a[200:203], a[136:139], v[144:147]
ds_read_b128 a[192:195], v176 offset:49408
v_exp_f32 v131, v131
v_mfma_f32_16x16x32_bf16 v[152:155], a[200:203], a[140:143], v[152:155]
ds_read_b64_tr_b16 a[44:45], v200 offset:28672
v_mfma_f32_16x16x32_bf16 v[148:151], a[204:207], a[136:139], v[148:151]
ds_read_b128 a[196:199], v176 offset:57600
v_exp_f32 v132, v132
v_mfma_f32_16x16x32_bf16 v[156:159], a[204:207], a[140:143], v[156:159]
ds_read_b64_tr_b16 a[46:47], v200 offset:30720
v_cvt_pk_bf16_f32 v161, v130, v131
s_waitcnt lgkmcnt(8)
v_mfma_f32_16x16x32_bf16 v[144:147], a[208:211], a[144:147], v[144:147]
ds_read_b128 a[200:203], v177 offset:49408
v_mfma_f32_16x16x32_bf16 v[152:155], a[208:211], a[148:151], v[152:155]
v_exp_f32 v133, v133
v_mfma_f32_16x16x32_bf16 v[148:151], a[212:215], a[144:147], v[148:151]
ds_read_b128 a[204:207], v177 offset:57600
v_exp_f32 v134, v134
v_mfma_f32_16x16x32_bf16 v[156:159], a[212:215], a[148:151], v[156:159]
v_cvt_pk_bf16_f32 v162, v132, v133
s_waitcnt vmcnt(5)
s_mov_b32 s34, 265216
buffer_load_dwordx4 v191, s[8:11], s34 offen offset:3072 nt lds
s_waitcnt lgkmcnt(6)
v_mfma_f32_16x16x32_bf16 v[144:147], a[216:219], a[152:155], v[144:147]
ds_read_b128 a[208:211], v178 offset:49408
v_mfma_f32_16x16x32_bf16 v[152:155], a[216:219], a[156:159], v[152:155]
v_exp_f32 v135, v135
v_mfma_f32_16x16x32_bf16 v[148:151], a[220:223], a[152:155], v[148:151]
ds_read_b128 a[212:215], v178 offset:57600
v_exp_f32 v136, v136
v_mfma_f32_16x16x32_bf16 v[156:159], a[220:223], a[156:159], v[156:159]
v_cvt_pk_bf16_f32 v163, v134, v135
s_waitcnt lgkmcnt(4)
v_mfma_f32_16x16x32_bf16 v[144:147], a[192:195], a[160:163], v[144:147]
ds_read_b128 a[216:219], v179 offset:49408
v_mfma_f32_16x16x32_bf16 v[152:155], a[192:195], a[164:167], v[152:155]
v_exp_f32 v137, v137
v_mfma_f32_16x16x32_bf16 v[148:151], a[196:199], a[160:163], v[148:151]
ds_read_b128 a[220:223], v179 offset:57600
v_exp_f32 v138, v138
v_mfma_f32_16x16x32_bf16 v[156:159], a[196:199], a[164:167], v[156:159]
v_cvt_pk_bf16_f32 v164, v136, v137
s_waitcnt lgkmcnt(4)
v_mfma_f32_16x16x32_bf16 v[144:147], a[200:203], a[168:171], v[144:147]
v_subrev_u32 v180, 65536, v180
v_subrev_u32 v181, 65536, v181
v_subrev_u32 v182, 65536, v182
v_subrev_u32 v183, 65536, v183
v_subrev_u32 v184, 65536, v184
v_subrev_u32 v185, 65536, v185
v_subrev_u32 v186, 65536, v186
v_subrev_u32 v187, 65536, v187
s_waitcnt lgkmcnt(0)
s_barrier
ds_read_b64_tr_b16 a[192:193], v180 offset:16384
v_exp_f32 v139, v139
v_mfma_f32_16x16x32_bf16 v[152:155], a[200:203], a[172:175], v[152:155]
ds_read_b64_tr_b16 a[194:195], v180 offset:24576
s_waitcnt vmcnt(5)
s_add_u32 m0, s33, 49152
s_mov_b32 s34, 199680
buffer_load_dwordx4 v192, s[12:15], s34 offen offset:0 nt lds
v_mfma_f32_16x16x32_bf16 v[148:151], a[204:207], a[168:171], v[148:151]
ds_read_b64_tr_b16 a[196:197], v181 offset:16384
v_exp_f32 v140, v140
v_mfma_f32_16x16x32_bf16 v[156:159], a[204:207], a[172:175], v[156:159]
ds_read_b64_tr_b16 a[198:199], v181 offset:24576
v_cvt_pk_bf16_f32 v165, v138, v139
s_waitcnt lgkmcnt(6)
v_mfma_f32_16x16x32_bf16 v[144:147], a[208:211], a[176:179], v[144:147]
ds_read_b64_tr_b16 a[200:201], v182 offset:16384
v_exp_f32 v141, v141
v_mfma_f32_16x16x32_bf16 v[152:155], a[208:211], a[180:183], v[152:155]
ds_read_b64_tr_b16 a[202:203], v182 offset:24576
v_mfma_f32_16x16x32_bf16 v[148:151], a[212:215], a[176:179], v[148:151]
ds_read_b64_tr_b16 a[204:205], v183 offset:16384
v_exp_f32 v142, v142
v_mfma_f32_16x16x32_bf16 v[156:159], a[212:215], a[180:183], v[156:159]
ds_read_b64_tr_b16 a[206:207], v183 offset:24576
v_cvt_pk_bf16_f32 v166, v140, v141
s_waitcnt lgkmcnt(8)
v_mfma_f32_16x16x32_bf16 v[144:147], a[216:219], a[184:187], v[144:147]
ds_read_b64_tr_b16 a[208:209], v184 offset:16384
v_exp_f32 v143, v143
v_mfma_f32_16x16x32_bf16 v[152:155], a[216:219], a[188:191], v[152:155]
ds_read_b64_tr_b16 a[210:211], v184 offset:24576
s_waitcnt vmcnt(5)
s_mov_b32 s34, 198656
buffer_load_dwordx4 v193, s[12:15], s34 offen offset:1024 nt lds
v_mfma_f32_16x16x32_bf16 v[148:151], a[220:223], a[184:187], v[148:151]
ds_read_b64_tr_b16 a[212:213], v185 offset:16384
v_cvt_pk_bf16_f32 v167, v142, v143
v_mfma_f32_16x16x32_bf16 v[156:159], a[220:223], a[188:191], v[156:159]
ds_read_b64_tr_b16 a[214:215], v185 offset:24576
s_nop 0
s_waitcnt lgkmcnt(8)
v_mfma_f32_16x16x32_bf16 v[0:3], a[192:195], v[160:163], v[0:3]
ds_read_b64_tr_b16 a[216:217], v186 offset:16384
v_mfma_f32_16x16x32_bf16 v[8:11], a[192:195], v[164:167], v[8:11]
ds_read_b64_tr_b16 a[218:219], v186 offset:24576
s_add_u32 m0, s33, 147456
s_lshl_b32 s71, s74, 7
buffer_load_dwordx4 v196, s[24:27], s71 offen offset:0  lds
v_mfma_f32_16x16x32_bf16 a[224:227], a[232:235], v[160:163], a[224:227]
v_mfma_f32_16x16x32_bf16 v[4:7], a[196:199], v[160:163], v[4:7]
ds_read_b64_tr_b16 a[220:221], v187 offset:16384
v_mfma_f32_16x16x32_bf16 v[12:15], a[196:199], v[164:167], v[12:15]
ds_read_b64_tr_b16 a[222:223], v187 offset:24576
v_mfma_f32_16x16x32_bf16 a[228:231], a[232:235], v[164:167], a[228:231]
s_waitcnt lgkmcnt(8)
v_mfma_f32_16x16x32_bf16 v[16:19], a[200:203], v[160:163], v[16:19]
ds_read_b64_tr_b16 a[192:193], v180 offset:16640
v_mfma_f32_16x16x32_bf16 v[24:27], a[200:203], v[164:167], v[24:27]
ds_read_b64_tr_b16 a[194:195], v180 offset:24832
v_mfma_f32_16x16x32_bf16 v[20:23], a[204:207], v[160:163], v[20:23]
ds_read_b64_tr_b16 a[196:197], v181 offset:16640
v_mfma_f32_16x16x32_bf16 v[28:31], a[204:207], v[164:167], v[28:31]
ds_read_b64_tr_b16 a[198:199], v181 offset:24832
s_waitcnt vmcnt(5)
s_add_u32 m0, s33, 49152
s_mov_b32 s34, 197632
buffer_load_dwordx4 v194, s[12:15], s34 offen offset:2048 nt lds
s_waitcnt lgkmcnt(8)
v_mfma_f32_16x16x32_bf16 v[32:35], a[208:211], v[160:163], v[32:35]
ds_read_b64_tr_b16 a[200:201], v182 offset:16640
v_max3_f32 v208, v144, v145, v146
v_mfma_f32_16x16x32_bf16 v[40:43], a[208:211], v[164:167], v[40:43]
ds_read_b64_tr_b16 a[202:203], v182 offset:24832
v_mfma_f32_16x16x32_bf16 v[36:39], a[212:215], v[160:163], v[36:39]
ds_read_b64_tr_b16 a[204:205], v183 offset:16640
v_max3_f32 v209, v152, v153, v154
v_mfma_f32_16x16x32_bf16 v[44:47], a[212:215], v[164:167], v[44:47]
ds_read_b64_tr_b16 a[206:207], v183 offset:24832
s_waitcnt lgkmcnt(8)
v_mfma_f32_16x16x32_bf16 v[48:51], a[216:219], v[160:163], v[48:51]
ds_read_b64_tr_b16 a[208:209], v184 offset:16640
v_max3_f32 v208, v208, v147, v148
v_mfma_f32_16x16x32_bf16 v[56:59], a[216:219], v[164:167], v[56:59]
ds_read_b64_tr_b16 a[210:211], v184 offset:24832
v_mfma_f32_16x16x32_bf16 v[52:55], a[220:223], v[160:163], v[52:55]
ds_read_b64_tr_b16 a[212:213], v185 offset:16640
v_max3_f32 v209, v209, v155, v156
v_mfma_f32_16x16x32_bf16 v[60:63], a[220:223], v[164:167], v[60:63]
ds_read_b64_tr_b16 a[214:215], v185 offset:24832
s_waitcnt vmcnt(5)
s_mov_b32 s34, 196608
buffer_load_dwordx4 v195, s[12:15], s34 offen offset:3072 nt lds
s_waitcnt lgkmcnt(8)
v_mfma_f32_16x16x32_bf16 v[64:67], a[192:195], v[160:163], v[64:67]
ds_read_b64_tr_b16 a[216:217], v186 offset:16640
v_max3_f32 v208, v208, v149, v150
v_mfma_f32_16x16x32_bf16 v[72:75], a[192:195], v[164:167], v[72:75]
ds_read_b64_tr_b16 a[218:219], v186 offset:24832
v_mfma_f32_16x16x32_bf16 v[68:71], a[196:199], v[160:163], v[68:71]
ds_read_b64_tr_b16 a[220:221], v187 offset:16640
v_max3_f32 v209, v209, v157, v158
v_mfma_f32_16x16x32_bf16 v[76:79], a[196:199], v[164:167], v[76:79]
ds_read_b64_tr_b16 a[222:223], v187 offset:24832
s_waitcnt lgkmcnt(8)
v_mfma_f32_16x16x32_bf16 v[80:83], a[200:203], v[160:163], v[80:83]
s_waitcnt lgkmcnt(0)
s_barrier
ds_read_b128 a[192:195], v176 offset:0
v_mfma_f32_16x16x32_bf16 v[88:91], a[200:203], v[164:167], v[88:91]
v_max_f32 v208, v208, v151
v_mfma_f32_16x16x32_bf16 v[84:87], a[204:207], v[160:163], v[84:87]
ds_read_b128 a[196:199], v176 offset:8192
v_mfma_f32_16x16x32_bf16 v[92:95], a[204:207], v[164:167], v[92:95]
v_max_f32 v209, v209, v159
s_waitcnt lgkmcnt(6)
v_mfma_f32_16x16x32_bf16 v[96:99], a[208:211], v[160:163], v[96:99]
ds_read_b128 a[200:203], v177 offset:0
v_max_f32 v210, v208, v209
v_mfma_f32_16x16x32_bf16 v[104:107], a[208:211], v[164:167], v[104:107]
ds_read_b64_tr_b16 a[48:49], v200 offset:0
s_waitcnt vmcnt(5)
s_add_u32 m0, s33, 16384
s_mov_b32 s34, 263168
buffer_load_dwordx4 v188, s[8:11], s34 offen offset:0 nt lds
s_add_u32 m0, s33, 147456
s_lshl_b32 s71, s74, 7
buffer_load_dwordx4 v197, s[24:27], s71 offen offset:1024  lds
v_mfma_f32_16x16x32_bf16 v[100:103], a[212:215], v[160:163], v[100:103]
ds_read_b128 a[204:207], v177 offset:8192
v_cmp_lt_f32 vcc, s80, v210
v_mfma_f32_16x16x32_bf16 v[108:111], a[212:215], v[164:167], v[108:111]
ds_read_b64_tr_b16 a[50:51], v200 offset:2048
s_waitcnt lgkmcnt(6)
v_mfma_f32_16x16x32_bf16 v[112:115], a[216:219], v[160:163], v[112:115]
ds_read_b128 a[208:211], v178 offset:0
v_mfma_f32_16x16x32_bf16 v[120:123], a[216:219], v[164:167], v[120:123]
ds_read_b64_tr_b16 a[52:53], v200 offset:4096
v_mfma_f32_16x16x32_bf16 v[116:119], a[220:223], v[160:163], v[116:119]
ds_read_b128 a[212:215], v178 offset:8192
v_mfma_f32_16x16x32_bf16 v[124:127], a[220:223], v[164:167], v[124:127]
ds_read_b64_tr_b16 a[54:55], v200 offset:6144
s_cbranch_vccz L_nors13
s_call_b64 s[82:83], L_rescale
L_nors13:
s_waitcnt lgkmcnt(8)
v_mfma_f32_16x16x32_bf16 v[128:131], a[192:195], a[128:131], v[168:171]
ds_read_b128 a[216:219], v179 offset:0
v_exp_f32 v144, v144
v_mfma_f32_16x16x32_bf16 v[136:139], a[192:195], a[132:135], v[172:175]
ds_read_b64_tr_b16 a[56:57], v200 offset:8192
v_exp_f32 v145, v145
s_waitcnt vmcnt(6)
s_add_u32 m0, s33, 16384
s_mov_b32 s34, 262144
buffer_load_dwordx4 v189, s[8:11], s34 offen offset:1024 nt lds
v_mfma_f32_16x16x32_bf16 v[132:135], a[196:199], a[128:131], v[168:171]
ds_read_b128 a[220:223], v179 offset:8192
v_exp_f32 v146, v146
v_mfma_f32_16x16x32_bf16 v[140:143], a[196:199], a[132:135], v[172:175]
ds_read_b64_tr_b16 a[58:59], v200 offset:10240
v_cvt_pk_bf16_f32 v160, v144, v145
s_waitcnt lgkmcnt(8)
v_mfma_f32_16x16x32_bf16 v[128:131], a[200:203], a[136:139], v[128:131]
ds_read_b128 a[192:195], v176 offset:256
v_exp_f32 v147, v147
v_mfma_f32_16x16x32_bf16 v[136:139], a[200:203], a[140:143], v[136:139]
ds_read_b64_tr_b16 a[60:61], v200 offset:12288
v_mfma_f32_16x16x32_bf16 v[132:135], a[204:207], a[136:139], v[132:135]
ds_read_b128 a[196:199], v176 offset:8448
v_exp_f32 v148, v148
v_mfma_f32_16x16x32_bf16 v[140:143], a[204:207], a[140:143], v[140:143]
ds_read_b64_tr_b16 a[62:63], v200 offset:14336
v_cvt_pk_bf16_f32 v161, v146, v147
s_waitcnt lgkmcnt(8)
v_mfma_f32_16x16x32_bf16 v[128:131], a[208:211], a[144:147], v[128:131]
ds_read_b128 a[200:203], v177 offset:256
v_mfma_f32_16x16x32_bf16 v[136:139], a[208:211], a[148:151], v[136:139]
v_exp_f32 v149, v149
v_mfma_f32_16x16x32_bf16 v[132:135], a[212:215], a[144:147], v[132:135]
ds_read_b128 a[204:207], v177 offset:8448
v_exp_f32 v150, v150
v_mfma_f32_16x16x32_bf16 v[140:143], a[212:215], a[148:151], v[140:143]
v_cvt_pk_bf16_f32 v162, v148, v149
s_waitcnt vmcnt(6)
s_mov_b32 s34, 265216
buffer_load_dwordx4 v190, s[8:11], s34 offen offset:2048 nt lds
s_waitcnt lgkmcnt(6)
v_mfma_f32_16x16x32_bf16 v[128:131], a[216:219], a[152:155], v[128:131]
ds_read_b128 a[208:211], v178 offset:256
v_mfma_f32_16x16x32_bf16 v[136:139], a[216:219], a[156:159], v[136:139]
v_exp_f32 v151, v151
v_mfma_f32_16x16x32_bf16 v[132:135], a[220:223], a[152:155], v[132:135]
ds_read_b128 a[212:215], v178 offset:8448
v_exp_f32 v152, v152
v_mfma_f32_16x16x32_bf16 v[140:143], a[220:223], a[156:159], v[140:143]
v_cvt_pk_bf16_f32 v163, v150, v151
s_waitcnt lgkmcnt(4)
v_mfma_f32_16x16x32_bf16 v[128:131], a[192:195], a[160:163], v[128:131]
ds_read_b128 a[216:219], v179 offset:256
v_mfma_f32_16x16x32_bf16 v[136:139], a[192:195], a[164:167], v[136:139]
v_exp_f32 v153, v153
s_add_u32 m0, s33, 147456
s_lshl_b32 s71, s74, 7
buffer_load_dwordx4 v198, s[24:27], s71 offen offset:2048  lds
v_mfma_f32_16x16x32_bf16 v[132:135], a[196:199], a[160:163], v[132:135]
ds_read_b128 a[220:223], v179 offset:8448
v_exp_f32 v154, v154
v_mfma_f32_16x16x32_bf16 v[140:143], a[196:199], a[164:167], v[140:143]
v_cvt_pk_bf16_f32 v164, v152, v153
s_waitcnt vmcnt(6)
s_add_u32 m0, s33, 16384
s_mov_b32 s34, 264192
buffer_load_dwordx4 v191, s[8:11], s34 offen offset:3072 nt lds
s_waitcnt lgkmcnt(4)
v_mfma_f32_16x16x32_bf16 v[128:131], a[200:203], a[168:171], v[128:131]
v_add_u32 v180, 65536, v180
v_add_u32 v181, 65536, v181
v_add_u32 v182, 65536, v182
v_add_u32 v183, 65536, v183
v_add_u32 v184, 65536, v184
v_add_u32 v185, 65536, v185
v_add_u32 v186, 65536, v186
v_add_u32 v187, 65536, v187
s_waitcnt lgkmcnt(0)
s_barrier
ds_read_b64_tr_b16 a[192:193], v180 offset:16384
v_exp_f32 v155, v155
v_mfma_f32_16x16x32_bf16 v[136:139], a[200:203], a[172:175], v[136:139]
ds_read_b64_tr_b16 a[194:195], v180 offset:24576
v_mfma_f32_16x16x32_bf16 v[132:135], a[204:207], a[168:171], v[132:135]
ds_read_b64_tr_b16 a[196:197], v181 offset:16384
v_exp_f32 v156, v156
v_mfma_f32_16x16x32_bf16 v[140:143], a[204:207], a[172:175], v[140:143]
ds_read_b64_tr_b16 a[198:199], v181 offset:24576
v_cvt_pk_bf16_f32 v165, v154, v155
s_waitcnt lgkmcnt(6)
v_mfma_f32_16x16x32_bf16 v[128:131], a[208:211], a[176:179], v[128:131]
ds_read_b64_tr_b16 a[200:201], v182 offset:16384
v_exp_f32 v157, v157
v_mfma_f32_16x16x32_bf16 v[136:139], a[208:211], a[180:183], v[136:139]
ds_read_b64_tr_b16 a[202:203], v182 offset:24576
v_mfma_f32_16x16x32_bf16 v[132:135], a[212:215], a[176:179], v[132:135]
ds_read_b64_tr_b16 a[204:205], v183 offset:16384
v_exp_f32 v158, v158
v_mfma_f32_16x16x32_bf16 v[140:143], a[212:215], a[180:183], v[140:143]
ds_read_b64_tr_b16 a[206:207], v183 offset:24576
v_cvt_pk_bf16_f32 v166, v156, v157
s_waitcnt lgkmcnt(8)
v_mfma_f32_16x16x32_bf16 v[128:131], a[216:219], a[184:187], v[128:131]
ds_read_b64_tr_b16 a[208:209], v184 offset:16384
v_exp_f32 v159, v159
v_mfma_f32_16x16x32_bf16 v[136:139], a[216:219], a[188:191], v[136:139]
ds_read_b64_tr_b16 a[210:211], v184 offset:24576
s_waitcnt vmcnt(6)
s_add_u32 m0, s33, 0
s_mov_b32 s34, 262144
buffer_load_dwordx4 v192, s[12:15], s34 offen offset:0 nt lds
v_mfma_f32_16x16x32_bf16 v[132:135], a[220:223], a[184:187], v[132:135]
ds_read_b64_tr_b16 a[212:213], v185 offset:16384
v_cvt_pk_bf16_f32 v167, v158, v159
v_mfma_f32_16x16x32_bf16 v[140:143], a[220:223], a[188:191], v[140:143]
ds_read_b64_tr_b16 a[214:215], v185 offset:24576
s_nop 0
s_waitcnt lgkmcnt(8)
v_mfma_f32_16x16x32_bf16 v[0:3], a[192:195], v[160:163], v[0:3]
ds_read_b64_tr_b16 a[216:217], v186 offset:16384
v_mfma_f32_16x16x32_bf16 v[8:11], a[192:195], v[164:167], v[8:11]
ds_read_b64_tr_b16 a[218:219], v186 offset:24576
v_mfma_f32_16x16x32_bf16 a[224:227], a[232:235], v[160:163], a[224:227]
v_mfma_f32_16x16x32_bf16 v[4:7], a[196:199], v[160:163], v[4:7]
ds_read_b64_tr_b16 a[220:221], v187 offset:16384
v_mfma_f32_16x16x32_bf16 v[12:15], a[196:199], v[164:167], v[12:15]
ds_read_b64_tr_b16 a[222:223], v187 offset:24576
v_mfma_f32_16x16x32_bf16 a[228:231], a[232:235], v[164:167], a[228:231]
s_waitcnt lgkmcnt(8)
v_mfma_f32_16x16x32_bf16 v[16:19], a[200:203], v[160:163], v[16:19]
ds_read_b64_tr_b16 a[192:193], v180 offset:16640
v_mfma_f32_16x16x32_bf16 v[24:27], a[200:203], v[164:167], v[24:27]
ds_read_b64_tr_b16 a[194:195], v180 offset:24832
s_waitcnt vmcnt(6)
s_mov_b32 s34, 263168
buffer_load_dwordx4 v193, s[12:15], s34 offen offset:1024 nt lds
v_mfma_f32_16x16x32_bf16 v[20:23], a[204:207], v[160:163], v[20:23]
ds_read_b64_tr_b16 a[196:197], v181 offset:16640
v_mfma_f32_16x16x32_bf16 v[28:31], a[204:207], v[164:167], v[28:31]
ds_read_b64_tr_b16 a[198:199], v181 offset:24832
s_waitcnt lgkmcnt(8)
v_mfma_f32_16x16x32_bf16 v[32:35], a[208:211], v[160:163], v[32:35]
ds_read_b64_tr_b16 a[200:201], v182 offset:16640
v_max3_f32 v208, v128, v129, v130
v_mfma_f32_16x16x32_bf16 v[40:43], a[208:211], v[164:167], v[40:43]
ds_read_b64_tr_b16 a[202:203], v182 offset:24832
s_add_u32 m0, s33, 147456
s_lshl_b32 s71, s74, 7
buffer_load_dwordx4 v199, s[24:27], s71 offen offset:3072  lds
v_mfma_f32_16x16x32_bf16 v[36:39], a[212:215], v[160:163], v[36:39]
ds_read_b64_tr_b16 a[204:205], v183 offset:16640
v_max3_f32 v209, v136, v137, v138
v_mfma_f32_16x16x32_bf16 v[44:47], a[212:215], v[164:167], v[44:47]
ds_read_b64_tr_b16 a[206:207], v183 offset:24832
s_waitcnt lgkmcnt(8)
v_mfma_f32_16x16x32_bf16 v[48:51], a[216:219], v[160:163], v[48:51]
ds_read_b64_tr_b16 a[208:209], v184 offset:16640
v_max3_f32 v208, v208, v131, v132
v_mfma_f32_16x16x32_bf16 v[56:59], a[216:219], v[164:167], v[56:59]
ds_read_b64_tr_b16 a[210:211], v184 offset:24832
v_mfma_f32_16x16x32_bf16 v[52:55], a[220:223], v[160:163], v[52:55]
ds_read_b64_tr_b16 a[212:213], v185 offset:16640
v_max3_f32 v209, v209, v139, v140
v_mfma_f32_16x16x32_bf16 v[60:63], a[220:223], v[164:167], v[60:63]
ds_read_b64_tr_b16 a[214:215], v185 offset:24832
s_waitcnt vmcnt(6)
s_add_u32 m0, s33, 0
s_mov_b32 s34, 264192
buffer_load_dwordx4 v194, s[12:15], s34 offen offset:2048 nt lds
s_waitcnt lgkmcnt(8)
v_mfma_f32_16x16x32_bf16 v[64:67], a[192:195], v[160:163], v[64:67]
ds_read_b64_tr_b16 a[216:217], v186 offset:16640
v_max3_f32 v208, v208, v133, v134
v_mfma_f32_16x16x32_bf16 v[72:75], a[192:195], v[164:167], v[72:75]
ds_read_b64_tr_b16 a[218:219], v186 offset:24832
v_mfma_f32_16x16x32_bf16 v[68:71], a[196:199], v[160:163], v[68:71]
ds_read_b64_tr_b16 a[220:221], v187 offset:16640
v_max3_f32 v209, v209, v141, v142
v_mfma_f32_16x16x32_bf16 v[76:79], a[196:199], v[164:167], v[76:79]
ds_read_b64_tr_b16 a[222:223], v187 offset:24832
s_waitcnt lgkmcnt(8)
v_mfma_f32_16x16x32_bf16 v[80:83], a[200:203], v[160:163], v[80:83]
s_waitcnt lgkmcnt(0)
s_barrier
ds_read_b128 a[192:195], v176 offset:32768
v_mfma_f32_16x16x32_bf16 v[88:91], a[200:203], v[164:167], v[88:91]
v_max_f32 v208, v208, v135
v_mfma_f32_16x16x32_bf16 v[84:87], a[204:207], v[160:163], v[84:87]
ds_read_b128 a[196:199], v176 offset:40960
v_mfma_f32_16x16x32_bf16 v[92:95], a[204:207], v[164:167], v[92:95]
v_max_f32 v209, v209, v143
s_waitcnt vmcnt(6)
s_mov_b32 s34, 265216
buffer_load_dwordx4 v195, s[12:15], s34 offen offset:3072 nt lds
s_waitcnt lgkmcnt(6)
v_mfma_f32_16x16x32_bf16 v[96:99], a[208:211], v[160:163], v[96:99]
ds_read_b128 a[200:203], v177 offset:32768
v_mfma_f32_16x16x32_bf16 v[104:107], a[208:211], v[164:167], v[104:107]
v_max_f32 v210, v208, v209
v_mfma_f32_16x16x32_bf16 v[100:103], a[212:215], v[160:163], v[100:103]
ds_read_b128 a[204:207], v177 offset:40960
v_mfma_f32_16x16x32_bf16 v[108:111], a[212:215], v[164:167], v[108:111]
v_cmp_lt_f32 vcc, s80, v210
s_waitcnt lgkmcnt(4)
v_mfma_f32_16x16x32_bf16 v[112:115], a[216:219], v[160:163], v[112:115]
ds_read_b128 a[208:211], v178 offset:32768
v_mfma_f32_16x16x32_bf16 v[120:123], a[216:219], v[164:167], v[120:123]
v_mfma_f32_16x16x32_bf16 v[116:119], a[220:223], v[160:163], v[116:119]
ds_read_b128 a[212:215], v178 offset:40960
v_mfma_f32_16x16x32_bf16 v[124:127], a[220:223], v[164:167], v[124:127]
s_cbranch_vccz L_nors14
s_call_b64 s[82:83], L_rescale
L_nors14:
s_waitcnt lgkmcnt(4)
v_mfma_f32_16x16x32_bf16 v[144:147], a[192:195], a[128:131], v[168:171]
ds_read_b128 a[216:219], v179 offset:32768
v_exp_f32 v128, v128
v_mfma_f32_16x16x32_bf16 v[152:155], a[192:195], a[132:135], v[172:175]
v_exp_f32 v129, v129
s_waitcnt vmcnt(5)
s_add_u32 m0, s33, 65536
s_mov_b32 s34, 264192
buffer_load_dwordx4 v188, s[8:11], s34 offen offset:0 nt lds
s_add_u32 m0, s33, 131072
s_lshl_b32 s71, s74, 7
s_add_u32 s71, s71, 114688
buffer_load_dwordx4 v196, s[24:27], s71 offen offset:0  lds
v_mfma_f32_16x16x32_bf16 v[148:151], a[196:199], a[128:131], v[168:171]
ds_read_b128 a[220:223], v179 offset:40960
v_exp_f32 v130, v130
v_mfma_f32_16x16x32_bf16 v[156:159], a[196:199], a[132:135], v[172:175]
v_cvt_pk_bf16_f32 v160, v128, v129
s_waitcnt lgkmcnt(4)
v_mfma_f32_16x16x32_bf16 v[144:147], a[200:203], a[136:139], v[144:147]
ds_read_b128 a[192:195], v176 offset:33024
v_mfma_f32_16x16x32_bf16 v[152:155], a[200:203], a[140:143], v[152:155]
v_exp_f32 v131, v131
v_mfma_f32_16x16x32_bf16 v[148:151], a[204:207], a[136:139], v[148:151]
ds_read_b128 a[196:199], v176 offset:41216
v_exp_f32 v132, v132
v_mfma_f32_16x16x32_bf16 v[156:159], a[204:207], a[140:143], v[156:159]
v_cvt_pk_bf16_f32 v161, v130, v131
s_waitcnt lgkmcnt(4)
v_mfma_f32_16x16x32_bf16 v[144:147], a[208:211], a[144:147], v[144:147]
ds_read_b128 a[200:203], v177 offset:33024
v_mfma_f32_16x16x32_bf16 v[152:155], a[208:211], a[148:151], v[152:155]
v_exp_f32 v133, v133
s_waitcnt vmcnt(6)
s_add_u32 m0, s33, 65536
s_mov_b32 s34, 265216
buffer_load_dwordx4 v189, s[8:11], s34 offen offset:1024 nt lds
v_mfma_f32_16x16x32_bf16 v[148:151], a[212:215], a[144:147], v[148:151]
ds_read_b128 a[204:207], v177 offset:41216
v_exp_f32 v134, v134
v_mfma_f32_16x16x32_bf16 v[156:159], a[212:215], a[148:151], v[156:159]
v_cvt_pk_bf16_f32 v162, v132, v133
s_waitcnt lgkmcnt(4)
v_mfma_f32_16x16x32_bf16 v[144:147], a[216:219], a[152:155], v[144:147]
ds_read_b128 a[208:211], v178 offset:33024
v_mfma_f32_16x16x32_bf16 v[152:155], a[216:219], a[156:159], v[152:155]
v_exp_f32 v135, v135
v_mfma_f32_16x16x32_bf16 v[148:151], a[220:223], a[152:155], v[148:151]
ds_read_b128 a[212:215], v178 offset:41216
v_exp_f32 v136, v136
v_mfma_f32_16x16x32_bf16 v[156:159], a[220:223], a[156:159], v[156:159]
v_cvt_pk_bf16_f32 v163, v134, v135
s_waitcnt lgkmcnt(4)
v_mfma_f32_16x16x32_bf16 v[144:147], a[192:195], a[160:163], v[144:147]
ds_read_b128 a[216:219], v179 offset:33024
v_mfma_f32_16x16x32_bf16 v[152:155], a[192:195], a[164:167], v[152:155]
v_exp_f32 v137, v137
v_mfma_f32_16x16x32_bf16 v[148:151], a[196:199], a[160:163], v[148:151]
ds_read_b128 a[220:223], v179 offset:41216
v_exp_f32 v138, v138
v_mfma_f32_16x16x32_bf16 v[156:159], a[196:199], a[164:167], v[156:159]
v_cvt_pk_bf16_f32 v164, v136, v137
s_waitcnt vmcnt(6)
s_mov_b32 s34, 262144
buffer_load_dwordx4 v190, s[8:11], s34 offen offset:2048 nt lds
s_waitcnt lgkmcnt(4)
v_mfma_f32_16x16x32_bf16 v[144:147], a[200:203], a[168:171], v[144:147]
s_waitcnt lgkmcnt(0)
s_barrier
ds_read_b64_tr_b16 a[192:193], v180 offset:32768
v_exp_f32 v139, v139
v_mfma_f32_16x16x32_bf16 v[152:155], a[200:203], a[172:175], v[152:155]
ds_read_b64_tr_b16 a[194:195], v180 offset:40960
v_mfma_f32_16x16x32_bf16 v[148:151], a[204:207], a[168:171], v[148:151]
ds_read_b64_tr_b16 a[196:197], v181 offset:32768
v_exp_f32 v140, v140
v_mfma_f32_16x16x32_bf16 v[156:159], a[204:207], a[172:175], v[156:159]
ds_read_b64_tr_b16 a[198:199], v181 offset:40960
v_cvt_pk_bf16_f32 v165, v138, v139
s_waitcnt lgkmcnt(6)
v_mfma_f32_16x16x32_bf16 v[144:147], a[208:211], a[176:179], v[144:147]
ds_read_b64_tr_b16 a[200:201], v182 offset:32768
v_exp_f32 v141, v141
v_mfma_f32_16x16x32_bf16 v[152:155], a[208:211], a[180:183], v[152:155]
ds_read_b64_tr_b16 a[202:203], v182 offset:40960
s_add_u32 m0, s33, 131072
s_lshl_b32 s71, s74, 7
s_add_u32 s71, s71, 114688
buffer_load_dwordx4 v197, s[24:27], s71 offen offset:1024  lds
v_mfma_f32_16x16x32_bf16 v[148:151], a[212:215], a[176:179], v[148:151]
ds_read_b64_tr_b16 a[204:205], v183 offset:32768
v_exp_f32 v142, v142
v_mfma_f32_16x16x32_bf16 v[156:159], a[212:215], a[180:183], v[156:159]
ds_read_b64_tr_b16 a[206:207], v183 offset:40960
v_cvt_pk_bf16_f32 v166, v140, v141
s_waitcnt vmcnt(6)
s_add_u32 m0, s33, 65536
s_mov_b32 s34, 263168
buffer_load_dwordx4 v191, s[8:11], s34 offen offset:3072 nt lds
s_waitcnt lgkmcnt(8)
v_mfma_f32_16x16x32_bf16 v[144:147], a[216:219], a[184:187], v[144:147]
ds_read_b64_tr_b16 a[208:209], v184 offset:32768
v_exp_f32 v143, v143
v_mfma_f32_16x16x32_bf16 v[152:155], a[216:219], a[188:191], v[152:155]
ds_read_b64_tr_b16 a[210:211], v184 offset:40960
v_mfma_f32_16x16x32_bf16 v[148:151], a[220:223], a[184:187], v[148:151]
ds_read_b64_tr_b16 a[212:213], v185 offset:32768
v_cvt_pk_bf16_f32 v167, v142, v143
v_mfma_f32_16x16x32_bf16 v[156:159], a[220:223], a[188:191], v[156:159]
ds_read_b64_tr_b16 a[214:215], v185 offset:40960
s_nop 0
s_waitcnt lgkmcnt(8)
v_mfma_f32_16x16x32_bf16 v[0:3], a[192:195], v[160:163], v[0:3]
ds_read_b64_tr_b16 a[216:217], v186 offset:32768
v_mfma_f32_16x16x32_bf16 v[8:11], a[192:195], v[164:167], v[8:11]
ds_read_b64_tr_b16 a[218:219], v186 offset:40960
v_mfma_f32_16x16x32_bf16 a[224:227], a[232:235], v[160:163], a[224:227]
v_mfma_f32_16x16x32_bf16 v[4:7], a[196:199], v[160:163], v[4:7]
ds_read_b64_tr_b16 a[220:221], v187 offset:32768
v_mfma_f32_16x16x32_bf16 v[12:15], a[196:199], v[164:167], v[12:15]
ds_read_b64_tr_b16 a[222:223], v187 offset:40960
v_mfma_f32_16x16x32_bf16 a[228:231], a[232:235], v[164:167], a[228:231]
s_waitcnt lgkmcnt(8)
v_mfma_f32_16x16x32_bf16 v[16:19], a[200:203], v[160:163], v[16:19]
ds_read_b64_tr_b16 a[192:193], v180 offset:33024
v_mfma_f32_16x16x32_bf16 v[24:27], a[200:203], v[164:167], v[24:27]
ds_read_b64_tr_b16 a[194:195], v180 offset:41216
s_waitcnt vmcnt(6)
s_add_u32 m0, s33, 32768
s_mov_b32 s34, 263168
buffer_load_dwordx4 v192, s[12:15], s34 offen offset:0 nt lds
v_mfma_f32_16x16x32_bf16 v[20:23], a[204:207], v[160:163], v[20:23]
ds_read_b64_tr_b16 a[196:197], v181 offset:33024
v_mfma_f32_16x16x32_bf16 v[28:31], a[204:207], v[164:167], v[28:31]
ds_read_b64_tr_b16 a[198:199], v181 offset:41216
s_waitcnt lgkmcnt(8)
v_mfma_f32_16x16x32_bf16 v[32:35], a[208:211], v[160:163], v[32:35]
ds_read_b64_tr_b16 a[200:201], v182 offset:33024
v_max3_f32 v208, v144, v145, v146
v_mfma_f32_16x16x32_bf16 v[40:43], a[208:211], v[164:167], v[40:43]
ds_read_b64_tr_b16 a[202:203], v182 offset:41216
v_mfma_f32_16x16x32_bf16 v[36:39], a[212:215], v[160:163], v[36:39]
ds_read_b64_tr_b16 a[204:205], v183 offset:33024
v_max3_f32 v209, v152, v153, v154
v_mfma_f32_16x16x32_bf16 v[44:47], a[212:215], v[164:167], v[44:47]
ds_read_b64_tr_b16 a[206:207], v183 offset:41216
s_waitcnt lgkmcnt(8)
v_mfma_f32_16x16x32_bf16 v[48:51], a[216:219], v[160:163], v[48:51]
ds_read_b64_tr_b16 a[208:209], v184 offset:33024
v_max3_f32 v208, v208, v147, v148
v_mfma_f32_16x16x32_bf16 v[56:59], a[216:219], v[164:167], v[56:59]
ds_read_b64_tr_b16 a[210:211], v184 offset:41216
s_waitcnt vmcnt(6)
s_mov_b32 s34, 262144
buffer_load_dwordx4 v193, s[12:15], s34 offen offset:1024 nt lds
v_mfma_f32_16x16x32_bf16 v[52:55], a[220:223], v[160:163], v[52:55]
ds_read_b64_tr_b16 a[212:213], v185 offset:33024
v_max3_f32 v209, v209, v155, v156
v_mfma_f32_16x16x32_bf16 v[60:63], a[220:223], v[164:167], v[60:63]
ds_read_b64_tr_b16 a[214:215], v185 offset:41216
s_waitcnt lgkmcnt(8)
v_mfma_f32_16x16x32_bf16 v[64:67], a[192:195], v[160:163], v[64:67]
ds_read_b64_tr_b16 a[216:217], v186 offset:33024
v_max3_f32 v208, v208, v149, v150
v_mfma_f32_16x16x32_bf16 v[72:75], a[192:195], v[164:167], v[72:75]
ds_read_b64_tr_b16 a[218:219], v186 offset:41216
s_add_u32 m0, s33, 131072
s_lshl_b32 s71, s74, 7
s_add_u32 s71, s71, 114688
buffer_load_dwordx4 v198, s[24:27], s71 offen offset:2048  lds
v_mfma_f32_16x16x32_bf16 v[68:71], a[196:199], v[160:163], v[68:71]
ds_read_b64_tr_b16 a[220:221], v187 offset:33024
v_max3_f32 v209, v209, v157, v158
v_mfma_f32_16x16x32_bf16 v[76:79], a[196:199], v[164:167], v[76:79]
ds_read_b64_tr_b16 a[222:223], v187 offset:41216
s_waitcnt lgkmcnt(8)
v_mfma_f32_16x16x32_bf16 v[80:83], a[200:203], v[160:163], v[80:83]
v_add_u32 v176, 65536, v176
v_add_u32 v177, 65536, v177
v_add_u32 v178, 65536, v178
v_add_u32 v179, 65536, v179
s_waitcnt lgkmcnt(0)
s_barrier
ds_read_b128 a[192:195], v176 offset:49152
v_mfma_f32_16x16x32_bf16 v[88:91], a[200:203], v[164:167], v[88:91]
v_max_f32 v208, v208, v151
v_mfma_f32_16x16x32_bf16 v[84:87], a[204:207], v[160:163], v[84:87]
ds_read_b128 a[196:199], v176 offset:57344
v_mfma_f32_16x16x32_bf16 v[92:95], a[204:207], v[164:167], v[92:95]
v_max_f32 v209, v209, v159
s_waitcnt vmcnt(6)
s_add_u32 m0, s33, 32768
s_mov_b32 s34, 265216
buffer_load_dwordx4 v194, s[12:15], s34 offen offset:2048 nt lds
s_waitcnt lgkmcnt(6)
v_mfma_f32_16x16x32_bf16 v[96:99], a[208:211], v[160:163], v[96:99]
ds_read_b128 a[200:203], v177 offset:49152
v_max_f32 v210, v208, v209
v_mfma_f32_16x16x32_bf16 v[104:107], a[208:211], v[164:167], v[104:107]
ds_read_b64_tr_b16 a[64:65], v200 offset:16384
v_mfma_f32_16x16x32_bf16 v[100:103], a[212:215], v[160:163], v[100:103]
ds_read_b128 a[204:207], v177 offset:57344
v_cmp_lt_f32 vcc, s80, v210
v_mfma_f32_16x16x32_bf16 v[108:111], a[212:215], v[164:167], v[108:111]
ds_read_b64_tr_b16 a[66:67], v200 offset:18432
s_waitcnt lgkmcnt(6)
v_mfma_f32_16x16x32_bf16 v[112:115], a[216:219], v[160:163], v[112:115]
ds_read_b128 a[208:211], v178 offset:49152
v_mfma_f32_16x16x32_bf16 v[120:123], a[216:219], v[164:167], v[120:123]
ds_read_b64_tr_b16 a[68:69], v200 offset:20480
v_mfma_f32_16x16x32_bf16 v[116:119], a[220:223], v[160:163], v[116:119]
ds_read_b128 a[212:215], v178 offset:57344
v_mfma_f32_16x16x32_bf16 v[124:127], a[220:223], v[164:167], v[124:127]
ds_read_b64_tr_b16 a[70:71], v200 offset:22528
s_waitcnt vmcnt(6)
s_mov_b32 s34, 264192
buffer_load_dwordx4 v195, s[12:15], s34 offen offset:3072 nt lds
s_cbranch_vccz L_nors15
s_call_b64 s[82:83], L_rescale
L_nors15:
s_waitcnt lgkmcnt(8)
v_mfma_f32_16x16x32_bf16 v[128:131], a[192:195], a[128:131], v[168:171]
ds_read_b128 a[216:219], v179 offset:49152
v_exp_f32 v144, v144
v_mfma_f32_16x16x32_bf16 v[136:139], a[192:195], a[132:135], v[172:175]
ds_read_b64_tr_b16 a[72:73], v200 offset:24576
v_exp_f32 v145, v145
v_mfma_f32_16x16x32_bf16 v[132:135], a[196:199], a[128:131], v[168:171]
ds_read_b128 a[220:223], v179 offset:57344
v_exp_f32 v146, v146
v_mfma_f32_16x16x32_bf16 v[140:143], a[196:199], a[132:135], v[172:175]
ds_read_b64_tr_b16 a[74:75], v200 offset:26624
v_cvt_pk_bf16_f32 v160, v144, v145
s_waitcnt lgkmcnt(8)
v_mfma_f32_16x16x32_bf16 v[128:131], a[200:203], a[136:139], v[128:131]
ds_read_b128 a[192:195], v176 offset:49408
v_exp_f32 v147, v147
v_mfma_f32_16x16x32_bf16 v[136:139], a[200:203], a[140:143], v[136:139]
ds_read_b64_tr_b16 a[76:77], v200 offset:28672
v_mfma_f32_16x16x32_bf16 v[132:135], a[204:207], a[136:139], v[132:135]
ds_read_b128 a[196:199], v176 offset:57600
v_exp_f32 v148, v148
v_mfma_f32_16x16x32_bf16 v[140:143], a[204:207], a[140:143], v[140:143]
ds_read_b64_tr_b16 a[78:79], v200 offset:30720
v_cvt_pk_bf16_f32 v161, v146, v147
s_waitcnt lgkmcnt(8)
v_mfma_f32_16x16x32_bf16 v[128:131], a[208:211], a[144:147], v[128:131]
ds_read_b128 a[200:203], v177 offset:49408
v_mfma_f32_16x16x32_bf16 v[136:139], a[208:211], a[148:151], v[136:139]
v_exp_f32 v149, v149
s_waitcnt vmcnt(5)
s_add_u32 m0, s33, 81920
s_mov_b32 s34, 265216
buffer_load_dwordx4 v188, s[8:11], s34 offen offset:0 nt lds
s_add_u32 m0, s33, 131072
s_lshl_b32 s71, s74, 7
s_add_u32 s71, s71, 114688
buffer_load_dwordx4 v199, s[24:27], s71 offen offset:3072  lds
v_mfma_f32_16x16x32_bf16 v[132:135], a[212:215], a[144:147], v[132:135]
ds_read_b128 a[204:207], v177 offset:57600
v_exp_f32 v150, v150
v_mfma_f32_16x16x32_bf16 v[140:143], a[212:215], a[148:151], v[140:143]
v_cvt_pk_bf16_f32 v162, v148, v149
s_waitcnt lgkmcnt(6)
v_mfma_f32_16x16x32_bf16 v[128:131], a[216:219], a[152:155], v[128:131]
ds_read_b128 a[208:211], v178 offset:49408
v_mfma_f32_16x16x32_bf16 v[136:139], a[216:219], a[156:159], v[136:139]
v_exp_f32 v151, v151
v_mfma_f32_16x16x32_bf16 v[132:135], a[220:223], a[152:155], v[132:135]
ds_read_b128 a[212:215], v178 offset:57600
v_exp_f32 v152, v152
v_mfma_f32_16x16x32_bf16 v[140:143], a[220:223], a[156:159], v[140:143]
v_cvt_pk_bf16_f32 v163, v150, v151
s_waitcnt lgkmcnt(4)
v_mfma_f32_16x16x32_bf16 v[128:131], a[192:195], a[160:163], v[128:131]
ds_read_b128 a[216:219], v179 offset:49408
v_mfma_f32_16x16x32_bf16 v[136:139], a[192:195], a[164:167], v[136:139]
v_exp_f32 v153, v153
s_waitcnt vmcnt(6)
s_add_u32 m0, s33, 81920
s_mov_b32 s34, 264192
buffer_load_dwordx4 v189, s[8:11], s34 offen offset:1024 nt lds
v_mfma_f32_16x16x32_bf16 v[132:135], a[196:199], a[160:163], v[132:135]
ds_read_b128 a[220:223], v179 offset:57600
v_exp_f32 v154, v154
v_mfma_f32_16x16x32_bf16 v[140:143], a[196:199], a[164:167], v[140:143]
v_cvt_pk_bf16_f32 v164, v152, v153
s_waitcnt lgkmcnt(4)
v_mfma_f32_16x16x32_bf16 v[128:131], a[200:203], a[168:171], v[128:131]
v_subrev_u32 v180, 65536, v180
v_subrev_u32 v181, 65536, v181
v_subrev_u32 v182, 65536, v182
v_subrev_u32 v183, 65536, v183
v_subrev_u32 v184, 65536, v184
v_subrev_u32 v185, 65536, v185
v_subrev_u32 v186, 65536, v186
v_subrev_u32 v187, 65536, v187
s_waitcnt lgkmcnt(0)
s_barrier
ds_read_b64_tr_b16 a[192:193], v180 offset:49152
v_exp_f32 v155, v155
v_mfma_f32_16x16x32_bf16 v[136:139], a[200:203], a[172:175], v[136:139]
ds_read_b64_tr_b16 a[194:195], v180 offset:57344
v_mfma_f32_16x16x32_bf16 v[132:135], a[204:207], a[168:171], v[132:135]
ds_read_b64_tr_b16 a[196:197], v181 offset:49152
v_exp_f32 v156, v156
v_mfma_f32_16x16x32_bf16 v[140:143], a[204:207], a[172:175], v[140:143]
ds_read_b64_tr_b16 a[198:199], v181 offset:57344
v_cvt_pk_bf16_f32 v165, v154, v155
s_waitcnt lgkmcnt(6)
v_mfma_f32_16x16x32_bf16 v[128:131], a[208:211], a[176:179], v[128:131]
ds_read_b64_tr_b16 a[200:201], v182 offset:49152
v_exp_f32 v157, v157
v_mfma_f32_16x16x32_bf16 v[136:139], a[208:211], a[180:183], v[136:139]
ds_read_b64_tr_b16 a[202:203], v182 offset:57344
v_mfma_f32_16x16x32_bf16 v[132:135], a[212:215], a[176:179], v[132:135]
ds_read_b64_tr_b16 a[204:205], v183 offset:49152
v_exp_f32 v158, v158
v_mfma_f32_16x16x32_bf16 v[140:143], a[212:215], a[180:183], v[140:143]
ds_read_b64_tr_b16 a[206:207], v183 offset:57344
v_cvt_pk_bf16_f32 v166, v156, v157
s_waitcnt vmcnt(6)
s_mov_b32 s34, 263168
buffer_load_dwordx4 v190, s[8:11], s34 offen offset:2048 nt lds
s_waitcnt lgkmcnt(8)
v_mfma_f32_16x16x32_bf16 v[128:131], a[216:219], a[184:187], v[128:131]
ds_read_b64_tr_b16 a[208:209], v184 offset:49152
v_exp_f32 v159, v159
v_mfma_f32_16x16x32_bf16 v[136:139], a[216:219], a[188:191], v[136:139]
ds_read_b64_tr_b16 a[210:211], v184 offset:57344
v_mfma_f32_16x16x32_bf16 v[132:135], a[220:223], a[184:187], v[132:135]
ds_read_b64_tr_b16 a[212:213], v185 offset:49152
v_cvt_pk_bf16_f32 v167, v158, v159
v_mfma_f32_16x16x32_bf16 v[140:143], a[220:223], a[188:191], v[140:143]
ds_read_b64_tr_b16 a[214:215], v185 offset:57344
s_nop 0
s_waitcnt lgkmcnt(8)
v_mfma_f32_16x16x32_bf16 v[0:3], a[192:195], v[160:163], v[0:3]
ds_read_b64_tr_b16 a[216:217], v186 offset:49152
v_mfma_f32_16x16x32_bf16 v[8:11], a[192:195], v[164:167], v[8:11]
ds_read_b64_tr_b16 a[218:219], v186 offset:57344
s_add_u32 m0, s33, 147456
s_lshl_b32 s71, s75, 7
buffer_load_dwordx4 v196, s[24:27], s71 offen offset:0  lds
v_mfma_f32_16x16x32_bf16 a[224:227], a[232:235], v[160:163], a[224:227]
v_mfma_f32_16x16x32_bf16 v[4:7], a[196:199], v[160:163], v[4:7]
ds_read_b64_tr_b16 a[220:221], v187 offset:49152
v_mfma_f32_16x16x32_bf16 v[12:15], a[196:199], v[164:167], v[12:15]
ds_read_b64_tr_b16 a[222:223], v187 offset:57344
s_waitcnt vmcnt(6)
s_add_u32 m0, s33, 81920
s_mov_b32 s34, 262144
buffer_load_dwordx4 v191, s[8:11], s34 offen offset:3072 nt lds
v_mfma_f32_16x16x32_bf16 a[228:231], a[232:235], v[164:167], a[228:231]
s_waitcnt lgkmcnt(8)
v_mfma_f32_16x16x32_bf16 v[16:19], a[200:203], v[160:163], v[16:19]
ds_read_b64_tr_b16 a[192:193], v180 offset:49408
v_mfma_f32_16x16x32_bf16 v[24:27], a[200:203], v[164:167], v[24:27]
ds_read_b64_tr_b16 a[194:195], v180 offset:57600
v_mfma_f32_16x16x32_bf16 v[20:23], a[204:207], v[160:163], v[20:23]
ds_read_b64_tr_b16 a[196:197], v181 offset:49408
v_mfma_f32_16x16x32_bf16 v[28:31], a[204:207], v[164:167], v[28:31]
ds_read_b64_tr_b16 a[198:199], v181 offset:57600
s_waitcnt lgkmcnt(8)
v_mfma_f32_16x16x32_bf16 v[32:35], a[208:211], v[160:163], v[32:35]
ds_read_b64_tr_b16 a[200:201], v182 offset:49408
v_max3_f32 v208, v128, v129, v130
v_mfma_f32_16x16x32_bf16 v[40:43], a[208:211], v[164:167], v[40:43]
ds_read_b64_tr_b16 a[202:203], v182 offset:57600
v_mfma_f32_16x16x32_bf16 v[36:39], a[212:215], v[160:163], v[36:39]
ds_read_b64_tr_b16 a[204:205], v183 offset:49408
v_max3_f32 v209, v136, v137, v138
v_mfma_f32_16x16x32_bf16 v[44:47], a[212:215], v[164:167], v[44:47]
ds_read_b64_tr_b16 a[206:207], v183 offset:57600
s_waitcnt lgkmcnt(8)
v_mfma_f32_16x16x32_bf16 v[48:51], a[216:219], v[160:163], v[48:51]
ds_read_b64_tr_b16 a[208:209], v184 offset:49408
v_max3_f32 v208, v208, v131, v132
v_mfma_f32_16x16x32_bf16 v[56:59], a[216:219], v[164:167], v[56:59]
ds_read_b64_tr_b16 a[210:211], v184 offset:57600
s_waitcnt vmcnt(6)
s_add_u32 m0, s33, 98304
s_mov_b32 s34, 264192
buffer_load_dwordx4 v192, s[12:15], s34 offen offset:0 nt lds
v_mfma_f32_16x16x32_bf16 v[52:55], a[220:223], v[160:163], v[52:55]
ds_read_b64_tr_b16 a[212:213], v185 offset:49408
v_max3_f32 v209, v209, v139, v140
v_mfma_f32_16x16x32_bf16 v[60:63], a[220:223], v[164:167], v[60:63]
ds_read_b64_tr_b16 a[214:215], v185 offset:57600
s_waitcnt lgkmcnt(8)
v_mfma_f32_16x16x32_bf16 v[64:67], a[192:195], v[160:163], v[64:67]
ds_read_b64_tr_b16 a[216:217], v186 offset:49408
v_max3_f32 v208, v208, v133, v134
v_mfma_f32_16x16x32_bf16 v[72:75], a[192:195], v[164:167], v[72:75]
ds_read_b64_tr_b16 a[218:219], v186 offset:57600
v_mfma_f32_16x16x32_bf16 v[68:71], a[196:199], v[160:163], v[68:71]
ds_read_b64_tr_b16 a[220:221], v187 offset:49408
v_max3_f32 v209, v209, v141, v142
v_mfma_f32_16x16x32_bf16 v[76:79], a[196:199], v[164:167], v[76:79]
ds_read_b64_tr_b16 a[222:223], v187 offset:57600
s_waitcnt lgkmcnt(8)
v_mfma_f32_16x16x32_bf16 v[80:83], a[200:203], v[160:163], v[80:83]
v_subrev_u32 v176, 65536, v176
v_subrev_u32 v177, 65536, v177
v_subrev_u32 v178, 65536, v178
v_subrev_u32 v179, 65536, v179
s_waitcnt lgkmcnt(0)
s_barrier
ds_read_b128 a[192:195], v176 offset:16384
v_mfma_f32_16x16x32_bf16 v[88:91], a[200:203], v[164:167], v[88:91]
v_max_f32 v208, v208, v135
s_waitcnt vmcnt(6)
s_mov_b32 s34, 265216
buffer_load_dwordx4 v193, s[12:15], s34 offen offset:1024 nt lds
v_mfma_f32_16x16x32_bf16 v[84:87], a[204:207], v[160:163], v[84:87]
ds_read_b128 a[196:199], v176 offset:24576
v_mfma_f32_16x16x32_bf16 v[92:95], a[204:207], v[164:167], v[92:95]
v_max_f32 v209, v209, v143
s_waitcnt lgkmcnt(6)
v_mfma_f32_16x16x32_bf16 v[96:99], a[208:211], v[160:163], v[96:99]
ds_read_b128 a[200:203], v177 offset:16384
v_mfma_f32_16x16x32_bf16 v[104:107], a[208:211], v[164:167], v[104:107]
v_max_f32 v210, v208, v209
s_add_u32 m0, s33, 147456
s_lshl_b32 s71, s75, 7
buffer_load_dwordx4 v197, s[24:27], s71 offen offset:1024  lds
v_mfma_f32_16x16x32_bf16 v[100:103], a[212:215], v[160:163], v[100:103]
ds_read_b128 a[204:207], v177 offset:24576
v_mfma_f32_16x16x32_bf16 v[108:111], a[212:215], v[164:167], v[108:111]
v_cmp_lt_f32 vcc, s80, v210
s_waitcnt lgkmcnt(4)
v_mfma_f32_16x16x32_bf16 v[112:115], a[216:219], v[160:163], v[112:115]
ds_read_b128 a[208:211], v178 offset:16384
v_mfma_f32_16x16x32_bf16 v[120:123], a[216:219], v[164:167], v[120:123]
v_mfma_f32_16x16x32_bf16 v[116:119], a[220:223], v[160:163], v[116:119]
ds_read_b128 a[212:215], v178 offset:24576
v_mfma_f32_16x16x32_bf16 v[124:127], a[220:223], v[164:167], v[124:127]
s_waitcnt vmcnt(6)
s_add_u32 m0, s33, 98304
s_mov_b32 s34, 262144
buffer_load_dwordx4 v194, s[12:15], s34 offen offset:2048 nt lds
s_cbranch_vccz L_nors16
s_call_b64 s[82:83], L_rescale
L_nors16:
s_waitcnt lgkmcnt(4)
v_mfma_f32_16x16x32_bf16 v[144:147], a[192:195], a[128:131], v[168:171]
ds_read_b128 a[216:219], v179 offset:16384
v_exp_f32 v128, v128
v_mfma_f32_16x16x32_bf16 v[152:155], a[192:195], a[132:135], v[172:175]
v_exp_f32 v129, v129
v_mfma_f32_16x16x32_bf16 v[148:151], a[196:199], a[128:131], v[168:171]
ds_read_b128 a[220:223], v179 offset:24576
v_exp_f32 v130, v130
v_mfma_f32_16x16x32_bf16 v[156:159], a[196:199], a[132:135], v[172:175]
v_cvt_pk_bf16_f32 v160, v128, v129
s_waitcnt lgkmcnt(4)
v_mfma_f32_16x16x32_bf16 v[144:147], a[200:203], a[136:139], v[144:147]
ds_read_b128 a[192:195], v176 offset:16640
v_mfma_f32_16x16x32_bf16 v[152:155], a[200:203], a[140:143], v[152:155]
v_exp_f32 v131, v131
v_mfma_f32_16x16x32_bf16 v[148:151], a[204:207], a[136:139], v[148:151]
ds_read_b128 a[196:199], v176 offset:24832
v_exp_f32 v132, v132
v_mfma_f32_16x16x32_bf16 v[156:159], a[204:207], a[140:143], v[156:159]
v_cvt_pk_bf16_f32 v161, v130, v131
s_waitcnt vmcnt(6)
s_mov_b32 s34, 263168
buffer_load_dwordx4 v195, s[12:15], s34 offen offset:3072 nt lds
s_waitcnt lgkmcnt(4)
v_mfma_f32_16x16x32_bf16 v[144:147], a[208:211], a[144:147], v[144:147]
ds_read_b128 a[200:203], v177 offset:16640
v_mfma_f32_16x16x32_bf16 v[152:155], a[208:211], a[148:151], v[152:155]
v_exp_f32 v133, v133
v_mfma_f32_16x16x32_bf16 v[148:151], a[212:215], a[144:147], v[148:151]
ds_read_b128 a[204:207], v177 offset:24832
v_exp_f32 v134, v134
v_mfma_f32_16x16x32_bf16 v[156:159], a[212:215], a[148:151], v[156:159]
v_cvt_pk_bf16_f32 v162, v132, v133
s_waitcnt lgkmcnt(4)
v_mfma_f32_16x16x32_bf16 v[144:147], a[216:219], a[152:155], v[144:147]
ds_read_b128 a[208:211], v178 offset:16640
v_mfma_f32_16x16x32_bf16 v[152:155], a[216:219], a[156:159], v[152:155]
v_exp_f32 v135, v135
v_mfma_f32_16x16x32_bf16 v[148:151], a[220:223], a[152:155], v[148:151]
ds_read_b128 a[212:215], v178 offset:24832
v_exp_f32 v136, v136
v_mfma_f32_16x16x32_bf16 v[156:159], a[220:223], a[156:159], v[156:159]
v_cvt_pk_bf16_f32 v163, v134, v135
s_waitcnt lgkmcnt(4)
v_mfma_f32_16x16x32_bf16 v[144:147], a[192:195], a[160:163], v[144:147]
ds_read_b128 a[216:219], v179 offset:16640
v_mfma_f32_16x16x32_bf16 v[152:155], a[192:195], a[164:167], v[152:155]
v_exp_f32 v137, v137
s_waitcnt vmcnt(5)
s_add_u32 m0, s33, 49152
s_mov_b32 s34, 327680
buffer_load_dwordx4 v188, s[8:11], s34 offen offset:0 nt lds
s_add_u32 m0, s33, 147456
s_lshl_b32 s71, s75, 7
buffer_load_dwordx4 v198, s[24:27], s71 offen offset:2048  lds
v_mfma_f32_16x16x32_bf16 v[148:151], a[196:199], a[160:163], v[148:151]
ds_read_b128 a[220:223], v179 offset:24832
v_exp_f32 v138, v138
v_mfma_f32_16x16x32_bf16 v[156:159], a[196:199], a[164:167], v[156:159]
v_cvt_pk_bf16_f32 v164, v136, v137
s_waitcnt lgkmcnt(4)
v_mfma_f32_16x16x32_bf16 v[144:147], a[200:203], a[168:171], v[144:147]
s_waitcnt lgkmcnt(0)
s_barrier
ds_read_b64_tr_b16 a[192:193], v180 offset:0
v_exp_f32 v139, v139
v_mfma_f32_16x16x32_bf16 v[152:155], a[200:203], a[172:175], v[152:155]
ds_read_b64_tr_b16 a[194:195], v180 offset:8192
v_mfma_f32_16x16x32_bf16 v[148:151], a[204:207], a[168:171], v[148:151]
ds_read_b64_tr_b16 a[196:197], v181 offset:0
v_exp_f32 v140, v140
v_mfma_f32_16x16x32_bf16 v[156:159], a[204:207], a[172:175], v[156:159]
ds_read_b64_tr_b16 a[198:199], v181 offset:8192
v_cvt_pk_bf16_f32 v165, v138, v139
s_waitcnt lgkmcnt(6)
v_mfma_f32_16x16x32_bf16 v[144:147], a[208:211], a[176:179], v[144:147]
ds_read_b64_tr_b16 a[200:201], v182 offset:0
v_exp_f32 v141, v141
v_mfma_f32_16x16x32_bf16 v[152:155], a[208:211], a[180:183], v[152:155]
ds_read_b64_tr_b16 a[202:203], v182 offset:8192
s_waitcnt vmcnt(6)
s_add_u32 m0, s33, 49152
s_mov_b32 s34, 328704
buffer_load_dwordx4 v189, s[8:11], s34 offen offset:1024 nt lds
v_mfma_f32_16x16x32_bf16 v[148:151], a[212:215], a[176:179], v[148:151]
ds_read_b64_tr_b16 a[204:205], v183 offset:0
v_exp_f32 v142, v142
v_mfma_f32_16x16x32_bf16 v[156:159], a[212:215], a[180:183], v[156:159]
ds_read_b64_tr_b16 a[206:207], v183 offset:8192
v_cvt_pk_bf16_f32 v166, v140, v141
s_waitcnt lgkmcnt(8)
v_mfma_f32_16x16x32_bf16 v[144:147], a[216:219], a[184:187], v[144:147]
ds_read_b64_tr_b16 a[208:209], v184 offset:0
v_exp_f32 v143, v143
v_mfma_f32_16x16x32_bf16 v[152:155], a[216:219], a[188:191], v[152:155]
ds_read_b64_tr_b16 a[210:211], v184 offset:8192
v_mfma_f32_16x16x32_bf16 v[148:151], a[220:223], a[184:187], v[148:151]
ds_read_b64_tr_b16 a[212:213], v185 offset:0
v_cvt_pk_bf16_f32 v167, v142, v143
v_mfma_f32_16x16x32_bf16 v[156:159], a[220:223], a[188:191], v[156:159]
ds_read_b64_tr_b16 a[214:215], v185 offset:8192
s_nop 0
s_waitcnt lgkmcnt(8)
v_mfma_f32_16x16x32_bf16 v[0:3], a[192:195], v[160:163], v[0:3]
ds_read_b64_tr_b16 a[216:217], v186 offset:0
v_mfma_f32_16x16x32_bf16 v[8:11], a[192:195], v[164:167], v[8:11]
ds_read_b64_tr_b16 a[218:219], v186 offset:8192
v_mfma_f32_16x16x32_bf16 a[224:227], a[232:235], v[160:163], a[224:227]
v_mfma_f32_16x16x32_bf16 v[4:7], a[196:199], v[160:163], v[4:7]
ds_read_b64_tr_b16 a[220:221], v187 offset:0
v_mfma_f32_16x16x32_bf16 v[12:15], a[196:199], v[164:167], v[12:15]
ds_read_b64_tr_b16 a[222:223], v187 offset:8192
s_waitcnt vmcnt(6)
s_mov_b32 s34, 329728
buffer_load_dwordx4 v190, s[8:11], s34 offen offset:2048 nt lds
v_mfma_f32_16x16x32_bf16 a[228:231], a[232:235], v[164:167], a[228:231]
s_waitcnt lgkmcnt(8)
v_mfma_f32_16x16x32_bf16 v[16:19], a[200:203], v[160:163], v[16:19]
ds_read_b64_tr_b16 a[192:193], v180 offset:256
v_mfma_f32_16x16x32_bf16 v[24:27], a[200:203], v[164:167], v[24:27]
ds_read_b64_tr_b16 a[194:195], v180 offset:8448
v_mfma_f32_16x16x32_bf16 v[20:23], a[204:207], v[160:163], v[20:23]
ds_read_b64_tr_b16 a[196:197], v181 offset:256
v_mfma_f32_16x16x32_bf16 v[28:31], a[204:207], v[164:167], v[28:31]
ds_read_b64_tr_b16 a[198:199], v181 offset:8448
s_waitcnt lgkmcnt(8)
v_mfma_f32_16x16x32_bf16 v[32:35], a[208:211], v[160:163], v[32:35]
ds_read_b64_tr_b16 a[200:201], v182 offset:256
v_max3_f32 v208, v144, v145, v146
v_mfma_f32_16x16x32_bf16 v[40:43], a[208:211], v[164:167], v[40:43]
ds_read_b64_tr_b16 a[202:203], v182 offset:8448
s_add_u32 m0, s33, 147456
s_lshl_b32 s71, s75, 7
buffer_load_dwordx4 v199, s[24:27], s71 offen offset:3072  lds
v_mfma_f32_16x16x32_bf16 v[36:39], a[212:215], v[160:163], v[36:39]
ds_read_b64_tr_b16 a[204:205], v183 offset:256
v_max3_f32 v209, v152, v153, v154
v_mfma_f32_16x16x32_bf16 v[44:47], a[212:215], v[164:167], v[44:47]
ds_read_b64_tr_b16 a[206:207], v183 offset:8448
s_waitcnt vmcnt(6)
s_add_u32 m0, s33, 49152
s_mov_b32 s34, 330752
buffer_load_dwordx4 v191, s[8:11], s34 offen offset:3072 nt lds
s_waitcnt lgkmcnt(8)
v_mfma_f32_16x16x32_bf16 v[48:51], a[216:219], v[160:163], v[48:51]
ds_read_b64_tr_b16 a[208:209], v184 offset:256
v_max3_f32 v208, v208, v147, v148
v_mfma_f32_16x16x32_bf16 v[56:59], a[216:219], v[164:167], v[56:59]
ds_read_b64_tr_b16 a[210:211], v184 offset:8448
v_mfma_f32_16x16x32_bf16 v[52:55], a[220:223], v[160:163], v[52:55]
ds_read_b64_tr_b16 a[212:213], v185 offset:256
v_max3_f32 v209, v209, v155, v156
v_mfma_f32_16x16x32_bf16 v[60:63], a[220:223], v[164:167], v[60:63]
ds_read_b64_tr_b16 a[214:215], v185 offset:8448
s_waitcnt lgkmcnt(8)
v_mfma_f32_16x16x32_bf16 v[64:67], a[192:195], v[160:163], v[64:67]
ds_read_b64_tr_b16 a[216:217], v186 offset:256
v_max3_f32 v208, v208, v149, v150
v_mfma_f32_16x16x32_bf16 v[72:75], a[192:195], v[164:167], v[72:75]
ds_read_b64_tr_b16 a[218:219], v186 offset:8448
v_mfma_f32_16x16x32_bf16 v[68:71], a[196:199], v[160:163], v[68:71]
ds_read_b64_tr_b16 a[220:221], v187 offset:256
v_max3_f32 v209, v209, v157, v158
v_mfma_f32_16x16x32_bf16 v[76:79], a[196:199], v[164:167], v[76:79]
ds_read_b64_tr_b16 a[222:223], v187 offset:8448
s_waitcnt lgkmcnt(8)
v_mfma_f32_16x16x32_bf16 v[80:83], a[200:203], v[160:163], v[80:83]
v_add_u32 v176, 65536, v176
v_add_u32 v177, 65536, v177
v_add_u32 v178, 65536, v178
v_add_u32 v179, 65536, v179
s_waitcnt lgkmcnt(0)
s_barrier
ds_read_b128 a[192:195], v176 offset:0
v_mfma_f32_16x16x32_bf16 v[88:91], a[200:203], v[164:167], v[88:91]
v_max_f32 v208, v208, v151
s_waitcnt vmcnt(6)
s_add_u32 m0, s33, 16384
s_mov_b32 s34, 265216
buffer_load_dwordx4 v192, s[12:15], s34 offen offset:0 nt lds
v_mfma_f32_16x16x32_bf16 v[84:87], a[204:207], v[160:163], v[84:87]
ds_read_b128 a[196:199], v176 offset:8192
v_mfma_f32_16x16x32_bf16 v[92:95], a[204:207], v[164:167], v[92:95]
v_max_f32 v209, v209, v159
s_waitcnt lgkmcnt(6)
v_mfma_f32_16x16x32_bf16 v[96:99], a[208:211], v[160:163], v[96:99]
ds_read_b128 a[200:203], v177 offset:0
v_max_f32 v210, v208, v209
v_mfma_f32_16x16x32_bf16 v[104:107], a[208:211], v[164:167], v[104:107]
ds_read_b64_tr_b16 a[80:81], v200 offset:0
v_mfma_f32_16x16x32_bf16 v[100:103], a[212:215], v[160:163], v[100:103]
ds_read_b128 a[204:207], v177 offset:8192
v_cmp_lt_f32 vcc, s80, v210
v_mfma_f32_16x16x32_bf16 v[108:111], a[212:215], v[164:167], v[108:111]
ds_read_b64_tr_b16 a[82:83], v200 offset:2048
s_waitcnt lgkmcnt(6)
v_mfma_f32_16x16x32_bf16 v[112:115], a[216:219], v[160:163], v[112:115]
ds_read_b128 a[208:211], v178 offset:0
v_mfma_f32_16x16x32_bf16 v[120:123], a[216:219], v[164:167], v[120:123]
ds_read_b64_tr_b16 a[84:85], v200 offset:4096
s_waitcnt vmcnt(6)
s_mov_b32 s34, 264192
buffer_load_dwordx4 v193, s[12:15], s34 offen offset:1024 nt lds
v_mfma_f32_16x16x32_bf16 v[116:119], a[220:223], v[160:163], v[116:119]
ds_read_b128 a[212:215], v178 offset:8192
v_mfma_f32_16x16x32_bf16 v[124:127], a[220:223], v[164:167], v[124:127]
ds_read_b64_tr_b16 a[86:87], v200 offset:6144
s_cbranch_vccz L_nors17
s_call_b64 s[82:83], L_rescale
L_nors17:
s_waitcnt lgkmcnt(8)
v_mfma_f32_16x16x32_bf16 v[128:131], a[192:195], a[128:131], v[168:171]
ds_read_b128 a[216:219], v179 offset:0
v_exp_f32 v144, v144
v_mfma_f32_16x16x32_bf16 v[136:139], a[192:195], a[132:135], v[172:175]
ds_read_b64_tr_b16 a[88:89], v200 offset:8192
v_exp_f32 v145, v145
s_add_u32 m0, s33, 114688
s_lshl_b32 s71, s75, 7
s_add_u32 s71, s71, 114688
buffer_load_dwordx4 v196, s[24:27], s71 offen offset:0  lds
v_mfma_f32_16x16x32_bf16 v[132:135], a[196:199], a[128:131], v[168:171]
ds_read_b128 a[220:223], v179 offset:8192
v_exp_f32 v146, v146
v_mfma_f32_16x16x32_bf16 v[140:143], a[196:199], a[132:135], v[172:175]
ds_read_b64_tr_b16 a[90:91], v200 offset:10240
v_cvt_pk_bf16_f32 v160, v144, v145
s_waitcnt lgkmcnt(8)
v_mfma_f32_16x16x32_bf16 v[128:131], a[200:203], a[136:139], v[128:131]
ds_read_b128 a[192:195], v176 offset:256
v_exp_f32 v147, v147
v_mfma_f32_16x16x32_bf16 v[136:139], a[200:203], a[140:143], v[136:139]
ds_read_b64_tr_b16 a[92:93], v200 offset:12288
v_mfma_f32_16x16x32_bf16 v[132:135], a[204:207], a[136:139], v[132:135]
ds_read_b128 a[196:199], v176 offset:8448
v_exp_f32 v148, v148
v_mfma_f32_16x16x32_bf16 v[140:143], a[204:207], a[140:143], v[140:143]
ds_read_b64_tr_b16 a[94:95], v200 offset:14336
v_cvt_pk_bf16_f32 v161, v146, v147
s_waitcnt vmcnt(6)
s_add_u32 m0, s33, 16384
s_mov_b32 s34, 263168
buffer_load_dwordx4 v194, s[12:15], s34 offen offset:2048 nt lds
s_waitcnt lgkmcnt(8)
v_mfma_f32_16x16x32_bf16 v[128:131], a[208:211], a[144:147], v[128:131]
ds_read_b128 a[200:203], v177 offset:256
v_mfma_f32_16x16x32_bf16 v[136:139], a[208:211], a[148:151], v[136:139]
v_exp_f32 v149, v149
v_mfma_f32_16x16x32_bf16 v[132:135], a[212:215], a[144:147], v[132:135]
ds_read_b128 a[204:207], v177 offset:8448
v_exp_f32 v150, v150
v_mfma_f32_16x16x32_bf16 v[140:143], a[212:215], a[148:151], v[140:143]
v_cvt_pk_bf16_f32 v162, v148, v149
s_waitcnt lgkmcnt(6)
v_mfma_f32_16x16x32_bf16 v[128:131], a[216:219], a[152:155], v[128:131]
ds_read_b128 a[208:211], v178 offset:256
v_mfma_f32_16x16x32_bf16 v[136:139], a[216:219], a[156:159], v[136:139]
v_exp_f32 v151, v151
v_mfma_f32_16x16x32_bf16 v[132:135], a[220:223], a[152:155], v[132:135]
ds_read_b128 a[212:215], v178 offset:8448
v_exp_f32 v152, v152
v_mfma_f32_16x16x32_bf16 v[140:143], a[220:223], a[156:159], v[140:143]
v_cvt_pk_bf16_f32 v163, v150, v151
s_waitcnt vmcnt(6)
s_mov_b32 s34, 262144
buffer_load_dwordx4 v195, s[12:15], s34 offen offset:3072 nt lds
s_waitcnt lgkmcnt(4)
v_mfma_f32_16x16x32_bf16 v[128:131], a[192:195], a[160:163], v[128:131]
ds_read_b128 a[216:219], v179 offset:256
v_mfma_f32_16x16x32_bf16 v[136:139], a[192:195], a[164:167], v[136:139]
v_exp_f32 v153, v153
v_mfma_f32_16x16x32_bf16 v[132:135], a[196:199], a[160:163], v[132:135]
ds_read_b128 a[220:223], v179 offset:8448
v_exp_f32 v154, v154
v_mfma_f32_16x16x32_bf16 v[140:143], a[196:199], a[164:167], v[140:143]
v_cvt_pk_bf16_f32 v164, v152, v153
s_waitcnt lgkmcnt(4)
v_mfma_f32_16x16x32_bf16 v[128:131], a[200:203], a[168:171], v[128:131]
s_waitcnt lgkmcnt(0)
s_barrier
ds_read_b64_tr_b16 a[192:193], v180 offset:32768
v_exp_f32 v155, v155
v_mfma_f32_16x16x32_bf16 v[136:139], a[200:203], a[172:175], v[136:139]
ds_read_b64_tr_b16 a[194:195], v180 offset:40960
v_mfma_f32_16x16x32_bf16 v[132:135], a[204:207], a[168:171], v[132:135]
ds_read_b64_tr_b16 a[196:197], v181 offset:32768
v_exp_f32 v156, v156
v_mfma_f32_16x16x32_bf16 v[140:143], a[204:207], a[172:175], v[140:143]
ds_read_b64_tr_b16 a[198:199], v181 offset:40960
v_cvt_pk_bf16_f32 v165, v154, v155
s_waitcnt lgkmcnt(6)
v_mfma_f32_16x16x32_bf16 v[128:131], a[208:211], a[176:179], v[128:131]
ds_read_b64_tr_b16 a[200:201], v182 offset:32768
v_exp_f32 v157, v157
v_mfma_f32_16x16x32_bf16 v[136:139], a[208:211], a[180:183], v[136:139]
ds_read_b64_tr_b16 a[202:203], v182 offset:40960
s_waitcnt vmcnt(5)
s_add_u32 m0, s33, 0
s_mov_b32 s34, 328704
buffer_load_dwordx4 v188, s[8:11], s34 offen offset:0 nt lds
s_add_u32 m0, s33, 114688
s_lshl_b32 s71, s75, 7
s_add_u32 s71, s71, 114688
buffer_load_dwordx4 v197, s[24:27], s71 offen offset:1024  lds
v_mfma_f32_16x16x32_bf16 v[132:135], a[212:215], a[176:179], v[132:135]
ds_read_b64_tr_b16 a[204:205], v183 offset:32768
v_exp_f32 v158, v158
v_mfma_f32_16x16x32_bf16 v[140:143], a[212:215], a[180:183], v[140:143]
ds_read_b64_tr_b16 a[206:207], v183 offset:40960
v_cvt_pk_bf16_f32 v166, v156, v157
s_waitcnt lgkmcnt(8)
v_mfma_f32_16x16x32_bf16 v[128:131], a[216:219], a[184:187], v[128:131]
ds_read_b64_tr_b16 a[208:209], v184 offset:32768
v_exp_f32 v159, v159
v_mfma_f32_16x16x32_bf16 v[136:139], a[216:219], a[188:191], v[136:139]
ds_read_b64_tr_b16 a[210:211], v184 offset:40960
v_mfma_f32_16x16x32_bf16 v[132:135], a[220:223], a[184:187], v[132:135]
ds_read_b64_tr_b16 a[212:213], v185 offset:32768
v_cvt_pk_bf16_f32 v167, v158, v159
v_mfma_f32_16x16x32_bf16 v[140:143], a[220:223], a[188:191], v[140:143]
ds_read_b64_tr_b16 a[214:215], v185 offset:40960
s_nop 0
s_waitcnt lgkmcnt(8)
v_mfma_f32_16x16x32_bf16 v[0:3], a[192:195], v[160:163], v[0:3]
ds_read_b64_tr_b16 a[216:217], v186 offset:32768
v_mfma_f32_16x16x32_bf16 v[8:11], a[192:195], v[164:167], v[8:11]
ds_read_b64_tr_b16 a[218:219], v186 offset:40960
s_waitcnt vmcnt(6)
s_add_u32 m0, s33, 0
s_mov_b32 s34, 327680
buffer_load_dwordx4 v189, s[8:11], s34 offen offset:1024 nt lds
v_mfma_f32_16x16x32_bf16 a[224:227], a[232:235], v[160:163], a[224:227]
v_mfma_f32_16x16x32_bf16 v[4:7], a[196:199], v[160:163], v[4:7]
ds_read_b64_tr_b16 a[220:221], v187 offset:32768
v_mfma_f32_16x16x32_bf16 v[12:15], a[196:199], v[164:167], v[12:15]
ds_read_b64_tr_b16 a[222:223], v187 offset:40960
v_mfma_f32_16x16x32_bf16 a[228:231], a[232:235], v[164:167], a[228:231]
s_waitcnt lgkmcnt(8)
v_mfma_f32_16x16x32_bf16 v[16:19], a[200:203], v[160:163], v[16:19]
ds_read_b64_tr_b16 a[192:193], v180 offset:33024
v_mfma_f32_16x16x32_bf16 v[24:27], a[200:203], v[164:167], v[24:27]
ds_read_b64_tr_b16 a[194:195], v180 offset:41216
v_mfma_f32_16x16x32_bf16 v[20:23], a[204:207], v[160:163], v[20:23]
ds_read_b64_tr_b16 a[196:197], v181 offset:33024
v_mfma_f32_16x16x32_bf16 v[28:31], a[204:207], v[164:167], v[28:31]
ds_read_b64_tr_b16 a[198:199], v181 offset:41216
s_waitcnt lgkmcnt(8)
v_mfma_f32_16x16x32_bf16 v[32:35], a[208:211], v[160:163], v[32:35]
ds_read_b64_tr_b16 a[200:201], v182 offset:33024
v_max3_f32 v208, v128, v129, v130
v_mfma_f32_16x16x32_bf16 v[40:43], a[208:211], v[164:167], v[40:43]
ds_read_b64_tr_b16 a[202:203], v182 offset:41216
v_mfma_f32_16x16x32_bf16 v[36:39], a[212:215], v[160:163], v[36:39]
ds_read_b64_tr_b16 a[204:205], v183 offset:33024
v_max3_f32 v209, v136, v137, v138
v_mfma_f32_16x16x32_bf16 v[44:47], a[212:215], v[164:167], v[44:47]
ds_read_b64_tr_b16 a[206:207], v183 offset:41216
s_waitcnt vmcnt(6)
s_mov_b32 s34, 330752
buffer_load_dwordx4 v190, s[8:11], s34 offen offset:2048 nt lds
s_waitcnt lgkmcnt(8)
v_mfma_f32_16x16x32_bf16 v[48:51], a[216:219], v[160:163], v[48:51]
ds_read_b64_tr_b16 a[208:209], v184 offset:33024
v_max3_f32 v208, v208, v131, v132
v_mfma_f32_16x16x32_bf16 v[56:59], a[216:219], v[164:167], v[56:59]
ds_read_b64_tr_b16 a[210:211], v184 offset:41216
v_mfma_f32_16x16x32_bf16 v[52:55], a[220:223], v[160:163], v[52:55]
ds_read_b64_tr_b16 a[212:213], v185 offset:33024
v_max3_f32 v209, v209, v139, v140
v_mfma_f32_16x16x32_bf16 v[60:63], a[220:223], v[164:167], v[60:63]
ds_read_b64_tr_b16 a[214:215], v185 offset:41216
s_waitcnt lgkmcnt(8)
v_mfma_f32_16x16x32_bf16 v[64:67], a[192:195], v[160:163], v[64:67]
ds_read_b64_tr_b16 a[216:217], v186 offset:33024
v_max3_f32 v208, v208, v133, v134
v_mfma_f32_16x16x32_bf16 v[72:75], a[192:195], v[164:167], v[72:75]
ds_read_b64_tr_b16 a[218:219], v186 offset:41216
s_add_u32 m0, s33, 114688
s_lshl_b32 s71, s75, 7
s_add_u32 s71, s71, 114688
buffer_load_dwordx4 v198, s[24:27], s71 offen offset:2048  lds
v_mfma_f32_16x16x32_bf16 v[68:71], a[196:199], v[160:163], v[68:71]
ds_read_b64_tr_b16 a[220:221], v187 offset:33024
v_max3_f32 v209, v209, v141, v142
v_mfma_f32_16x16x32_bf16 v[76:79], a[196:199], v[164:167], v[76:79]
ds_read_b64_tr_b16 a[222:223], v187 offset:41216
s_waitcnt vmcnt(6)
s_add_u32 m0, s33, 0
s_mov_b32 s34, 329728
buffer_load_dwordx4 v191, s[8:11], s34 offen offset:3072 nt lds
s_waitcnt lgkmcnt(8)
v_mfma_f32_16x16x32_bf16 v[80:83], a[200:203], v[160:163], v[80:83]
s_waitcnt lgkmcnt(0)
s_barrier
ds_read_b128 a[192:195], v176 offset:16384
v_mfma_f32_16x16x32_bf16 v[88:91], a[200:203], v[164:167], v[88:91]
v_max_f32 v208, v208, v135
v_mfma_f32_16x16x32_bf16 v[84:87], a[204:207], v[160:163], v[84:87]
ds_read_b128 a[196:199], v176 offset:24576
v_mfma_f32_16x16x32_bf16 v[92:95], a[204:207], v[164:167], v[92:95]
v_max_f32 v209, v209, v143
s_waitcnt lgkmcnt(6)
v_mfma_f32_16x16x32_bf16 v[96:99], a[208:211], v[160:163], v[96:99]
ds_read_b128 a[200:203], v177 offset:16384
v_max_f32 v210, v208, v209
v_mfma_f32_16x16x32_bf16 v[104:107], a[208:211], v[164:167], v[104:107]
ds_read_b64_tr_b16 a[96:97], v200 offset:16384
v_mfma_f32_16x16x32_bf16 v[100:103], a[212:215], v[160:163], v[100:103]
ds_read_b128 a[204:207], v177 offset:24576
v_cmp_lt_f32 vcc, s80, v210
v_mfma_f32_16x16x32_bf16 v[108:111], a[212:215], v[164:167], v[108:111]
ds_read_b64_tr_b16 a[98:99], v200 offset:18432
s_waitcnt lgkmcnt(6)
v_mfma_f32_16x16x32_bf16 v[112:115], a[216:219], v[160:163], v[112:115]
ds_read_b128 a[208:211], v178 offset:16384
v_mfma_f32_16x16x32_bf16 v[120:123], a[216:219], v[164:167], v[120:123]
ds_read_b64_tr_b16 a[100:101], v200 offset:20480
s_waitcnt vmcnt(6)
s_add_u32 m0, s33, 32768
s_mov_b32 s34, 327680
buffer_load_dwordx4 v192, s[12:15], s34 offen offset:0 nt lds
v_mfma_f32_16x16x32_bf16 v[116:119], a[220:223], v[160:163], v[116:119]
ds_read_b128 a[212:215], v178 offset:24576
v_mfma_f32_16x16x32_bf16 v[124:127], a[220:223], v[164:167], v[124:127]
ds_read_b64_tr_b16 a[102:103], v200 offset:22528
s_cbranch_vccz L_nors18
s_call_b64 s[82:83], L_rescale
L_nors18:
s_waitcnt lgkmcnt(8)
v_mfma_f32_16x16x32_bf16 v[144:147], a[192:195], a[128:131], v[168:171]
ds_read_b128 a[216:219], v179 offset:16384
v_exp_f32 v128, v128
v_mfma_f32_16x16x32_bf16 v[152:155], a[192:195], a[132:135], v[172:175]
ds_read_b64_tr_b16 a[104:105], v200 offset:24576
v_exp_f32 v129, v129
v_mfma_f32_16x16x32_bf16 v[148:151], a[196:199], a[128:131], v[168:171]
ds_read_b128 a[220:223], v179 offset:24576
v_exp_f32 v130, v130
v_mfma_f32_16x16x32_bf16 v[156:159], a[196:199], a[132:135], v[172:175]
ds_read_b64_tr_b16 a[106:107], v200 offset:26624
v_cvt_pk_bf16_f32 v160, v128, v129
s_waitcnt lgkmcnt(8)
v_mfma_f32_16x16x32_bf16 v[144:147], a[200:203], a[136:139], v[144:147]
ds_read_b128 a[192:195], v176 offset:16640
v_exp_f32 v131, v131
v_mfma_f32_16x16x32_bf16 v[152:155], a[200:203], a[140:143], v[152:155]
ds_read_b64_tr_b16 a[108:109], v200 offset:28672
v_mfma_f32_16x16x32_bf16 v[148:151], a[204:207], a[136:139], v[148:151]
ds_read_b128 a[196:199], v176 offset:24832
v_exp_f32 v132, v132
v_mfma_f32_16x16x32_bf16 v[156:159], a[204:207], a[140:143], v[156:159]
ds_read_b64_tr_b16 a[110:111], v200 offset:30720
v_cvt_pk_bf16_f32 v161, v130, v131
s_waitcnt vmcnt(6)
s_mov_b32 s34, 328704
buffer_load_dwordx4 v193, s[12:15], s34 offen offset:1024 nt lds
s_waitcnt lgkmcnt(8)
v_mfma_f32_16x16x32_bf16 v[144:147], a[208:211], a[144:147], v[144:147]
ds_read_b128 a[200:203], v177 offset:16640
v_mfma_f32_16x16x32_bf16 v[152:155], a[208:211], a[148:151], v[152:155]
v_exp_f32 v133, v133
s_add_u32 m0, s33, 114688
s_lshl_b32 s71, s75, 7
s_add_u32 s71, s71, 114688
buffer_load_dwordx4 v199, s[24:27], s71 offen offset:3072  lds
v_mfma_f32_16x16x32_bf16 v[148:151], a[212:215], a[144:147], v[148:151]
ds_read_b128 a[204:207], v177 offset:24832
v_exp_f32 v134, v134
v_mfma_f32_16x16x32_bf16 v[156:159], a[212:215], a[148:151], v[156:159]
v_cvt_pk_bf16_f32 v162, v132, v133
s_waitcnt lgkmcnt(6)
v_mfma_f32_16x16x32_bf16 v[144:147], a[216:219], a[152:155], v[144:147]
ds_read_b128 a[208:211], v178 offset:16640
v_mfma_f32_16x16x32_bf16 v[152:155], a[216:219], a[156:159], v[152:155]
v_exp_f32 v135, v135
v_mfma_f32_16x16x32_bf16 v[148:151], a[220:223], a[152:155], v[148:151]
ds_read_b128 a[212:215], v178 offset:24832
v_exp_f32 v136, v136
v_mfma_f32_16x16x32_bf16 v[156:159], a[220:223], a[156:159], v[156:159]
v_cvt_pk_bf16_f32 v163, v134, v135
s_waitcnt vmcnt(6)
s_add_u32 m0, s33, 32768
s_mov_b32 s34, 329728
buffer_load_dwordx4 v194, s[12:15], s34 offen offset:2048 nt lds
s_waitcnt lgkmcnt(4)
v_mfma_f32_16x16x32_bf16 v[144:147], a[192:195], a[160:163], v[144:147]
ds_read_b128 a[216:219], v179 offset:16640
v_mfma_f32_16x16x32_bf16 v[152:155], a[192:195], a[164:167], v[152:155]
v_exp_f32 v137, v137
v_mfma_f32_16x16x32_bf16 v[148:151], a[196:199], a[160:163], v[148:151]
ds_read_b128 a[220:223], v179 offset:24832
v_exp_f32 v138, v138
v_mfma_f32_16x16x32_bf16 v[156:159], a[196:199], a[164:167], v[156:159]
v_cvt_pk_bf16_f32 v164, v136, v137
s_waitcnt lgkmcnt(4)
v_mfma_f32_16x16x32_bf16 v[144:147], a[200:203], a[168:171], v[144:147]
v_add_u32 v180, 65536, v180
v_add_u32 v181, 65536, v181
v_add_u32 v182, 65536, v182
v_add_u32 v183, 65536, v183
v_add_u32 v184, 65536, v184
v_add_u32 v185, 65536, v185
v_add_u32 v186, 65536, v186
v_add_u32 v187, 65536, v187
s_waitcnt lgkmcnt(0)
s_barrier
ds_read_b64_tr_b16 a[192:193], v180 offset:32768
v_exp_f32 v139, v139
v_mfma_f32_16x16x32_bf16 v[152:155], a[200:203], a[172:175], v[152:155]
ds_read_b64_tr_b16 a[194:195], v180 offset:40960
v_mfma_f32_16x16x32_bf16 v[148:151], a[204:207], a[168:171], v[148:151]
ds_read_b64_tr_b16 a[196:197], v181 offset:32768
v_exp_f32 v140, v140
v_mfma_f32_16x16x32_bf16 v[156:159], a[204:207], a[172:175], v[156:159]
ds_read_b64_tr_b16 a[198:199], v181 offset:40960
v_cvt_pk_bf16_f32 v165, v138, v139
s_waitcnt lgkmcnt(6)
v_mfma_f32_16x16x32_bf16 v[144:147], a[208:211], a[176:179], v[144:147]
ds_read_b64_tr_b16 a[200:201], v182 offset:32768
v_exp_f32 v141, v141
v_mfma_f32_16x16x32_bf16 v[152:155], a[208:211], a[180:183], v[152:155]
ds_read_b64_tr_b16 a[202:203], v182 offset:40960
s_waitcnt vmcnt(6)
s_mov_b32 s34, 330752
buffer_load_dwordx4 v195, s[12:15], s34 offen offset:3072 nt lds
v_mfma_f32_16x16x32_bf16 v[148:151], a[212:215], a[176:179], v[148:151]
ds_read_b64_tr_b16 a[204:205], v183 offset:32768
v_exp_f32 v142, v142
v_mfma_f32_16x16x32_bf16 v[156:159], a[212:215], a[180:183], v[156:159]
ds_read_b64_tr_b16 a[206:207], v183 offset:40960
v_cvt_pk_bf16_f32 v166, v140, v141
s_waitcnt lgkmcnt(8)
v_mfma_f32_16x16x32_bf16 v[144:147], a[216:219], a[184:187], v[144:147]
ds_read_b64_tr_b16 a[208:209], v184 offset:32768
v_exp_f32 v143, v143
v_mfma_f32_16x16x32_bf16 v[152:155], a[216:219], a[188:191], v[152:155]
ds_read_b64_tr_b16 a[210:211], v184 offset:40960
v_mfma_f32_16x16x32_bf16 v[148:151], a[220:223], a[184:187], v[148:151]
ds_read_b64_tr_b16 a[212:213], v185 offset:32768
v_cvt_pk_bf16_f32 v167, v142, v143
v_mfma_f32_16x16x32_bf16 v[156:159], a[220:223], a[188:191], v[156:159]
ds_read_b64_tr_b16 a[214:215], v185 offset:40960
s_nop 0
s_waitcnt lgkmcnt(8)
v_mfma_f32_16x16x32_bf16 v[0:3], a[192:195], v[160:163], v[0:3]
ds_read_b64_tr_b16 a[216:217], v186 offset:32768
v_mfma_f32_16x16x32_bf16 v[8:11], a[192:195], v[164:167], v[8:11]
ds_read_b64_tr_b16 a[218:219], v186 offset:40960
s_waitcnt vmcnt(5)
s_add_u32 m0, s33, 65536
s_mov_b32 s34, 329728
buffer_load_dwordx4 v188, s[8:11], s34 offen offset:0 nt lds
s_add_u32 m0, s33, 147456
s_lshl_b32 s71, s76, 7
buffer_load_dwordx4 v196, s[24:27], s71 offen offset:0  lds
v_mfma_f32_16x16x32_bf16 a[224:227], a[232:235], v[160:163], a[224:227]
v_mfma_f32_16x16x32_bf16 v[4:7], a[196:199], v[160:163], v[4:7]
ds_read_b64_tr_b16 a[220:221], v187 offset:32768
v_mfma_f32_16x16x32_bf16 v[12:15], a[196:199], v[164:167], v[12:15]
ds_read_b64_tr_b16 a[222:223], v187 offset:40960
v_mfma_f32_16x16x32_bf16 a[228:231], a[232:235], v[164:167], a[228:231]
s_waitcnt lgkmcnt(8)
v_mfma_f32_16x16x32_bf16 v[16:19], a[200:203], v[160:163], v[16:19]
ds_read_b64_tr_b16 a[192:193], v180 offset:33024
v_mfma_f32_16x16x32_bf16 v[24:27], a[200:203], v[164:167], v[24:27]
ds_read_b64_tr_b16 a[194:195], v180 offset:41216
v_mfma_f32_16x16x32_bf16 v[20:23], a[204:207], v[160:163], v[20:23]
ds_read_b64_tr_b16 a[196:197], v181 offset:33024
v_mfma_f32_16x16x32_bf16 v[28:31], a[204:207], v[164:167], v[28:31]
ds_read_b64_tr_b16 a[198:199], v181 offset:41216
s_waitcnt lgkmcnt(8)
v_mfma_f32_16x16x32_bf16 v[32:35], a[208:211], v[160:163], v[32:35]
ds_read_b64_tr_b16 a[200:201], v182 offset:33024
v_max3_f32 v208, v144, v145, v146
v_mfma_f32_16x16x32_bf16 v[40:43], a[208:211], v[164:167], v[40:43]
ds_read_b64_tr_b16 a[202:203], v182 offset:41216
v_mfma_f32_16x16x32_bf16 v[36:39], a[212:215], v[160:163], v[36:39]
ds_read_b64_tr_b16 a[204:205], v183 offset:33024
v_max3_f32 v209, v152, v153, v154
v_mfma_f32_16x16x32_bf16 v[44:47], a[212:215], v[164:167], v[44:47]
ds_read_b64_tr_b16 a[206:207], v183 offset:41216
s_waitcnt vmcnt(6)
s_add_u32 m0, s33, 65536
s_mov_b32 s34, 330752
buffer_load_dwordx4 v189, s[8:11], s34 offen offset:1024 nt lds
s_waitcnt lgkmcnt(8)
v_mfma_f32_16x16x32_bf16 v[48:51], a[216:219], v[160:163], v[48:51]
ds_read_b64_tr_b16 a[208:209], v184 offset:33024
v_max3_f32 v208, v208, v147, v148
v_mfma_f32_16x16x32_bf16 v[56:59], a[216:219], v[164:167], v[56:59]
ds_read_b64_tr_b16 a[210:211], v184 offset:41216
v_mfma_f32_16x16x32_bf16 v[52:55], a[220:223], v[160:163], v[52:55]
ds_read_b64_tr_b16 a[212:213], v185 offset:33024
v_max3_f32 v209, v209, v155, v156
v_mfma_f32_16x16x32_bf16 v[60:63], a[220:223], v[164:167], v[60:63]
ds_read_b64_tr_b16 a[214:215], v185 offset:41216
s_waitcnt lgkmcnt(8)
v_mfma_f32_16x16x32_bf16 v[64:67], a[192:195], v[160:163], v[64:67]
ds_read_b64_tr_b16 a[216:217], v186 offset:33024
v_max3_f32 v208, v208, v149, v150
v_mfma_f32_16x16x32_bf16 v[72:75], a[192:195], v[164:167], v[72:75]
ds_read_b64_tr_b16 a[218:219], v186 offset:41216
v_mfma_f32_16x16x32_bf16 v[68:71], a[196:199], v[160:163], v[68:71]
ds_read_b64_tr_b16 a[220:221], v187 offset:33024
v_max3_f32 v209, v209, v157, v158
v_mfma_f32_16x16x32_bf16 v[76:79], a[196:199], v[164:167], v[76:79]
ds_read_b64_tr_b16 a[222:223], v187 offset:41216
s_waitcnt vmcnt(6)
s_mov_b32 s34, 327680
buffer_load_dwordx4 v190, s[8:11], s34 offen offset:2048 nt lds
s_waitcnt lgkmcnt(8)
v_mfma_f32_16x16x32_bf16 v[80:83], a[200:203], v[160:163], v[80:83]
v_subrev_u32 v176, 65536, v176
v_subrev_u32 v177, 65536, v177
v_subrev_u32 v178, 65536, v178
v_subrev_u32 v179, 65536, v179
s_waitcnt lgkmcnt(0)
s_barrier
ds_read_b128 a[192:195], v176 offset:49152
v_mfma_f32_16x16x32_bf16 v[88:91], a[200:203], v[164:167], v[88:91]
v_max_f32 v208, v208, v151
v_mfma_f32_16x16x32_bf16 v[84:87], a[204:207], v[160:163], v[84:87]
ds_read_b128 a[196:199], v176 offset:57344
v_mfma_f32_16x16x32_bf16 v[92:95], a[204:207], v[164:167], v[92:95]
v_max_f32 v209, v209, v159
s_waitcnt lgkmcnt(6)
v_mfma_f32_16x16x32_bf16 v[96:99], a[208:211], v[160:163], v[96:99]
ds_read_b128 a[200:203], v177 offset:49152
v_mfma_f32_16x16x32_bf16 v[104:107], a[208:211], v[164:167], v[104:107]
v_max_f32 v210, v208, v209
s_add_u32 m0, s33, 147456
s_lshl_b32 s71, s76, 7
buffer_load_dwordx4 v197, s[24:27], s71 offen offset:1024  lds
v_mfma_f32_16x16x32_bf16 v[100:103], a[212:215], v[160:163], v[100:103]
ds_read_b128 a[204:207], v177 offset:57344
v_mfma_f32_16x16x32_bf16 v[108:111], a[212:215], v[164:167], v[108:111]
v_cmp_lt_f32 vcc, s80, v210
s_waitcnt lgkmcnt(4)
v_mfma_f32_16x16x32_bf16 v[112:115], a[216:219], v[160:163], v[112:115]
ds_read_b128 a[208:211], v178 offset:49152
v_mfma_f32_16x16x32_bf16 v[120:123], a[216:219], v[164:167], v[120:123]
s_waitcnt vmcnt(6)
s_add_u32 m0, s33, 65536
s_mov_b32 s34, 328704
buffer_load_dwordx4 v191, s[8:11], s34 offen offset:3072 nt lds
v_mfma_f32_16x16x32_bf16 v[116:119], a[220:223], v[160:163], v[116:119]
ds_read_b128 a[212:215], v178 offset:57344
v_mfma_f32_16x16x32_bf16 v[124:127], a[220:223], v[164:167], v[124:127]
s_cbranch_vccz L_nors19
s_call_b64 s[82:83], L_rescale
L_nors19:
s_waitcnt lgkmcnt(4)
v_mfma_f32_16x16x32_bf16 v[128:131], a[192:195], a[128:131], v[168:171]
ds_read_b128 a[216:219], v179 offset:49152
v_exp_f32 v144, v144
v_mfma_f32_16x16x32_bf16 v[136:139], a[192:195], a[132:135], v[172:175]
v_exp_f32 v145, v145
v_mfma_f32_16x16x32_bf16 v[132:135], a[196:199], a[128:131], v[168:171]
ds_read_b128 a[220:223], v179 offset:57344
v_exp_f32 v146, v146
v_mfma_f32_16x16x32_bf16 v[140:143], a[196:199], a[132:135], v[172:175]
v_cvt_pk_bf16_f32 v160, v144, v145
s_waitcnt lgkmcnt(4)
v_mfma_f32_16x16x32_bf16 v[128:131], a[200:203], a[136:139], v[128:131]
ds_read_b128 a[192:195], v176 offset:49408
v_mfma_f32_16x16x32_bf16 v[136:139], a[200:203], a[140:143], v[136:139]
v_exp_f32 v147, v147
s_waitcnt vmcnt(6)
s_add_u32 m0, s33, 81920
s_mov_b32 s34, 328704
buffer_load_dwordx4 v192, s[12:15], s34 offen offset:0 nt lds
v_mfma_f32_16x16x32_bf16 v[132:135], a[204:207], a[136:139], v[132:135]
ds_read_b128 a[196:199], v176 offset:57600
v_exp_f32 v148, v148
v_mfma_f32_16x16x32_bf16 v[140:143], a[204:207], a[140:143], v[140:143]
v_cvt_pk_bf16_f32 v161, v146, v147
s_waitcnt lgkmcnt(4)
v_mfma_f32_16x16x32_bf16 v[128:131], a[208:211], a[144:147], v[128:131]
ds_read_b128 a[200:203], v177 offset:49408
v_mfma_f32_16x16x32_bf16 v[136:139], a[208:211], a[148:151], v[136:139]
v_exp_f32 v149, v149
v_mfma_f32_16x16x32_bf16 v[132:135], a[212:215], a[144:147], v[132:135]
ds_read_b128 a[204:207], v177 offset:57600
v_exp_f32 v150, v150
v_mfma_f32_16x16x32_bf16 v[140:143], a[212:215], a[148:151], v[140:143]
v_cvt_pk_bf16_f32 v162, v148, v149
s_waitcnt lgkmcnt(4)
v_mfma_f32_16x16x32_bf16 v[128:131], a[216:219], a[152:155], v[128:131]
ds_read_b128 a[208:211], v178 offset:49408
v_mfma_f32_16x16x32_bf16 v[136:139], a[216:219], a[156:159], v[136:139]
v_exp_f32 v151, v151
v_mfma_f32_16x16x32_bf16 v[132:135], a[220:223], a[152:155], v[132:135]
ds_read_b128 a[212:215], v178 offset:57600
v_exp_f32 v152, v152
v_mfma_f32_16x16x32_bf16 v[140:143], a[220:223], a[156:159], v[140:143]
v_cvt_pk_bf16_f32 v163, v150, v151
s_waitcnt vmcnt(6)
s_mov_b32 s34, 327680
buffer_load_dwordx4 v193, s[12:15], s34 offen offset:1024 nt lds
s_waitcnt lgkmcnt(4)
v_mfma_f32_16x16x32_bf16 v[128:131], a[192:195], a[160:163], v[128:131]
ds_read_b128 a[216:219], v179 offset:49408
v_mfma_f32_16x16x32_bf16 v[136:139], a[192:195], a[164:167], v[136:139]
v_exp_f32 v153, v153
s_add_u32 m0, s33, 147456
s_lshl_b32 s71, s76, 7
buffer_load_dwordx4 v198, s[24:27], s71 offen offset:2048  lds
v_mfma_f32_16x16x32_bf16 v[132:135], a[196:199], a[160:163], v[132:135]
ds_read_b128 a[220:223], v179 offset:57600
v_exp_f32 v154, v154
v_mfma_f32_16x16x32_bf16 v[140:143], a[196:199], a[164:167], v[140:143]
v_cvt_pk_bf16_f32 v164, v152, v153
s_waitcnt lgkmcnt(4)
v_mfma_f32_16x16x32_bf16 v[128:131], a[200:203], a[168:171], v[128:131]
v_subrev_u32 v180, 65536, v180
v_subrev_u32 v181, 65536, v181
v_subrev_u32 v182, 65536, v182
v_subrev_u32 v183, 65536, v183
v_subrev_u32 v184, 65536, v184
v_subrev_u32 v185, 65536, v185
v_subrev_u32 v186, 65536, v186
v_subrev_u32 v187, 65536, v187
s_waitcnt lgkmcnt(0)
s_barrier
ds_read_b64_tr_b16 a[192:193], v180 offset:16384
v_exp_f32 v155, v155
v_mfma_f32_16x16x32_bf16 v[136:139], a[200:203], a[172:175], v[136:139]
ds_read_b64_tr_b16 a[194:195], v180 offset:24576
v_mfma_f32_16x16x32_bf16 v[132:135], a[204:207], a[168:171], v[132:135]
ds_read_b64_tr_b16 a[196:197], v181 offset:16384
v_exp_f32 v156, v156
v_mfma_f32_16x16x32_bf16 v[140:143], a[204:207], a[172:175], v[140:143]
ds_read_b64_tr_b16 a[198:199], v181 offset:24576
v_cvt_pk_bf16_f32 v165, v154, v155
s_waitcnt vmcnt(6)
s_add_u32 m0, s33, 81920
s_mov_b32 s34, 330752
buffer_load_dwordx4 v194, s[12:15], s34 offen offset:2048 nt lds
s_waitcnt lgkmcnt(6)
v_mfma_f32_16x16x32_bf16 v[128:131], a[208:211], a[176:179], v[128:131]
ds_read_b64_tr_b16 a[200:201], v182 offset:16384
v_exp_f32 v157, v157
v_mfma_f32_16x16x32_bf16 v[136:139], a[208:211], a[180:183], v[136:139]
ds_read_b64_tr_b16 a[202:203], v182 offset:24576
v_mfma_f32_16x16x32_bf16 v[132:135], a[212:215], a[176:179], v[132:135]
ds_read_b64_tr_b16 a[204:205], v183 offset:16384
v_exp_f32 v158, v158
v_mfma_f32_16x16x32_bf16 v[140:143], a[212:215], a[180:183], v[140:143]
ds_read_b64_tr_b16 a[206:207], v183 offset:24576
v_cvt_pk_bf16_f32 v166, v156, v157
s_waitcnt lgkmcnt(8)
v_mfma_f32_16x16x32_bf16 v[128:131], a[216:219], a[184:187], v[128:131]
ds_read_b64_tr_b16 a[208:209], v184 offset:16384
v_exp_f32 v159, v159
v_mfma_f32_16x16x32_bf16 v[136:139], a[216:219], a[188:191], v[136:139]
ds_read_b64_tr_b16 a[210:211], v184 offset:24576
v_mfma_f32_16x16x32_bf16 v[132:135], a[220:223], a[184:187], v[132:135]
ds_read_b64_tr_b16 a[212:213], v185 offset:16384
v_cvt_pk_bf16_f32 v167, v158, v159
v_mfma_f32_16x16x32_bf16 v[140:143], a[220:223], a[188:191], v[140:143]
ds_read_b64_tr_b16 a[214:215], v185 offset:24576
s_nop 0
s_waitcnt lgkmcnt(8)
v_mfma_f32_16x16x32_bf16 v[0:3], a[192:195], v[160:163], v[0:3]
ds_read_b64_tr_b16 a[216:217], v186 offset:16384
v_mfma_f32_16x16x32_bf16 v[8:11], a[192:195], v[164:167], v[8:11]
ds_read_b64_tr_b16 a[218:219], v186 offset:24576
s_waitcnt vmcnt(6)
s_mov_b32 s34, 329728
buffer_load_dwordx4 v195, s[12:15], s34 offen offset:3072 nt lds
v_mfma_f32_16x16x32_bf16 a[224:227], a[232:235], v[160:163], a[224:227]
v_mfma_f32_16x16x32_bf16 v[4:7], a[196:199], v[160:163], v[4:7]
ds_read_b64_tr_b16 a[220:221], v187 offset:16384
v_mfma_f32_16x16x32_bf16 v[12:15], a[196:199], v[164:167], v[12:15]
ds_read_b64_tr_b16 a[222:223], v187 offset:24576
v_mfma_f32_16x16x32_bf16 a[228:231], a[232:235], v[164:167], a[228:231]
s_waitcnt lgkmcnt(8)
v_mfma_f32_16x16x32_bf16 v[16:19], a[200:203], v[160:163], v[16:19]
ds_read_b64_tr_b16 a[192:193], v180 offset:16640
v_mfma_f32_16x16x32_bf16 v[24:27], a[200:203], v[164:167], v[24:27]
ds_read_b64_tr_b16 a[194:195], v180 offset:24832
v_mfma_f32_16x16x32_bf16 v[20:23], a[204:207], v[160:163], v[20:23]
ds_read_b64_tr_b16 a[196:197], v181 offset:16640
v_mfma_f32_16x16x32_bf16 v[28:31], a[204:207], v[164:167], v[28:31]
ds_read_b64_tr_b16 a[198:199], v181 offset:24832
s_waitcnt lgkmcnt(8)
v_mfma_f32_16x16x32_bf16 v[32:35], a[208:211], v[160:163], v[32:35]
ds_read_b64_tr_b16 a[200:201], v182 offset:16640
v_max3_f32 v208, v128, v129, v130
v_mfma_f32_16x16x32_bf16 v[40:43], a[208:211], v[164:167], v[40:43]
ds_read_b64_tr_b16 a[202:203], v182 offset:24832
s_waitcnt vmcnt(5)
s_add_u32 m0, s33, 49152
s_mov_b32 s34, 330752
buffer_load_dwordx4 v188, s[8:11], s34 offen offset:0 nt lds
s_add_u32 m0, s33, 147456
s_lshl_b32 s71, s76, 7
buffer_load_dwordx4 v199, s[24:27], s71 offen offset:3072  lds
v_mfma_f32_16x16x32_bf16 v[36:39], a[212:215], v[160:163], v[36:39]
ds_read_b64_tr_b16 a[204:205], v183 offset:16640
v_max3_f32 v209, v136, v137, v138
v_mfma_f32_16x16x32_bf16 v[44:47], a[212:215], v[164:167], v[44:47]
ds_read_b64_tr_b16 a[206:207], v183 offset:24832
s_waitcnt lgkmcnt(8)
v_mfma_f32_16x16x32_bf16 v[48:51], a[216:219], v[160:163], v[48:51]
ds_read_b64_tr_b16 a[208:209], v184 offset:16640
v_max3_f32 v208, v208, v131, v132
v_mfma_f32_16x16x32_bf16 v[56:59], a[216:219], v[164:167], v[56:59]
ds_read_b64_tr_b16 a[210:211], v184 offset:24832
v_mfma_f32_16x16x32_bf16 v[52:55], a[220:223], v[160:163], v[52:55]
ds_read_b64_tr_b16 a[212:213], v185 offset:16640
v_max3_f32 v209, v209, v139, v140
v_mfma_f32_16x16x32_bf16 v[60:63], a[220:223], v[164:167], v[60:63]
ds_read_b64_tr_b16 a[214:215], v185 offset:24832
s_waitcnt lgkmcnt(8)
v_mfma_f32_16x16x32_bf16 v[64:67], a[192:195], v[160:163], v[64:67]
ds_read_b64_tr_b16 a[216:217], v186 offset:16640
v_max3_f32 v208, v208, v133, v134
v_mfma_f32_16x16x32_bf16 v[72:75], a[192:195], v[164:167], v[72:75]
ds_read_b64_tr_b16 a[218:219], v186 offset:24832
v_mfma_f32_16x16x32_bf16 v[68:71], a[196:199], v[160:163], v[68:71]
ds_read_b64_tr_b16 a[220:221], v187 offset:16640
v_max3_f32 v209, v209, v141, v142
v_mfma_f32_16x16x32_bf16 v[76:79], a[196:199], v[164:167], v[76:79]
ds_read_b64_tr_b16 a[222:223], v187 offset:24832
s_waitcnt vmcnt(6)
s_add_u32 m0, s33, 49152
s_mov_b32 s34, 329728
buffer_load_dwordx4 v189, s[8:11], s34 offen offset:1024 nt lds
s_waitcnt lgkmcnt(8)
v_mfma_f32_16x16x32_bf16 v[80:83], a[200:203], v[160:163], v[80:83]
s_waitcnt lgkmcnt(0)
s_barrier
v_subrev_u32 v200, 65536, v200
ds_read_b128 a[192:195], v176 offset:0
v_mfma_f32_16x16x32_bf16 v[88:91], a[200:203], v[164:167], v[88:91]
v_max_f32 v208, v208, v135
v_mfma_f32_16x16x32_bf16 v[84:87], a[204:207], v[160:163], v[84:87]
ds_read_b128 a[196:199], v176 offset:8192
v_mfma_f32_16x16x32_bf16 v[92:95], a[204:207], v[164:167], v[92:95]
v_max_f32 v209, v209, v143
s_waitcnt lgkmcnt(6)
v_mfma_f32_16x16x32_bf16 v[96:99], a[208:211], v[160:163], v[96:99]
ds_read_b128 a[200:203], v177 offset:0
v_max_f32 v210, v208, v209
v_mfma_f32_16x16x32_bf16 v[104:107], a[208:211], v[164:167], v[104:107]
ds_read_b64_tr_b16 a[112:113], v200 offset:49152
v_mfma_f32_16x16x32_bf16 v[100:103], a[212:215], v[160:163], v[100:103]
ds_read_b128 a[204:207], v177 offset:8192
v_cmp_lt_f32 vcc, s80, v210
v_mfma_f32_16x16x32_bf16 v[108:111], a[212:215], v[164:167], v[108:111]
ds_read_b64_tr_b16 a[114:115], v200 offset:51200
s_waitcnt vmcnt(6)
s_mov_b32 s34, 328704
buffer_load_dwordx4 v190, s[8:11], s34 offen offset:2048 nt lds
s_waitcnt lgkmcnt(6)
v_mfma_f32_16x16x32_bf16 v[112:115], a[216:219], v[160:163], v[112:115]
ds_read_b128 a[208:211], v178 offset:0
v_mfma_f32_16x16x32_bf16 v[120:123], a[216:219], v[164:167], v[120:123]
ds_read_b64_tr_b16 a[116:117], v200 offset:53248
v_mfma_f32_16x16x32_bf16 v[116:119], a[220:223], v[160:163], v[116:119]
ds_read_b128 a[212:215], v178 offset:8192
v_mfma_f32_16x16x32_bf16 v[124:127], a[220:223], v[164:167], v[124:127]
ds_read_b64_tr_b16 a[118:119], v200 offset:55296
s_cbranch_vccz L_nors20
s_call_b64 s[82:83], L_rescale
L_nors20:
s_waitcnt lgkmcnt(8)
v_mfma_f32_16x16x32_bf16 v[144:147], a[192:195], a[128:131], v[168:171]
ds_read_b128 a[216:219], v179 offset:0
v_exp_f32 v128, v128
v_mfma_f32_16x16x32_bf16 v[152:155], a[192:195], a[132:135], v[172:175]
ds_read_b64_tr_b16 a[120:121], v200 offset:57344
v_exp_f32 v129, v129
s_add_u32 m0, s33, 131072
s_lshl_b32 s71, s76, 7
s_add_u32 s71, s71, 114688
buffer_load_dwordx4 v196, s[24:27], s71 offen offset:0  lds
v_mfma_f32_16x16x32_bf16 v[148:151], a[196:199], a[128:131], v[168:171]
ds_read_b128 a[220:223], v179 offset:8192
v_exp_f32 v130, v130
v_mfma_f32_16x16x32_bf16 v[156:159], a[196:199], a[132:135], v[172:175]
ds_read_b64_tr_b16 a[122:123], v200 offset:59392
v_cvt_pk_bf16_f32 v160, v128, v129
s_waitcnt lgkmcnt(8)
v_mfma_f32_16x16x32_bf16 v[144:147], a[200:203], a[136:139], v[144:147]
ds_read_b128 a[192:195], v176 offset:256
v_exp_f32 v131, v131
v_mfma_f32_16x16x32_bf16 v[152:155], a[200:203], a[140:143], v[152:155]
ds_read_b64_tr_b16 a[124:125], v200 offset:61440
s_waitcnt vmcnt(6)
s_add_u32 m0, s33, 49152
s_mov_b32 s34, 327680
buffer_load_dwordx4 v191, s[8:11], s34 offen offset:3072 nt lds
v_mfma_f32_16x16x32_bf16 v[148:151], a[204:207], a[136:139], v[148:151]
ds_read_b128 a[196:199], v176 offset:8448
v_exp_f32 v132, v132
v_mfma_f32_16x16x32_bf16 v[156:159], a[204:207], a[140:143], v[156:159]
ds_read_b64_tr_b16 a[126:127], v200 offset:63488
v_cvt_pk_bf16_f32 v161, v130, v131
s_waitcnt lgkmcnt(8)
v_mfma_f32_16x16x32_bf16 v[144:147], a[208:211], a[144:147], v[144:147]
ds_read_b128 a[200:203], v177 offset:256
v_mfma_f32_16x16x32_bf16 v[152:155], a[208:211], a[148:151], v[152:155]
v_exp_f32 v133, v133
v_mfma_f32_16x16x32_bf16 v[148:151], a[212:215], a[144:147], v[148:151]
ds_read_b128 a[204:207], v177 offset:8448
v_exp_f32 v134, v134
v_mfma_f32_16x16x32_bf16 v[156:159], a[212:215], a[148:151], v[156:159]
v_cvt_pk_bf16_f32 v162, v132, v133
s_waitcnt lgkmcnt(6)
v_mfma_f32_16x16x32_bf16 v[144:147], a[216:219], a[152:155], v[144:147]
ds_read_b128 a[208:211], v178 offset:256
v_mfma_f32_16x16x32_bf16 v[152:155], a[216:219], a[156:159], v[152:155]
v_exp_f32 v135, v135
s_waitcnt vmcnt(6)
s_add_u32 m0, s33, 16384
s_mov_b32 s34, 329728
buffer_load_dwordx4 v192, s[12:15], s34 offen offset:0 nt lds
v_mfma_f32_16x16x32_bf16 v[148:151], a[220:223], a[152:155], v[148:151]
ds_read_b128 a[212:215], v178 offset:8448
v_exp_f32 v136, v136
v_mfma_f32_16x16x32_bf16 v[156:159], a[220:223], a[156:159], v[156:159]
v_cvt_pk_bf16_f32 v163, v134, v135
s_waitcnt lgkmcnt(4)
v_mfma_f32_16x16x32_bf16 v[144:147], a[192:195], a[160:163], v[144:147]
ds_read_b128 a[216:219], v179 offset:256
v_mfma_f32_16x16x32_bf16 v[152:155], a[192:195], a[164:167], v[152:155]
v_exp_f32 v137, v137
v_mfma_f32_16x16x32_bf16 v[148:151], a[196:199], a[160:163], v[148:151]
ds_read_b128 a[220:223], v179 offset:8448
v_exp_f32 v138, v138
v_mfma_f32_16x16x32_bf16 v[156:159], a[196:199], a[164:167], v[156:159]
v_cvt_pk_bf16_f32 v164, v136, v137
s_waitcnt lgkmcnt(4)
v_mfma_f32_16x16x32_bf16 v[144:147], a[200:203], a[168:171], v[144:147]
s_waitcnt lgkmcnt(0)
s_barrier
ds_read_b64_tr_b16 a[192:193], v180 offset:32768
v_exp_f32 v139, v139
v_mfma_f32_16x16x32_bf16 v[152:155], a[200:203], a[172:175], v[152:155]
ds_read_b64_tr_b16 a[194:195], v180 offset:40960
v_mfma_f32_16x16x32_bf16 v[148:151], a[204:207], a[168:171], v[148:151]
ds_read_b64_tr_b16 a[196:197], v181 offset:32768
v_exp_f32 v140, v140
v_mfma_f32_16x16x32_bf16 v[156:159], a[204:207], a[172:175], v[156:159]
ds_read_b64_tr_b16 a[198:199], v181 offset:40960
v_cvt_pk_bf16_f32 v165, v138, v139
s_waitcnt vmcnt(6)
s_mov_b32 s34, 330752
buffer_load_dwordx4 v193, s[12:15], s34 offen offset:1024 nt lds
s_waitcnt lgkmcnt(6)
v_mfma_f32_16x16x32_bf16 v[144:147], a[208:211], a[176:179], v[144:147]
ds_read_b64_tr_b16 a[200:201], v182 offset:32768
v_exp_f32 v141, v141
v_mfma_f32_16x16x32_bf16 v[152:155], a[208:211], a[180:183], v[152:155]
ds_read_b64_tr_b16 a[202:203], v182 offset:40960
s_add_u32 m0, s33, 131072
s_lshl_b32 s71, s76, 7
s_add_u32 s71, s71, 114688
buffer_load_dwordx4 v197, s[24:27], s71 offen offset:1024  lds
v_mfma_f32_16x16x32_bf16 v[148:151], a[212:215], a[176:179], v[148:151]
ds_read_b64_tr_b16 a[204:205], v183 offset:32768
v_exp_f32 v142, v142
v_mfma_f32_16x16x32_bf16 v[156:159], a[212:215], a[180:183], v[156:159]
ds_read_b64_tr_b16 a[206:207], v183 offset:40960
v_cvt_pk_bf16_f32 v166, v140, v141
s_waitcnt lgkmcnt(8)
v_mfma_f32_16x16x32_bf16 v[144:147], a[216:219], a[184:187], v[144:147]
ds_read_b64_tr_b16 a[208:209], v184 offset:32768
v_exp_f32 v143, v143
v_mfma_f32_16x16x32_bf16 v[152:155], a[216:219], a[188:191], v[152:155]
ds_read_b64_tr_b16 a[210:211], v184 offset:40960
v_mfma_f32_16x16x32_bf16 v[148:151], a[220:223], a[184:187], v[148:151]
ds_read_b64_tr_b16 a[212:213], v185 offset:32768
v_cvt_pk_bf16_f32 v167, v142, v143
v_mfma_f32_16x16x32_bf16 v[156:159], a[220:223], a[188:191], v[156:159]
ds_read_b64_tr_b16 a[214:215], v185 offset:40960
s_waitcnt vmcnt(6)
s_add_u32 m0, s33, 16384
s_mov_b32 s34, 327680
buffer_load_dwordx4 v194, s[12:15], s34 offen offset:2048 nt lds
s_nop 0
s_waitcnt lgkmcnt(8)
v_mfma_f32_16x16x32_bf16 v[0:3], a[192:195], v[160:163], v[0:3]
ds_read_b64_tr_b16 a[216:217], v186 offset:32768
v_mfma_f32_16x16x32_bf16 v[8:11], a[192:195], v[164:167], v[8:11]
ds_read_b64_tr_b16 a[218:219], v186 offset:40960
v_mfma_f32_16x16x32_bf16 a[224:227], a[232:235], v[160:163], a[224:227]
v_mfma_f32_16x16x32_bf16 v[4:7], a[196:199], v[160:163], v[4:7]
ds_read_b64_tr_b16 a[220:221], v187 offset:32768
v_mfma_f32_16x16x32_bf16 v[12:15], a[196:199], v[164:167], v[12:15]
ds_read_b64_tr_b16 a[222:223], v187 offset:40960
v_mfma_f32_16x16x32_bf16 a[228:231], a[232:235], v[164:167], a[228:231]
s_waitcnt lgkmcnt(8)
v_mfma_f32_16x16x32_bf16 v[16:19], a[200:203], v[160:163], v[16:19]
ds_read_b64_tr_b16 a[192:193], v180 offset:33024
v_mfma_f32_16x16x32_bf16 v[24:27], a[200:203], v[164:167], v[24:27]
ds_read_b64_tr_b16 a[194:195], v180 offset:41216
v_mfma_f32_16x16x32_bf16 v[20:23], a[204:207], v[160:163], v[20:23]
ds_read_b64_tr_b16 a[196:197], v181 offset:33024
v_mfma_f32_16x16x32_bf16 v[28:31], a[204:207], v[164:167], v[28:31]
ds_read_b64_tr_b16 a[198:199], v181 offset:41216
s_waitcnt lgkmcnt(8)
v_mfma_f32_16x16x32_bf16 v[32:35], a[208:211], v[160:163], v[32:35]
ds_read_b64_tr_b16 a[200:201], v182 offset:33024
v_max3_f32 v208, v144, v145, v146
v_mfma_f32_16x16x32_bf16 v[40:43], a[208:211], v[164:167], v[40:43]
ds_read_b64_tr_b16 a[202:203], v182 offset:41216
s_waitcnt vmcnt(6)
s_mov_b32 s34, 328704
buffer_load_dwordx4 v195, s[12:15], s34 offen offset:3072 nt lds
v_mfma_f32_16x16x32_bf16 v[36:39], a[212:215], v[160:163], v[36:39]
ds_read_b64_tr_b16 a[204:205], v183 offset:33024
v_max3_f32 v209, v152, v153, v154
v_mfma_f32_16x16x32_bf16 v[44:47], a[212:215], v[164:167], v[44:47]
ds_read_b64_tr_b16 a[206:207], v183 offset:41216
s_waitcnt lgkmcnt(8)
v_mfma_f32_16x16x32_bf16 v[48:51], a[216:219], v[160:163], v[48:51]
ds_read_b64_tr_b16 a[208:209], v184 offset:33024
v_max3_f32 v208, v208, v147, v148
v_mfma_f32_16x16x32_bf16 v[56:59], a[216:219], v[164:167], v[56:59]
ds_read_b64_tr_b16 a[210:211], v184 offset:41216
v_mfma_f32_16x16x32_bf16 v[52:55], a[220:223], v[160:163], v[52:55]
ds_read_b64_tr_b16 a[212:213], v185 offset:33024
v_max3_f32 v209, v209, v155, v156
v_mfma_f32_16x16x32_bf16 v[60:63], a[220:223], v[164:167], v[60:63]
ds_read_b64_tr_b16 a[214:215], v185 offset:41216
s_waitcnt lgkmcnt(8)
v_mfma_f32_16x16x32_bf16 v[64:67], a[192:195], v[160:163], v[64:67]
ds_read_b64_tr_b16 a[216:217], v186 offset:33024
v_max3_f32 v208, v208, v149, v150
v_mfma_f32_16x16x32_bf16 v[72:75], a[192:195], v[164:167], v[72:75]
ds_read_b64_tr_b16 a[218:219], v186 offset:41216
s_waitcnt vmcnt(5)
s_add_u32 m0, s33, 0
s_mov_b32 s34, 393216
buffer_load_dwordx4 v188, s[8:11], s34 offen offset:0 nt lds
s_add_u32 m0, s33, 131072
s_lshl_b32 s71, s76, 7
s_add_u32 s71, s71, 114688
buffer_load_dwordx4 v198, s[24:27], s71 offen offset:2048  lds
v_mfma_f32_16x16x32_bf16 v[68:71], a[196:199], v[160:163], v[68:71]
ds_read_b64_tr_b16 a[220:221], v187 offset:33024
v_max3_f32 v209, v209, v157, v158
v_mfma_f32_16x16x32_bf16 v[76:79], a[196:199], v[164:167], v[76:79]
ds_read_b64_tr_b16 a[222:223], v187 offset:41216
s_waitcnt lgkmcnt(8)
v_mfma_f32_16x16x32_bf16 v[80:83], a[200:203], v[160:163], v[80:83]
v_add_u32 v176, 65536, v176
v_add_u32 v177, 65536, v177
v_add_u32 v178, 65536, v178
v_add_u32 v179, 65536, v179
s_waitcnt lgkmcnt(0)
s_barrier
v_add_u32 v200, 65536, v200
ds_read_b128 a[192:195], v176 offset:0
v_mfma_f32_16x16x32_bf16 v[88:91], a[200:203], v[164:167], v[88:91]
v_max_f32 v208, v208, v151
v_mfma_f32_16x16x32_bf16 v[84:87], a[204:207], v[160:163], v[84:87]
ds_read_b128 a[196:199], v176 offset:8192
v_mfma_f32_16x16x32_bf16 v[92:95], a[204:207], v[164:167], v[92:95]
v_max_f32 v209, v209, v159
s_waitcnt lgkmcnt(6)
v_mfma_f32_16x16x32_bf16 v[96:99], a[208:211], v[160:163], v[96:99]
ds_read_b128 a[200:203], v177 offset:0
v_max_f32 v210, v208, v209
v_mfma_f32_16x16x32_bf16 v[104:107], a[208:211], v[164:167], v[104:107]
ds_read_b64_tr_b16 a[236:237], v200 offset:16384
v_mfma_f32_16x16x32_bf16 v[100:103], a[212:215], v[160:163], v[100:103]
ds_read_b128 a[204:207], v177 offset:8192
v_cmp_lt_f32 vcc, s80, v210
v_mfma_f32_16x16x32_bf16 v[108:111], a[212:215], v[164:167], v[108:111]
ds_read_b64_tr_b16 a[238:239], v200 offset:18432
s_waitcnt vmcnt(6)
s_add_u32 m0, s33, 0
s_mov_b32 s34, 394240
buffer_load_dwordx4 v189, s[8:11], s34 offen offset:1024 nt lds
s_waitcnt lgkmcnt(6)
v_mfma_f32_16x16x32_bf16 v[112:115], a[216:219], v[160:163], v[112:115]
ds_read_b128 a[208:211], v178 offset:0
v_mfma_f32_16x16x32_bf16 v[120:123], a[216:219], v[164:167], v[120:123]
ds_read_b64_tr_b16 a[240:241], v200 offset:20480
v_mfma_f32_16x16x32_bf16 v[116:119], a[220:223], v[160:163], v[116:119]
ds_read_b128 a[212:215], v178 offset:8192
v_mfma_f32_16x16x32_bf16 v[124:127], a[220:223], v[164:167], v[124:127]
ds_read_b64_tr_b16 a[242:243], v200 offset:22528
s_cbranch_vccz L_nors21
s_call_b64 s[82:83], L_rescale
L_nors21:
s_waitcnt lgkmcnt(8)
v_mfma_f32_16x16x32_bf16 v[128:131], a[192:195], a[128:131], v[168:171]
ds_read_b128 a[216:219], v179 offset:0
v_exp_f32 v144, v144
v_mfma_f32_16x16x32_bf16 v[136:139], a[192:195], a[132:135], v[172:175]
ds_read_b64_tr_b16 a[244:245], v200 offset:24576
v_exp_f32 v145, v145
v_mfma_f32_16x16x32_bf16 v[132:135], a[196:199], a[128:131], v[168:171]
ds_read_b128 a[220:223], v179 offset:8192
v_exp_f32 v146, v146
v_mfma_f32_16x16x32_bf16 v[140:143], a[196:199], a[132:135], v[172:175]
ds_read_b64_tr_b16 a[246:247], v200 offset:26624
v_cvt_pk_bf16_f32 v160, v144, v145
s_waitcnt vmcnt(6)
s_mov_b32 s34, 395264
buffer_load_dwordx4 v190, s[8:11], s34 offen offset:2048 nt lds
s_waitcnt lgkmcnt(8)
v_mfma_f32_16x16x32_bf16 v[128:131], a[200:203], a[136:139], v[128:131]
ds_read_b128 a[192:195], v176 offset:256
v_exp_f32 v147, v147
v_mfma_f32_16x16x32_bf16 v[136:139], a[200:203], a[140:143], v[136:139]
ds_read_b64_tr_b16 a[248:249], v200 offset:28672
v_mfma_f32_16x16x32_bf16 v[132:135], a[204:207], a[136:139], v[132:135]
ds_read_b128 a[196:199], v176 offset:8448
v_exp_f32 v148, v148
v_mfma_f32_16x16x32_bf16 v[140:143], a[204:207], a[140:143], v[140:143]
ds_read_b64_tr_b16 a[250:251], v200 offset:30720
v_cvt_pk_bf16_f32 v161, v146, v147
s_waitcnt lgkmcnt(8)
v_mfma_f32_16x16x32_bf16 v[128:131], a[208:211], a[144:147], v[128:131]
ds_read_b128 a[200:203], v177 offset:256
v_mfma_f32_16x16x32_bf16 v[136:139], a[208:211], a[148:151], v[136:139]
v_exp_f32 v149, v149
s_add_u32 m0, s33, 131072
s_lshl_b32 s71, s76, 7
s_add_u32 s71, s71, 114688
buffer_load_dwordx4 v199, s[24:27], s71 offen offset:3072  lds
v_mfma_f32_16x16x32_bf16 v[132:135], a[212:215], a[144:147], v[132:135]
ds_read_b128 a[204:207], v177 offset:8448
v_exp_f32 v150, v150
v_mfma_f32_16x16x32_bf16 v[140:143], a[212:215], a[148:151], v[140:143]
v_cvt_pk_bf16_f32 v162, v148, v149
s_waitcnt lgkmcnt(6)
v_mfma_f32_16x16x32_bf16 v[128:131], a[216:219], a[152:155], v[128:131]
ds_read_b128 a[208:211], v178 offset:256
v_mfma_f32_16x16x32_bf16 v[136:139], a[216:219], a[156:159], v[136:139]
v_exp_f32 v151, v151
s_waitcnt vmcnt(6)
s_add_u32 m0, s33, 0
s_mov_b32 s34, 396288
buffer_load_dwordx4 v191, s[8:11], s34 offen offset:3072 nt lds
v_mfma_f32_16x16x32_bf16 v[132:135], a[220:223], a[152:155], v[132:135]
ds_read_b128 a[212:215], v178 offset:8448
v_exp_f32 v152, v152
v_mfma_f32_16x16x32_bf16 v[140:143], a[220:223], a[156:159], v[140:143]
v_cvt_pk_bf16_f32 v163, v150, v151
s_waitcnt lgkmcnt(4)
v_mfma_f32_16x16x32_bf16 v[128:131], a[192:195], a[160:163], v[128:131]
ds_read_b128 a[216:219], v179 offset:256
v_mfma_f32_16x16x32_bf16 v[136:139], a[192:195], a[164:167], v[136:139]
v_exp_f32 v153, v153
v_mfma_f32_16x16x32_bf16 v[132:135], a[196:199], a[160:163], v[132:135]
ds_read_b128 a[220:223], v179 offset:8448
v_exp_f32 v154, v154
v_mfma_f32_16x16x32_bf16 v[140:143], a[196:199], a[164:167], v[140:143]
v_cvt_pk_bf16_f32 v164, v152, v153
s_waitcnt lgkmcnt(4)
v_mfma_f32_16x16x32_bf16 v[128:131], a[200:203], a[168:171], v[128:131]
v_add_u32 v180, 65536, v180
v_add_u32 v181, 65536, v181
v_add_u32 v182, 65536, v182
v_add_u32 v183, 65536, v183
v_add_u32 v184, 65536, v184
v_add_u32 v185, 65536, v185
v_add_u32 v186, 65536, v186
v_add_u32 v187, 65536, v187
s_waitcnt lgkmcnt(0)
s_barrier
ds_read_b64_tr_b16 a[192:193], v180 offset:16384
v_exp_f32 v155, v155
v_mfma_f32_16x16x32_bf16 v[136:139], a[200:203], a[172:175], v[136:139]
ds_read_b64_tr_b16 a[194:195], v180 offset:24576
s_waitcnt vmcnt(6)
s_add_u32 m0, s33, 32768
s_mov_b32 s34, 330752
buffer_load_dwordx4 v192, s[12:15], s34 offen offset:0 nt lds
v_mfma_f32_16x16x32_bf16 v[132:135], a[204:207], a[168:171], v[132:135]
ds_read_b64_tr_b16 a[196:197], v181 offset:16384
v_exp_f32 v156, v156
v_mfma_f32_16x16x32_bf16 v[140:143], a[204:207], a[172:175], v[140:143]
ds_read_b64_tr_b16 a[198:199], v181 offset:24576
v_cvt_pk_bf16_f32 v165, v154, v155
s_waitcnt lgkmcnt(6)
v_mfma_f32_16x16x32_bf16 v[128:131], a[208:211], a[176:179], v[128:131]
ds_read_b64_tr_b16 a[200:201], v182 offset:16384
v_exp_f32 v157, v157
v_mfma_f32_16x16x32_bf16 v[136:139], a[208:211], a[180:183], v[136:139]
ds_read_b64_tr_b16 a[202:203], v182 offset:24576
v_mfma_f32_16x16x32_bf16 v[132:135], a[212:215], a[176:179], v[132:135]
ds_read_b64_tr_b16 a[204:205], v183 offset:16384
v_exp_f32 v158, v158
v_mfma_f32_16x16x32_bf16 v[140:143], a[212:215], a[180:183], v[140:143]
ds_read_b64_tr_b16 a[206:207], v183 offset:24576
v_cvt_pk_bf16_f32 v166, v156, v157
s_waitcnt lgkmcnt(8)
v_mfma_f32_16x16x32_bf16 v[128:131], a[216:219], a[184:187], v[128:131]
ds_read_b64_tr_b16 a[208:209], v184 offset:16384
v_exp_f32 v159, v159
v_mfma_f32_16x16x32_bf16 v[136:139], a[216:219], a[188:191], v[136:139]
ds_read_b64_tr_b16 a[210:211], v184 offset:24576
v_mfma_f32_16x16x32_bf16 v[132:135], a[220:223], a[184:187], v[132:135]
ds_read_b64_tr_b16 a[212:213], v185 offset:16384
v_cvt_pk_bf16_f32 v167, v158, v159
v_mfma_f32_16x16x32_bf16 v[140:143], a[220:223], a[188:191], v[140:143]
ds_read_b64_tr_b16 a[214:215], v185 offset:24576
s_waitcnt vmcnt(6)
s_mov_b32 s34, 329728
buffer_load_dwordx4 v193, s[12:15], s34 offen offset:1024 nt lds
s_nop 0
s_waitcnt lgkmcnt(8)
v_mfma_f32_16x16x32_bf16 v[0:3], a[192:195], v[160:163], v[0:3]
ds_read_b64_tr_b16 a[216:217], v186 offset:16384
v_mfma_f32_16x16x32_bf16 v[8:11], a[192:195], v[164:167], v[8:11]
ds_read_b64_tr_b16 a[218:219], v186 offset:24576
s_add_u32 m0, s33, 147456
s_lshl_b32 s71, s77, 7
buffer_load_dwordx4 v196, s[24:27], s71 offen offset:0  lds
v_mfma_f32_16x16x32_bf16 a[224:227], a[232:235], v[160:163], a[224:227]
v_mfma_f32_16x16x32_bf16 v[4:7], a[196:199], v[160:163], v[4:7]
ds_read_b64_tr_b16 a[220:221], v187 offset:16384
v_mfma_f32_16x16x32_bf16 v[12:15], a[196:199], v[164:167], v[12:15]
ds_read_b64_tr_b16 a[222:223], v187 offset:24576
v_mfma_f32_16x16x32_bf16 a[228:231], a[232:235], v[164:167], a[228:231]
s_waitcnt lgkmcnt(8)
v_mfma_f32_16x16x32_bf16 v[16:19], a[200:203], v[160:163], v[16:19]
ds_read_b64_tr_b16 a[192:193], v180 offset:16640
v_mfma_f32_16x16x32_bf16 v[24:27], a[200:203], v[164:167], v[24:27]
ds_read_b64_tr_b16 a[194:195], v180 offset:24832
v_mfma_f32_16x16x32_bf16 v[20:23], a[204:207], v[160:163], v[20:23]
ds_read_b64_tr_b16 a[196:197], v181 offset:16640
v_mfma_f32_16x16x32_bf16 v[28:31], a[204:207], v[164:167], v[28:31]
ds_read_b64_tr_b16 a[198:199], v181 offset:24832
s_waitcnt vmcnt(6)
s_add_u32 m0, s33, 32768
s_mov_b32 s34, 328704
buffer_load_dwordx4 v194, s[12:15], s34 offen offset:2048 nt lds
s_waitcnt lgkmcnt(8)
v_mfma_f32_16x16x32_bf16 v[32:35], a[208:211], v[160:163], v[32:35]
ds_read_b64_tr_b16 a[200:201], v182 offset:16640
v_max3_f32 v208, v128, v129, v130
v_mfma_f32_16x16x32_bf16 v[40:43], a[208:211], v[164:167], v[40:43]
ds_read_b64_tr_b16 a[202:203], v182 offset:24832
v_mfma_f32_16x16x32_bf16 v[36:39], a[212:215], v[160:163], v[36:39]
ds_read_b64_tr_b16 a[204:205], v183 offset:16640
v_max3_f32 v209, v136, v137, v138
v_mfma_f32_16x16x32_bf16 v[44:47], a[212:215], v[164:167], v[44:47]
ds_read_b64_tr_b16 a[206:207], v183 offset:24832
s_waitcnt lgkmcnt(8)
v_mfma_f32_16x16x32_bf16 v[48:51], a[216:219], v[160:163], v[48:51]
ds_read_b64_tr_b16 a[208:209], v184 offset:16640
v_max3_f32 v208, v208, v131, v132
v_mfma_f32_16x16x32_bf16 v[56:59], a[216:219], v[164:167], v[56:59]
ds_read_b64_tr_b16 a[210:211], v184 offset:24832
v_mfma_f32_16x16x32_bf16 v[52:55], a[220:223], v[160:163], v[52:55]
ds_read_b64_tr_b16 a[212:213], v185 offset:16640
v_max3_f32 v209, v209, v139, v140
v_mfma_f32_16x16x32_bf16 v[60:63], a[220:223], v[164:167], v[60:63]
ds_read_b64_tr_b16 a[214:215], v185 offset:24832
s_waitcnt lgkmcnt(8)
v_mfma_f32_16x16x32_bf16 v[64:67], a[192:195], v[160:163], v[64:67]
ds_read_b64_tr_b16 a[216:217], v186 offset:16640
v_max3_f32 v208, v208, v133, v134
v_mfma_f32_16x16x32_bf16 v[72:75], a[192:195], v[164:167], v[72:75]
ds_read_b64_tr_b16 a[218:219], v186 offset:24832
s_waitcnt vmcnt(6)
s_mov_b32 s34, 327680
buffer_load_dwordx4 v195, s[12:15], s34 offen offset:3072 nt lds
v_mfma_f32_16x16x32_bf16 v[68:71], a[196:199], v[160:163], v[68:71]
ds_read_b64_tr_b16 a[220:221], v187 offset:16640
v_max3_f32 v209, v209, v141, v142
v_mfma_f32_16x16x32_bf16 v[76:79], a[196:199], v[164:167], v[76:79]
ds_read_b64_tr_b16 a[222:223], v187 offset:24832
s_waitcnt lgkmcnt(8)
v_mfma_f32_16x16x32_bf16 v[80:83], a[200:203], v[160:163], v[80:83]
v_subrev_u32 v176, 65536, v176
v_subrev_u32 v177, 65536, v177
v_subrev_u32 v178, 65536, v178
v_subrev_u32 v179, 65536, v179
s_waitcnt lgkmcnt(0)
s_barrier
ds_read_b128 a[192:195], v176 offset:49152
v_mfma_f32_16x16x32_bf16 v[88:91], a[200:203], v[164:167], v[88:91]
v_max_f32 v208, v208, v135
v_mfma_f32_16x16x32_bf16 v[84:87], a[204:207], v[160:163], v[84:87]
ds_read_b128 a[196:199], v176 offset:57344
v_mfma_f32_16x16x32_bf16 v[92:95], a[204:207], v[164:167], v[92:95]
v_max_f32 v209, v209, v143
s_waitcnt lgkmcnt(6)
v_mfma_f32_16x16x32_bf16 v[96:99], a[208:211], v[160:163], v[96:99]
ds_read_b128 a[200:203], v177 offset:49152
v_mfma_f32_16x16x32_bf16 v[104:107], a[208:211], v[164:167], v[104:107]
v_max_f32 v210, v208, v209
s_waitcnt vmcnt(5)
s_add_u32 m0, s33, 65536
s_mov_b32 s34, 394240
buffer_load_dwordx4 v188, s[8:11], s34 offen offset:0 nt lds
s_add_u32 m0, s33, 147456
s_lshl_b32 s71, s77, 7
buffer_load_dwordx4 v197, s[24:27], s71 offen offset:1024  lds
v_mfma_f32_16x16x32_bf16 v[100:103], a[212:215], v[160:163], v[100:103]
ds_read_b128 a[204:207], v177 offset:57344
v_mfma_f32_16x16x32_bf16 v[108:111], a[212:215], v[164:167], v[108:111]
v_cmp_lt_f32 vcc, s80, v210
s_waitcnt lgkmcnt(4)
v_mfma_f32_16x16x32_bf16 v[112:115], a[216:219], v[160:163], v[112:115]
ds_read_b128 a[208:211], v178 offset:49152
v_mfma_f32_16x16x32_bf16 v[120:123], a[216:219], v[164:167], v[120:123]
v_mfma_f32_16x16x32_bf16 v[116:119], a[220:223], v[160:163], v[116:119]
ds_read_b128 a[212:215], v178 offset:57344
v_mfma_f32_16x16x32_bf16 v[124:127], a[220:223], v[164:167], v[124:127]
s_cbranch_vccz L_nors22
s_call_b64 s[82:83], L_rescale
L_nors22:
s_waitcnt lgkmcnt(4)
v_mfma_f32_16x16x32_bf16 v[144:147], a[192:195], a[128:131], v[168:171]
ds_read_b128 a[216:219], v179 offset:49152
v_exp_f32 v128, v128
v_mfma_f32_16x16x32_bf16 v[152:155], a[192:195], a[132:135], v[172:175]
v_exp_f32 v129, v129
v_mfma_f32_16x16x32_bf16 v[148:151], a[196:199], a[128:131], v[168:171]
ds_read_b128 a[220:223], v179 offset:57344
v_exp_f32 v130, v130
v_mfma_f32_16x16x32_bf16 v[156:159], a[196:199], a[132:135], v[172:175]
v_cvt_pk_bf16_f32 v160, v128, v129
s_waitcnt vmcnt(6)
s_add_u32 m0, s33, 65536
s_mov_b32 s34, 393216
buffer_load_dwordx4 v189, s[8:11], s34 offen offset:1024 nt lds
s_waitcnt lgkmcnt(4)
v_mfma_f32_16x16x32_bf16 v[144:147], a[200:203], a[136:139], v[144:147]
ds_read_b128 a[192:195], v176 offset:49408
v_mfma_f32_16x16x32_bf16 v[152:155], a[200:203], a[140:143], v[152:155]
v_exp_f32 v131, v131
v_mfma_f32_16x16x32_bf16 v[148:151], a[204:207], a[136:139], v[148:151]
ds_read_b128 a[196:199], v176 offset:57600
v_exp_f32 v132, v132
v_mfma_f32_16x16x32_bf16 v[156:159], a[204:207], a[140:143], v[156:159]
v_cvt_pk_bf16_f32 v161, v130, v131
s_waitcnt lgkmcnt(4)
v_mfma_f32_16x16x32_bf16 v[144:147], a[208:211], a[144:147], v[144:147]
ds_read_b128 a[200:203], v177 offset:49408
v_mfma_f32_16x16x32_bf16 v[152:155], a[208:211], a[148:151], v[152:155]
v_exp_f32 v133, v133
v_mfma_f32_16x16x32_bf16 v[148:151], a[212:215], a[144:147], v[148:151]
ds_read_b128 a[204:207], v177 offset:57600
v_exp_f32 v134, v134
v_mfma_f32_16x16x32_bf16 v[156:159], a[212:215], a[148:151], v[156:159]
v_cvt_pk_bf16_f32 v162, v132, v133
s_waitcnt vmcnt(6)
s_mov_b32 s34, 396288
buffer_load_dwordx4 v190, s[8:11], s34 offen offset:2048 nt lds
s_waitcnt lgkmcnt(4)
v_mfma_f32_16x16x32_bf16 v[144:147], a[216:219], a[152:155], v[144:147]
ds_read_b128 a[208:211], v178 offset:49408
v_mfma_f32_16x16x32_bf16 v[152:155], a[216:219], a[156:159], v[152:155]
v_exp_f32 v135, v135
v_mfma_f32_16x16x32_bf16 v[148:151], a[220:223], a[152:155], v[148:151]
ds_read_b128 a[212:215], v178 offset:57600
v_exp_f32 v136, v136
v_mfma_f32_16x16x32_bf16 v[156:159], a[220:223], a[156:159], v[156:159]
v_cvt_pk_bf16_f32 v163, v134, v135
s_waitcnt lgkmcnt(4)
v_mfma_f32_16x16x32_bf16 v[144:147], a[192:195], a[160:163], v[144:147]
ds_read_b128 a[216:219], v179 offset:49408
v_mfma_f32_16x16x32_bf16 v[152:155], a[192:195], a[164:167], v[152:155]
v_exp_f32 v137, v137
s_add_u32 m0, s33, 147456
s_lshl_b32 s71, s77, 7
buffer_load_dwordx4 v198, s[24:27], s71 offen offset:2048  lds
v_mfma_f32_16x16x32_bf16 v[148:151], a[196:199], a[160:163], v[148:151]
ds_read_b128 a[220:223], v179 offset:57600
v_exp_f32 v138, v138
v_mfma_f32_16x16x32_bf16 v[156:159], a[196:199], a[164:167], v[156:159]
v_cvt_pk_bf16_f32 v164, v136, v137
s_waitcnt lgkmcnt(4)
v_mfma_f32_16x16x32_bf16 v[144:147], a[200:203], a[168:171], v[144:147]
v_subrev_u32 v180, 65536, v180
v_subrev_u32 v181, 65536, v181
v_subrev_u32 v182, 65536, v182
v_subrev_u32 v183, 65536, v183
v_subrev_u32 v184, 65536, v184
v_subrev_u32 v185, 65536, v185
v_subrev_u32 v186, 65536, v186
v_subrev_u32 v187, 65536, v187
s_waitcnt lgkmcnt(0)
s_barrier
ds_read_b64_tr_b16 a[192:193], v180 offset:16384
v_exp_f32 v139, v139
v_mfma_f32_16x16x32_bf16 v[152:155], a[200:203], a[172:175], v[152:155]
ds_read_b64_tr_b16 a[194:195], v180 offset:24576
s_waitcnt vmcnt(6)
s_add_u32 m0, s33, 65536
s_mov_b32 s34, 395264
buffer_load_dwordx4 v191, s[8:11], s34 offen offset:3072 nt lds
v_mfma_f32_16x16x32_bf16 v[148:151], a[204:207], a[168:171], v[148:151]
ds_read_b64_tr_b16 a[196:197], v181 offset:16384
v_exp_f32 v140, v140
v_mfma_f32_16x16x32_bf16 v[156:159], a[204:207], a[172:175], v[156:159]
ds_read_b64_tr_b16 a[198:199], v181 offset:24576
v_cvt_pk_bf16_f32 v165, v138, v139
s_waitcnt lgkmcnt(6)
v_mfma_f32_16x16x32_bf16 v[144:147], a[208:211], a[176:179], v[144:147]
ds_read_b64_tr_b16 a[200:201], v182 offset:16384
v_exp_f32 v141, v141
v_mfma_f32_16x16x32_bf16 v[152:155], a[208:211], a[180:183], v[152:155]
ds_read_b64_tr_b16 a[202:203], v182 offset:24576
v_mfma_f32_16x16x32_bf16 v[148:151], a[212:215], a[176:179], v[148:151]
ds_read_b64_tr_b16 a[204:205], v183 offset:16384
v_exp_f32 v142, v142
v_mfma_f32_16x16x32_bf16 v[156:159], a[212:215], a[180:183], v[156:159]
ds_read_b64_tr_b16 a[206:207], v183 offset:24576
v_cvt_pk_bf16_f32 v166, v140, v141
s_waitcnt lgkmcnt(8)
v_mfma_f32_16x16x32_bf16 v[144:147], a[216:219], a[184:187], v[144:147]
ds_read_b64_tr_b16 a[208:209], v184 offset:16384
v_exp_f32 v143, v143
v_mfma_f32_16x16x32_bf16 v[152:155], a[216:219], a[188:191], v[152:155]
ds_read_b64_tr_b16 a[210:211], v184 offset:24576
s_waitcnt vmcnt(6)
s_add_u32 m0, s33, 49152
s_mov_b32 s34, 393216
buffer_load_dwordx4 v192, s[12:15], s34 offen offset:0 nt lds
v_mfma_f32_16x16x32_bf16 v[148:151], a[220:223], a[184:187], v[148:151]
ds_read_b64_tr_b16 a[212:213], v185 offset:16384
v_cvt_pk_bf16_f32 v167, v142, v143
v_mfma_f32_16x16x32_bf16 v[156:159], a[220:223], a[188:191], v[156:159]
ds_read_b64_tr_b16 a[214:215], v185 offset:24576
s_nop 0
s_waitcnt lgkmcnt(8)
v_mfma_f32_16x16x32_bf16 v[0:3], a[192:195], v[160:163], v[0:3]
ds_read_b64_tr_b16 a[216:217], v186 offset:16384
v_mfma_f32_16x16x32_bf16 v[8:11], a[192:195], v[164:167], v[8:11]
ds_read_b64_tr_b16 a[218:219], v186 offset:24576
v_mfma_f32_16x16x32_bf16 a[224:227], a[232:235], v[160:163], a[224:227]
v_mfma_f32_16x16x32_bf16 v[4:7], a[196:199], v[160:163], v[4:7]
ds_read_b64_tr_b16 a[220:221], v187 offset:16384
v_mfma_f32_16x16x32_bf16 v[12:15], a[196:199], v[164:167], v[12:15]
ds_read_b64_tr_b16 a[222:223], v187 offset:24576
v_mfma_f32_16x16x32_bf16 a[228:231], a[232:235], v[164:167], a[228:231]
s_waitcnt lgkmcnt(8)
v_mfma_f32_16x16x32_bf16 v[16:19], a[200:203], v[160:163], v[16:19]
ds_read_b64_tr_b16 a[192:193], v180 offset:16640
v_mfma_f32_16x16x32_bf16 v[24:27], a[200:203], v[164:167], v[24:27]
ds_read_b64_tr_b16 a[194:195], v180 offset:24832
v_mfma_f32_16x16x32_bf16 v[20:23], a[204:207], v[160:163], v[20:23]
ds_read_b64_tr_b16 a[196:197], v181 offset:16640
v_mfma_f32_16x16x32_bf16 v[28:31], a[204:207], v[164:167], v[28:31]
ds_read_b64_tr_b16 a[198:199], v181 offset:24832
s_waitcnt vmcnt(6)
s_mov_b32 s34, 394240
buffer_load_dwordx4 v193, s[12:15], s34 offen offset:1024 nt lds
s_waitcnt lgkmcnt(8)
v_mfma_f32_16x16x32_bf16 v[32:35], a[208:211], v[160:163], v[32:35]
ds_read_b64_tr_b16 a[200:201], v182 offset:16640
v_max3_f32 v208, v144, v145, v146
v_mfma_f32_16x16x32_bf16 v[40:43], a[208:211], v[164:167], v[40:43]
ds_read_b64_tr_b16 a[202:203], v182 offset:24832
s_add_u32 m0, s33, 147456
s_lshl_b32 s71, s77, 7
buffer_load_dwordx4 v199, s[24:27], s71 offen offset:3072  lds
v_mfma_f32_16x16x32_bf16 v[36:39], a[212:215], v[160:163], v[36:39]
ds_read_b64_tr_b16 a[204:205], v183 offset:16640
v_max3_f32 v209, v152, v153, v154
v_mfma_f32_16x16x32_bf16 v[44:47], a[212:215], v[164:167], v[44:47]
ds_read_b64_tr_b16 a[206:207], v183 offset:24832
s_waitcnt lgkmcnt(8)
v_mfma_f32_16x16x32_bf16 v[48:51], a[216:219], v[160:163], v[48:51]
ds_read_b64_tr_b16 a[208:209], v184 offset:16640
v_max3_f32 v208, v208, v147, v148
v_mfma_f32_16x16x32_bf16 v[56:59], a[216:219], v[164:167], v[56:59]
ds_read_b64_tr_b16 a[210:211], v184 offset:24832
v_mfma_f32_16x16x32_bf16 v[52:55], a[220:223], v[160:163], v[52:55]
ds_read_b64_tr_b16 a[212:213], v185 offset:16640
v_max3_f32 v209, v209, v155, v156
v_mfma_f32_16x16x32_bf16 v[60:63], a[220:223], v[164:167], v[60:63]
ds_read_b64_tr_b16 a[214:215], v185 offset:24832
s_waitcnt vmcnt(6)
s_add_u32 m0, s33, 49152
s_mov_b32 s34, 395264
buffer_load_dwordx4 v194, s[12:15], s34 offen offset:2048 nt lds
s_waitcnt lgkmcnt(8)
v_mfma_f32_16x16x32_bf16 v[64:67], a[192:195], v[160:163], v[64:67]
ds_read_b64_tr_b16 a[216:217], v186 offset:16640
v_max3_f32 v208, v208, v149, v150
v_mfma_f32_16x16x32_bf16 v[72:75], a[192:195], v[164:167], v[72:75]
ds_read_b64_tr_b16 a[218:219], v186 offset:24832
v_mfma_f32_16x16x32_bf16 v[68:71], a[196:199], v[160:163], v[68:71]
ds_read_b64_tr_b16 a[220:221], v187 offset:16640
v_max3_f32 v209, v209, v157, v158
v_mfma_f32_16x16x32_bf16 v[76:79], a[196:199], v[164:167], v[76:79]
ds_read_b64_tr_b16 a[222:223], v187 offset:24832
s_waitcnt lgkmcnt(8)
v_mfma_f32_16x16x32_bf16 v[80:83], a[200:203], v[160:163], v[80:83]
s_waitcnt lgkmcnt(0)
s_barrier
buffer_load_dword v227, v228, s[44:47], 0 offen sc1
ds_read_b128 a[192:195], v176 offset:0
v_mfma_f32_16x16x32_bf16 v[88:91], a[200:203], v[164:167], v[88:91]
v_max_f32 v208, v208, v151
v_mfma_f32_16x16x32_bf16 v[84:87], a[204:207], v[160:163], v[84:87]
ds_read_b128 a[196:199], v176 offset:8192
v_mfma_f32_16x16x32_bf16 v[92:95], a[204:207], v[164:167], v[92:95]
v_max_f32 v209, v209, v159
s_waitcnt lgkmcnt(6)
v_mfma_f32_16x16x32_bf16 v[96:99], a[208:211], v[160:163], v[96:99]
ds_read_b128 a[200:203], v177 offset:0
v_mfma_f32_16x16x32_bf16 v[104:107], a[208:211], v[164:167], v[104:107]
v_max_f32 v210, v208, v209
s_waitcnt vmcnt(7)
s_mov_b32 s34, 396288
buffer_load_dwordx4 v195, s[12:15], s34 offen offset:3072 nt lds
v_mfma_f32_16x16x32_bf16 v[100:103], a[212:215], v[160:163], v[100:103]
ds_read_b128 a[204:207], v177 offset:8192
v_mfma_f32_16x16x32_bf16 v[108:111], a[212:215], v[164:167], v[108:111]
v_cmp_lt_f32 vcc, s80, v210
s_waitcnt lgkmcnt(4)
v_mfma_f32_16x16x32_bf16 v[112:115], a[216:219], v[160:163], v[112:115]
ds_read_b128 a[208:211], v178 offset:0
v_mfma_f32_16x16x32_bf16 v[120:123], a[216:219], v[164:167], v[120:123]
v_mfma_f32_16x16x32_bf16 v[116:119], a[220:223], v[160:163], v[116:119]
ds_read_b128 a[212:215], v178 offset:8192
v_mfma_f32_16x16x32_bf16 v[124:127], a[220:223], v[164:167], v[124:127]
s_cbranch_vccz L_nors23
s_call_b64 s[82:83], L_rescale
L_nors23:
s_waitcnt lgkmcnt(4)
v_mfma_f32_16x16x32_bf16 v[128:131], a[192:195], a[128:131], v[168:171]
ds_read_b128 a[216:219], v179 offset:0
v_exp_f32 v144, v144
v_mfma_f32_16x16x32_bf16 v[136:139], a[192:195], a[132:135], v[172:175]
v_exp_f32 v145, v145
s_waitcnt vmcnt(6)
s_add_u32 m0, s33, 16384
s_mov_b32 s34, 395264
buffer_load_dwordx4 v188, s[8:11], s34 offen offset:0 nt lds
s_add_u32 m0, s33, 114688
s_lshl_b32 s71, s77, 7
s_add_u32 s71, s71, 114688
buffer_load_dwordx4 v196, s[24:27], s71 offen offset:0  lds
v_mfma_f32_16x16x32_bf16 v[132:135], a[196:199], a[128:131], v[168:171]
ds_read_b128 a[220:223], v179 offset:8192
v_exp_f32 v146, v146
v_mfma_f32_16x16x32_bf16 v[140:143], a[196:199], a[132:135], v[172:175]
v_cvt_pk_bf16_f32 v160, v144, v145
s_waitcnt lgkmcnt(4)
v_mfma_f32_16x16x32_bf16 v[128:131], a[200:203], a[136:139], v[128:131]
ds_read_b128 a[192:195], v176 offset:256
v_mfma_f32_16x16x32_bf16 v[136:139], a[200:203], a[140:143], v[136:139]
v_exp_f32 v147, v147
v_mfma_f32_16x16x32_bf16 v[132:135], a[204:207], a[136:139], v[132:135]
ds_read_b128 a[196:199], v176 offset:8448
v_exp_f32 v148, v148
v_mfma_f32_16x16x32_bf16 v[140:143], a[204:207], a[140:143], v[140:143]
v_cvt_pk_bf16_f32 v161, v146, v147
s_waitcnt lgkmcnt(4)
v_mfma_f32_16x16x32_bf16 v[128:131], a[208:211], a[144:147], v[128:131]
ds_read_b128 a[200:203], v177 offset:256
v_mfma_f32_16x16x32_bf16 v[136:139], a[208:211], a[148:151], v[136:139]
v_exp_f32 v149, v149
v_mfma_f32_16x16x32_bf16 v[132:135], a[212:215], a[144:147], v[132:135]
ds_read_b128 a[204:207], v177 offset:8448
v_exp_f32 v150, v150
v_mfma_f32_16x16x32_bf16 v[140:143], a[212:215], a[148:151], v[140:143]
v_cvt_pk_bf16_f32 v162, v148, v149
s_waitcnt vmcnt(7)
s_add_u32 m0, s33, 16384
s_mov_b32 s34, 396288
buffer_load_dwordx4 v189, s[8:11], s34 offen offset:1024 nt lds
s_waitcnt lgkmcnt(4)
v_mfma_f32_16x16x32_bf16 v[128:131], a[216:219], a[152:155], v[128:131]
ds_read_b128 a[208:211], v178 offset:256
v_mfma_f32_16x16x32_bf16 v[136:139], a[216:219], a[156:159], v[136:139]
v_exp_f32 v151, v151
v_mfma_f32_16x16x32_bf16 v[132:135], a[220:223], a[152:155], v[132:135]
ds_read_b128 a[212:215], v178 offset:8448
v_exp_f32 v152, v152
v_mfma_f32_16x16x32_bf16 v[140:143], a[220:223], a[156:159], v[140:143]
v_cvt_pk_bf16_f32 v163, v150, v151
s_waitcnt lgkmcnt(4)
v_mfma_f32_16x16x32_bf16 v[128:131], a[192:195], a[160:163], v[128:131]
ds_read_b128 a[216:219], v179 offset:256
v_mfma_f32_16x16x32_bf16 v[136:139], a[192:195], a[164:167], v[136:139]
v_exp_f32 v153, v153
v_mfma_f32_16x16x32_bf16 v[132:135], a[196:199], a[160:163], v[132:135]
ds_read_b128 a[220:223], v179 offset:8448
v_exp_f32 v154, v154
v_mfma_f32_16x16x32_bf16 v[140:143], a[196:199], a[164:167], v[140:143]
v_cvt_pk_bf16_f32 v164, v152, v153
s_waitcnt vmcnt(7)
s_mov_b32 s34, 393216
buffer_load_dwordx4 v190, s[8:11], s34 offen offset:2048 nt lds
s_waitcnt lgkmcnt(4)
v_mfma_f32_16x16x32_bf16 v[128:131], a[200:203], a[168:171], v[128:131]
s_waitcnt lgkmcnt(0)
s_barrier
ds_read_b64_tr_b16 a[192:193], v180 offset:32768
v_exp_f32 v155, v155
v_mfma_f32_16x16x32_bf16 v[136:139], a[200:203], a[172:175], v[136:139]
ds_read_b64_tr_b16 a[194:195], v180 offset:40960
v_mfma_f32_16x16x32_bf16 v[132:135], a[204:207], a[168:171], v[132:135]
ds_read_b64_tr_b16 a[196:197], v181 offset:32768
v_exp_f32 v156, v156
v_mfma_f32_16x16x32_bf16 v[140:143], a[204:207], a[172:175], v[140:143]
ds_read_b64_tr_b16 a[198:199], v181 offset:40960
v_cvt_pk_bf16_f32 v165, v154, v155
s_waitcnt lgkmcnt(6)
v_mfma_f32_16x16x32_bf16 v[128:131], a[208:211], a[176:179], v[128:131]
ds_read_b64_tr_b16 a[200:201], v182 offset:32768
v_exp_f32 v157, v157
v_mfma_f32_16x16x32_bf16 v[136:139], a[208:211], a[180:183], v[136:139]
ds_read_b64_tr_b16 a[202:203], v182 offset:40960
s_add_u32 m0, s33, 114688
s_lshl_b32 s71, s77, 7
s_add_u32 s71, s71, 114688
buffer_load_dwordx4 v197, s[24:27], s71 offen offset:1024  lds
v_mfma_f32_16x16x32_bf16 v[132:135], a[212:215], a[176:179], v[132:135]
ds_read_b64_tr_b16 a[204:205], v183 offset:32768
v_exp_f32 v158, v158
v_mfma_f32_16x16x32_bf16 v[140:143], a[212:215], a[180:183], v[140:143]
ds_read_b64_tr_b16 a[206:207], v183 offset:40960
v_cvt_pk_bf16_f32 v166, v156, v157
s_waitcnt lgkmcnt(8)
v_mfma_f32_16x16x32_bf16 v[128:131], a[216:219], a[184:187], v[128:131]
ds_read_b64_tr_b16 a[208:209], v184 offset:32768
v_exp_f32 v159, v159
v_mfma_f32_16x16x32_bf16 v[136:139], a[216:219], a[188:191], v[136:139]
ds_read_b64_tr_b16 a[210:211], v184 offset:40960
s_waitcnt vmcnt(7)
s_add_u32 m0, s33, 16384
s_mov_b32 s34, 394240
buffer_load_dwordx4 v191, s[8:11], s34 offen offset:3072 nt lds
v_mfma_f32_16x16x32_bf16 v[132:135], a[220:223], a[184:187], v[132:135]
ds_read_b64_tr_b16 a[212:213], v185 offset:32768
v_cvt_pk_bf16_f32 v167, v158, v159
v_mfma_f32_16x16x32_bf16 v[140:143], a[220:223], a[188:191], v[140:143]
ds_read_b64_tr_b16 a[214:215], v185 offset:40960
s_nop 0
s_waitcnt lgkmcnt(8)
v_mfma_f32_16x16x32_bf16 v[0:3], a[192:195], v[160:163], v[0:3]
ds_read_b64_tr_b16 a[216:217], v186 offset:32768
v_mfma_f32_16x16x32_bf16 v[8:11], a[192:195], v[164:167], v[8:11]
ds_read_b64_tr_b16 a[218:219], v186 offset:40960
v_mfma_f32_16x16x32_bf16 a[224:227], a[232:235], v[160:163], a[224:227]
v_mfma_f32_16x16x32_bf16 v[4:7], a[196:199], v[160:163], v[4:7]
ds_read_b64_tr_b16 a[220:221], v187 offset:32768
v_mfma_f32_16x16x32_bf16 v[12:15], a[196:199], v[164:167], v[12:15]
ds_read_b64_tr_b16 a[222:223], v187 offset:40960
v_mfma_f32_16x16x32_bf16 a[228:231], a[232:235], v[164:167], a[228:231]
s_waitcnt lgkmcnt(8)
v_mfma_f32_16x16x32_bf16 v[16:19], a[200:203], v[160:163], v[16:19]
ds_read_b64_tr_b16 a[192:193], v180 offset:33024
v_mfma_f32_16x16x32_bf16 v[24:27], a[200:203], v[164:167], v[24:27]
ds_read_b64_tr_b16 a[194:195], v180 offset:41216
s_waitcnt vmcnt(6)
s_add_u32 m0, s33, 0
s_mov_b32 s34, 394240
buffer_load_dwordx4 v192, s[12:15], s34 offen offset:0 nt lds
v_mfma_f32_16x16x32_bf16 v[20:23], a[204:207], v[160:163], v[20:23]
ds_read_b64_tr_b16 a[196:197], v181 offset:33024
v_mfma_f32_16x16x32_bf16 v[28:31], a[204:207], v[164:167], v[28:31]
ds_read_b64_tr_b16 a[198:199], v181 offset:41216
s_waitcnt lgkmcnt(8)
v_mfma_f32_16x16x32_bf16 v[32:35], a[208:211], v[160:163], v[32:35]
ds_read_b64_tr_b16 a[200:201], v182 offset:33024
v_max3_f32 v208, v128, v129, v130
v_mfma_f32_16x16x32_bf16 v[40:43], a[208:211], v[164:167], v[40:43]
ds_read_b64_tr_b16 a[202:203], v182 offset:41216
v_mfma_f32_16x16x32_bf16 v[36:39], a[212:215], v[160:163], v[36:39]
ds_read_b64_tr_b16 a[204:205], v183 offset:33024
v_max3_f32 v209, v136, v137, v138
v_mfma_f32_16x16x32_bf16 v[44:47], a[212:215], v[164:167], v[44:47]
ds_read_b64_tr_b16 a[206:207], v183 offset:41216
s_waitcnt lgkmcnt(8)
v_mfma_f32_16x16x32_bf16 v[48:51], a[216:219], v[160:163], v[48:51]
ds_read_b64_tr_b16 a[208:209], v184 offset:33024
v_max3_f32 v208, v208, v131, v132
v_mfma_f32_16x16x32_bf16 v[56:59], a[216:219], v[164:167], v[56:59]
ds_read_b64_tr_b16 a[210:211], v184 offset:41216
v_mfma_f32_16x16x32_bf16 v[52:55], a[220:223], v[160:163], v[52:55]
ds_read_b64_tr_b16 a[212:213], v185 offset:33024
v_max3_f32 v209, v209, v139, v140
v_mfma_f32_16x16x32_bf16 v[60:63], a[220:223], v[164:167], v[60:63]
ds_read_b64_tr_b16 a[214:215], v185 offset:41216
s_waitcnt vmcnt(6)
s_mov_b32 s34, 393216
buffer_load_dwordx4 v193, s[12:15], s34 offen offset:1024 nt lds
s_waitcnt lgkmcnt(8)
v_mfma_f32_16x16x32_bf16 v[64:67], a[192:195], v[160:163], v[64:67]
ds_read_b64_tr_b16 a[216:217], v186 offset:33024
v_max3_f32 v208, v208, v133, v134
v_mfma_f32_16x16x32_bf16 v[72:75], a[192:195], v[164:167], v[72:75]
ds_read_b64_tr_b16 a[218:219], v186 offset:41216
s_add_u32 m0, s33, 114688
s_lshl_b32 s71, s77, 7
s_add_u32 s71, s71, 114688
buffer_load_dwordx4 v198, s[24:27], s71 offen offset:2048  lds
v_mfma_f32_16x16x32_bf16 v[68:71], a[196:199], v[160:163], v[68:71]
ds_read_b64_tr_b16 a[220:221], v187 offset:33024
v_max3_f32 v209, v209, v141, v142
v_mfma_f32_16x16x32_bf16 v[76:79], a[196:199], v[164:167], v[76:79]
ds_read_b64_tr_b16 a[222:223], v187 offset:41216
s_waitcnt lgkmcnt(8)
v_mfma_f32_16x16x32_bf16 v[80:83], a[200:203], v[160:163], v[80:83]
v_add_u32 v176, 65536, v176
v_add_u32 v177, 65536, v177
v_add_u32 v178, 65536, v178
v_add_u32 v179, 65536, v179
s_waitcnt lgkmcnt(0)
s_barrier
ds_read_b128 a[192:195], v176 offset:0
v_mfma_f32_16x16x32_bf16 v[88:91], a[200:203], v[164:167], v[88:91]
v_max_f32 v208, v208, v135
v_mfma_f32_16x16x32_bf16 v[84:87], a[204:207], v[160:163], v[84:87]
ds_read_b128 a[196:199], v176 offset:8192
v_mfma_f32_16x16x32_bf16 v[92:95], a[204:207], v[164:167], v[92:95]
v_max_f32 v209, v209, v143
s_waitcnt vmcnt(6)
s_add_u32 m0, s33, 0
s_mov_b32 s34, 396288
buffer_load_dwordx4 v194, s[12:15], s34 offen offset:2048 nt lds
s_waitcnt lgkmcnt(6)
v_mfma_f32_16x16x32_bf16 v[96:99], a[208:211], v[160:163], v[96:99]
ds_read_b128 a[200:203], v177 offset:0
v_mfma_f32_16x16x32_bf16 v[104:107], a[208:211], v[164:167], v[104:107]
v_max_f32 v210, v208, v209
v_mfma_f32_16x16x32_bf16 v[100:103], a[212:215], v[160:163], v[100:103]
ds_read_b128 a[204:207], v177 offset:8192
v_mfma_f32_16x16x32_bf16 v[108:111], a[212:215], v[164:167], v[108:111]
v_cmp_lt_f32 vcc, s80, v210
s_waitcnt lgkmcnt(4)
v_mfma_f32_16x16x32_bf16 v[112:115], a[216:219], v[160:163], v[112:115]
ds_read_b128 a[208:211], v178 offset:0
v_mfma_f32_16x16x32_bf16 v[120:123], a[216:219], v[164:167], v[120:123]
v_mfma_f32_16x16x32_bf16 v[116:119], a[220:223], v[160:163], v[116:119]
ds_read_b128 a[212:215], v178 offset:8192
v_mfma_f32_16x16x32_bf16 v[124:127], a[220:223], v[164:167], v[124:127]
s_cbranch_vccz L_nors24
s_call_b64 s[82:83], L_rescale
L_nors24:
s_waitcnt lgkmcnt(4)
v_mfma_f32_16x16x32_bf16 v[144:147], a[192:195], a[128:131], v[168:171]
ds_read_b128 a[216:219], v179 offset:0
v_exp_f32 v128, v128
v_mfma_f32_16x16x32_bf16 v[152:155], a[192:195], a[132:135], v[172:175]
v_exp_f32 v129, v129
s_waitcnt vmcnt(6)
s_mov_b32 s34, 395264
buffer_load_dwordx4 v195, s[12:15], s34 offen offset:3072 nt lds
v_mfma_f32_16x16x32_bf16 v[148:151], a[196:199], a[128:131], v[168:171]
ds_read_b128 a[220:223], v179 offset:8192
v_exp_f32 v130, v130
v_mfma_f32_16x16x32_bf16 v[156:159], a[196:199], a[132:135], v[172:175]
v_cvt_pk_bf16_f32 v160, v128, v129
s_waitcnt lgkmcnt(4)
v_mfma_f32_16x16x32_bf16 v[144:147], a[200:203], a[136:139], v[144:147]
ds_read_b128 a[192:195], v176 offset:256
v_mfma_f32_16x16x32_bf16 v[152:155], a[200:203], a[140:143], v[152:155]
v_exp_f32 v131, v131
v_mfma_f32_16x16x32_bf16 v[148:151], a[204:207], a[136:139], v[148:151]
ds_read_b128 a[196:199], v176 offset:8448
v_exp_f32 v132, v132
v_mfma_f32_16x16x32_bf16 v[156:159], a[204:207], a[140:143], v[156:159]
v_cvt_pk_bf16_f32 v161, v130, v131
s_waitcnt lgkmcnt(4)
v_mfma_f32_16x16x32_bf16 v[144:147], a[208:211], a[144:147], v[144:147]
ds_read_b128 a[200:203], v177 offset:256
v_mfma_f32_16x16x32_bf16 v[152:155], a[208:211], a[148:151], v[152:155]
v_exp_f32 v133, v133
s_add_u32 m0, s33, 114688
s_lshl_b32 s71, s77, 7
s_add_u32 s71, s71, 114688
buffer_load_dwordx4 v199, s[24:27], s71 offen offset:3072  lds
v_mfma_f32_16x16x32_bf16 v[148:151], a[212:215], a[144:147], v[148:151]
ds_read_b128 a[204:207], v177 offset:8448
v_exp_f32 v134, v134
v_mfma_f32_16x16x32_bf16 v[156:159], a[212:215], a[148:151], v[156:159]
v_cvt_pk_bf16_f32 v162, v132, v133
s_waitcnt vmcnt(6)
s_add_u32 m0, s33, 32768
s_mov_b32 s34, 396288
buffer_load_dwordx4 v188, s[8:11], s34 offen offset:0 nt lds
s_waitcnt lgkmcnt(4)
v_mfma_f32_16x16x32_bf16 v[144:147], a[216:219], a[152:155], v[144:147]
ds_read_b128 a[208:211], v178 offset:256
v_mfma_f32_16x16x32_bf16 v[152:155], a[216:219], a[156:159], v[152:155]
v_exp_f32 v135, v135
v_mfma_f32_16x16x32_bf16 v[148:151], a[220:223], a[152:155], v[148:151]
ds_read_b128 a[212:215], v178 offset:8448
v_exp_f32 v136, v136
v_mfma_f32_16x16x32_bf16 v[156:159], a[220:223], a[156:159], v[156:159]
v_cvt_pk_bf16_f32 v163, v134, v135
s_waitcnt lgkmcnt(4)
v_mfma_f32_16x16x32_bf16 v[144:147], a[192:195], a[160:163], v[144:147]
ds_read_b128 a[216:219], v179 offset:256
v_mfma_f32_16x16x32_bf16 v[152:155], a[192:195], a[164:167], v[152:155]
v_exp_f32 v137, v137
v_mfma_f32_16x16x32_bf16 v[148:151], a[196:199], a[160:163], v[148:151]
ds_read_b128 a[220:223], v179 offset:8448
v_exp_f32 v138, v138
v_mfma_f32_16x16x32_bf16 v[156:159], a[196:199], a[164:167], v[156:159]
v_cvt_pk_bf16_f32 v164, v136, v137
s_waitcnt vmcnt(6)
s_mov_b32 s34, 395264
buffer_load_dwordx4 v189, s[8:11], s34 offen offset:1024 nt lds
s_waitcnt lgkmcnt(4)
v_mfma_f32_16x16x32_bf16 v[144:147], a[200:203], a[168:171], v[144:147]
s_waitcnt lgkmcnt(0)
s_barrier
ds_read_b64_tr_b16 a[192:193], v180 offset:49152
v_exp_f32 v139, v139
v_mfma_f32_16x16x32_bf16 v[152:155], a[200:203], a[172:175], v[152:155]
ds_read_b64_tr_b16 a[194:195], v180 offset:57344
v_mfma_f32_16x16x32_bf16 v[148:151], a[204:207], a[168:171], v[148:151]
ds_read_b64_tr_b16 a[196:197], v181 offset:49152
v_exp_f32 v140, v140
v_mfma_f32_16x16x32_bf16 v[156:159], a[204:207], a[172:175], v[156:159]
ds_read_b64_tr_b16 a[198:199], v181 offset:57344
v_cvt_pk_bf16_f32 v165, v138, v139
s_waitcnt lgkmcnt(6)
v_mfma_f32_16x16x32_bf16 v[144:147], a[208:211], a[176:179], v[144:147]
ds_read_b64_tr_b16 a[200:201], v182 offset:49152
v_exp_f32 v141, v141
v_mfma_f32_16x16x32_bf16 v[152:155], a[208:211], a[180:183], v[152:155]
ds_read_b64_tr_b16 a[202:203], v182 offset:57344
v_mfma_f32_16x16x32_bf16 v[148:151], a[212:215], a[176:179], v[148:151]
ds_read_b64_tr_b16 a[204:205], v183 offset:49152
v_exp_f32 v142, v142
v_mfma_f32_16x16x32_bf16 v[156:159], a[212:215], a[180:183], v[156:159]
ds_read_b64_tr_b16 a[206:207], v183 offset:57344
v_cvt_pk_bf16_f32 v166, v140, v141
s_waitcnt lgkmcnt(8)
v_mfma_f32_16x16x32_bf16 v[144:147], a[216:219], a[184:187], v[144:147]
ds_read_b64_tr_b16 a[208:209], v184 offset:49152
v_exp_f32 v143, v143
v_mfma_f32_16x16x32_bf16 v[152:155], a[216:219], a[188:191], v[152:155]
ds_read_b64_tr_b16 a[210:211], v184 offset:57344
s_waitcnt vmcnt(6)
s_mov_b32 s34, 394240
buffer_load_dwordx4 v190, s[8:11], s34 offen offset:2048 nt lds
v_mfma_f32_16x16x32_bf16 v[148:151], a[220:223], a[184:187], v[148:151]
ds_read_b64_tr_b16 a[212:213], v185 offset:49152
v_cvt_pk_bf16_f32 v167, v142, v143
v_mfma_f32_16x16x32_bf16 v[156:159], a[220:223], a[188:191], v[156:159]
ds_read_b64_tr_b16 a[214:215], v185 offset:57344
s_nop 0
s_waitcnt lgkmcnt(8)
v_mfma_f32_16x16x32_bf16 v[0:3], a[192:195], v[160:163], v[0:3]
ds_read_b64_tr_b16 a[216:217], v186 offset:49152
v_mfma_f32_16x16x32_bf16 v[8:11], a[192:195], v[164:167], v[8:11]
ds_read_b64_tr_b16 a[218:219], v186 offset:57344
s_add_u32 m0, s33, 98304
s_lshl_b32 s71, s78, 7
buffer_load_dwordx4 v196, s[24:27], s71 offen offset:0  lds
v_mfma_f32_16x16x32_bf16 a[224:227], a[232:235], v[160:163], a[224:227]
v_mfma_f32_16x16x32_bf16 v[4:7], a[196:199], v[160:163], v[4:7]
ds_read_b64_tr_b16 a[220:221], v187 offset:49152
v_mfma_f32_16x16x32_bf16 v[12:15], a[196:199], v[164:167], v[12:15]
ds_read_b64_tr_b16 a[222:223], v187 offset:57344
v_mfma_f32_16x16x32_bf16 a[228:231], a[232:235], v[164:167], a[228:231]
s_waitcnt lgkmcnt(8)
v_mfma_f32_16x16x32_bf16 v[16:19], a[200:203], v[160:163], v[16:19]
ds_read_b64_tr_b16 a[192:193], v180 offset:49408
v_mfma_f32_16x16x32_bf16 v[24:27], a[200:203], v[164:167], v[24:27]
ds_read_b64_tr_b16 a[194:195], v180 offset:57600
s_waitcnt vmcnt(6)
s_add_u32 m0, s33, 32768
s_mov_b32 s34, 393216
buffer_load_dwordx4 v191, s[8:11], s34 offen offset:3072 nt lds
v_mfma_f32_16x16x32_bf16 v[20:23], a[204:207], v[160:163], v[20:23]
ds_read_b64_tr_b16 a[196:197], v181 offset:49408
v_mfma_f32_16x16x32_bf16 v[28:31], a[204:207], v[164:167], v[28:31]
ds_read_b64_tr_b16 a[198:199], v181 offset:57600
s_waitcnt lgkmcnt(8)
v_mfma_f32_16x16x32_bf16 v[32:35], a[208:211], v[160:163], v[32:35]
ds_read_b64_tr_b16 a[200:201], v182 offset:49408
v_max3_f32 v208, v144, v145, v146
v_mfma_f32_16x16x32_bf16 v[40:43], a[208:211], v[164:167], v[40:43]
ds_read_b64_tr_b16 a[202:203], v182 offset:57600
v_mfma_f32_16x16x32_bf16 v[36:39], a[212:215], v[160:163], v[36:39]
ds_read_b64_tr_b16 a[204:205], v183 offset:49408
v_max3_f32 v209, v152, v153, v154
v_mfma_f32_16x16x32_bf16 v[44:47], a[212:215], v[164:167], v[44:47]
ds_read_b64_tr_b16 a[206:207], v183 offset:57600
s_waitcnt lgkmcnt(8)
v_mfma_f32_16x16x32_bf16 v[48:51], a[216:219], v[160:163], v[48:51]
ds_read_b64_tr_b16 a[208:209], v184 offset:49408
v_max3_f32 v208, v208, v147, v148
v_mfma_f32_16x16x32_bf16 v[56:59], a[216:219], v[164:167], v[56:59]
ds_read_b64_tr_b16 a[210:211], v184 offset:57600
v_mfma_f32_16x16x32_bf16 v[52:55], a[220:223], v[160:163], v[52:55]
ds_read_b64_tr_b16 a[212:213], v185 offset:49408
v_max3_f32 v209, v209, v155, v156
v_mfma_f32_16x16x32_bf16 v[60:63], a[220:223], v[164:167], v[60:63]
ds_read_b64_tr_b16 a[214:215], v185 offset:57600
s_waitcnt vmcnt(6)
s_add_u32 m0, s33, 65536
s_mov_b32 s34, 395264
buffer_load_dwordx4 v192, s[12:15], s34 offen offset:0 nt lds
s_waitcnt lgkmcnt(8)
v_mfma_f32_16x16x32_bf16 v[64:67], a[192:195], v[160:163], v[64:67]
ds_read_b64_tr_b16 a[216:217], v186 offset:49408
v_max3_f32 v208, v208, v149, v150
v_mfma_f32_16x16x32_bf16 v[72:75], a[192:195], v[164:167], v[72:75]
ds_read_b64_tr_b16 a[218:219], v186 offset:57600
v_mfma_f32_16x16x32_bf16 v[68:71], a[196:199], v[160:163], v[68:71]
ds_read_b64_tr_b16 a[220:221], v187 offset:49408
v_max3_f32 v209, v209, v157, v158
v_mfma_f32_16x16x32_bf16 v[76:79], a[196:199], v[164:167], v[76:79]
ds_read_b64_tr_b16 a[222:223], v187 offset:57600
s_waitcnt lgkmcnt(8)
v_mfma_f32_16x16x32_bf16 v[80:83], a[200:203], v[160:163], v[80:83]
v_subrev_u32 v176, 65536, v176
v_subrev_u32 v177, 65536, v177
v_subrev_u32 v178, 65536, v178
v_subrev_u32 v179, 65536, v179
s_waitcnt lgkmcnt(0)
s_barrier
ds_read_b128 a[192:195], v176 offset:16384
v_mfma_f32_16x16x32_bf16 v[88:91], a[200:203], v[164:167], v[88:91]
v_max_f32 v208, v208, v151
v_mfma_f32_16x16x32_bf16 v[84:87], a[204:207], v[160:163], v[84:87]
ds_read_b128 a[196:199], v176 offset:24576
v_mfma_f32_16x16x32_bf16 v[92:95], a[204:207], v[164:167], v[92:95]
v_max_f32 v209, v209, v159
s_waitcnt vmcnt(5)
s_mov_b32 s34, 396288
buffer_load_dwordx4 v193, s[12:15], s34 offen offset:1024 nt lds
s_waitcnt lgkmcnt(6)
v_mfma_f32_16x16x32_bf16 v[96:99], a[208:211], v[160:163], v[96:99]
ds_read_b128 a[200:203], v177 offset:16384
v_mfma_f32_16x16x32_bf16 v[104:107], a[208:211], v[164:167], v[104:107]
v_max_f32 v210, v208, v209
s_add_u32 m0, s33, 98304
s_lshl_b32 s71, s78, 7
buffer_load_dwordx4 v197, s[24:27], s71 offen offset:1024  lds
v_mfma_f32_16x16x32_bf16 v[100:103], a[212:215], v[160:163], v[100:103]
ds_read_b128 a[204:207], v177 offset:24576
v_mfma_f32_16x16x32_bf16 v[108:111], a[212:215], v[164:167], v[108:111]
v_cmp_lt_f32 vcc, s80, v210
s_waitcnt lgkmcnt(4)
v_mfma_f32_16x16x32_bf16 v[112:115], a[216:219], v[160:163], v[112:115]
ds_read_b128 a[208:211], v178 offset:16384
v_mfma_f32_16x16x32_bf16 v[120:123], a[216:219], v[164:167], v[120:123]
v_mfma_f32_16x16x32_bf16 v[116:119], a[220:223], v[160:163], v[116:119]
ds_read_b128 a[212:215], v178 offset:24576
v_mfma_f32_16x16x32_bf16 v[124:127], a[220:223], v[164:167], v[124:127]
s_cbranch_vccz L_nors25
s_call_b64 s[82:83], L_rescale
L_nors25:
s_waitcnt lgkmcnt(4)
v_mfma_f32_16x16x32_bf16 v[128:131], a[192:195], a[128:131], v[168:171]
ds_read_b128 a[216:219], v179 offset:16384
v_exp_f32 v144, v144
v_mfma_f32_16x16x32_bf16 v[136:139], a[192:195], a[132:135], v[172:175]
v_exp_f32 v145, v145
s_waitcnt vmcnt(6)
s_add_u32 m0, s33, 65536
s_mov_b32 s34, 393216
buffer_load_dwordx4 v194, s[12:15], s34 offen offset:2048 nt lds
v_mfma_f32_16x16x32_bf16 v[132:135], a[196:199], a[128:131], v[168:171]
ds_read_b128 a[220:223], v179 offset:24576
v_exp_f32 v146, v146
v_mfma_f32_16x16x32_bf16 v[140:143], a[196:199], a[132:135], v[172:175]
v_cvt_pk_bf16_f32 v160, v144, v145
s_waitcnt lgkmcnt(4)
v_mfma_f32_16x16x32_bf16 v[128:131], a[200:203], a[136:139], v[128:131]
ds_read_b128 a[192:195], v176 offset:16640
v_mfma_f32_16x16x32_bf16 v[136:139], a[200:203], a[140:143], v[136:139]
v_exp_f32 v147, v147
v_mfma_f32_16x16x32_bf16 v[132:135], a[204:207], a[136:139], v[132:135]
ds_read_b128 a[196:199], v176 offset:24832
v_exp_f32 v148, v148
v_mfma_f32_16x16x32_bf16 v[140:143], a[204:207], a[140:143], v[140:143]
v_cvt_pk_bf16_f32 v161, v146, v147
s_waitcnt lgkmcnt(4)
v_mfma_f32_16x16x32_bf16 v[128:131], a[208:211], a[144:147], v[128:131]
ds_read_b128 a[200:203], v177 offset:16640
v_mfma_f32_16x16x32_bf16 v[136:139], a[208:211], a[148:151], v[136:139]
v_exp_f32 v149, v149
s_waitcnt vmcnt(6)
s_mov_b32 s34, 394240
buffer_load_dwordx4 v195, s[12:15], s34 offen offset:3072 nt lds
v_mfma_f32_16x16x32_bf16 v[132:135], a[212:215], a[144:147], v[132:135]
ds_read_b128 a[204:207], v177 offset:24832
v_exp_f32 v150, v150
v_mfma_f32_16x16x32_bf16 v[140:143], a[212:215], a[148:151], v[140:143]
v_cvt_pk_bf16_f32 v162, v148, v149
s_waitcnt lgkmcnt(4)
v_mfma_f32_16x16x32_bf16 v[128:131], a[216:219], a[152:155], v[128:131]
ds_read_b128 a[208:211], v178 offset:16640
v_mfma_f32_16x16x32_bf16 v[136:139], a[216:219], a[156:159], v[136:139]
v_exp_f32 v151, v151
v_mfma_f32_16x16x32_bf16 v[132:135], a[220:223], a[152:155], v[132:135]
ds_read_b128 a[212:215], v178 offset:24832
v_exp_f32 v152, v152
v_mfma_f32_16x16x32_bf16 v[140:143], a[220:223], a[156:159], v[140:143]
v_cvt_pk_bf16_f32 v163, v150, v151
s_waitcnt lgkmcnt(4)
v_mfma_f32_16x16x32_bf16 v[128:131], a[192:195], a[160:163], v[128:131]
ds_read_b128 a[216:219], v179 offset:16640
v_mfma_f32_16x16x32_bf16 v[136:139], a[192:195], a[164:167], v[136:139]
v_exp_f32 v153, v153
s_add_u32 m0, s33, 98304
s_lshl_b32 s71, s78, 7
buffer_load_dwordx4 v198, s[24:27], s71 offen offset:2048  lds
v_mfma_f32_16x16x32_bf16 v[132:135], a[196:199], a[160:163], v[132:135]
ds_read_b128 a[220:223], v179 offset:24832
v_exp_f32 v154, v154
v_mfma_f32_16x16x32_bf16 v[140:143], a[196:199], a[164:167], v[140:143]
v_cvt_pk_bf16_f32 v164, v152, v153
s_waitcnt vmcnt(6)
s_add_u32 m0, s33, 49152
s_mov_b32 s34, 458752
buffer_load_dwordx4 v188, s[8:11], s34 offen offset:0 nt lds
s_waitcnt lgkmcnt(4)
v_mfma_f32_16x16x32_bf16 v[128:131], a[200:203], a[168:171], v[128:131]
s_waitcnt lgkmcnt(0)
s_barrier
ds_read_b64_tr_b16 a[192:193], v180 offset:0
v_exp_f32 v155, v155
v_mfma_f32_16x16x32_bf16 v[136:139], a[200:203], a[172:175], v[136:139]
ds_read_b64_tr_b16 a[194:195], v180 offset:8192
v_mfma_f32_16x16x32_bf16 v[132:135], a[204:207], a[168:171], v[132:135]
ds_read_b64_tr_b16 a[196:197], v181 offset:0
v_exp_f32 v156, v156
v_mfma_f32_16x16x32_bf16 v[140:143], a[204:207], a[172:175], v[140:143]
ds_read_b64_tr_b16 a[198:199], v181 offset:8192
v_cvt_pk_bf16_f32 v165, v154, v155
s_waitcnt lgkmcnt(6)
v_mfma_f32_16x16x32_bf16 v[128:131], a[208:211], a[176:179], v[128:131]
ds_read_b64_tr_b16 a[200:201], v182 offset:0
v_exp_f32 v157, v157
v_mfma_f32_16x16x32_bf16 v[136:139], a[208:211], a[180:183], v[136:139]
ds_read_b64_tr_b16 a[202:203], v182 offset:8192
v_mfma_f32_16x16x32_bf16 v[132:135], a[212:215], a[176:179], v[132:135]
ds_read_b64_tr_b16 a[204:205], v183 offset:0
v_exp_f32 v158, v158
v_mfma_f32_16x16x32_bf16 v[140:143], a[212:215], a[180:183], v[140:143]
ds_read_b64_tr_b16 a[206:207], v183 offset:8192
v_cvt_pk_bf16_f32 v166, v156, v157
s_waitcnt vmcnt(6)
s_mov_b32 s34, 459776
buffer_load_dwordx4 v189, s[8:11], s34 offen offset:1024 nt lds
s_waitcnt lgkmcnt(8)
v_mfma_f32_16x16x32_bf16 v[128:131], a[216:219], a[184:187], v[128:131]
ds_read_b64_tr_b16 a[208:209], v184 offset:0
v_exp_f32 v159, v159
v_mfma_f32_16x16x32_bf16 v[136:139], a[216:219], a[188:191], v[136:139]
ds_read_b64_tr_b16 a[210:211], v184 offset:8192
v_mfma_f32_16x16x32_bf16 v[132:135], a[220:223], a[184:187], v[132:135]
ds_read_b64_tr_b16 a[212:213], v185 offset:0
v_cvt_pk_bf16_f32 v167, v158, v159
v_mfma_f32_16x16x32_bf16 v[140:143], a[220:223], a[188:191], v[140:143]
ds_read_b64_tr_b16 a[214:215], v185 offset:8192
s_nop 0
s_waitcnt lgkmcnt(8)
v_mfma_f32_16x16x32_bf16 v[0:3], a[192:195], v[160:163], v[0:3]
ds_read_b64_tr_b16 a[216:217], v186 offset:0
v_mfma_f32_16x16x32_bf16 v[8:11], a[192:195], v[164:167], v[8:11]
ds_read_b64_tr_b16 a[218:219], v186 offset:8192
v_mfma_f32_16x16x32_bf16 a[224:227], a[232:235], v[160:163], a[224:227]
v_mfma_f32_16x16x32_bf16 v[4:7], a[196:199], v[160:163], v[4:7]
ds_read_b64_tr_b16 a[220:221], v187 offset:0
v_mfma_f32_16x16x32_bf16 v[12:15], a[196:199], v[164:167], v[12:15]
ds_read_b64_tr_b16 a[222:223], v187 offset:8192
v_mfma_f32_16x16x32_bf16 a[228:231], a[232:235], v[164:167], a[228:231]
s_waitcnt lgkmcnt(8)
v_mfma_f32_16x16x32_bf16 v[16:19], a[200:203], v[160:163], v[16:19]
ds_read_b64_tr_b16 a[192:193], v180 offset:256
v_mfma_f32_16x16x32_bf16 v[24:27], a[200:203], v[164:167], v[24:27]
ds_read_b64_tr_b16 a[194:195], v180 offset:8448
s_waitcnt vmcnt(6)
s_mov_b32 s34, 460800
buffer_load_dwordx4 v190, s[8:11], s34 offen offset:2048 nt lds
v_mfma_f32_16x16x32_bf16 v[20:23], a[204:207], v[160:163], v[20:23]
ds_read_b64_tr_b16 a[196:197], v181 offset:256
v_mfma_f32_16x16x32_bf16 v[28:31], a[204:207], v[164:167], v[28:31]
ds_read_b64_tr_b16 a[198:199], v181 offset:8448
s_waitcnt lgkmcnt(8)
v_mfma_f32_16x16x32_bf16 v[32:35], a[208:211], v[160:163], v[32:35]
ds_read_b64_tr_b16 a[200:201], v182 offset:256
v_max3_f32 v208, v128, v129, v130
v_mfma_f32_16x16x32_bf16 v[40:43], a[208:211], v[164:167], v[40:43]
ds_read_b64_tr_b16 a[202:203], v182 offset:8448
s_add_u32 m0, s33, 98304
s_lshl_b32 s71, s78, 7
buffer_load_dwordx4 v199, s[24:27], s71 offen offset:3072  lds
v_mfma_f32_16x16x32_bf16 v[36:39], a[212:215], v[160:163], v[36:39]
ds_read_b64_tr_b16 a[204:205], v183 offset:256
v_max3_f32 v209, v136, v137, v138
v_mfma_f32_16x16x32_bf16 v[44:47], a[212:215], v[164:167], v[44:47]
ds_read_b64_tr_b16 a[206:207], v183 offset:8448
s_waitcnt lgkmcnt(8)
v_mfma_f32_16x16x32_bf16 v[48:51], a[216:219], v[160:163], v[48:51]
ds_read_b64_tr_b16 a[208:209], v184 offset:256
v_max3_f32 v208, v208, v131, v132
v_mfma_f32_16x16x32_bf16 v[56:59], a[216:219], v[164:167], v[56:59]
ds_read_b64_tr_b16 a[210:211], v184 offset:8448
s_waitcnt vmcnt(6)
s_add_u32 m0, s33, 49152
s_mov_b32 s34, 461824
buffer_load_dwordx4 v191, s[8:11], s34 offen offset:3072 nt lds
v_mfma_f32_16x16x32_bf16 v[52:55], a[220:223], v[160:163], v[52:55]
ds_read_b64_tr_b16 a[212:213], v185 offset:256
v_max3_f32 v209, v209, v139, v140
v_mfma_f32_16x16x32_bf16 v[60:63], a[220:223], v[164:167], v[60:63]
ds_read_b64_tr_b16 a[214:215], v185 offset:8448
s_waitcnt lgkmcnt(8)
v_mfma_f32_16x16x32_bf16 v[64:67], a[192:195], v[160:163], v[64:67]
ds_read_b64_tr_b16 a[216:217], v186 offset:256
v_max3_f32 v208, v208, v133, v134
v_mfma_f32_16x16x32_bf16 v[72:75], a[192:195], v[164:167], v[72:75]
ds_read_b64_tr_b16 a[218:219], v186 offset:8448
v_mfma_f32_16x16x32_bf16 v[68:71], a[196:199], v[160:163], v[68:71]
ds_read_b64_tr_b16 a[220:221], v187 offset:256
v_max3_f32 v209, v209, v141, v142
v_mfma_f32_16x16x32_bf16 v[76:79], a[196:199], v[164:167], v[76:79]
ds_read_b64_tr_b16 a[222:223], v187 offset:8448
s_waitcnt lgkmcnt(8)
v_mfma_f32_16x16x32_bf16 v[80:83], a[200:203], v[160:163], v[80:83]
s_waitcnt lgkmcnt(0)
s_barrier
ds_read_b128 a[192:195], v176 offset:32768
v_mfma_f32_16x16x32_bf16 v[88:91], a[200:203], v[164:167], v[88:91]
v_max_f32 v208, v208, v135
v_mfma_f32_16x16x32_bf16 v[84:87], a[204:207], v[160:163], v[84:87]
ds_read_b128 a[196:199], v176 offset:40960
v_mfma_f32_16x16x32_bf16 v[92:95], a[204:207], v[164:167], v[92:95]
v_max_f32 v209, v209, v143
s_waitcnt vmcnt(6)
s_add_u32 m0, s33, 16384
s_mov_b32 s34, 396288
buffer_load_dwordx4 v192, s[12:15], s34 offen offset:0 nt lds
s_waitcnt lgkmcnt(6)
v_mfma_f32_16x16x32_bf16 v[96:99], a[208:211], v[160:163], v[96:99]
ds_read_b128 a[200:203], v177 offset:32768
v_mfma_f32_16x16x32_bf16 v[104:107], a[208:211], v[164:167], v[104:107]
v_max_f32 v210, v208, v209
v_mfma_f32_16x16x32_bf16 v[100:103], a[212:215], v[160:163], v[100:103]
ds_read_b128 a[204:207], v177 offset:40960
v_mfma_f32_16x16x32_bf16 v[108:111], a[212:215], v[164:167], v[108:111]
v_cmp_lt_f32 vcc, s80, v210
s_waitcnt lgkmcnt(4)
v_mfma_f32_16x16x32_bf16 v[112:115], a[216:219], v[160:163], v[112:115]
ds_read_b128 a[208:211], v178 offset:32768
v_mfma_f32_16x16x32_bf16 v[120:123], a[216:219], v[164:167], v[120:123]
v_mfma_f32_16x16x32_bf16 v[116:119], a[220:223], v[160:163], v[116:119]
ds_read_b128 a[212:215], v178 offset:40960
v_mfma_f32_16x16x32_bf16 v[124:127], a[220:223], v[164:167], v[124:127]
s_waitcnt vmcnt(5)
s_mov_b32 s34, 395264
buffer_load_dwordx4 v193, s[12:15], s34 offen offset:1024 nt lds
s_cbranch_vccz L_nors26
s_call_b64 s[82:83], L_rescale
L_nors26:
s_waitcnt lgkmcnt(4)
v_mfma_f32_16x16x32_bf16 v[144:147], a[192:195], a[128:131], v[168:171]
ds_read_b128 a[216:219], v179 offset:32768
v_exp_f32 v128, v128
v_mfma_f32_16x16x32_bf16 v[152:155], a[192:195], a[132:135], v[172:175]
v_exp_f32 v129, v129
s_add_u32 m0, s33, 81920
s_lshl_b32 s71, s78, 7
s_add_u32 s71, s71, 114688
buffer_load_dwordx4 v196, s[24:27], s71 offen offset:0  lds
v_mfma_f32_16x16x32_bf16 v[148:151], a[196:199], a[128:131], v[168:171]
ds_read_b128 a[220:223], v179 offset:40960
v_exp_f32 v130, v130
v_mfma_f32_16x16x32_bf16 v[156:159], a[196:199], a[132:135], v[172:175]
v_cvt_pk_bf16_f32 v160, v128, v129
s_waitcnt lgkmcnt(4)
v_mfma_f32_16x16x32_bf16 v[144:147], a[200:203], a[136:139], v[144:147]
ds_read_b128 a[192:195], v176 offset:33024
v_mfma_f32_16x16x32_bf16 v[152:155], a[200:203], a[140:143], v[152:155]
v_exp_f32 v131, v131
v_mfma_f32_16x16x32_bf16 v[148:151], a[204:207], a[136:139], v[148:151]
ds_read_b128 a[196:199], v176 offset:41216
v_exp_f32 v132, v132
v_mfma_f32_16x16x32_bf16 v[156:159], a[204:207], a[140:143], v[156:159]
v_cvt_pk_bf16_f32 v161, v130, v131
s_waitcnt lgkmcnt(4)
v_mfma_f32_16x16x32_bf16 v[144:147], a[208:211], a[144:147], v[144:147]
ds_read_b128 a[200:203], v177 offset:33024
v_mfma_f32_16x16x32_bf16 v[152:155], a[208:211], a[148:151], v[152:155]
v_exp_f32 v133, v133
s_waitcnt vmcnt(6)
s_add_u32 m0, s33, 16384
s_mov_b32 s34, 394240
buffer_load_dwordx4 v194, s[12:15], s34 offen offset:2048 nt lds
v_mfma_f32_16x16x32_bf16 v[148:151], a[212:215], a[144:147], v[148:151]
ds_read_b128 a[204:207], v177 offset:41216
v_exp_f32 v134, v134
v_mfma_f32_16x16x32_bf16 v[156:159], a[212:215], a[148:151], v[156:159]
v_cvt_pk_bf16_f32 v162, v132, v133
s_waitcnt lgkmcnt(4)
v_mfma_f32_16x16x32_bf16 v[144:147], a[216:219], a[152:155], v[144:147]
ds_read_b128 a[208:211], v178 offset:33024
v_mfma_f32_16x16x32_bf16 v[152:155], a[216:219], a[156:159], v[152:155]
v_exp_f32 v135, v135
v_mfma_f32_16x16x32_bf16 v[148:151], a[220:223], a[152:155], v[148:151]
ds_read_b128 a[212:215], v178 offset:41216
v_exp_f32 v136, v136
v_mfma_f32_16x16x32_bf16 v[156:159], a[220:223], a[156:159], v[156:159]
v_cvt_pk_bf16_f32 v163, v134, v135
s_waitcnt lgkmcnt(4)
v_mfma_f32_16x16x32_bf16 v[144:147], a[192:195], a[160:163], v[144:147]
ds_read_b128 a[216:219], v179 offset:33024
v_mfma_f32_16x16x32_bf16 v[152:155], a[192:195], a[164:167], v[152:155]
v_exp_f32 v137, v137
s_waitcnt vmcnt(6)
s_mov_b32 s34, 393216
buffer_load_dwordx4 v195, s[12:15], s34 offen offset:3072 nt lds
v_mfma_f32_16x16x32_bf16 v[148:151], a[196:199], a[160:163], v[148:151]
ds_read_b128 a[220:223], v179 offset:41216
v_exp_f32 v138, v138
v_mfma_f32_16x16x32_bf16 v[156:159], a[196:199], a[164:167], v[156:159]
v_cvt_pk_bf16_f32 v164, v136, v137
s_waitcnt lgkmcnt(4)
v_mfma_f32_16x16x32_bf16 v[144:147], a[200:203], a[168:171], v[144:147]
v_add_u32 v180, 65536, v180
v_add_u32 v181, 65536, v181
v_add_u32 v182, 65536, v182
v_add_u32 v183, 65536, v183
v_add_u32 v184, 65536, v184
v_add_u32 v185, 65536, v185
v_add_u32 v186, 65536, v186
v_add_u32 v187, 65536, v187
s_waitcnt lgkmcnt(0)
s_barrier
ds_read_b64_tr_b16 a[192:193], v180 offset:0
v_exp_f32 v139, v139
v_mfma_f32_16x16x32_bf16 v[152:155], a[200:203], a[172:175], v[152:155]
ds_read_b64_tr_b16 a[194:195], v180 offset:8192
v_mfma_f32_16x16x32_bf16 v[148:151], a[204:207], a[168:171], v[148:151]
ds_read_b64_tr_b16 a[196:197], v181 offset:0
v_exp_f32 v140, v140
v_mfma_f32_16x16x32_bf16 v[156:159], a[204:207], a[172:175], v[156:159]
ds_read_b64_tr_b16 a[198:199], v181 offset:8192
v_cvt_pk_bf16_f32 v165, v138, v139
s_waitcnt lgkmcnt(6)
v_mfma_f32_16x16x32_bf16 v[144:147], a[208:211], a[176:179], v[144:147]
ds_read_b64_tr_b16 a[200:201], v182 offset:0
v_exp_f32 v141, v141
v_mfma_f32_16x16x32_bf16 v[152:155], a[208:211], a[180:183], v[152:155]
ds_read_b64_tr_b16 a[202:203], v182 offset:8192
s_add_u32 m0, s33, 81920
s_lshl_b32 s71, s78, 7
s_add_u32 s71, s71, 114688
buffer_load_dwordx4 v197, s[24:27], s71 offen offset:1024  lds
v_mfma_f32_16x16x32_bf16 v[148:151], a[212:215], a[176:179], v[148:151]
ds_read_b64_tr_b16 a[204:205], v183 offset:0
v_exp_f32 v142, v142
v_mfma_f32_16x16x32_bf16 v[156:159], a[212:215], a[180:183], v[156:159]
ds_read_b64_tr_b16 a[206:207], v183 offset:8192
v_cvt_pk_bf16_f32 v166, v140, v141
s_waitcnt vmcnt(6)
s_add_u32 m0, s33, 0
s_mov_b32 s34, 459776
buffer_load_dwordx4 v188, s[8:11], s34 offen offset:0 nt lds
s_waitcnt lgkmcnt(8)
v_mfma_f32_16x16x32_bf16 v[144:147], a[216:219], a[184:187], v[144:147]
ds_read_b64_tr_b16 a[208:209], v184 offset:0
v_exp_f32 v143, v143
v_mfma_f32_16x16x32_bf16 v[152:155], a[216:219], a[188:191], v[152:155]
ds_read_b64_tr_b16 a[210:211], v184 offset:8192
v_mfma_f32_16x16x32_bf16 v[148:151], a[220:223], a[184:187], v[148:151]
ds_read_b64_tr_b16 a[212:213], v185 offset:0
v_cvt_pk_bf16_f32 v167, v142, v143
v_mfma_f32_16x16x32_bf16 v[156:159], a[220:223], a[188:191], v[156:159]
ds_read_b64_tr_b16 a[214:215], v185 offset:8192
s_nop 0
s_waitcnt lgkmcnt(8)
v_mfma_f32_16x16x32_bf16 v[0:3], a[192:195], v[160:163], v[0:3]
ds_read_b64_tr_b16 a[216:217], v186 offset:0
v_mfma_f32_16x16x32_bf16 v[8:11], a[192:195], v[164:167], v[8:11]
ds_read_b64_tr_b16 a[218:219], v186 offset:8192
v_mfma_f32_16x16x32_bf16 a[224:227], a[232:235], v[160:163], a[224:227]
v_mfma_f32_16x16x32_bf16 v[4:7], a[196:199], v[160:163], v[4:7]
ds_read_b64_tr_b16 a[220:221], v187 offset:0
v_mfma_f32_16x16x32_bf16 v[12:15], a[196:199], v[164:167], v[12:15]
ds_read_b64_tr_b16 a[222:223], v187 offset:8192
s_waitcnt vmcnt(6)
s_mov_b32 s34, 458752
buffer_load_dwordx4 v189, s[8:11], s34 offen offset:1024 nt lds
v_mfma_f32_16x16x32_bf16 a[228:231], a[232:235], v[164:167], a[228:231]
s_waitcnt lgkmcnt(8)
v_mfma_f32_16x16x32_bf16 v[16:19], a[200:203], v[160:163], v[16:19]
ds_read_b64_tr_b16 a[192:193], v180 offset:256
v_mfma_f32_16x16x32_bf16 v[24:27], a[200:203], v[164:167], v[24:27]
ds_read_b64_tr_b16 a[194:195], v180 offset:8448
v_mfma_f32_16x16x32_bf16 v[20:23], a[204:207], v[160:163], v[20:23]
ds_read_b64_tr_b16 a[196:197], v181 offset:256
v_mfma_f32_16x16x32_bf16 v[28:31], a[204:207], v[164:167], v[28:31]
ds_read_b64_tr_b16 a[198:199], v181 offset:8448
s_waitcnt lgkmcnt(8)
v_mfma_f32_16x16x32_bf16 v[32:35], a[208:211], v[160:163], v[32:35]
ds_read_b64_tr_b16 a[200:201], v182 offset:256
v_max3_f32 v208, v144, v145, v146
v_mfma_f32_16x16x32_bf16 v[40:43], a[208:211], v[164:167], v[40:43]
ds_read_b64_tr_b16 a[202:203], v182 offset:8448
v_mfma_f32_16x16x32_bf16 v[36:39], a[212:215], v[160:163], v[36:39]
ds_read_b64_tr_b16 a[204:205], v183 offset:256
v_max3_f32 v209, v152, v153, v154
v_mfma_f32_16x16x32_bf16 v[44:47], a[212:215], v[164:167], v[44:47]
ds_read_b64_tr_b16 a[206:207], v183 offset:8448
s_waitcnt lgkmcnt(8)
v_mfma_f32_16x16x32_bf16 v[48:51], a[216:219], v[160:163], v[48:51]
ds_read_b64_tr_b16 a[208:209], v184 offset:256
v_max3_f32 v208, v208, v147, v148
v_mfma_f32_16x16x32_bf16 v[56:59], a[216:219], v[164:167], v[56:59]
ds_read_b64_tr_b16 a[210:211], v184 offset:8448
s_waitcnt vmcnt(6)
s_mov_b32 s34, 461824
buffer_load_dwordx4 v190, s[8:11], s34 offen offset:2048 nt lds
v_mfma_f32_16x16x32_bf16 v[52:55], a[220:223], v[160:163], v[52:55]
ds_read_b64_tr_b16 a[212:213], v185 offset:256
v_max3_f32 v209, v209, v155, v156
v_mfma_f32_16x16x32_bf16 v[60:63], a[220:223], v[164:167], v[60:63]
ds_read_b64_tr_b16 a[214:215], v185 offset:8448
s_waitcnt lgkmcnt(8)
v_mfma_f32_16x16x32_bf16 v[64:67], a[192:195], v[160:163], v[64:67]
ds_read_b64_tr_b16 a[216:217], v186 offset:256
v_max3_f32 v208, v208, v149, v150
v_mfma_f32_16x16x32_bf16 v[72:75], a[192:195], v[164:167], v[72:75]
ds_read_b64_tr_b16 a[218:219], v186 offset:8448
s_add_u32 m0, s33, 81920
s_lshl_b32 s71, s78, 7
s_add_u32 s71, s71, 114688
buffer_load_dwordx4 v198, s[24:27], s71 offen offset:2048  lds
v_mfma_f32_16x16x32_bf16 v[68:71], a[196:199], v[160:163], v[68:71]
ds_read_b64_tr_b16 a[220:221], v187 offset:256
v_max3_f32 v209, v209, v157, v158
v_mfma_f32_16x16x32_bf16 v[76:79], a[196:199], v[164:167], v[76:79]
ds_read_b64_tr_b16 a[222:223], v187 offset:8448
s_waitcnt lgkmcnt(8)
v_mfma_f32_16x16x32_bf16 v[80:83], a[200:203], v[160:163], v[80:83]
s_waitcnt lgkmcnt(0)
s_barrier
ds_read_b128 a[192:195], v176 offset:49152
v_mfma_f32_16x16x32_bf16 v[88:91], a[200:203], v[164:167], v[88:91]
v_max_f32 v208, v208, v151
s_waitcnt vmcnt(6)
s_add_u32 m0, s33, 0
s_mov_b32 s34, 460800
buffer_load_dwordx4 v191, s[8:11], s34 offen offset:3072 nt lds
v_mfma_f32_16x16x32_bf16 v[84:87], a[204:207], v[160:163], v[84:87]
ds_read_b128 a[196:199], v176 offset:57344
v_mfma_f32_16x16x32_bf16 v[92:95], a[204:207], v[164:167], v[92:95]
v_max_f32 v209, v209, v159
s_waitcnt lgkmcnt(6)
v_mfma_f32_16x16x32_bf16 v[96:99], a[208:211], v[160:163], v[96:99]
ds_read_b128 a[200:203], v177 offset:49152
v_mfma_f32_16x16x32_bf16 v[104:107], a[208:211], v[164:167], v[104:107]
v_max_f32 v210, v208, v209
v_mfma_f32_16x16x32_bf16 v[100:103], a[212:215], v[160:163], v[100:103]
ds_read_b128 a[204:207], v177 offset:57344
v_mfma_f32_16x16x32_bf16 v[108:111], a[212:215], v[164:167], v[108:111]
v_cmp_lt_f32 vcc, s80, v210
s_waitcnt lgkmcnt(4)
v_mfma_f32_16x16x32_bf16 v[112:115], a[216:219], v[160:163], v[112:115]
ds_read_b128 a[208:211], v178 offset:49152
v_mfma_f32_16x16x32_bf16 v[120:123], a[216:219], v[164:167], v[120:123]
v_mfma_f32_16x16x32_bf16 v[116:119], a[220:223], v[160:163], v[116:119]
ds_read_b128 a[212:215], v178 offset:57344
v_mfma_f32_16x16x32_bf16 v[124:127], a[220:223], v[164:167], v[124:127]
s_waitcnt vmcnt(6)
s_add_u32 m0, s33, 32768
s_mov_b32 s34, 458752
buffer_load_dwordx4 v192, s[12:15], s34 offen offset:0 nt lds
s_cbranch_vccz L_nors27
s_call_b64 s[82:83], L_rescale
L_nors27:
s_waitcnt lgkmcnt(4)
v_mfma_f32_16x16x32_bf16 v[128:131], a[192:195], a[128:131], v[168:171]
ds_read_b128 a[216:219], v179 offset:49152
v_exp_f32 v144, v144
v_mfma_f32_16x16x32_bf16 v[136:139], a[192:195], a[132:135], v[172:175]
v_exp_f32 v145, v145
v_mfma_f32_16x16x32_bf16 v[132:135], a[196:199], a[128:131], v[168:171]
ds_read_b128 a[220:223], v179 offset:57344
v_exp_f32 v146, v146
v_mfma_f32_16x16x32_bf16 v[140:143], a[196:199], a[132:135], v[172:175]
v_cvt_pk_bf16_f32 v160, v144, v145
s_waitcnt lgkmcnt(4)
v_mfma_f32_16x16x32_bf16 v[128:131], a[200:203], a[136:139], v[128:131]
ds_read_b128 a[192:195], v176 offset:49408
v_mfma_f32_16x16x32_bf16 v[136:139], a[200:203], a[140:143], v[136:139]
v_exp_f32 v147, v147
v_mfma_f32_16x16x32_bf16 v[132:135], a[204:207], a[136:139], v[132:135]
ds_read_b128 a[196:199], v176 offset:57600
v_exp_f32 v148, v148
v_mfma_f32_16x16x32_bf16 v[140:143], a[204:207], a[140:143], v[140:143]
v_cvt_pk_bf16_f32 v161, v146, v147
s_waitcnt vmcnt(5)
s_mov_b32 s34, 459776
buffer_load_dwordx4 v193, s[12:15], s34 offen offset:1024 nt lds
s_waitcnt lgkmcnt(4)
v_mfma_f32_16x16x32_bf16 v[128:131], a[208:211], a[144:147], v[128:131]
ds_read_b128 a[200:203], v177 offset:49408
v_mfma_f32_16x16x32_bf16 v[136:139], a[208:211], a[148:151], v[136:139]
v_exp_f32 v149, v149
s_add_u32 m0, s33, 81920
s_lshl_b32 s71, s78, 7
s_add_u32 s71, s71, 114688
buffer_load_dwordx4 v199, s[24:27], s71 offen offset:3072  lds
v_mfma_f32_16x16x32_bf16 v[132:135], a[212:215], a[144:147], v[132:135]
ds_read_b128 a[204:207], v177 offset:57600
v_exp_f32 v150, v150
v_mfma_f32_16x16x32_bf16 v[140:143], a[212:215], a[148:151], v[140:143]
v_cvt_pk_bf16_f32 v162, v148, v149
s_waitcnt lgkmcnt(4)
v_mfma_f32_16x16x32_bf16 v[128:131], a[216:219], a[152:155], v[128:131]
ds_read_b128 a[208:211], v178 offset:49408
v_mfma_f32_16x16x32_bf16 v[136:139], a[216:219], a[156:159], v[136:139]
v_exp_f32 v151, v151
v_mfma_f32_16x16x32_bf16 v[132:135], a[220:223], a[152:155], v[132:135]
ds_read_b128 a[212:215], v178 offset:57600
v_exp_f32 v152, v152
v_mfma_f32_16x16x32_bf16 v[140:143], a[220:223], a[156:159], v[140:143]
v_cvt_pk_bf16_f32 v163, v150, v151
s_waitcnt lgkmcnt(4)
v_mfma_f32_16x16x32_bf16 v[128:131], a[192:195], a[160:163], v[128:131]
ds_read_b128 a[216:219], v179 offset:49408
v_mfma_f32_16x16x32_bf16 v[136:139], a[192:195], a[164:167], v[136:139]
v_exp_f32 v153, v153
s_waitcnt vmcnt(6)
s_add_u32 m0, s33, 32768
s_mov_b32 s34, 460800
buffer_load_dwordx4 v194, s[12:15], s34 offen offset:2048 nt lds
v_mfma_f32_16x16x32_bf16 v[132:135], a[196:199], a[160:163], v[132:135]
ds_read_b128 a[220:223], v179 offset:57600
v_exp_f32 v154, v154
v_mfma_f32_16x16x32_bf16 v[140:143], a[196:199], a[164:167], v[140:143]
v_cvt_pk_bf16_f32 v164, v152, v153
s_waitcnt lgkmcnt(4)
v_mfma_f32_16x16x32_bf16 v[128:131], a[200:203], a[168:171], v[128:131]
v_subrev_u32 v180, 65536, v180
v_subrev_u32 v181, 65536, v181
v_subrev_u32 v182, 65536, v182
v_subrev_u32 v183, 65536, v183
v_subrev_u32 v184, 65536, v184
v_subrev_u32 v185, 65536, v185
v_subrev_u32 v186, 65536, v186
v_subrev_u32 v187, 65536, v187
s_waitcnt lgkmcnt(0)
s_barrier
ds_read_b64_tr_b16 a[192:193], v180 offset:16384
v_exp_f32 v155, v155
v_mfma_f32_16x16x32_bf16 v[136:139], a[200:203], a[172:175], v[136:139]
ds_read_b64_tr_b16 a[194:195], v180 offset:24576
v_mfma_f32_16x16x32_bf16 v[132:135], a[204:207], a[168:171], v[132:135]
ds_read_b64_tr_b16 a[196:197], v181 offset:16384
v_exp_f32 v156, v156
v_mfma_f32_16x16x32_bf16 v[140:143], a[204:207], a[172:175], v[140:143]
ds_read_b64_tr_b16 a[198:199], v181 offset:24576
v_cvt_pk_bf16_f32 v165, v154, v155
s_waitcnt lgkmcnt(6)
v_mfma_f32_16x16x32_bf16 v[128:131], a[208:211], a[176:179], v[128:131]
ds_read_b64_tr_b16 a[200:201], v182 offset:16384
v_exp_f32 v157, v157
v_mfma_f32_16x16x32_bf16 v[136:139], a[208:211], a[180:183], v[136:139]
ds_read_b64_tr_b16 a[202:203], v182 offset:24576
s_waitcnt vmcnt(6)
s_mov_b32 s34, 461824
buffer_load_dwordx4 v195, s[12:15], s34 offen offset:3072 nt lds
v_mfma_f32_16x16x32_bf16 v[132:135], a[212:215], a[176:179], v[132:135]
ds_read_b64_tr_b16 a[204:205], v183 offset:16384
v_exp_f32 v158, v158
v_mfma_f32_16x16x32_bf16 v[140:143], a[212:215], a[180:183], v[140:143]
ds_read_b64_tr_b16 a[206:207], v183 offset:24576
v_cvt_pk_bf16_f32 v166, v156, v157
s_waitcnt lgkmcnt(8)
v_mfma_f32_16x16x32_bf16 v[128:131], a[216:219], a[184:187], v[128:131]
ds_read_b64_tr_b16 a[208:209], v184 offset:16384
v_exp_f32 v159, v159
v_mfma_f32_16x16x32_bf16 v[136:139], a[216:219], a[188:191], v[136:139]
ds_read_b64_tr_b16 a[210:211], v184 offset:24576
v_mfma_f32_16x16x32_bf16 v[132:135], a[220:223], a[184:187], v[132:135]
ds_read_b64_tr_b16 a[212:213], v185 offset:16384
v_cvt_pk_bf16_f32 v167, v158, v159
v_mfma_f32_16x16x32_bf16 v[140:143], a[220:223], a[188:191], v[140:143]
ds_read_b64_tr_b16 a[214:215], v185 offset:24576
s_nop 0
s_waitcnt lgkmcnt(8)
v_mfma_f32_16x16x32_bf16 v[0:3], a[192:195], v[160:163], v[0:3]
ds_read_b64_tr_b16 a[216:217], v186 offset:16384
v_mfma_f32_16x16x32_bf16 v[8:11], a[192:195], v[164:167], v[8:11]
ds_read_b64_tr_b16 a[218:219], v186 offset:24576
v_mfma_f32_16x16x32_bf16 a[224:227], a[232:235], v[160:163], a[224:227]
v_mfma_f32_16x16x32_bf16 v[4:7], a[196:199], v[160:163], v[4:7]
ds_read_b64_tr_b16 a[220:221], v187 offset:16384
v_mfma_f32_16x16x32_bf16 v[12:15], a[196:199], v[164:167], v[12:15]
ds_read_b64_tr_b16 a[222:223], v187 offset:24576
s_waitcnt vmcnt(5)
s_add_u32 m0, s33, 49152
s_mov_b32 s34, 460800
buffer_load_dwordx4 v188, s[8:11], s34 offen offset:0 nt lds
v_mfma_f32_16x16x32_bf16 a[228:231], a[232:235], v[164:167], a[228:231]
s_waitcnt lgkmcnt(8)
v_mfma_f32_16x16x32_bf16 v[16:19], a[200:203], v[160:163], v[16:19]
ds_read_b64_tr_b16 a[192:193], v180 offset:16640
v_mfma_f32_16x16x32_bf16 v[24:27], a[200:203], v[164:167], v[24:27]
ds_read_b64_tr_b16 a[194:195], v180 offset:24832
v_mfma_f32_16x16x32_bf16 v[20:23], a[204:207], v[160:163], v[20:23]
ds_read_b64_tr_b16 a[196:197], v181 offset:16640
v_mfma_f32_16x16x32_bf16 v[28:31], a[204:207], v[164:167], v[28:31]
ds_read_b64_tr_b16 a[198:199], v181 offset:24832
s_waitcnt lgkmcnt(8)
v_mfma_f32_16x16x32_bf16 v[32:35], a[208:211], v[160:163], v[32:35]
ds_read_b64_tr_b16 a[200:201], v182 offset:16640
v_max3_f32 v208, v128, v129, v130
v_mfma_f32_16x16x32_bf16 v[40:43], a[208:211], v[164:167], v[40:43]
ds_read_b64_tr_b16 a[202:203], v182 offset:24832
v_mfma_f32_16x16x32_bf16 v[36:39], a[212:215], v[160:163], v[36:39]
ds_read_b64_tr_b16 a[204:205], v183 offset:16640
v_max3_f32 v209, v136, v137, v138
v_mfma_f32_16x16x32_bf16 v[44:47], a[212:215], v[164:167], v[44:47]
ds_read_b64_tr_b16 a[206:207], v183 offset:24832
s_waitcnt vmcnt(5)
s_mov_b32 s34, 461824
buffer_load_dwordx4 v189, s[8:11], s34 offen offset:1024 nt lds
s_waitcnt lgkmcnt(8)
v_mfma_f32_16x16x32_bf16 v[48:51], a[216:219], v[160:163], v[48:51]
ds_read_b64_tr_b16 a[208:209], v184 offset:16640
v_max3_f32 v208, v208, v131, v132
v_mfma_f32_16x16x32_bf16 v[56:59], a[216:219], v[164:167], v[56:59]
ds_read_b64_tr_b16 a[210:211], v184 offset:24832
v_mfma_f32_16x16x32_bf16 v[52:55], a[220:223], v[160:163], v[52:55]
ds_read_b64_tr_b16 a[212:213], v185 offset:16640
v_max3_f32 v209, v209, v139, v140
v_mfma_f32_16x16x32_bf16 v[60:63], a[220:223], v[164:167], v[60:63]
ds_read_b64_tr_b16 a[214:215], v185 offset:24832
s_waitcnt lgkmcnt(8)
v_mfma_f32_16x16x32_bf16 v[64:67], a[192:195], v[160:163], v[64:67]
ds_read_b64_tr_b16 a[216:217], v186 offset:16640
v_max3_f32 v208, v208, v133, v134
v_mfma_f32_16x16x32_bf16 v[72:75], a[192:195], v[164:167], v[72:75]
ds_read_b64_tr_b16 a[218:219], v186 offset:24832
v_mfma_f32_16x16x32_bf16 v[68:71], a[196:199], v[160:163], v[68:71]
ds_read_b64_tr_b16 a[220:221], v187 offset:16640
v_max3_f32 v209, v209, v141, v142
v_mfma_f32_16x16x32_bf16 v[76:79], a[196:199], v[164:167], v[76:79]
ds_read_b64_tr_b16 a[222:223], v187 offset:24832
s_waitcnt lgkmcnt(8)
v_mfma_f32_16x16x32_bf16 v[80:83], a[200:203], v[160:163], v[80:83]
s_waitcnt lgkmcnt(0)
s_barrier
ds_read_b128 a[192:195], v176 offset:0
v_mfma_f32_16x16x32_bf16 v[88:91], a[200:203], v[164:167], v[88:91]
v_max_f32 v208, v208, v135
s_waitcnt vmcnt(5)
s_mov_b32 s34, 458752
buffer_load_dwordx4 v190, s[8:11], s34 offen offset:2048 nt lds
v_mfma_f32_16x16x32_bf16 v[84:87], a[204:207], v[160:163], v[84:87]
ds_read_b128 a[196:199], v176 offset:8192
v_mfma_f32_16x16x32_bf16 v[92:95], a[204:207], v[164:167], v[92:95]
v_max_f32 v209, v209, v143
s_waitcnt lgkmcnt(6)
v_mfma_f32_16x16x32_bf16 v[96:99], a[208:211], v[160:163], v[96:99]
ds_read_b128 a[200:203], v177 offset:0
v_mfma_f32_16x16x32_bf16 v[104:107], a[208:211], v[164:167], v[104:107]
v_max_f32 v210, v208, v209
v_mfma_f32_16x16x32_bf16 v[100:103], a[212:215], v[160:163], v[100:103]
ds_read_b128 a[204:207], v177 offset:8192
v_mfma_f32_16x16x32_bf16 v[108:111], a[212:215], v[164:167], v[108:111]
v_cmp_lt_f32 vcc, s80, v210
s_waitcnt lgkmcnt(4)
v_mfma_f32_16x16x32_bf16 v[112:115], a[216:219], v[160:163], v[112:115]
ds_read_b128 a[208:211], v178 offset:0
v_mfma_f32_16x16x32_bf16 v[120:123], a[216:219], v[164:167], v[120:123]
s_waitcnt vmcnt(4)
s_mov_b32 s34, 459776
buffer_load_dwordx4 v191, s[8:11], s34 offen offset:3072 nt lds
v_mfma_f32_16x16x32_bf16 v[116:119], a[220:223], v[160:163], v[116:119]
ds_read_b128 a[212:215], v178 offset:8192
v_mfma_f32_16x16x32_bf16 v[124:127], a[220:223], v[164:167], v[124:127]
s_cbranch_vccz L_nors28
s_call_b64 s[82:83], L_rescale
L_nors28:
s_waitcnt lgkmcnt(4)
v_mfma_f32_16x16x32_bf16 v[144:147], a[192:195], a[128:131], v[168:171]
ds_read_b128 a[216:219], v179 offset:0
v_exp_f32 v128, v128
v_mfma_f32_16x16x32_bf16 v[152:155], a[192:195], a[132:135], v[172:175]
v_exp_f32 v129, v129
v_mfma_f32_16x16x32_bf16 v[148:151], a[196:199], a[128:131], v[168:171]
ds_read_b128 a[220:223], v179 offset:8192
v_exp_f32 v130, v130
v_mfma_f32_16x16x32_bf16 v[156:159], a[196:199], a[132:135], v[172:175]
v_cvt_pk_bf16_f32 v160, v128, v129
s_waitcnt lgkmcnt(4)
v_mfma_f32_16x16x32_bf16 v[144:147], a[200:203], a[136:139], v[144:147]
ds_read_b128 a[192:195], v176 offset:256
v_mfma_f32_16x16x32_bf16 v[152:155], a[200:203], a[140:143], v[152:155]
v_exp_f32 v131, v131
v_mfma_f32_16x16x32_bf16 v[148:151], a[204:207], a[136:139], v[148:151]
ds_read_b128 a[196:199], v176 offset:8448
v_exp_f32 v132, v132
v_mfma_f32_16x16x32_bf16 v[156:159], a[204:207], a[140:143], v[156:159]
v_cvt_pk_bf16_f32 v161, v130, v131
s_waitcnt vmcnt(4)
s_add_u32 m0, s33, 16384
s_mov_b32 s34, 459776
buffer_load_dwordx4 v192, s[12:15], s34 offen offset:0 nt lds
s_waitcnt lgkmcnt(4)
v_mfma_f32_16x16x32_bf16 v[144:147], a[208:211], a[144:147], v[144:147]
ds_read_b128 a[200:203], v177 offset:256
v_mfma_f32_16x16x32_bf16 v[152:155], a[208:211], a[148:151], v[152:155]
v_exp_f32 v133, v133
v_mfma_f32_16x16x32_bf16 v[148:151], a[212:215], a[144:147], v[148:151]
ds_read_b128 a[204:207], v177 offset:8448
v_exp_f32 v134, v134
v_mfma_f32_16x16x32_bf16 v[156:159], a[212:215], a[148:151], v[156:159]
v_cvt_pk_bf16_f32 v162, v132, v133
s_waitcnt lgkmcnt(4)
v_mfma_f32_16x16x32_bf16 v[144:147], a[216:219], a[152:155], v[144:147]
ds_read_b128 a[208:211], v178 offset:256
v_mfma_f32_16x16x32_bf16 v[152:155], a[216:219], a[156:159], v[152:155]
v_exp_f32 v135, v135
v_mfma_f32_16x16x32_bf16 v[148:151], a[220:223], a[152:155], v[148:151]
ds_read_b128 a[212:215], v178 offset:8448
v_exp_f32 v136, v136
v_mfma_f32_16x16x32_bf16 v[156:159], a[220:223], a[156:159], v[156:159]
v_cvt_pk_bf16_f32 v163, v134, v135
s_waitcnt vmcnt(4)
s_mov_b32 s34, 458752
buffer_load_dwordx4 v193, s[12:15], s34 offen offset:1024 nt lds
s_waitcnt lgkmcnt(4)
v_mfma_f32_16x16x32_bf16 v[144:147], a[192:195], a[160:163], v[144:147]
ds_read_b128 a[216:219], v179 offset:256
v_mfma_f32_16x16x32_bf16 v[152:155], a[192:195], a[164:167], v[152:155]
v_exp_f32 v137, v137
v_mfma_f32_16x16x32_bf16 v[148:151], a[196:199], a[160:163], v[148:151]
ds_read_b128 a[220:223], v179 offset:8448
v_exp_f32 v138, v138
v_mfma_f32_16x16x32_bf16 v[156:159], a[196:199], a[164:167], v[156:159]
v_cvt_pk_bf16_f32 v164, v136, v137
s_waitcnt lgkmcnt(4)
v_mfma_f32_16x16x32_bf16 v[144:147], a[200:203], a[168:171], v[144:147]
s_waitcnt lgkmcnt(0)
s_barrier
ds_read_b64_tr_b16 a[192:193], v180 offset:32768
v_exp_f32 v139, v139
v_mfma_f32_16x16x32_bf16 v[152:155], a[200:203], a[172:175], v[152:155]
ds_read_b64_tr_b16 a[194:195], v180 offset:40960
v_mfma_f32_16x16x32_bf16 v[148:151], a[204:207], a[168:171], v[148:151]
ds_read_b64_tr_b16 a[196:197], v181 offset:32768
v_exp_f32 v140, v140
v_mfma_f32_16x16x32_bf16 v[156:159], a[204:207], a[172:175], v[156:159]
ds_read_b64_tr_b16 a[198:199], v181 offset:40960
v_cvt_pk_bf16_f32 v165, v138, v139
s_waitcnt lgkmcnt(6)
v_mfma_f32_16x16x32_bf16 v[144:147], a[208:211], a[176:179], v[144:147]
ds_read_b64_tr_b16 a[200:201], v182 offset:32768
v_exp_f32 v141, v141
v_mfma_f32_16x16x32_bf16 v[152:155], a[208:211], a[180:183], v[152:155]
ds_read_b64_tr_b16 a[202:203], v182 offset:40960
s_waitcnt vmcnt(4)
s_mov_b32 s34, 461824
buffer_load_dwordx4 v194, s[12:15], s34 offen offset:2048 nt lds
v_mfma_f32_16x16x32_bf16 v[148:151], a[212:215], a[176:179], v[148:151]
ds_read_b64_tr_b16 a[204:205], v183 offset:32768
v_exp_f32 v142, v142
v_mfma_f32_16x16x32_bf16 v[156:159], a[212:215], a[180:183], v[156:159]
ds_read_b64_tr_b16 a[206:207], v183 offset:40960
v_cvt_pk_bf16_f32 v166, v140, v141
s_waitcnt lgkmcnt(8)
v_mfma_f32_16x16x32_bf16 v[144:147], a[216:219], a[184:187], v[144:147]
ds_read_b64_tr_b16 a[208:209], v184 offset:32768
v_exp_f32 v143, v143
v_mfma_f32_16x16x32_bf16 v[152:155], a[216:219], a[188:191], v[152:155]
ds_read_b64_tr_b16 a[210:211], v184 offset:40960
v_mfma_f32_16x16x32_bf16 v[148:151], a[220:223], a[184:187], v[148:151]
ds_read_b64_tr_b16 a[212:213], v185 offset:32768
v_cvt_pk_bf16_f32 v167, v142, v143
v_mfma_f32_16x16x32_bf16 v[156:159], a[220:223], a[188:191], v[156:159]
ds_read_b64_tr_b16 a[214:215], v185 offset:40960
s_nop 0
s_waitcnt lgkmcnt(8)
v_mfma_f32_16x16x32_bf16 v[0:3], a[192:195], v[160:163], v[0:3]
ds_read_b64_tr_b16 a[216:217], v186 offset:32768
v_mfma_f32_16x16x32_bf16 v[8:11], a[192:195], v[164:167], v[8:11]
ds_read_b64_tr_b16 a[218:219], v186 offset:40960
s_waitcnt vmcnt(4)
s_mov_b32 s34, 460800
buffer_load_dwordx4 v195, s[12:15], s34 offen offset:3072 nt lds
v_mfma_f32_16x16x32_bf16 a[224:227], a[232:235], v[160:163], a[224:227]
v_mfma_f32_16x16x32_bf16 v[4:7], a[196:199], v[160:163], v[4:7]
ds_read_b64_tr_b16 a[220:221], v187 offset:32768
v_mfma_f32_16x16x32_bf16 v[12:15], a[196:199], v[164:167], v[12:15]
ds_read_b64_tr_b16 a[222:223], v187 offset:40960
v_mfma_f32_16x16x32_bf16 a[228:231], a[232:235], v[164:167], a[228:231]
s_waitcnt lgkmcnt(8)
v_mfma_f32_16x16x32_bf16 v[16:19], a[200:203], v[160:163], v[16:19]
ds_read_b64_tr_b16 a[192:193], v180 offset:33024
v_mfma_f32_16x16x32_bf16 v[24:27], a[200:203], v[164:167], v[24:27]
ds_read_b64_tr_b16 a[194:195], v180 offset:41216
v_mfma_f32_16x16x32_bf16 v[20:23], a[204:207], v[160:163], v[20:23]
ds_read_b64_tr_b16 a[196:197], v181 offset:33024
v_mfma_f32_16x16x32_bf16 v[28:31], a[204:207], v[164:167], v[28:31]
ds_read_b64_tr_b16 a[198:199], v181 offset:41216
s_waitcnt lgkmcnt(8)
v_mfma_f32_16x16x32_bf16 v[32:35], a[208:211], v[160:163], v[32:35]
ds_read_b64_tr_b16 a[200:201], v182 offset:33024
v_max3_f32 v208, v144, v145, v146
v_mfma_f32_16x16x32_bf16 v[40:43], a[208:211], v[164:167], v[40:43]
ds_read_b64_tr_b16 a[202:203], v182 offset:41216
v_mfma_f32_16x16x32_bf16 v[36:39], a[212:215], v[160:163], v[36:39]
ds_read_b64_tr_b16 a[204:205], v183 offset:33024
v_max3_f32 v209, v152, v153, v154
v_mfma_f32_16x16x32_bf16 v[44:47], a[212:215], v[164:167], v[44:47]
ds_read_b64_tr_b16 a[206:207], v183 offset:41216
s_waitcnt vmcnt(4)
s_add_u32 m0, s33, 0
s_mov_b32 s34, 461824
buffer_load_dwordx4 v188, s[8:11], s34 offen offset:0 nt lds
s_waitcnt lgkmcnt(8)
v_mfma_f32_16x16x32_bf16 v[48:51], a[216:219], v[160:163], v[48:51]
ds_read_b64_tr_b16 a[208:209], v184 offset:33024
v_max3_f32 v208, v208, v147, v148
v_mfma_f32_16x16x32_bf16 v[56:59], a[216:219], v[164:167], v[56:59]
ds_read_b64_tr_b16 a[210:211], v184 offset:41216
v_mfma_f32_16x16x32_bf16 v[52:55], a[220:223], v[160:163], v[52:55]
ds_read_b64_tr_b16 a[212:213], v185 offset:33024
v_max3_f32 v209, v209, v155, v156
v_mfma_f32_16x16x32_bf16 v[60:63], a[220:223], v[164:167], v[60:63]
ds_read_b64_tr_b16 a[214:215], v185 offset:41216
s_waitcnt lgkmcnt(8)
v_mfma_f32_16x16x32_bf16 v[64:67], a[192:195], v[160:163], v[64:67]
ds_read_b64_tr_b16 a[216:217], v186 offset:33024
v_max3_f32 v208, v208, v149, v150
v_mfma_f32_16x16x32_bf16 v[72:75], a[192:195], v[164:167], v[72:75]
ds_read_b64_tr_b16 a[218:219], v186 offset:41216
v_mfma_f32_16x16x32_bf16 v[68:71], a[196:199], v[160:163], v[68:71]
ds_read_b64_tr_b16 a[220:221], v187 offset:33024
v_max3_f32 v209, v209, v157, v158
v_mfma_f32_16x16x32_bf16 v[76:79], a[196:199], v[164:167], v[76:79]
ds_read_b64_tr_b16 a[222:223], v187 offset:41216
s_waitcnt vmcnt(4)
s_mov_b32 s34, 460800
buffer_load_dwordx4 v189, s[8:11], s34 offen offset:1024 nt lds
s_waitcnt lgkmcnt(8)
v_mfma_f32_16x16x32_bf16 v[80:83], a[200:203], v[160:163], v[80:83]
s_waitcnt lgkmcnt(0)
s_barrier
ds_read_b128 a[192:195], v176 offset:49152
v_mfma_f32_16x16x32_bf16 v[88:91], a[200:203], v[164:167], v[88:91]
v_max_f32 v208, v208, v151
v_mfma_f32_16x16x32_bf16 v[84:87], a[204:207], v[160:163], v[84:87]
ds_read_b128 a[196:199], v176 offset:57344
v_mfma_f32_16x16x32_bf16 v[92:95], a[204:207], v[164:167], v[92:95]
v_max_f32 v209, v209, v159
s_waitcnt lgkmcnt(6)
v_mfma_f32_16x16x32_bf16 v[96:99], a[208:211], v[160:163], v[96:99]
ds_read_b128 a[200:203], v177 offset:49152
v_mfma_f32_16x16x32_bf16 v[104:107], a[208:211], v[164:167], v[104:107]
v_max_f32 v210, v208, v209
v_mfma_f32_16x16x32_bf16 v[100:103], a[212:215], v[160:163], v[100:103]
ds_read_b128 a[204:207], v177 offset:57344
v_mfma_f32_16x16x32_bf16 v[108:111], a[212:215], v[164:167], v[108:111]
v_cmp_lt_f32 vcc, s80, v210
s_waitcnt lgkmcnt(4)
v_mfma_f32_16x16x32_bf16 v[112:115], a[216:219], v[160:163], v[112:115]
ds_read_b128 a[208:211], v178 offset:49152
v_mfma_f32_16x16x32_bf16 v[120:123], a[216:219], v[164:167], v[120:123]
s_waitcnt vmcnt(4)
s_mov_b32 s34, 459776
buffer_load_dwordx4 v190, s[8:11], s34 offen offset:2048 nt lds
v_mfma_f32_16x16x32_bf16 v[116:119], a[220:223], v[160:163], v[116:119]
ds_read_b128 a[212:215], v178 offset:57344
v_mfma_f32_16x16x32_bf16 v[124:127], a[220:223], v[164:167], v[124:127]
s_cbranch_vccz L_nors29
s_call_b64 s[82:83], L_rescale
L_nors29:
s_waitcnt lgkmcnt(4)
v_mfma_f32_16x16x32_bf16 v[128:131], a[192:195], a[128:131], v[168:171]
ds_read_b128 a[216:219], v179 offset:49152
v_exp_f32 v144, v144
v_mfma_f32_16x16x32_bf16 v[136:139], a[192:195], a[132:135], v[172:175]
v_exp_f32 v145, v145
v_mfma_f32_16x16x32_bf16 v[132:135], a[196:199], a[128:131], v[168:171]
ds_read_b128 a[220:223], v179 offset:57344
v_exp_f32 v146, v146
v_mfma_f32_16x16x32_bf16 v[140:143], a[196:199], a[132:135], v[172:175]
v_cvt_pk_bf16_f32 v160, v144, v145
s_waitcnt lgkmcnt(4)
v_mfma_f32_16x16x32_bf16 v[128:131], a[200:203], a[136:139], v[128:131]
ds_read_b128 a[192:195], v176 offset:49408
v_mfma_f32_16x16x32_bf16 v[136:139], a[200:203], a[140:143], v[136:139]
v_exp_f32 v147, v147
s_waitcnt vmcnt(4)
s_mov_b32 s34, 458752
buffer_load_dwordx4 v191, s[8:11], s34 offen offset:3072 nt lds
v_mfma_f32_16x16x32_bf16 v[132:135], a[204:207], a[136:139], v[132:135]
ds_read_b128 a[196:199], v176 offset:57600
v_exp_f32 v148, v148
v_mfma_f32_16x16x32_bf16 v[140:143], a[204:207], a[140:143], v[140:143]
v_cvt_pk_bf16_f32 v161, v146, v147
s_waitcnt lgkmcnt(4)
v_mfma_f32_16x16x32_bf16 v[128:131], a[208:211], a[144:147], v[128:131]
ds_read_b128 a[200:203], v177 offset:49408
v_mfma_f32_16x16x32_bf16 v[136:139], a[208:211], a[148:151], v[136:139]
v_exp_f32 v149, v149
v_mfma_f32_16x16x32_bf16 v[132:135], a[212:215], a[144:147], v[132:135]
ds_read_b128 a[204:207], v177 offset:57600
v_exp_f32 v150, v150
v_mfma_f32_16x16x32_bf16 v[140:143], a[212:215], a[148:151], v[140:143]
v_cvt_pk_bf16_f32 v162, v148, v149
s_waitcnt lgkmcnt(4)
v_mfma_f32_16x16x32_bf16 v[128:131], a[216:219], a[152:155], v[128:131]
ds_read_b128 a[208:211], v178 offset:49408
v_mfma_f32_16x16x32_bf16 v[136:139], a[216:219], a[156:159], v[136:139]
v_exp_f32 v151, v151
v_mfma_f32_16x16x32_bf16 v[132:135], a[220:223], a[152:155], v[132:135]
ds_read_b128 a[212:215], v178 offset:57600
v_exp_f32 v152, v152
v_mfma_f32_16x16x32_bf16 v[140:143], a[220:223], a[156:159], v[140:143]
v_cvt_pk_bf16_f32 v163, v150, v151
s_waitcnt vmcnt(4)
s_add_u32 m0, s33, 32768
s_mov_b32 s34, 460800
buffer_load_dwordx4 v192, s[12:15], s34 offen offset:0 nt lds
s_waitcnt lgkmcnt(4)
v_mfma_f32_16x16x32_bf16 v[128:131], a[192:195], a[160:163], v[128:131]
ds_read_b128 a[216:219], v179 offset:49408
v_mfma_f32_16x16x32_bf16 v[136:139], a[192:195], a[164:167], v[136:139]
v_exp_f32 v153, v153
v_mfma_f32_16x16x32_bf16 v[132:135], a[196:199], a[160:163], v[132:135]
ds_read_b128 a[220:223], v179 offset:57600
v_exp_f32 v154, v154
v_mfma_f32_16x16x32_bf16 v[140:143], a[196:199], a[164:167], v[140:143]
v_cvt_pk_bf16_f32 v164, v152, v153
s_waitcnt lgkmcnt(4)
v_mfma_f32_16x16x32_bf16 v[128:131], a[200:203], a[168:171], v[128:131]
s_waitcnt lgkmcnt(0)
s_barrier
ds_read_b64_tr_b16 a[192:193], v180 offset:16384
v_exp_f32 v155, v155
v_mfma_f32_16x16x32_bf16 v[136:139], a[200:203], a[172:175], v[136:139]
ds_read_b64_tr_b16 a[194:195], v180 offset:24576
v_mfma_f32_16x16x32_bf16 v[132:135], a[204:207], a[168:171], v[132:135]
ds_read_b64_tr_b16 a[196:197], v181 offset:16384
v_exp_f32 v156, v156
v_mfma_f32_16x16x32_bf16 v[140:143], a[204:207], a[172:175], v[140:143]
ds_read_b64_tr_b16 a[198:199], v181 offset:24576
v_cvt_pk_bf16_f32 v165, v154, v155
s_waitcnt vmcnt(4)
s_mov_b32 s34, 461824
buffer_load_dwordx4 v193, s[12:15], s34 offen offset:1024 nt lds
s_waitcnt lgkmcnt(6)
v_mfma_f32_16x16x32_bf16 v[128:131], a[208:211], a[176:179], v[128:131]
ds_read_b64_tr_b16 a[200:201], v182 offset:16384
v_exp_f32 v157, v157
v_mfma_f32_16x16x32_bf16 v[136:139], a[208:211], a[180:183], v[136:139]
ds_read_b64_tr_b16 a[202:203], v182 offset:24576
v_mfma_f32_16x16x32_bf16 v[132:135], a[212:215], a[176:179], v[132:135]
ds_read_b64_tr_b16 a[204:205], v183 offset:16384
v_exp_f32 v158, v158
v_mfma_f32_16x16x32_bf16 v[140:143], a[212:215], a[180:183], v[140:143]
ds_read_b64_tr_b16 a[206:207], v183 offset:24576
v_cvt_pk_bf16_f32 v166, v156, v157
s_waitcnt lgkmcnt(8)
v_mfma_f32_16x16x32_bf16 v[128:131], a[216:219], a[184:187], v[128:131]
ds_read_b64_tr_b16 a[208:209], v184 offset:16384
v_exp_f32 v159, v159
v_mfma_f32_16x16x32_bf16 v[136:139], a[216:219], a[188:191], v[136:139]
ds_read_b64_tr_b16 a[210:211], v184 offset:24576
v_mfma_f32_16x16x32_bf16 v[132:135], a[220:223], a[184:187], v[132:135]
ds_read_b64_tr_b16 a[212:213], v185 offset:16384
v_cvt_pk_bf16_f32 v167, v158, v159
v_mfma_f32_16x16x32_bf16 v[140:143], a[220:223], a[188:191], v[140:143]
ds_read_b64_tr_b16 a[214:215], v185 offset:24576
s_nop 0
s_waitcnt lgkmcnt(8)
v_mfma_f32_16x16x32_bf16 v[0:3], a[192:195], v[160:163], v[0:3]
ds_read_b64_tr_b16 a[216:217], v186 offset:16384
v_mfma_f32_16x16x32_bf16 v[8:11], a[192:195], v[164:167], v[8:11]
ds_read_b64_tr_b16 a[218:219], v186 offset:24576
s_waitcnt vmcnt(4)
s_mov_b32 s34, 458752
buffer_load_dwordx4 v194, s[12:15], s34 offen offset:2048 nt lds
v_mfma_f32_16x16x32_bf16 a[224:227], a[232:235], v[160:163], a[224:227]
v_mfma_f32_16x16x32_bf16 v[4:7], a[196:199], v[160:163], v[4:7]
ds_read_b64_tr_b16 a[220:221], v187 offset:16384
v_mfma_f32_16x16x32_bf16 v[12:15], a[196:199], v[164:167], v[12:15]
ds_read_b64_tr_b16 a[222:223], v187 offset:24576
v_mfma_f32_16x16x32_bf16 a[228:231], a[232:235], v[164:167], a[228:231]
s_waitcnt lgkmcnt(8)
v_mfma_f32_16x16x32_bf16 v[16:19], a[200:203], v[160:163], v[16:19]
ds_read_b64_tr_b16 a[192:193], v180 offset:16640
v_mfma_f32_16x16x32_bf16 v[24:27], a[200:203], v[164:167], v[24:27]
ds_read_b64_tr_b16 a[194:195], v180 offset:24832
v_mfma_f32_16x16x32_bf16 v[20:23], a[204:207], v[160:163], v[20:23]
ds_read_b64_tr_b16 a[196:197], v181 offset:16640
v_mfma_f32_16x16x32_bf16 v[28:31], a[204:207], v[164:167], v[28:31]
ds_read_b64_tr_b16 a[198:199], v181 offset:24832
s_waitcnt lgkmcnt(8)
v_mfma_f32_16x16x32_bf16 v[32:35], a[208:211], v[160:163], v[32:35]
ds_read_b64_tr_b16 a[200:201], v182 offset:16640
v_max3_f32 v208, v128, v129, v130
v_mfma_f32_16x16x32_bf16 v[40:43], a[208:211], v[164:167], v[40:43]
ds_read_b64_tr_b16 a[202:203], v182 offset:24832
s_waitcnt vmcnt(4)
s_mov_b32 s34, 459776
buffer_load_dwordx4 v195, s[12:15], s34 offen offset:3072 nt lds
v_mfma_f32_16x16x32_bf16 v[36:39], a[212:215], v[160:163], v[36:39]
ds_read_b64_tr_b16 a[204:205], v183 offset:16640
v_max3_f32 v209, v136, v137, v138
v_mfma_f32_16x16x32_bf16 v[44:47], a[212:215], v[164:167], v[44:47]
ds_read_b64_tr_b16 a[206:207], v183 offset:24832
s_waitcnt lgkmcnt(8)
v_mfma_f32_16x16x32_bf16 v[48:51], a[216:219], v[160:163], v[48:51]
ds_read_b64_tr_b16 a[208:209], v184 offset:16640
v_max3_f32 v208, v208, v131, v132
v_mfma_f32_16x16x32_bf16 v[56:59], a[216:219], v[164:167], v[56:59]
ds_read_b64_tr_b16 a[210:211], v184 offset:24832
v_mfma_f32_16x16x32_bf16 v[52:55], a[220:223], v[160:163], v[52:55]
ds_read_b64_tr_b16 a[212:213], v185 offset:16640
v_max3_f32 v209, v209, v139, v140
v_mfma_f32_16x16x32_bf16 v[60:63], a[220:223], v[164:167], v[60:63]
ds_read_b64_tr_b16 a[214:215], v185 offset:24832
s_waitcnt lgkmcnt(8)
v_mfma_f32_16x16x32_bf16 v[64:67], a[192:195], v[160:163], v[64:67]
ds_read_b64_tr_b16 a[216:217], v186 offset:16640
v_max3_f32 v208, v208, v133, v134
v_mfma_f32_16x16x32_bf16 v[72:75], a[192:195], v[164:167], v[72:75]
ds_read_b64_tr_b16 a[218:219], v186 offset:24832
v_mfma_f32_16x16x32_bf16 v[68:71], a[196:199], v[160:163], v[68:71]
ds_read_b64_tr_b16 a[220:221], v187 offset:16640
v_max3_f32 v209, v209, v141, v142
v_mfma_f32_16x16x32_bf16 v[76:79], a[196:199], v[164:167], v[76:79]
ds_read_b64_tr_b16 a[222:223], v187 offset:24832
s_waitcnt vmcnt(4)
s_add_u32 m0, s33, 65536
s_mov_b32 s34, 461824
buffer_load_dwordx4 v192, s[12:15], s34 offen offset:0 nt lds
s_waitcnt lgkmcnt(8)
v_mfma_f32_16x16x32_bf16 v[80:83], a[200:203], v[160:163], v[80:83]
s_waitcnt lgkmcnt(0)
s_barrier
ds_read_b128 a[192:195], v176 offset:0
v_mfma_f32_16x16x32_bf16 v[88:91], a[200:203], v[164:167], v[88:91]
v_max_f32 v208, v208, v135
v_mfma_f32_16x16x32_bf16 v[84:87], a[204:207], v[160:163], v[84:87]
ds_read_b128 a[196:199], v176 offset:8192
v_mfma_f32_16x16x32_bf16 v[92:95], a[204:207], v[164:167], v[92:95]
v_max_f32 v209, v209, v143
s_waitcnt lgkmcnt(6)
v_mfma_f32_16x16x32_bf16 v[96:99], a[208:211], v[160:163], v[96:99]
ds_read_b128 a[200:203], v177 offset:0
v_mfma_f32_16x16x32_bf16 v[104:107], a[208:211], v[164:167], v[104:107]
v_max_f32 v210, v208, v209
v_mfma_f32_16x16x32_bf16 v[100:103], a[212:215], v[160:163], v[100:103]
ds_read_b128 a[204:207], v177 offset:8192
v_mfma_f32_16x16x32_bf16 v[108:111], a[212:215], v[164:167], v[108:111]
v_cmp_lt_f32 vcc, s80, v210
s_waitcnt vmcnt(4)
s_mov_b32 s34, 460800
buffer_load_dwordx4 v193, s[12:15], s34 offen offset:1024 nt lds
s_waitcnt lgkmcnt(4)
v_mfma_f32_16x16x32_bf16 v[112:115], a[216:219], v[160:163], v[112:115]
ds_read_b128 a[208:211], v178 offset:0
v_mfma_f32_16x16x32_bf16 v[120:123], a[216:219], v[164:167], v[120:123]
v_mfma_f32_16x16x32_bf16 v[116:119], a[220:223], v[160:163], v[116:119]
ds_read_b128 a[212:215], v178 offset:8192
v_mfma_f32_16x16x32_bf16 v[124:127], a[220:223], v[164:167], v[124:127]
s_cbranch_vccz L_nors30
s_call_b64 s[82:83], L_rescale
L_nors30:
s_waitcnt lgkmcnt(4)
v_mfma_f32_16x16x32_bf16 v[144:147], a[192:195], a[128:131], v[168:171]
ds_read_b128 a[216:219], v179 offset:0
v_exp_f32 v128, v128
v_mfma_f32_16x16x32_bf16 v[152:155], a[192:195], a[132:135], v[172:175]
v_exp_f32 v129, v129
v_mfma_f32_16x16x32_bf16 v[148:151], a[196:199], a[128:131], v[168:171]
ds_read_b128 a[220:223], v179 offset:8192
v_exp_f32 v130, v130
v_mfma_f32_16x16x32_bf16 v[156:159], a[196:199], a[132:135], v[172:175]
v_cvt_pk_bf16_f32 v160, v128, v129
s_waitcnt lgkmcnt(4)
v_mfma_f32_16x16x32_bf16 v[144:147], a[200:203], a[136:139], v[144:147]
ds_read_b128 a[192:195], v176 offset:256
v_mfma_f32_16x16x32_bf16 v[152:155], a[200:203], a[140:143], v[152:155]
v_exp_f32 v131, v131
s_waitcnt vmcnt(4)
s_mov_b32 s34, 459776
buffer_load_dwordx4 v194, s[12:15], s34 offen offset:2048 nt lds
v_mfma_f32_16x16x32_bf16 v[148:151], a[204:207], a[136:139], v[148:151]
ds_read_b128 a[196:199], v176 offset:8448
v_exp_f32 v132, v132
v_mfma_f32_16x16x32_bf16 v[156:159], a[204:207], a[140:143], v[156:159]
v_cvt_pk_bf16_f32 v161, v130, v131
s_waitcnt lgkmcnt(4)
v_mfma_f32_16x16x32_bf16 v[144:147], a[208:211], a[144:147], v[144:147]
ds_read_b128 a[200:203], v177 offset:256
v_mfma_f32_16x16x32_bf16 v[152:155], a[208:211], a[148:151], v[152:155]
v_exp_f32 v133, v133
v_mfma_f32_16x16x32_bf16 v[148:151], a[212:215], a[144:147], v[148:151]
ds_read_b128 a[204:207], v177 offset:8448
v_exp_f32 v134, v134
v_mfma_f32_16x16x32_bf16 v[156:159], a[212:215], a[148:151], v[156:159]
v_cvt_pk_bf16_f32 v162, v132, v133
s_waitcnt lgkmcnt(4)
v_mfma_f32_16x16x32_bf16 v[144:147], a[216:219], a[152:155], v[144:147]
ds_read_b128 a[208:211], v178 offset:256
v_mfma_f32_16x16x32_bf16 v[152:155], a[216:219], a[156:159], v[152:155]
v_exp_f32 v135, v135
s_waitcnt vmcnt(4)
s_mov_b32 s34, 458752
buffer_load_dwordx4 v195, s[12:15], s34 offen offset:3072 nt lds
v_mfma_f32_16x16x32_bf16 v[148:151], a[220:223], a[152:155], v[148:151]
ds_read_b128 a[212:215], v178 offset:8448
v_exp_f32 v136, v136
v_mfma_f32_16x16x32_bf16 v[156:159], a[220:223], a[156:159], v[156:159]
v_cvt_pk_bf16_f32 v163, v134, v135
s_waitcnt lgkmcnt(4)
v_mfma_f32_16x16x32_bf16 v[144:147], a[192:195], a[160:163], v[144:147]
ds_read_b128 a[216:219], v179 offset:256
v_mfma_f32_16x16x32_bf16 v[152:155], a[192:195], a[164:167], v[152:155]
v_exp_f32 v137, v137
v_mfma_f32_16x16x32_bf16 v[148:151], a[196:199], a[160:163], v[148:151]
ds_read_b128 a[220:223], v179 offset:8448
v_exp_f32 v138, v138
v_mfma_f32_16x16x32_bf16 v[156:159], a[196:199], a[164:167], v[156:159]
v_cvt_pk_bf16_f32 v164, v136, v137
s_waitcnt lgkmcnt(4)
v_mfma_f32_16x16x32_bf16 v[144:147], a[200:203], a[168:171], v[144:147]
s_waitcnt vmcnt(4)
s_waitcnt lgkmcnt(0)
s_barrier
ds_read_b64_tr_b16 a[192:193], v180 offset:32768
v_exp_f32 v139, v139
v_mfma_f32_16x16x32_bf16 v[152:155], a[200:203], a[172:175], v[152:155]
ds_read_b64_tr_b16 a[194:195], v180 offset:40960
v_mfma_f32_16x16x32_bf16 v[148:151], a[204:207], a[168:171], v[148:151]
ds_read_b64_tr_b16 a[196:197], v181 offset:32768
v_exp_f32 v140, v140
v_mfma_f32_16x16x32_bf16 v[156:159], a[204:207], a[172:175], v[156:159]
ds_read_b64_tr_b16 a[198:199], v181 offset:40960
v_cvt_pk_bf16_f32 v165, v138, v139
s_waitcnt lgkmcnt(6)
v_mfma_f32_16x16x32_bf16 v[144:147], a[208:211], a[176:179], v[144:147]
ds_read_b64_tr_b16 a[200:201], v182 offset:32768
v_exp_f32 v141, v141
v_mfma_f32_16x16x32_bf16 v[152:155], a[208:211], a[180:183], v[152:155]
ds_read_b64_tr_b16 a[202:203], v182 offset:40960
v_mfma_f32_16x16x32_bf16 v[148:151], a[212:215], a[176:179], v[148:151]
ds_read_b64_tr_b16 a[204:205], v183 offset:32768
v_exp_f32 v142, v142
v_mfma_f32_16x16x32_bf16 v[156:159], a[212:215], a[180:183], v[156:159]
ds_read_b64_tr_b16 a[206:207], v183 offset:40960
v_cvt_pk_bf16_f32 v166, v140, v141
s_waitcnt lgkmcnt(8)
v_mfma_f32_16x16x32_bf16 v[144:147], a[216:219], a[184:187], v[144:147]
ds_read_b64_tr_b16 a[208:209], v184 offset:32768
v_exp_f32 v143, v143
v_mfma_f32_16x16x32_bf16 v[152:155], a[216:219], a[188:191], v[152:155]
ds_read_b64_tr_b16 a[210:211], v184 offset:40960
v_mfma_f32_16x16x32_bf16 v[148:151], a[220:223], a[184:187], v[148:151]
ds_read_b64_tr_b16 a[212:213], v185 offset:32768
v_cvt_pk_bf16_f32 v167, v142, v143
v_mfma_f32_16x16x32_bf16 v[156:159], a[220:223], a[188:191], v[156:159]
ds_read_b64_tr_b16 a[214:215], v185 offset:40960
s_nop 0
s_waitcnt lgkmcnt(8)
v_mfma_f32_16x16x32_bf16 v[0:3], a[192:195], v[160:163], v[0:3]
ds_read_b64_tr_b16 a[216:217], v186 offset:32768
v_mfma_f32_16x16x32_bf16 v[8:11], a[192:195], v[164:167], v[8:11]
ds_read_b64_tr_b16 a[218:219], v186 offset:40960
v_mfma_f32_16x16x32_bf16 a[224:227], a[232:235], v[160:163], a[224:227]
v_mfma_f32_16x16x32_bf16 v[4:7], a[196:199], v[160:163], v[4:7]
ds_read_b64_tr_b16 a[220:221], v187 offset:32768
v_mfma_f32_16x16x32_bf16 v[12:15], a[196:199], v[164:167], v[12:15]
ds_read_b64_tr_b16 a[222:223], v187 offset:40960
v_mfma_f32_16x16x32_bf16 a[228:231], a[232:235], v[164:167], a[228:231]
s_waitcnt lgkmcnt(8)
v_mfma_f32_16x16x32_bf16 v[16:19], a[200:203], v[160:163], v[16:19]
ds_read_b64_tr_b16 a[192:193], v180 offset:33024
v_mfma_f32_16x16x32_bf16 v[24:27], a[200:203], v[164:167], v[24:27]
ds_read_b64_tr_b16 a[194:195], v180 offset:41216
v_mfma_f32_16x16x32_bf16 v[20:23], a[204:207], v[160:163], v[20:23]
ds_read_b64_tr_b16 a[196:197], v181 offset:33024
v_mfma_f32_16x16x32_bf16 v[28:31], a[204:207], v[164:167], v[28:31]
ds_read_b64_tr_b16 a[198:199], v181 offset:41216
s_waitcnt lgkmcnt(8)
v_mfma_f32_16x16x32_bf16 v[32:35], a[208:211], v[160:163], v[32:35]
ds_read_b64_tr_b16 a[200:201], v182 offset:33024
v_max3_f32 v208, v144, v145, v146
v_mfma_f32_16x16x32_bf16 v[40:43], a[208:211], v[164:167], v[40:43]
ds_read_b64_tr_b16 a[202:203], v182 offset:41216
v_mfma_f32_16x16x32_bf16 v[36:39], a[212:215], v[160:163], v[36:39]
ds_read_b64_tr_b16 a[204:205], v183 offset:33024
v_max3_f32 v209, v152, v153, v154
v_mfma_f32_16x16x32_bf16 v[44:47], a[212:215], v[164:167], v[44:47]
ds_read_b64_tr_b16 a[206:207], v183 offset:41216
s_waitcnt lgkmcnt(8)
v_mfma_f32_16x16x32_bf16 v[48:51], a[216:219], v[160:163], v[48:51]
ds_read_b64_tr_b16 a[208:209], v184 offset:33024
v_max3_f32 v208, v208, v147, v148
v_mfma_f32_16x16x32_bf16 v[56:59], a[216:219], v[164:167], v[56:59]
ds_read_b64_tr_b16 a[210:211], v184 offset:41216
v_mfma_f32_16x16x32_bf16 v[52:55], a[220:223], v[160:163], v[52:55]
ds_read_b64_tr_b16 a[212:213], v185 offset:33024
v_max3_f32 v209, v209, v155, v156
v_mfma_f32_16x16x32_bf16 v[60:63], a[220:223], v[164:167], v[60:63]
ds_read_b64_tr_b16 a[214:215], v185 offset:41216
s_waitcnt lgkmcnt(8)
v_mfma_f32_16x16x32_bf16 v[64:67], a[192:195], v[160:163], v[64:67]
ds_read_b64_tr_b16 a[216:217], v186 offset:33024
v_max3_f32 v208, v208, v149, v150
v_mfma_f32_16x16x32_bf16 v[72:75], a[192:195], v[164:167], v[72:75]
ds_read_b64_tr_b16 a[218:219], v186 offset:41216
v_mfma_f32_16x16x32_bf16 v[68:71], a[196:199], v[160:163], v[68:71]
ds_read_b64_tr_b16 a[220:221], v187 offset:33024
v_max3_f32 v209, v209, v157, v158
v_mfma_f32_16x16x32_bf16 v[76:79], a[196:199], v[164:167], v[76:79]
ds_read_b64_tr_b16 a[222:223], v187 offset:41216
s_waitcnt lgkmcnt(8)
v_mfma_f32_16x16x32_bf16 v[80:83], a[200:203], v[160:163], v[80:83]
v_max_f32 v208, v208, v151
v_mfma_f32_16x16x32_bf16 v[88:91], a[200:203], v[164:167], v[88:91]
v_mfma_f32_16x16x32_bf16 v[84:87], a[204:207], v[160:163], v[84:87]
v_max_f32 v209, v209, v159
v_mfma_f32_16x16x32_bf16 v[92:95], a[204:207], v[164:167], v[92:95]
s_waitcnt lgkmcnt(4)
v_mfma_f32_16x16x32_bf16 v[96:99], a[208:211], v[160:163], v[96:99]
v_max_f32 v210, v208, v209
v_mfma_f32_16x16x32_bf16 v[104:107], a[208:211], v[164:167], v[104:107]
v_mfma_f32_16x16x32_bf16 v[100:103], a[212:215], v[160:163], v[100:103]
v_cmp_lt_f32 vcc, s80, v210
v_mfma_f32_16x16x32_bf16 v[108:111], a[212:215], v[164:167], v[108:111]
s_waitcnt lgkmcnt(0)
v_mfma_f32_16x16x32_bf16 v[112:115], a[216:219], v[160:163], v[112:115]
v_mfma_f32_16x16x32_bf16 v[120:123], a[216:219], v[164:167], v[120:123]
v_mfma_f32_16x16x32_bf16 v[116:119], a[220:223], v[160:163], v[116:119]
v_mfma_f32_16x16x32_bf16 v[124:127], a[220:223], v[164:167], v[124:127]
s_cbranch_vccz L_nors31
s_call_b64 s[82:83], L_rescale
L_nors31:
v_exp_f32 v144, v144
v_exp_f32 v145, v145
v_exp_f32 v146, v146
v_cvt_pk_bf16_f32 v160, v144, v145
v_exp_f32 v147, v147
v_exp_f32 v148, v148
v_cvt_pk_bf16_f32 v161, v146, v147
v_exp_f32 v149, v149
v_exp_f32 v150, v150
v_cvt_pk_bf16_f32 v162, v148, v149
v_exp_f32 v151, v151
v_exp_f32 v152, v152
v_cvt_pk_bf16_f32 v163, v150, v151
v_exp_f32 v153, v153
v_exp_f32 v154, v154
v_cvt_pk_bf16_f32 v164, v152, v153
v_exp_f32 v155, v155
v_exp_f32 v156, v156
v_cvt_pk_bf16_f32 v165, v154, v155
v_exp_f32 v157, v157
v_exp_f32 v158, v158
v_cvt_pk_bf16_f32 v166, v156, v157
v_exp_f32 v159, v159
s_nop 0
v_cvt_pk_bf16_f32 v167, v158, v159
s_nop 1
v_mfma_f32_16x16x32_bf16 a[224:227], a[232:235], v[160:163], a[224:227]
v_mfma_f32_16x16x32_bf16 a[228:231], a[232:235], v[164:167], a[228:231]
s_nop 7
v_accvgpr_read_b32 v232, a224
v_accvgpr_read_b32 v233, a226
v_accvgpr_read_b32 v234, a228
v_accvgpr_read_b32 v235, a230
v_rcp_f32 v232, v232
v_rcp_f32 v233, v233
v_rcp_f32 v234, v234
v_rcp_f32 v235, v235
s_nop 0
v_pk_mul_f32 v[0:1], v[0:1], v[232:233]
v_pk_mul_f32 v[2:3], v[2:3], v[232:233]
v_pk_mul_f32 v[4:5], v[4:5], v[232:233]
v_pk_mul_f32 v[6:7], v[6:7], v[232:233]
v_pk_mul_f32 v[8:9], v[8:9], v[234:235]
v_pk_mul_f32 v[10:11], v[10:11], v[234:235]
v_pk_mul_f32 v[12:13], v[12:13], v[234:235]
v_pk_mul_f32 v[14:15], v[14:15], v[234:235]
v_pk_mul_f32 v[16:17], v[16:17], v[232:233]
v_pk_mul_f32 v[18:19], v[18:19], v[232:233]
v_pk_mul_f32 v[20:21], v[20:21], v[232:233]
v_pk_mul_f32 v[22:23], v[22:23], v[232:233]
v_pk_mul_f32 v[24:25], v[24:25], v[234:235]
v_pk_mul_f32 v[26:27], v[26:27], v[234:235]
v_pk_mul_f32 v[28:29], v[28:29], v[234:235]
v_pk_mul_f32 v[30:31], v[30:31], v[234:235]
v_pk_mul_f32 v[32:33], v[32:33], v[232:233]
v_pk_mul_f32 v[34:35], v[34:35], v[232:233]
v_pk_mul_f32 v[36:37], v[36:37], v[232:233]
v_pk_mul_f32 v[38:39], v[38:39], v[232:233]
v_pk_mul_f32 v[40:41], v[40:41], v[234:235]
v_pk_mul_f32 v[42:43], v[42:43], v[234:235]
v_pk_mul_f32 v[44:45], v[44:45], v[234:235]
v_pk_mul_f32 v[46:47], v[46:47], v[234:235]
v_pk_mul_f32 v[48:49], v[48:49], v[232:233]
v_pk_mul_f32 v[50:51], v[50:51], v[232:233]
v_pk_mul_f32 v[52:53], v[52:53], v[232:233]
v_pk_mul_f32 v[54:55], v[54:55], v[232:233]
v_pk_mul_f32 v[56:57], v[56:57], v[234:235]
v_pk_mul_f32 v[58:59], v[58:59], v[234:235]
v_pk_mul_f32 v[60:61], v[60:61], v[234:235]
v_pk_mul_f32 v[62:63], v[62:63], v[234:235]
v_pk_mul_f32 v[64:65], v[64:65], v[232:233]
v_pk_mul_f32 v[66:67], v[66:67], v[232:233]
v_pk_mul_f32 v[68:69], v[68:69], v[232:233]
v_pk_mul_f32 v[70:71], v[70:71], v[232:233]
v_pk_mul_f32 v[72:73], v[72:73], v[234:235]
v_pk_mul_f32 v[74:75], v[74:75], v[234:235]
v_pk_mul_f32 v[76:77], v[76:77], v[234:235]
v_pk_mul_f32 v[78:79], v[78:79], v[234:235]
v_pk_mul_f32 v[80:81], v[80:81], v[232:233]
v_pk_mul_f32 v[82:83], v[82:83], v[232:233]
v_pk_mul_f32 v[84:85], v[84:85], v[232:233]
v_pk_mul_f32 v[86:87], v[86:87], v[232:233]
v_pk_mul_f32 v[88:89], v[88:89], v[234:235]
v_pk_mul_f32 v[90:91], v[90:91], v[234:235]
v_pk_mul_f32 v[92:93], v[92:93], v[234:235]
v_pk_mul_f32 v[94:95], v[94:95], v[234:235]
v_pk_mul_f32 v[96:97], v[96:97], v[232:233]
v_pk_mul_f32 v[98:99], v[98:99], v[232:233]
v_pk_mul_f32 v[100:101], v[100:101], v[232:233]
v_pk_mul_f32 v[102:103], v[102:103], v[232:233]
v_pk_mul_f32 v[104:105], v[104:105], v[234:235]
v_pk_mul_f32 v[106:107], v[106:107], v[234:235]
v_pk_mul_f32 v[108:109], v[108:109], v[234:235]
v_pk_mul_f32 v[110:111], v[110:111], v[234:235]
v_pk_mul_f32 v[112:113], v[112:113], v[232:233]
v_pk_mul_f32 v[114:115], v[114:115], v[232:233]
v_pk_mul_f32 v[116:117], v[116:117], v[232:233]
v_pk_mul_f32 v[118:119], v[118:119], v[232:233]
v_pk_mul_f32 v[120:121], v[120:121], v[234:235]
v_pk_mul_f32 v[122:123], v[122:123], v[234:235]
v_pk_mul_f32 v[124:125], v[124:125], v[234:235]
v_pk_mul_f32 v[126:127], v[126:127], v[234:235]
v_pk_mul_f32 v[144:145], v[144:145], v[232:233]
v_pk_mul_f32 v[146:147], v[146:147], v[232:233]
v_pk_mul_f32 v[148:149], v[148:149], v[232:233]
v_pk_mul_f32 v[150:151], v[150:151], v[232:233]
v_pk_mul_f32 v[152:153], v[152:153], v[234:235]
v_pk_mul_f32 v[154:155], v[154:155], v[234:235]
v_pk_mul_f32 v[156:157], v[156:157], v[234:235]
v_pk_mul_f32 v[158:159], v[158:159], v[234:235]
v_cvt_pk_bf16_f32 v160, v144, v145
v_cvt_pk_bf16_f32 v161, v146, v147
v_cvt_pk_bf16_f32 v162, v148, v149
v_cvt_pk_bf16_f32 v163, v150, v151
v_cvt_pk_bf16_f32 v164, v152, v153
v_cvt_pk_bf16_f32 v165, v154, v155
v_cvt_pk_bf16_f32 v166, v156, v157
v_cvt_pk_bf16_f32 v167, v158, v159
v_add_u32 v180, 65536, v180
v_add_u32 v181, 65536, v181
v_add_u32 v182, 65536, v182
v_add_u32 v183, 65536, v183
v_add_u32 v184, 65536, v184
v_add_u32 v185, 65536, v185
v_add_u32 v186, 65536, v186
v_add_u32 v187, 65536, v187
s_waitcnt vmcnt(0)
s_waitcnt lgkmcnt(0)
s_barrier
ds_read_b64_tr_b16 a[192:193], v180 offset:0
ds_read_b64_tr_b16 a[194:195], v180 offset:8192
ds_read_b64_tr_b16 a[196:197], v181 offset:0
ds_read_b64_tr_b16 a[198:199], v181 offset:8192
ds_read_b64_tr_b16 a[200:201], v182 offset:0
ds_read_b64_tr_b16 a[202:203], v182 offset:8192
ds_read_b64_tr_b16 a[204:205], v183 offset:0
ds_read_b64_tr_b16 a[206:207], v183 offset:8192
ds_read_b64_tr_b16 a[208:209], v184 offset:0
ds_read_b64_tr_b16 a[210:211], v184 offset:8192
ds_read_b64_tr_b16 a[212:213], v185 offset:0
ds_read_b64_tr_b16 a[214:215], v185 offset:8192
s_waitcnt lgkmcnt(8)
v_mfma_f32_16x16x32_bf16 v[0:3], a[192:195], v[160:163], v[0:3]
ds_read_b64_tr_b16 a[216:217], v186 offset:0
v_mfma_f32_16x16x32_bf16 v[8:11], a[192:195], v[164:167], v[8:11]
ds_read_b64_tr_b16 a[218:219], v186 offset:8192
v_mfma_f32_16x16x32_bf16 v[4:7], a[196:199], v[160:163], v[4:7]
ds_read_b64_tr_b16 a[220:221], v187 offset:0
v_mfma_f32_16x16x32_bf16 v[12:15], a[196:199], v[164:167], v[12:15]
ds_read_b64_tr_b16 a[222:223], v187 offset:8192
s_waitcnt lgkmcnt(8)
v_mfma_f32_16x16x32_bf16 v[16:19], a[200:203], v[160:163], v[16:19]
ds_read_b64_tr_b16 a[192:193], v180 offset:256
v_mfma_f32_16x16x32_bf16 v[24:27], a[200:203], v[164:167], v[24:27]
ds_read_b64_tr_b16 a[194:195], v180 offset:8448
v_mfma_f32_16x16x32_bf16 v[20:23], a[204:207], v[160:163], v[20:23]
ds_read_b64_tr_b16 a[196:197], v181 offset:256
v_mfma_f32_16x16x32_bf16 v[28:31], a[204:207], v[164:167], v[28:31]
ds_read_b64_tr_b16 a[198:199], v181 offset:8448
s_waitcnt lgkmcnt(8)
v_mfma_f32_16x16x32_bf16 v[32:35], a[208:211], v[160:163], v[32:35]
ds_read_b64_tr_b16 a[200:201], v182 offset:256
v_cvt_pk_bf16_f32 v0, v0, v1
v_cvt_pk_bf16_f32 v1, v2, v3
v_mfma_f32_16x16x32_bf16 v[40:43], a[208:211], v[164:167], v[40:43]
ds_read_b64_tr_b16 a[202:203], v182 offset:8448
v_cvt_pk_bf16_f32 v2, v4, v5
v_cvt_pk_bf16_f32 v3, v6, v7
v_mfma_f32_16x16x32_bf16 v[36:39], a[212:215], v[160:163], v[36:39]
ds_read_b64_tr_b16 a[204:205], v183 offset:256
v_cvt_pk_bf16_f32 v4, v8, v9
v_cvt_pk_bf16_f32 v5, v10, v11
v_mfma_f32_16x16x32_bf16 v[44:47], a[212:215], v[164:167], v[44:47]
ds_read_b64_tr_b16 a[206:207], v183 offset:8448
v_cvt_pk_bf16_f32 v6, v12, v13
v_cvt_pk_bf16_f32 v7, v14, v15
s_waitcnt lgkmcnt(8)
v_mfma_f32_16x16x32_bf16 v[48:51], a[216:219], v[160:163], v[48:51]
ds_read_b64_tr_b16 a[208:209], v184 offset:256
v_cvt_pk_bf16_f32 v8, v16, v17
v_cvt_pk_bf16_f32 v9, v18, v19
v_mfma_f32_16x16x32_bf16 v[56:59], a[216:219], v[164:167], v[56:59]
ds_read_b64_tr_b16 a[210:211], v184 offset:8448
v_cvt_pk_bf16_f32 v10, v20, v21
v_cvt_pk_bf16_f32 v11, v22, v23
v_mfma_f32_16x16x32_bf16 v[52:55], a[220:223], v[160:163], v[52:55]
ds_read_b64_tr_b16 a[212:213], v185 offset:256
v_cvt_pk_bf16_f32 v12, v24, v25
v_cvt_pk_bf16_f32 v13, v26, v27
v_mfma_f32_16x16x32_bf16 v[60:63], a[220:223], v[164:167], v[60:63]
ds_read_b64_tr_b16 a[214:215], v185 offset:8448
v_cvt_pk_bf16_f32 v14, v28, v29
v_cvt_pk_bf16_f32 v15, v30, v31
s_waitcnt lgkmcnt(8)
v_mfma_f32_16x16x32_bf16 v[64:67], a[192:195], v[160:163], v[64:67]
ds_read_b64_tr_b16 a[216:217], v186 offset:256
v_cvt_pk_bf16_f32 v16, v32, v33
v_cvt_pk_bf16_f32 v17, v34, v35
v_mfma_f32_16x16x32_bf16 v[72:75], a[192:195], v[164:167], v[72:75]
ds_read_b64_tr_b16 a[218:219], v186 offset:8448
v_cvt_pk_bf16_f32 v18, v36, v37
v_cvt_pk_bf16_f32 v19, v38, v39
v_mfma_f32_16x16x32_bf16 v[68:71], a[196:199], v[160:163], v[68:71]
ds_read_b64_tr_b16 a[220:221], v187 offset:256
v_cvt_pk_bf16_f32 v20, v40, v41
v_cvt_pk_bf16_f32 v21, v42, v43
v_mfma_f32_16x16x32_bf16 v[76:79], a[196:199], v[164:167], v[76:79]
ds_read_b64_tr_b16 a[222:223], v187 offset:8448
v_cvt_pk_bf16_f32 v22, v44, v45
v_cvt_pk_bf16_f32 v23, v46, v47
s_waitcnt lgkmcnt(8)
v_mfma_f32_16x16x32_bf16 v[80:83], a[200:203], v[160:163], v[80:83]
v_cvt_pk_bf16_f32 v24, v48, v49
v_cvt_pk_bf16_f32 v25, v50, v51
v_mfma_f32_16x16x32_bf16 v[88:91], a[200:203], v[164:167], v[88:91]
v_cvt_pk_bf16_f32 v26, v52, v53
v_cvt_pk_bf16_f32 v27, v54, v55
v_mfma_f32_16x16x32_bf16 v[84:87], a[204:207], v[160:163], v[84:87]
v_cvt_pk_bf16_f32 v28, v56, v57
v_cvt_pk_bf16_f32 v29, v58, v59
v_mfma_f32_16x16x32_bf16 v[92:95], a[204:207], v[164:167], v[92:95]
v_cvt_pk_bf16_f32 v30, v60, v61
v_cvt_pk_bf16_f32 v31, v62, v63
s_waitcnt lgkmcnt(4)
v_mfma_f32_16x16x32_bf16 v[96:99], a[208:211], v[160:163], v[96:99]
ds_read_b64_tr_b16 a[128:129], v200 offset:0
v_cvt_pk_bf16_f32 v32, v64, v65
v_cvt_pk_bf16_f32 v33, v66, v67
v_mfma_f32_16x16x32_bf16 v[104:107], a[208:211], v[164:167], v[104:107]
ds_read_b64_tr_b16 a[130:131], v200 offset:2048
v_cvt_pk_bf16_f32 v34, v68, v69
v_cvt_pk_bf16_f32 v35, v70, v71
v_mfma_f32_16x16x32_bf16 v[100:103], a[212:215], v[160:163], v[100:103]
ds_read_b64_tr_b16 a[132:133], v200 offset:4096
v_cvt_pk_bf16_f32 v36, v72, v73
v_cvt_pk_bf16_f32 v37, v74, v75
v_mfma_f32_16x16x32_bf16 v[108:111], a[212:215], v[164:167], v[108:111]
ds_read_b64_tr_b16 a[134:135], v200 offset:6144
v_cvt_pk_bf16_f32 v38, v76, v77
v_cvt_pk_bf16_f32 v39, v78, v79
s_waitcnt lgkmcnt(4)
v_mfma_f32_16x16x32_bf16 v[112:115], a[216:219], v[160:163], v[112:115]
ds_read_b64_tr_b16 a[136:137], v200 offset:8192
v_cvt_pk_bf16_f32 v40, v80, v81
v_cvt_pk_bf16_f32 v41, v82, v83
v_mfma_f32_16x16x32_bf16 v[120:123], a[216:219], v[164:167], v[120:123]
ds_read_b64_tr_b16 a[138:139], v200 offset:10240
v_cvt_pk_bf16_f32 v42, v84, v85
v_cvt_pk_bf16_f32 v43, v86, v87
v_mfma_f32_16x16x32_bf16 v[116:119], a[220:223], v[160:163], v[116:119]
ds_read_b64_tr_b16 a[140:141], v200 offset:12288
v_cvt_pk_bf16_f32 v44, v88, v89
v_cvt_pk_bf16_f32 v45, v90, v91
v_mfma_f32_16x16x32_bf16 v[124:127], a[220:223], v[164:167], v[124:127]
ds_read_b64_tr_b16 a[142:143], v200 offset:14336
v_cvt_pk_bf16_f32 v46, v92, v93
v_cvt_pk_bf16_f32 v47, v94, v95
v_mfma_f32_16x16x32_bf16 v[160:163], a[0:3], v[0:3], 0
ds_write_b128 v219, v[0:3] offset:0
v_cvt_pk_bf16_f32 v48, v96, v97
v_cvt_pk_bf16_f32 v49, v98, v99
v_mfma_f32_16x16x32_bf16 v[164:167], a[0:3], v[4:7], 0
ds_read_b64_tr_b16 a[144:145], v200 offset:16384
v_cvt_pk_bf16_f32 v50, v100, v101
v_cvt_pk_bf16_f32 v51, v102, v103
v_mfma_f32_16x16x32_bf16 v[160:163], a[4:7], v[8:11], v[160:163]
ds_write_b128 v219, v[4:7] offset:1024
v_cvt_pk_bf16_f32 v52, v104, v105
v_cvt_pk_bf16_f32 v53, v106, v107
v_mfma_f32_16x16x32_bf16 v[164:167], a[4:7], v[12:15], v[164:167]
ds_read_b64_tr_b16 a[146:147], v200 offset:18432
v_cvt_pk_bf16_f32 v54, v108, v109
v_cvt_pk_bf16_f32 v55, v110, v111
s_waitcnt lgkmcnt(8)
v_mfma_f32_16x16x32_bf16 v[160:163], a[8:11], v[16:19], v[160:163]
ds_write_b128 v219, v[8:11] offset:2048
v_cvt_pk_bf16_f32 v56, v112, v113
v_cvt_pk_bf16_f32 v57, v114, v115
v_mfma_f32_16x16x32_bf16 v[164:167], a[8:11], v[20:23], v[164:167]
ds_read_b64_tr_b16 a[148:149], v200 offset:20480
v_cvt_pk_bf16_f32 v58, v116, v117
v_cvt_pk_bf16_f32 v59, v118, v119
v_mfma_f32_16x16x32_bf16 v[160:163], a[12:15], v[24:27], v[160:163]
ds_write_b128 v219, v[12:15] offset:3072
v_cvt_pk_bf16_f32 v60, v120, v121
v_cvt_pk_bf16_f32 v61, v122, v123
v_mfma_f32_16x16x32_bf16 v[164:167], a[12:15], v[28:31], v[164:167]
ds_read_b64_tr_b16 a[150:151], v200 offset:22528
v_cvt_pk_bf16_f32 v62, v124, v125
v_cvt_pk_bf16_f32 v63, v126, v127
s_waitcnt lgkmcnt(8)
v_mfma_f32_16x16x32_bf16 v[160:163], a[16:19], v[32:35], v[160:163]
ds_write_b128 v219, v[16:19] offset:4096
v_mfma_f32_16x16x32_bf16 v[164:167], a[16:19], v[36:39], v[164:167]
ds_read_b64_tr_b16 a[152:153], v200 offset:24576
v_mfma_f32_16x16x32_bf16 v[160:163], a[20:23], v[40:43], v[160:163]
ds_write_b128 v219, v[20:23] offset:5120
v_mfma_f32_16x16x32_bf16 v[164:167], a[20:23], v[44:47], v[164:167]
ds_read_b64_tr_b16 a[154:155], v200 offset:26624
s_waitcnt lgkmcnt(8)
v_mfma_f32_16x16x32_bf16 v[160:163], a[24:27], v[48:51], v[160:163]
ds_write_b128 v219, v[24:27] offset:6144
v_mfma_f32_16x16x32_bf16 v[164:167], a[24:27], v[52:55], v[164:167]
ds_read_b64_tr_b16 a[156:157], v200 offset:28672
v_mfma_f32_16x16x32_bf16 v[160:163], a[28:31], v[56:59], v[160:163]
ds_write_b128 v219, v[28:31] offset:7168
v_mfma_f32_16x16x32_bf16 v[164:167], a[28:31], v[60:63], v[164:167]
ds_read_b64_tr_b16 a[158:159], v200 offset:30720
s_waitcnt lgkmcnt(8)
v_mfma_f32_16x16x32_bf16 v[168:171], a[32:35], v[0:3], 0
v_subrev_u32 v200, 65536, v200
ds_write_b128 v219, v[32:35] offset:8192
v_mfma_f32_16x16x32_bf16 v[172:175], a[32:35], v[4:7], 0
ds_read_b64_tr_b16 a[160:161], v200 offset:49152
v_mfma_f32_16x16x32_bf16 v[168:171], a[36:39], v[8:11], v[168:171]
ds_write_b128 v219, v[36:39] offset:9216
v_mfma_f32_16x16x32_bf16 v[172:175], a[36:39], v[12:15], v[172:175]
ds_read_b64_tr_b16 a[162:163], v200 offset:51200
s_waitcnt lgkmcnt(8)
v_mfma_f32_16x16x32_bf16 v[168:171], a[40:43], v[16:19], v[168:171]
ds_write_b128 v219, v[40:43] offset:10240
v_mfma_f32_16x16x32_bf16 v[172:175], a[40:43], v[20:23], v[172:175]
ds_read_b64_tr_b16 a[164:165], v200 offset:53248
v_mfma_f32_16x16x32_bf16 v[168:171], a[44:47], v[24:27], v[168:171]
ds_write_b128 v219, v[44:47] offset:11264
v_mfma_f32_16x16x32_bf16 v[172:175], a[44:47], v[28:31], v[172:175]
ds_read_b64_tr_b16 a[166:167], v200 offset:55296
s_waitcnt lgkmcnt(8)
v_mfma_f32_16x16x32_bf16 v[168:171], a[48:51], v[32:35], v[168:171]
ds_write_b128 v219, v[48:51] offset:12288
v_cvt_pk_bf16_f32 v144, v160, v161
v_mfma_f32_16x16x32_bf16 v[172:175], a[48:51], v[36:39], v[172:175]
ds_read_b64_tr_b16 a[168:169], v200 offset:57344
v_cvt_pk_bf16_f32 v145, v162, v163
v_mfma_f32_16x16x32_bf16 v[168:171], a[52:55], v[40:43], v[168:171]
ds_write_b128 v219, v[52:55] offset:13312
v_cvt_pk_bf16_f32 v146, v164, v165
v_mfma_f32_16x16x32_bf16 v[172:175], a[52:55], v[44:47], v[172:175]
ds_read_b64_tr_b16 a[170:171], v200 offset:59392
v_cvt_pk_bf16_f32 v147, v166, v167
s_waitcnt lgkmcnt(8)
v_mfma_f32_16x16x32_bf16 v[168:171], a[56:59], v[48:51], v[168:171]
ds_write_b128 v219, v[56:59] offset:14336
v_mfma_f32_16x16x32_bf16 v[172:175], a[56:59], v[52:55], v[172:175]
ds_read_b64_tr_b16 a[172:173], v200 offset:61440
v_mfma_f32_16x16x32_bf16 v[168:171], a[60:63], v[56:59], v[168:171]
ds_write_b128 v219, v[60:63] offset:15360
v_mfma_f32_16x16x32_bf16 v[172:175], a[60:63], v[60:63], v[172:175]
ds_read_b64_tr_b16 a[174:175], v200 offset:63488
s_waitcnt lgkmcnt(8)
v_mfma_f32_16x16x32_bf16 v[160:163], a[64:67], v[0:3], 0
ds_read_b64_tr_b16 a[176:177], v200 offset:32768
v_mfma_f32_16x16x32_bf16 v[164:167], a[64:67], v[4:7], 0
v_mfma_f32_16x16x32_bf16 v[160:163], a[68:71], v[8:11], v[160:163]
ds_read_b64_tr_b16 a[178:179], v200 offset:34816
v_mfma_f32_16x16x32_bf16 v[164:167], a[68:71], v[12:15], v[164:167]
s_waitcnt lgkmcnt(6)
v_mfma_f32_16x16x32_bf16 v[160:163], a[72:75], v[16:19], v[160:163]
ds_read_b64_tr_b16 a[180:181], v200 offset:36864
v_mfma_f32_16x16x32_bf16 v[164:167], a[72:75], v[20:23], v[164:167]
v_mfma_f32_16x16x32_bf16 v[160:163], a[76:79], v[24:27], v[160:163]
ds_read_b64_tr_b16 a[182:183], v200 offset:38912
v_mfma_f32_16x16x32_bf16 v[164:167], a[76:79], v[28:31], v[164:167]
s_waitcnt lgkmcnt(4)
v_mfma_f32_16x16x32_bf16 v[160:163], a[80:83], v[32:35], v[160:163]
ds_read_b64_tr_b16 a[184:185], v200 offset:40960
v_cvt_pk_bf16_f32 v148, v168, v169
v_mfma_f32_16x16x32_bf16 v[164:167], a[80:83], v[36:39], v[164:167]
v_cvt_pk_bf16_f32 v149, v170, v171
v_mfma_f32_16x16x32_bf16 v[160:163], a[84:87], v[40:43], v[160:163]
ds_read_b64_tr_b16 a[186:187], v200 offset:43008
v_cvt_pk_bf16_f32 v150, v172, v173
v_mfma_f32_16x16x32_bf16 v[164:167], a[84:87], v[44:47], v[164:167]
v_cvt_pk_bf16_f32 v151, v174, v175
s_waitcnt lgkmcnt(4)
v_mfma_f32_16x16x32_bf16 v[160:163], a[88:91], v[48:51], v[160:163]
s_barrier
ds_read_b64_tr_b16 a[188:189], v200 offset:45056
v_mfma_f32_16x16x32_bf16 v[164:167], a[88:91], v[52:55], v[164:167]
v_mfma_f32_16x16x32_bf16 v[160:163], a[92:95], v[56:59], v[160:163]
ds_read_b64_tr_b16 a[190:191], v200 offset:47104
v_mfma_f32_16x16x32_bf16 v[164:167], a[92:95], v[60:63], v[164:167]
s_waitcnt lgkmcnt(4)
v_mfma_f32_16x16x32_bf16 v[168:171], a[96:99], v[0:3], 0
ds_read_b64_tr_b16 v[128:129], v200 offset:16384
v_mfma_f32_16x16x32_bf16 v[172:175], a[96:99], v[4:7], 0
v_mfma_f32_16x16x32_bf16 v[168:171], a[100:103], v[8:11], v[168:171]
ds_read_b64_tr_b16 v[130:131], v200 offset:18432
v_mfma_f32_16x16x32_bf16 v[172:175], a[100:103], v[12:15], v[172:175]
s_waitcnt lgkmcnt(4)
v_mfma_f32_16x16x32_bf16 v[168:171], a[104:107], v[16:19], v[168:171]
ds_read_b64_tr_b16 v[132:133], v200 offset:20480
v_mfma_f32_16x16x32_bf16 v[172:175], a[104:107], v[20:23], v[172:175]
ds_read_b128 v[64:67], v201 offset:0
v_mfma_f32_16x16x32_bf16 v[168:171], a[108:111], v[24:27], v[168:171]
ds_read_b64_tr_b16 v[134:135], v200 offset:22528
v_mfma_f32_16x16x32_bf16 v[172:175], a[108:111], v[28:31], v[172:175]
ds_read_b128 v[68:71], v201 offset:1024
s_waitcnt lgkmcnt(6)
v_mfma_f32_16x16x32_bf16 v[168:171], a[112:115], v[32:35], v[168:171]
ds_read_b64_tr_b16 v[136:137], v200 offset:24576
v_cvt_pk_bf16_f32 v152, v160, v161
v_mfma_f32_16x16x32_bf16 v[172:175], a[112:115], v[36:39], v[172:175]
ds_read_b128 v[72:75], v201 offset:2048
v_cvt_pk_bf16_f32 v153, v162, v163
v_mfma_f32_16x16x32_bf16 v[168:171], a[116:119], v[40:43], v[168:171]
ds_read_b64_tr_b16 v[138:139], v200 offset:26624
v_cvt_pk_bf16_f32 v154, v164, v165
v_mfma_f32_16x16x32_bf16 v[172:175], a[116:119], v[44:47], v[172:175]
ds_read_b128 v[76:79], v201 offset:3072
v_cvt_pk_bf16_f32 v155, v166, v167
s_waitcnt lgkmcnt(8)
v_mfma_f32_16x16x32_bf16 v[168:171], a[120:123], v[48:51], v[168:171]
ds_read_b64_tr_b16 v[140:141], v200 offset:28672
v_mfma_f32_16x16x32_bf16 v[172:175], a[120:123], v[52:55], v[172:175]
ds_read_b128 v[80:83], v201 offset:4096
v_mfma_f32_16x16x32_bf16 v[168:171], a[124:127], v[56:59], v[168:171]
ds_read_b64_tr_b16 v[142:143], v200 offset:30720
v_mfma_f32_16x16x32_bf16 v[172:175], a[124:127], v[60:63], v[172:175]
ds_read_b128 v[84:87], v201 offset:5120
s_waitcnt lgkmcnt(8)
v_mfma_f32_16x16x32_bf16 v[160:163], a[236:239], v[0:3], 0
ds_read_b128 v[88:91], v201 offset:6144
v_mfma_f32_16x16x32_bf16 v[164:167], a[236:239], v[4:7], 0
v_mfma_f32_16x16x32_bf16 v[160:163], a[240:243], v[8:11], v[160:163]
ds_read_b128 v[92:95], v201 offset:7168
v_mfma_f32_16x16x32_bf16 v[164:167], a[240:243], v[12:15], v[164:167]
s_waitcnt lgkmcnt(6)
v_mfma_f32_16x16x32_bf16 v[160:163], a[244:247], v[16:19], v[160:163]
ds_read_b128 v[96:99], v201 offset:8192
v_mfma_f32_16x16x32_bf16 v[164:167], a[244:247], v[20:23], v[164:167]
v_mfma_f32_16x16x32_bf16 v[160:163], a[248:251], v[24:27], v[160:163]
ds_read_b128 v[100:103], v201 offset:9216
v_mfma_f32_16x16x32_bf16 v[164:167], a[248:251], v[28:31], v[164:167]
s_waitcnt lgkmcnt(4)
v_mfma_f32_16x16x32_bf16 v[160:163], a[128:131], v[32:35], v[160:163]
ds_read_b128 v[104:107], v201 offset:10240
v_cvt_pk_bf16_f32 v156, v168, v169
v_mfma_f32_16x16x32_bf16 v[164:167], a[128:131], v[36:39], v[164:167]
v_cvt_pk_bf16_f32 v157, v170, v171
v_mfma_f32_16x16x32_bf16 v[160:163], a[132:135], v[40:43], v[160:163]
ds_read_b128 v[108:111], v201 offset:11264
v_cvt_pk_bf16_f32 v158, v172, v173
v_mfma_f32_16x16x32_bf16 v[164:167], a[132:135], v[44:47], v[164:167]
v_cvt_pk_bf16_f32 v159, v174, v175
s_waitcnt lgkmcnt(4)
v_mfma_f32_16x16x32_bf16 v[160:163], a[136:139], v[48:51], v[160:163]
ds_read_b128 v[112:115], v201 offset:12288
v_mfma_f32_16x16x32_bf16 v[164:167], a[136:139], v[52:55], v[164:167]
v_mfma_f32_16x16x32_bf16 v[160:163], a[140:143], v[56:59], v[160:163]
ds_read_b128 v[116:119], v201 offset:13312
v_mfma_f32_16x16x32_bf16 v[164:167], a[140:143], v[60:63], v[164:167]
s_waitcnt lgkmcnt(4)
v_mfma_f32_16x16x32_bf16 v[168:171], a[144:147], v[0:3], 0
ds_read_b128 v[120:123], v201 offset:14336
v_mfma_f32_16x16x32_bf16 v[172:175], a[144:147], v[4:7], 0
v_mfma_f32_16x16x32_bf16 v[168:171], a[148:151], v[8:11], v[168:171]
ds_read_b128 v[124:127], v201 offset:15360
v_mfma_f32_16x16x32_bf16 v[172:175], a[148:151], v[12:15], v[172:175]
s_waitcnt lgkmcnt(4)
v_mfma_f32_16x16x32_bf16 v[168:171], a[152:155], v[16:19], v[168:171]
v_mfma_f32_16x16x32_bf16 v[172:175], a[152:155], v[20:23], v[172:175]
v_mfma_f32_16x16x32_bf16 v[168:171], a[156:159], v[24:27], v[168:171]
v_mfma_f32_16x16x32_bf16 v[172:175], a[156:159], v[28:31], v[172:175]
s_waitcnt lgkmcnt(2)
v_mfma_f32_16x16x32_bf16 v[168:171], a[160:163], v[32:35], v[168:171]
v_cvt_pk_bf16_f32 v176, v160, v161
v_mfma_f32_16x16x32_bf16 v[172:175], a[160:163], v[36:39], v[172:175]
v_cvt_pk_bf16_f32 v177, v162, v163
v_mfma_f32_16x16x32_bf16 v[168:171], a[164:167], v[40:43], v[168:171]
v_cvt_pk_bf16_f32 v178, v164, v165
v_mfma_f32_16x16x32_bf16 v[172:175], a[164:167], v[44:47], v[172:175]
v_cvt_pk_bf16_f32 v179, v166, v167
s_waitcnt lgkmcnt(0)
v_mfma_f32_16x16x32_bf16 v[168:171], a[168:171], v[48:51], v[168:171]
v_mfma_f32_16x16x32_bf16 v[172:175], a[168:171], v[52:55], v[172:175]
s_add_u32 s35, s52, s64
buffer_store_dwordx4 v[144:147], v218, s[28:31], s35 offen sc1
v_mfma_f32_16x16x32_bf16 v[168:171], a[172:175], v[56:59], v[168:171]
v_mfma_f32_16x16x32_bf16 v[172:175], a[172:175], v[60:63], v[172:175]
v_mfma_f32_16x16x32_bf16 v[160:163], a[176:179], v[0:3], 0
v_mfma_f32_16x16x32_bf16 v[164:167], a[176:179], v[4:7], 0
v_mfma_f32_16x16x32_bf16 v[160:163], a[180:183], v[8:11], v[160:163]
v_mfma_f32_16x16x32_bf16 v[164:167], a[180:183], v[12:15], v[164:167]
s_add_u32 s35, s52, s65
buffer_store_dwordx4 v[148:151], v218, s[28:31], s35 offen sc1
v_mfma_f32_16x16x32_bf16 v[160:163], a[184:187], v[16:19], v[160:163]
v_mfma_f32_16x16x32_bf16 v[164:167], a[184:187], v[20:23], v[164:167]
v_mfma_f32_16x16x32_bf16 v[160:163], a[188:191], v[24:27], v[160:163]
v_mfma_f32_16x16x32_bf16 v[164:167], a[188:191], v[28:31], v[164:167]
v_mfma_f32_16x16x32_bf16 v[160:163], v[128:131], v[32:35], v[160:163]
v_cvt_pk_bf16_f32 v180, v168, v169
v_mfma_f32_16x16x32_bf16 v[164:167], v[128:131], v[36:39], v[164:167]
v_cvt_pk_bf16_f32 v181, v170, v171
s_add_u32 s35, s52, s66
buffer_store_dwordx4 v[152:155], v218, s[28:31], s35 offen sc1
v_mfma_f32_16x16x32_bf16 v[160:163], v[132:135], v[40:43], v[160:163]
v_cvt_pk_bf16_f32 v182, v172, v173
v_mfma_f32_16x16x32_bf16 v[164:167], v[132:135], v[44:47], v[164:167]
v_cvt_pk_bf16_f32 v183, v174, v175
v_mfma_f32_16x16x32_bf16 v[160:163], v[136:139], v[48:51], v[160:163]
v_mfma_f32_16x16x32_bf16 v[164:167], v[136:139], v[52:55], v[164:167]
v_mfma_f32_16x16x32_bf16 v[160:163], v[140:143], v[56:59], v[160:163]
v_mfma_f32_16x16x32_bf16 v[164:167], v[140:143], v[60:63], v[164:167]
s_add_u32 s35, s52, s67
buffer_store_dwordx4 v[156:159], v218, s[28:31], s35 offen sc1
v_mfma_f32_16x16x32_bf16 v[168:171], a[0:3], v[64:67], 0
v_mfma_f32_16x16x32_bf16 v[172:175], a[0:3], v[68:71], 0
v_mfma_f32_16x16x32_bf16 v[168:171], a[4:7], v[72:75], v[168:171]
v_mfma_f32_16x16x32_bf16 v[172:175], a[4:7], v[76:79], v[172:175]
v_mfma_f32_16x16x32_bf16 v[168:171], a[8:11], v[80:83], v[168:171]
v_mfma_f32_16x16x32_bf16 v[172:175], a[8:11], v[84:87], v[172:175]
s_add_u32 s35, s52, s68
buffer_store_dwordx4 v[176:179], v218, s[28:31], s35 offen sc1
v_mfma_f32_16x16x32_bf16 v[168:171], a[12:15], v[88:91], v[168:171]
v_mfma_f32_16x16x32_bf16 v[172:175], a[12:15], v[92:95], v[172:175]
v_mfma_f32_16x16x32_bf16 v[168:171], a[16:19], v[96:99], v[168:171]
v_cvt_pk_bf16_f32 v184, v160, v161
v_mfma_f32_16x16x32_bf16 v[172:175], a[16:19], v[100:103], v[172:175]
v_cvt_pk_bf16_f32 v185, v162, v163
v_mfma_f32_16x16x32_bf16 v[168:171], a[20:23], v[104:107], v[168:171]
v_cvt_pk_bf16_f32 v186, v164, v165
v_mfma_f32_16x16x32_bf16 v[172:175], a[20:23], v[108:111], v[172:175]
v_cvt_pk_bf16_f32 v187, v166, v167
s_add_u32 s35, s52, s69
buffer_store_dwordx4 v[180:183], v218, s[28:31], s35 offen sc1
v_mfma_f32_16x16x32_bf16 v[168:171], a[24:27], v[112:115], v[168:171]
v_mfma_f32_16x16x32_bf16 v[172:175], a[24:27], v[116:119], v[172:175]
v_mfma_f32_16x16x32_bf16 v[168:171], a[28:31], v[120:123], v[168:171]
v_mfma_f32_16x16x32_bf16 v[172:175], a[28:31], v[124:127], v[172:175]
v_mfma_f32_16x16x32_bf16 v[160:163], a[32:35], v[64:67], 0
v_mfma_f32_16x16x32_bf16 v[164:167], a[32:35], v[68:71], 0
s_add_u32 s35, s52, s70
buffer_store_dwordx4 v[184:187], v218, s[28:31], s35 offen sc1
v_mfma_f32_16x16x32_bf16 v[160:163], a[36:39], v[72:75], v[160:163]
v_mfma_f32_16x16x32_bf16 v[164:167], a[36:39], v[76:79], v[164:167]
v_mfma_f32_16x16x32_bf16 v[160:163], a[40:43], v[80:83], v[160:163]
v_mfma_f32_16x16x32_bf16 v[164:167], a[40:43], v[84:87], v[164:167]
v_mfma_f32_16x16x32_bf16 v[160:163], a[44:47], v[88:91], v[160:163]
v_mfma_f32_16x16x32_bf16 v[164:167], a[44:47], v[92:95], v[164:167]
v_mfma_f32_16x16x32_bf16 v[160:163], a[48:51], v[96:99], v[160:163]
v_cvt_pk_bf16_f32 v188, v168, v169
v_mfma_f32_16x16x32_bf16 v[164:167], a[48:51], v[100:103], v[164:167]
v_cvt_pk_bf16_f32 v189, v170, v171
v_mfma_f32_16x16x32_bf16 v[160:163], a[52:55], v[104:107], v[160:163]
v_cvt_pk_bf16_f32 v190, v172, v173
v_mfma_f32_16x16x32_bf16 v[164:167], a[52:55], v[108:111], v[164:167]
v_cvt_pk_bf16_f32 v191, v174, v175
v_mfma_f32_16x16x32_bf16 v[160:163], a[56:59], v[112:115], v[160:163]
v_mfma_f32_16x16x32_bf16 v[164:167], a[56:59], v[116:119], v[164:167]
s_add_u32 s35, s53, s64
buffer_store_dwordx4 v[188:191], v218, s[28:31], s35 offen sc1
v_mfma_f32_16x16x32_bf16 v[160:163], a[60:63], v[120:123], v[160:163]
v_mfma_f32_16x16x32_bf16 v[164:167], a[60:63], v[124:127], v[164:167]
v_mfma_f32_16x16x32_bf16 v[168:171], a[64:67], v[64:67], 0
v_mfma_f32_16x16x32_bf16 v[172:175], a[64:67], v[68:71], 0
v_mfma_f32_16x16x32_bf16 v[168:171], a[68:71], v[72:75], v[168:171]
v_mfma_f32_16x16x32_bf16 v[172:175], a[68:71], v[76:79], v[172:175]
v_mfma_f32_16x16x32_bf16 v[168:171], a[72:75], v[80:83], v[168:171]
v_mfma_f32_16x16x32_bf16 v[172:175], a[72:75], v[84:87], v[172:175]
v_mfma_f32_16x16x32_bf16 v[168:171], a[76:79], v[88:91], v[168:171]
v_mfma_f32_16x16x32_bf16 v[172:175], a[76:79], v[92:95], v[172:175]
v_mfma_f32_16x16x32_bf16 v[168:171], a[80:83], v[96:99], v[168:171]
v_cvt_pk_bf16_f32 v236, v160, v161
v_mfma_f32_16x16x32_bf16 v[172:175], a[80:83], v[100:103], v[172:175]
v_cvt_pk_bf16_f32 v237, v162, v163
v_mfma_f32_16x16x32_bf16 v[168:171], a[84:87], v[104:107], v[168:171]
v_cvt_pk_bf16_f32 v238, v164, v165
v_mfma_f32_16x16x32_bf16 v[172:175], a[84:87], v[108:111], v[172:175]
v_cvt_pk_bf16_f32 v239, v166, v167
v_mfma_f32_16x16x32_bf16 v[168:171], a[88:91], v[112:115], v[168:171]
v_mfma_f32_16x16x32_bf16 v[172:175], a[88:91], v[116:119], v[172:175]
s_add_u32 s35, s53, s65
buffer_store_dwordx4 v[236:239], v218, s[28:31], s35 offen sc1
v_mfma_f32_16x16x32_bf16 v[168:171], a[92:95], v[120:123], v[168:171]
v_mfma_f32_16x16x32_bf16 v[172:175], a[92:95], v[124:127], v[172:175]
v_mfma_f32_16x16x32_bf16 v[160:163], a[96:99], v[64:67], 0
v_mfma_f32_16x16x32_bf16 v[164:167], a[96:99], v[68:71], 0
v_mfma_f32_16x16x32_bf16 v[160:163], a[100:103], v[72:75], v[160:163]
v_mfma_f32_16x16x32_bf16 v[164:167], a[100:103], v[76:79], v[164:167]
v_mfma_f32_16x16x32_bf16 v[160:163], a[104:107], v[80:83], v[160:163]
ds_read_b128 v[0:3], v202 offset:0
v_mfma_f32_16x16x32_bf16 v[164:167], a[104:107], v[84:87], v[164:167]
v_mfma_f32_16x16x32_bf16 v[160:163], a[108:111], v[88:91], v[160:163]
ds_read_b128 v[4:7], v202 offset:1024
v_mfma_f32_16x16x32_bf16 v[164:167], a[108:111], v[92:95], v[164:167]
v_mfma_f32_16x16x32_bf16 v[160:163], a[112:115], v[96:99], v[160:163]
ds_read_b128 v[8:11], v202 offset:2048
v_cvt_pk_bf16_f32 v240, v168, v169
v_mfma_f32_16x16x32_bf16 v[164:167], a[112:115], v[100:103], v[164:167]
v_cvt_pk_bf16_f32 v241, v170, v171
v_mfma_f32_16x16x32_bf16 v[160:163], a[116:119], v[104:107], v[160:163]
ds_read_b128 v[12:15], v202 offset:3072
v_cvt_pk_bf16_f32 v242, v172, v173
v_mfma_f32_16x16x32_bf16 v[164:167], a[116:119], v[108:111], v[164:167]
v_cvt_pk_bf16_f32 v243, v174, v175
v_mfma_f32_16x16x32_bf16 v[160:163], a[120:123], v[112:115], v[160:163]
ds_read_b128 v[16:19], v202 offset:4096
v_mfma_f32_16x16x32_bf16 v[164:167], a[120:123], v[116:119], v[164:167]
s_add_u32 s35, s53, s66
buffer_store_dwordx4 v[240:243], v218, s[28:31], s35 offen sc1
v_mfma_f32_16x16x32_bf16 v[160:163], a[124:127], v[120:123], v[160:163]
ds_read_b128 v[20:23], v202 offset:5120
v_mfma_f32_16x16x32_bf16 v[164:167], a[124:127], v[124:127], v[164:167]
s_waitcnt lgkmcnt(4)
v_mfma_f32_16x16x32_bf16 v[168:171], a[236:239], v[64:67], 0
ds_read_b128 v[24:27], v202 offset:6144
v_mfma_f32_16x16x32_bf16 v[172:175], a[236:239], v[68:71], 0
v_mfma_f32_16x16x32_bf16 v[168:171], a[240:243], v[72:75], v[168:171]
ds_read_b128 v[28:31], v202 offset:7168
v_mfma_f32_16x16x32_bf16 v[172:175], a[240:243], v[76:79], v[172:175]
s_waitcnt lgkmcnt(4)
v_mfma_f32_16x16x32_bf16 v[168:171], a[244:247], v[80:83], v[168:171]
ds_read_b128 v[32:35], v202 offset:8192
v_mfma_f32_16x16x32_bf16 v[172:175], a[244:247], v[84:87], v[172:175]
v_mfma_f32_16x16x32_bf16 v[168:171], a[248:251], v[88:91], v[168:171]
ds_read_b128 v[36:39], v202 offset:9216
v_mfma_f32_16x16x32_bf16 v[172:175], a[248:251], v[92:95], v[172:175]
s_waitcnt lgkmcnt(4)
v_mfma_f32_16x16x32_bf16 v[168:171], a[128:131], v[96:99], v[168:171]
ds_read_b128 v[40:43], v202 offset:10240
v_cvt_pk_bf16_f32 v244, v160, v161
v_mfma_f32_16x16x32_bf16 v[172:175], a[128:131], v[100:103], v[172:175]
v_cvt_pk_bf16_f32 v245, v162, v163
v_mfma_f32_16x16x32_bf16 v[168:171], a[132:135], v[104:107], v[168:171]
ds_read_b128 v[44:47], v202 offset:11264
v_cvt_pk_bf16_f32 v246, v164, v165
v_mfma_f32_16x16x32_bf16 v[172:175], a[132:135], v[108:111], v[172:175]
v_cvt_pk_bf16_f32 v247, v166, v167
s_waitcnt lgkmcnt(4)
v_mfma_f32_16x16x32_bf16 v[168:171], a[136:139], v[112:115], v[168:171]
ds_read_b128 v[48:51], v202 offset:12288
v_mfma_f32_16x16x32_bf16 v[172:175], a[136:139], v[116:119], v[172:175]
s_add_u32 s35, s53, s67
buffer_store_dwordx4 v[244:247], v218, s[28:31], s35 offen sc1
v_mfma_f32_16x16x32_bf16 v[168:171], a[140:143], v[120:123], v[168:171]
ds_read_b128 v[52:55], v202 offset:13312
v_mfma_f32_16x16x32_bf16 v[172:175], a[140:143], v[124:127], v[172:175]
s_waitcnt lgkmcnt(4)
v_mfma_f32_16x16x32_bf16 v[160:163], a[144:147], v[64:67], 0
ds_read_b128 v[56:59], v202 offset:14336
v_mfma_f32_16x16x32_bf16 v[164:167], a[144:147], v[68:71], 0
v_mfma_f32_16x16x32_bf16 v[160:163], a[148:151], v[72:75], v[160:163]
ds_read_b128 v[60:63], v202 offset:15360
v_mfma_f32_16x16x32_bf16 v[164:167], a[148:151], v[76:79], v[164:167]
s_waitcnt lgkmcnt(4)
v_mfma_f32_16x16x32_bf16 v[160:163], a[152:155], v[80:83], v[160:163]
v_mfma_f32_16x16x32_bf16 v[164:167], a[152:155], v[84:87], v[164:167]
v_mfma_f32_16x16x32_bf16 v[160:163], a[156:159], v[88:91], v[160:163]
v_mfma_f32_16x16x32_bf16 v[164:167], a[156:159], v[92:95], v[164:167]
s_waitcnt lgkmcnt(2)
v_mfma_f32_16x16x32_bf16 v[160:163], a[160:163], v[96:99], v[160:163]
v_cvt_pk_bf16_f32 v248, v168, v169
v_mfma_f32_16x16x32_bf16 v[164:167], a[160:163], v[100:103], v[164:167]
v_cvt_pk_bf16_f32 v249, v170, v171
v_mfma_f32_16x16x32_bf16 v[160:163], a[164:167], v[104:107], v[160:163]
v_cvt_pk_bf16_f32 v250, v172, v173
v_mfma_f32_16x16x32_bf16 v[164:167], a[164:167], v[108:111], v[164:167]
v_cvt_pk_bf16_f32 v251, v174, v175
s_waitcnt lgkmcnt(0)
v_mfma_f32_16x16x32_bf16 v[160:163], a[168:171], v[112:115], v[160:163]
v_mfma_f32_16x16x32_bf16 v[164:167], a[168:171], v[116:119], v[164:167]
s_add_u32 s35, s53, s68
buffer_store_dwordx4 v[248:251], v218, s[28:31], s35 offen sc1
v_mfma_f32_16x16x32_bf16 v[160:163], a[172:175], v[120:123], v[160:163]
v_mfma_f32_16x16x32_bf16 v[164:167], a[172:175], v[124:127], v[164:167]
v_mfma_f32_16x16x32_bf16 v[168:171], a[176:179], v[64:67], 0
v_mfma_f32_16x16x32_bf16 v[172:175], a[176:179], v[68:71], 0
v_mfma_f32_16x16x32_bf16 v[168:171], a[180:183], v[72:75], v[168:171]
v_mfma_f32_16x16x32_bf16 v[172:175], a[180:183], v[76:79], v[172:175]
v_mfma_f32_16x16x32_bf16 v[168:171], a[184:187], v[80:83], v[168:171]
v_mfma_f32_16x16x32_bf16 v[172:175], a[184:187], v[84:87], v[172:175]
v_mfma_f32_16x16x32_bf16 v[168:171], a[188:191], v[88:91], v[168:171]
v_mfma_f32_16x16x32_bf16 v[172:175], a[188:191], v[92:95], v[172:175]
v_mfma_f32_16x16x32_bf16 v[168:171], v[128:131], v[96:99], v[168:171]
v_cvt_pk_bf16_f32 v144, v160, v161
v_mfma_f32_16x16x32_bf16 v[172:175], v[128:131], v[100:103], v[172:175]
v_cvt_pk_bf16_f32 v145, v162, v163
v_mfma_f32_16x16x32_bf16 v[168:171], v[132:135], v[104:107], v[168:171]
v_cvt_pk_bf16_f32 v146, v164, v165
v_mfma_f32_16x16x32_bf16 v[172:175], v[132:135], v[108:111], v[172:175]
v_cvt_pk_bf16_f32 v147, v166, v167
v_mfma_f32_16x16x32_bf16 v[168:171], v[136:139], v[112:115], v[168:171]
v_mfma_f32_16x16x32_bf16 v[172:175], v[136:139], v[116:119], v[172:175]
s_add_u32 s35, s53, s69
buffer_store_dwordx4 v[144:147], v218, s[28:31], s35 offen sc1
v_mfma_f32_16x16x32_bf16 v[168:171], v[140:143], v[120:123], v[168:171]
v_mfma_f32_16x16x32_bf16 v[172:175], v[140:143], v[124:127], v[172:175]
v_mfma_f32_16x16x32_bf16 v[160:163], a[0:3], v[0:3], 0
v_mfma_f32_16x16x32_bf16 v[164:167], a[0:3], v[4:7], 0
v_mfma_f32_16x16x32_bf16 v[160:163], a[4:7], v[8:11], v[160:163]
v_mfma_f32_16x16x32_bf16 v[164:167], a[4:7], v[12:15], v[164:167]
v_mfma_f32_16x16x32_bf16 v[160:163], a[8:11], v[16:19], v[160:163]
v_mfma_f32_16x16x32_bf16 v[164:167], a[8:11], v[20:23], v[164:167]
v_mfma_f32_16x16x32_bf16 v[160:163], a[12:15], v[24:27], v[160:163]
v_mfma_f32_16x16x32_bf16 v[164:167], a[12:15], v[28:31], v[164:167]
v_mfma_f32_16x16x32_bf16 v[160:163], a[16:19], v[32:35], v[160:163]
v_cvt_pk_bf16_f32 v148, v168, v169
v_mfma_f32_16x16x32_bf16 v[164:167], a[16:19], v[36:39], v[164:167]
v_cvt_pk_bf16_f32 v149, v170, v171
v_mfma_f32_16x16x32_bf16 v[160:163], a[20:23], v[40:43], v[160:163]
v_cvt_pk_bf16_f32 v150, v172, v173
v_mfma_f32_16x16x32_bf16 v[164:167], a[20:23], v[44:47], v[164:167]
v_cvt_pk_bf16_f32 v151, v174, v175
v_mfma_f32_16x16x32_bf16 v[160:163], a[24:27], v[48:51], v[160:163]
v_mfma_f32_16x16x32_bf16 v[164:167], a[24:27], v[52:55], v[164:167]
s_add_u32 s35, s53, s70
buffer_store_dwordx4 v[148:151], v218, s[28:31], s35 offen sc1
v_mfma_f32_16x16x32_bf16 v[160:163], a[28:31], v[56:59], v[160:163]
v_mfma_f32_16x16x32_bf16 v[164:167], a[28:31], v[60:63], v[164:167]
v_mfma_f32_16x16x32_bf16 v[168:171], a[32:35], v[0:3], 0
v_mfma_f32_16x16x32_bf16 v[172:175], a[32:35], v[4:7], 0
v_mfma_f32_16x16x32_bf16 v[168:171], a[36:39], v[8:11], v[168:171]
v_mfma_f32_16x16x32_bf16 v[172:175], a[36:39], v[12:15], v[172:175]
v_mfma_f32_16x16x32_bf16 v[168:171], a[40:43], v[16:19], v[168:171]
v_mfma_f32_16x16x32_bf16 v[172:175], a[40:43], v[20:23], v[172:175]
v_mfma_f32_16x16x32_bf16 v[168:171], a[44:47], v[24:27], v[168:171]
v_mfma_f32_16x16x32_bf16 v[172:175], a[44:47], v[28:31], v[172:175]
v_mfma_f32_16x16x32_bf16 v[168:171], a[48:51], v[32:35], v[168:171]
v_cvt_pk_bf16_f32 v152, v160, v161
v_mfma_f32_16x16x32_bf16 v[172:175], a[48:51], v[36:39], v[172:175]
v_cvt_pk_bf16_f32 v153, v162, v163
v_mfma_f32_16x16x32_bf16 v[168:171], a[52:55], v[40:43], v[168:171]
v_cvt_pk_bf16_f32 v154, v164, v165
v_mfma_f32_16x16x32_bf16 v[172:175], a[52:55], v[44:47], v[172:175]
v_cvt_pk_bf16_f32 v155, v166, v167
v_mfma_f32_16x16x32_bf16 v[168:171], a[56:59], v[48:51], v[168:171]
v_mfma_f32_16x16x32_bf16 v[172:175], a[56:59], v[52:55], v[172:175]
s_add_u32 s35, s54, s64
buffer_store_dwordx4 v[152:155], v218, s[28:31], s35 offen sc1
v_mfma_f32_16x16x32_bf16 v[168:171], a[60:63], v[56:59], v[168:171]
v_mfma_f32_16x16x32_bf16 v[172:175], a[60:63], v[60:63], v[172:175]
v_mfma_f32_16x16x32_bf16 v[160:163], a[64:67], v[0:3], 0
v_mfma_f32_16x16x32_bf16 v[164:167], a[64:67], v[4:7], 0
v_mfma_f32_16x16x32_bf16 v[160:163], a[68:71], v[8:11], v[160:163]
v_mfma_f32_16x16x32_bf16 v[164:167], a[68:71], v[12:15], v[164:167]
v_mfma_f32_16x16x32_bf16 v[160:163], a[72:75], v[16:19], v[160:163]
v_mfma_f32_16x16x32_bf16 v[164:167], a[72:75], v[20:23], v[164:167]
v_mfma_f32_16x16x32_bf16 v[160:163], a[76:79], v[24:27], v[160:163]
v_mfma_f32_16x16x32_bf16 v[164:167], a[76:79], v[28:31], v[164:167]
v_mfma_f32_16x16x32_bf16 v[160:163], a[80:83], v[32:35], v[160:163]
v_cvt_pk_bf16_f32 v156, v168, v169
v_mfma_f32_16x16x32_bf16 v[164:167], a[80:83], v[36:39], v[164:167]
v_cvt_pk_bf16_f32 v157, v170, v171
v_mfma_f32_16x16x32_bf16 v[160:163], a[84:87], v[40:43], v[160:163]
v_cvt_pk_bf16_f32 v158, v172, v173
v_mfma_f32_16x16x32_bf16 v[164:167], a[84:87], v[44:47], v[164:167]
v_cvt_pk_bf16_f32 v159, v174, v175
v_mfma_f32_16x16x32_bf16 v[160:163], a[88:91], v[48:51], v[160:163]
v_mfma_f32_16x16x32_bf16 v[164:167], a[88:91], v[52:55], v[164:167]
s_add_u32 s35, s54, s65
buffer_store_dwordx4 v[156:159], v218, s[28:31], s35 offen sc1
v_mfma_f32_16x16x32_bf16 v[160:163], a[92:95], v[56:59], v[160:163]
v_mfma_f32_16x16x32_bf16 v[164:167], a[92:95], v[60:63], v[164:167]
v_mfma_f32_16x16x32_bf16 v[168:171], a[96:99], v[0:3], 0
v_mfma_f32_16x16x32_bf16 v[172:175], a[96:99], v[4:7], 0
v_mfma_f32_16x16x32_bf16 v[168:171], a[100:103], v[8:11], v[168:171]
v_mfma_f32_16x16x32_bf16 v[172:175], a[100:103], v[12:15], v[172:175]
v_mfma_f32_16x16x32_bf16 v[168:171], a[104:107], v[16:19], v[168:171]
ds_read_b128 v[64:67], v203 offset:0
v_mfma_f32_16x16x32_bf16 v[172:175], a[104:107], v[20:23], v[172:175]
v_mfma_f32_16x16x32_bf16 v[168:171], a[108:111], v[24:27], v[168:171]
ds_read_b128 v[68:71], v203 offset:1024
v_mfma_f32_16x16x32_bf16 v[172:175], a[108:111], v[28:31], v[172:175]
v_mfma_f32_16x16x32_bf16 v[168:171], a[112:115], v[32:35], v[168:171]
ds_read_b128 v[72:75], v203 offset:2048
v_cvt_pk_bf16_f32 v176, v160, v161
v_mfma_f32_16x16x32_bf16 v[172:175], a[112:115], v[36:39], v[172:175]
v_cvt_pk_bf16_f32 v177, v162, v163
v_mfma_f32_16x16x32_bf16 v[168:171], a[116:119], v[40:43], v[168:171]
ds_read_b128 v[76:79], v203 offset:3072
v_cvt_pk_bf16_f32 v178, v164, v165
v_mfma_f32_16x16x32_bf16 v[172:175], a[116:119], v[44:47], v[172:175]
v_cvt_pk_bf16_f32 v179, v166, v167
v_mfma_f32_16x16x32_bf16 v[168:171], a[120:123], v[48:51], v[168:171]
ds_read_b128 v[80:83], v203 offset:4096
v_mfma_f32_16x16x32_bf16 v[172:175], a[120:123], v[52:55], v[172:175]
s_add_u32 s35, s54, s66
buffer_store_dwordx4 v[176:179], v218, s[28:31], s35 offen sc1
v_mfma_f32_16x16x32_bf16 v[168:171], a[124:127], v[56:59], v[168:171]
ds_read_b128 v[84:87], v203 offset:5120
v_mfma_f32_16x16x32_bf16 v[172:175], a[124:127], v[60:63], v[172:175]
s_waitcnt lgkmcnt(4)
v_mfma_f32_16x16x32_bf16 v[160:163], a[236:239], v[0:3], 0
ds_read_b128 v[88:91], v203 offset:6144
v_mfma_f32_16x16x32_bf16 v[164:167], a[236:239], v[4:7], 0
v_mfma_f32_16x16x32_bf16 v[160:163], a[240:243], v[8:11], v[160:163]
ds_read_b128 v[92:95], v203 offset:7168
v_mfma_f32_16x16x32_bf16 v[164:167], a[240:243], v[12:15], v[164:167]
s_waitcnt lgkmcnt(4)
v_mfma_f32_16x16x32_bf16 v[160:163], a[244:247], v[16:19], v[160:163]
ds_read_b128 v[96:99], v203 offset:8192
v_mfma_f32_16x16x32_bf16 v[164:167], a[244:247], v[20:23], v[164:167]
v_mfma_f32_16x16x32_bf16 v[160:163], a[248:251], v[24:27], v[160:163]
ds_read_b128 v[100:103], v203 offset:9216
v_mfma_f32_16x16x32_bf16 v[164:167], a[248:251], v[28:31], v[164:167]
s_waitcnt lgkmcnt(4)
v_mfma_f32_16x16x32_bf16 v[160:163], a[128:131], v[32:35], v[160:163]
ds_read_b128 v[104:107], v203 offset:10240
v_cvt_pk_bf16_f32 v180, v168, v169
v_mfma_f32_16x16x32_bf16 v[164:167], a[128:131], v[36:39], v[164:167]
v_cvt_pk_bf16_f32 v181, v170, v171
v_mfma_f32_16x16x32_bf16 v[160:163], a[132:135], v[40:43], v[160:163]
ds_read_b128 v[108:111], v203 offset:11264
v_cvt_pk_bf16_f32 v182, v172, v173
v_mfma_f32_16x16x32_bf16 v[164:167], a[132:135], v[44:47], v[164:167]
v_cvt_pk_bf16_f32 v183, v174, v175
s_waitcnt lgkmcnt(4)
v_mfma_f32_16x16x32_bf16 v[160:163], a[136:139], v[48:51], v[160:163]
ds_read_b128 v[112:115], v203 offset:12288
v_mfma_f32_16x16x32_bf16 v[164:167], a[136:139], v[52:55], v[164:167]
s_add_u32 s35, s54, s67
buffer_store_dwordx4 v[180:183], v218, s[28:31], s35 offen sc1
v_mfma_f32_16x16x32_bf16 v[160:163], a[140:143], v[56:59], v[160:163]
ds_read_b128 v[116:119], v203 offset:13312
v_mfma_f32_16x16x32_bf16 v[164:167], a[140:143], v[60:63], v[164:167]
s_waitcnt lgkmcnt(4)
v_mfma_f32_16x16x32_bf16 v[168:171], a[144:147], v[0:3], 0
ds_read_b128 v[120:123], v203 offset:14336
v_mfma_f32_16x16x32_bf16 v[172:175], a[144:147], v[4:7], 0
v_mfma_f32_16x16x32_bf16 v[168:171], a[148:151], v[8:11], v[168:171]
ds_read_b128 v[124:127], v203 offset:15360
v_mfma_f32_16x16x32_bf16 v[172:175], a[148:151], v[12:15], v[172:175]
s_waitcnt lgkmcnt(4)
v_mfma_f32_16x16x32_bf16 v[168:171], a[152:155], v[16:19], v[168:171]
v_mfma_f32_16x16x32_bf16 v[172:175], a[152:155], v[20:23], v[172:175]
v_mfma_f32_16x16x32_bf16 v[168:171], a[156:159], v[24:27], v[168:171]
v_mfma_f32_16x16x32_bf16 v[172:175], a[156:159], v[28:31], v[172:175]
s_waitcnt lgkmcnt(2)
v_mfma_f32_16x16x32_bf16 v[168:171], a[160:163], v[32:35], v[168:171]
v_cvt_pk_bf16_f32 v184, v160, v161
v_mfma_f32_16x16x32_bf16 v[172:175], a[160:163], v[36:39], v[172:175]
v_cvt_pk_bf16_f32 v185, v162, v163
v_mfma_f32_16x16x32_bf16 v[168:171], a[164:167], v[40:43], v[168:171]
v_cvt_pk_bf16_f32 v186, v164, v165
v_mfma_f32_16x16x32_bf16 v[172:175], a[164:167], v[44:47], v[172:175]
v_cvt_pk_bf16_f32 v187, v166, v167
s_waitcnt lgkmcnt(0)
v_mfma_f32_16x16x32_bf16 v[168:171], a[168:171], v[48:51], v[168:171]
v_mfma_f32_16x16x32_bf16 v[172:175], a[168:171], v[52:55], v[172:175]
s_add_u32 s35, s54, s68
buffer_store_dwordx4 v[184:187], v218, s[28:31], s35 offen sc1
v_mfma_f32_16x16x32_bf16 v[168:171], a[172:175], v[56:59], v[168:171]
v_mfma_f32_16x16x32_bf16 v[172:175], a[172:175], v[60:63], v[172:175]
v_mfma_f32_16x16x32_bf16 v[160:163], a[176:179], v[0:3], 0
v_mfma_f32_16x16x32_bf16 v[164:167], a[176:179], v[4:7], 0
v_mfma_f32_16x16x32_bf16 v[160:163], a[180:183], v[8:11], v[160:163]
v_mfma_f32_16x16x32_bf16 v[164:167], a[180:183], v[12:15], v[164:167]
v_mfma_f32_16x16x32_bf16 v[160:163], a[184:187], v[16:19], v[160:163]
v_mfma_f32_16x16x32_bf16 v[164:167], a[184:187], v[20:23], v[164:167]
v_mfma_f32_16x16x32_bf16 v[160:163], a[188:191], v[24:27], v[160:163]
v_mfma_f32_16x16x32_bf16 v[164:167], a[188:191], v[28:31], v[164:167]
v_mfma_f32_16x16x32_bf16 v[160:163], v[128:131], v[32:35], v[160:163]
v_cvt_pk_bf16_f32 v188, v168, v169
v_mfma_f32_16x16x32_bf16 v[164:167], v[128:131], v[36:39], v[164:167]
v_cvt_pk_bf16_f32 v189, v170, v171
v_mfma_f32_16x16x32_bf16 v[160:163], v[132:135], v[40:43], v[160:163]
v_cvt_pk_bf16_f32 v190, v172, v173
v_mfma_f32_16x16x32_bf16 v[164:167], v[132:135], v[44:47], v[164:167]
v_cvt_pk_bf16_f32 v191, v174, v175
v_mfma_f32_16x16x32_bf16 v[160:163], v[136:139], v[48:51], v[160:163]
v_mfma_f32_16x16x32_bf16 v[164:167], v[136:139], v[52:55], v[164:167]
s_add_u32 s35, s54, s69
buffer_store_dwordx4 v[188:191], v218, s[28:31], s35 offen sc1
v_mfma_f32_16x16x32_bf16 v[160:163], v[140:143], v[56:59], v[160:163]
v_mfma_f32_16x16x32_bf16 v[164:167], v[140:143], v[60:63], v[164:167]
v_mfma_f32_16x16x32_bf16 v[168:171], a[0:3], v[64:67], 0
v_mfma_f32_16x16x32_bf16 v[172:175], a[0:3], v[68:71], 0
v_mfma_f32_16x16x32_bf16 v[168:171], a[4:7], v[72:75], v[168:171]
v_mfma_f32_16x16x32_bf16 v[172:175], a[4:7], v[76:79], v[172:175]
v_mfma_f32_16x16x32_bf16 v[168:171], a[8:11], v[80:83], v[168:171]
v_mfma_f32_16x16x32_bf16 v[172:175], a[8:11], v[84:87], v[172:175]
v_mfma_f32_16x16x32_bf16 v[168:171], a[12:15], v[88:91], v[168:171]
v_mfma_f32_16x16x32_bf16 v[172:175], a[12:15], v[92:95], v[172:175]
v_mfma_f32_16x16x32_bf16 v[168:171], a[16:19], v[96:99], v[168:171]
v_cvt_pk_bf16_f32 v236, v160, v161
v_mfma_f32_16x16x32_bf16 v[172:175], a[16:19], v[100:103], v[172:175]
v_cvt_pk_bf16_f32 v237, v162, v163
v_mfma_f32_16x16x32_bf16 v[168:171], a[20:23], v[104:107], v[168:171]
v_cvt_pk_bf16_f32 v238, v164, v165
v_mfma_f32_16x16x32_bf16 v[172:175], a[20:23], v[108:111], v[172:175]
v_cvt_pk_bf16_f32 v239, v166, v167
v_mfma_f32_16x16x32_bf16 v[168:171], a[24:27], v[112:115], v[168:171]
v_mfma_f32_16x16x32_bf16 v[172:175], a[24:27], v[116:119], v[172:175]
s_add_u32 s35, s54, s70
buffer_store_dwordx4 v[236:239], v218, s[28:31], s35 offen sc1
v_mfma_f32_16x16x32_bf16 v[168:171], a[28:31], v[120:123], v[168:171]
v_mfma_f32_16x16x32_bf16 v[172:175], a[28:31], v[124:127], v[172:175]
v_mfma_f32_16x16x32_bf16 v[160:163], a[32:35], v[64:67], 0
v_mfma_f32_16x16x32_bf16 v[164:167], a[32:35], v[68:71], 0
v_mfma_f32_16x16x32_bf16 v[160:163], a[36:39], v[72:75], v[160:163]
v_mfma_f32_16x16x32_bf16 v[164:167], a[36:39], v[76:79], v[164:167]
v_mfma_f32_16x16x32_bf16 v[160:163], a[40:43], v[80:83], v[160:163]
v_mfma_f32_16x16x32_bf16 v[164:167], a[40:43], v[84:87], v[164:167]
v_mfma_f32_16x16x32_bf16 v[160:163], a[44:47], v[88:91], v[160:163]
v_mfma_f32_16x16x32_bf16 v[164:167], a[44:47], v[92:95], v[164:167]
v_mfma_f32_16x16x32_bf16 v[160:163], a[48:51], v[96:99], v[160:163]
v_cvt_pk_bf16_f32 v240, v168, v169
v_mfma_f32_16x16x32_bf16 v[164:167], a[48:51], v[100:103], v[164:167]
v_cvt_pk_bf16_f32 v241, v170, v171
v_mfma_f32_16x16x32_bf16 v[160:163], a[52:55], v[104:107], v[160:163]
v_cvt_pk_bf16_f32 v242, v172, v173
v_mfma_f32_16x16x32_bf16 v[164:167], a[52:55], v[108:111], v[164:167]
v_cvt_pk_bf16_f32 v243, v174, v175
v_mfma_f32_16x16x32_bf16 v[160:163], a[56:59], v[112:115], v[160:163]
v_mfma_f32_16x16x32_bf16 v[164:167], a[56:59], v[116:119], v[164:167]
s_add_u32 s35, s55, s64
buffer_store_dwordx4 v[240:243], v218, s[28:31], s35 offen sc1
v_mfma_f32_16x16x32_bf16 v[160:163], a[60:63], v[120:123], v[160:163]
v_mfma_f32_16x16x32_bf16 v[164:167], a[60:63], v[124:127], v[164:167]
v_mfma_f32_16x16x32_bf16 v[168:171], a[64:67], v[64:67], 0
v_mfma_f32_16x16x32_bf16 v[172:175], a[64:67], v[68:71], 0
v_mfma_f32_16x16x32_bf16 v[168:171], a[68:71], v[72:75], v[168:171]
v_mfma_f32_16x16x32_bf16 v[172:175], a[68:71], v[76:79], v[172:175]
v_mfma_f32_16x16x32_bf16 v[168:171], a[72:75], v[80:83], v[168:171]
v_mfma_f32_16x16x32_bf16 v[172:175], a[72:75], v[84:87], v[172:175]
v_mfma_f32_16x16x32_bf16 v[168:171], a[76:79], v[88:91], v[168:171]
v_mfma_f32_16x16x32_bf16 v[172:175], a[76:79], v[92:95], v[172:175]
v_mfma_f32_16x16x32_bf16 v[168:171], a[80:83], v[96:99], v[168:171]
v_cvt_pk_bf16_f32 v244, v160, v161
v_mfma_f32_16x16x32_bf16 v[172:175], a[80:83], v[100:103], v[172:175]
v_cvt_pk_bf16_f32 v245, v162, v163
v_mfma_f32_16x16x32_bf16 v[168:171], a[84:87], v[104:107], v[168:171]
v_cvt_pk_bf16_f32 v246, v164, v165
v_mfma_f32_16x16x32_bf16 v[172:175], a[84:87], v[108:111], v[172:175]
v_cvt_pk_bf16_f32 v247, v166, v167
v_mfma_f32_16x16x32_bf16 v[168:171], a[88:91], v[112:115], v[168:171]
v_mfma_f32_16x16x32_bf16 v[172:175], a[88:91], v[116:119], v[172:175]
s_add_u32 s35, s55, s65
buffer_store_dwordx4 v[244:247], v218, s[28:31], s35 offen sc1
v_mfma_f32_16x16x32_bf16 v[168:171], a[92:95], v[120:123], v[168:171]
v_mfma_f32_16x16x32_bf16 v[172:175], a[92:95], v[124:127], v[172:175]
v_mfma_f32_16x16x32_bf16 v[160:163], a[96:99], v[64:67], 0
v_mfma_f32_16x16x32_bf16 v[164:167], a[96:99], v[68:71], 0
v_mfma_f32_16x16x32_bf16 v[160:163], a[100:103], v[72:75], v[160:163]
v_mfma_f32_16x16x32_bf16 v[164:167], a[100:103], v[76:79], v[164:167]
v_mfma_f32_16x16x32_bf16 v[160:163], a[104:107], v[80:83], v[160:163]
v_mfma_f32_16x16x32_bf16 v[164:167], a[104:107], v[84:87], v[164:167]
v_mfma_f32_16x16x32_bf16 v[160:163], a[108:111], v[88:91], v[160:163]
v_mfma_f32_16x16x32_bf16 v[164:167], a[108:111], v[92:95], v[164:167]
v_mfma_f32_16x16x32_bf16 v[160:163], a[112:115], v[96:99], v[160:163]
v_cvt_pk_bf16_f32 v248, v168, v169
v_mfma_f32_16x16x32_bf16 v[164:167], a[112:115], v[100:103], v[164:167]
v_cvt_pk_bf16_f32 v249, v170, v171
v_mfma_f32_16x16x32_bf16 v[160:163], a[116:119], v[104:107], v[160:163]
v_cvt_pk_bf16_f32 v250, v172, v173
v_mfma_f32_16x16x32_bf16 v[164:167], a[116:119], v[108:111], v[164:167]
v_cvt_pk_bf16_f32 v251, v174, v175
v_mfma_f32_16x16x32_bf16 v[160:163], a[120:123], v[112:115], v[160:163]
v_mfma_f32_16x16x32_bf16 v[164:167], a[120:123], v[116:119], v[164:167]
s_add_u32 s35, s55, s66
buffer_store_dwordx4 v[248:251], v218, s[28:31], s35 offen sc1
v_mfma_f32_16x16x32_bf16 v[160:163], a[124:127], v[120:123], v[160:163]
v_mfma_f32_16x16x32_bf16 v[164:167], a[124:127], v[124:127], v[164:167]
v_mfma_f32_16x16x32_bf16 v[168:171], a[236:239], v[64:67], 0
v_mfma_f32_16x16x32_bf16 v[172:175], a[236:239], v[68:71], 0
v_mfma_f32_16x16x32_bf16 v[168:171], a[240:243], v[72:75], v[168:171]
v_mfma_f32_16x16x32_bf16 v[172:175], a[240:243], v[76:79], v[172:175]
v_mfma_f32_16x16x32_bf16 v[168:171], a[244:247], v[80:83], v[168:171]
v_mfma_f32_16x16x32_bf16 v[172:175], a[244:247], v[84:87], v[172:175]
v_mfma_f32_16x16x32_bf16 v[168:171], a[248:251], v[88:91], v[168:171]
v_mfma_f32_16x16x32_bf16 v[172:175], a[248:251], v[92:95], v[172:175]
v_mfma_f32_16x16x32_bf16 v[168:171], a[128:131], v[96:99], v[168:171]
v_cvt_pk_bf16_f32 v144, v160, v161
v_mfma_f32_16x16x32_bf16 v[172:175], a[128:131], v[100:103], v[172:175]
v_cvt_pk_bf16_f32 v145, v162, v163
v_mfma_f32_16x16x32_bf16 v[168:171], a[132:135], v[104:107], v[168:171]
v_cvt_pk_bf16_f32 v146, v164, v165
v_mfma_f32_16x16x32_bf16 v[172:175], a[132:135], v[108:111], v[172:175]
v_cvt_pk_bf16_f32 v147, v166, v167
v_mfma_f32_16x16x32_bf16 v[168:171], a[136:139], v[112:115], v[168:171]
v_mfma_f32_16x16x32_bf16 v[172:175], a[136:139], v[116:119], v[172:175]
s_add_u32 s35, s55, s67
buffer_store_dwordx4 v[144:147], v218, s[28:31], s35 offen sc1
v_mfma_f32_16x16x32_bf16 v[168:171], a[140:143], v[120:123], v[168:171]
v_mfma_f32_16x16x32_bf16 v[172:175], a[140:143], v[124:127], v[172:175]
v_mfma_f32_16x16x32_bf16 v[160:163], a[144:147], v[64:67], 0
v_mfma_f32_16x16x32_bf16 v[164:167], a[144:147], v[68:71], 0
v_mfma_f32_16x16x32_bf16 v[160:163], a[148:151], v[72:75], v[160:163]
v_mfma_f32_16x16x32_bf16 v[164:167], a[148:151], v[76:79], v[164:167]
v_mfma_f32_16x16x32_bf16 v[160:163], a[152:155], v[80:83], v[160:163]
v_mfma_f32_16x16x32_bf16 v[164:167], a[152:155], v[84:87], v[164:167]
v_mfma_f32_16x16x32_bf16 v[160:163], a[156:159], v[88:91], v[160:163]
v_mfma_f32_16x16x32_bf16 v[164:167], a[156:159], v[92:95], v[164:167]
v_mfma_f32_16x16x32_bf16 v[160:163], a[160:163], v[96:99], v[160:163]
v_cvt_pk_bf16_f32 v148, v168, v169
v_mfma_f32_16x16x32_bf16 v[164:167], a[160:163], v[100:103], v[164:167]
v_cvt_pk_bf16_f32 v149, v170, v171
v_mfma_f32_16x16x32_bf16 v[160:163], a[164:167], v[104:107], v[160:163]
v_cvt_pk_bf16_f32 v150, v172, v173
v_mfma_f32_16x16x32_bf16 v[164:167], a[164:167], v[108:111], v[164:167]
v_cvt_pk_bf16_f32 v151, v174, v175
v_mfma_f32_16x16x32_bf16 v[160:163], a[168:171], v[112:115], v[160:163]
v_mfma_f32_16x16x32_bf16 v[164:167], a[168:171], v[116:119], v[164:167]
s_add_u32 s35, s55, s68
buffer_store_dwordx4 v[148:151], v218, s[28:31], s35 offen sc1
v_mfma_f32_16x16x32_bf16 v[160:163], a[172:175], v[120:123], v[160:163]
v_mfma_f32_16x16x32_bf16 v[164:167], a[172:175], v[124:127], v[164:167]
v_mfma_f32_16x16x32_bf16 v[168:171], a[176:179], v[64:67], 0
v_mfma_f32_16x16x32_bf16 v[172:175], a[176:179], v[68:71], 0
v_mfma_f32_16x16x32_bf16 v[168:171], a[180:183], v[72:75], v[168:171]
v_mfma_f32_16x16x32_bf16 v[172:175], a[180:183], v[76:79], v[172:175]
v_mfma_f32_16x16x32_bf16 v[168:171], a[184:187], v[80:83], v[168:171]
v_mfma_f32_16x16x32_bf16 v[172:175], a[184:187], v[84:87], v[172:175]
v_mfma_f32_16x16x32_bf16 v[168:171], a[188:191], v[88:91], v[168:171]
v_mfma_f32_16x16x32_bf16 v[172:175], a[188:191], v[92:95], v[172:175]
v_mfma_f32_16x16x32_bf16 v[168:171], v[128:131], v[96:99], v[168:171]
v_cvt_pk_bf16_f32 v152, v160, v161
v_mfma_f32_16x16x32_bf16 v[172:175], v[128:131], v[100:103], v[172:175]
v_cvt_pk_bf16_f32 v153, v162, v163
v_mfma_f32_16x16x32_bf16 v[168:171], v[132:135], v[104:107], v[168:171]
v_cvt_pk_bf16_f32 v154, v164, v165
v_mfma_f32_16x16x32_bf16 v[172:175], v[132:135], v[108:111], v[172:175]
v_cvt_pk_bf16_f32 v155, v166, v167
v_mfma_f32_16x16x32_bf16 v[168:171], v[136:139], v[112:115], v[168:171]
v_mfma_f32_16x16x32_bf16 v[172:175], v[136:139], v[116:119], v[172:175]
s_add_u32 s35, s55, s69
buffer_store_dwordx4 v[152:155], v218, s[28:31], s35 offen sc1
v_mfma_f32_16x16x32_bf16 v[168:171], v[140:143], v[120:123], v[168:171]
v_mfma_f32_16x16x32_bf16 v[172:175], v[140:143], v[124:127], v[172:175]
s_nop 7
v_cvt_pk_bf16_f32 v156, v168, v169
v_cvt_pk_bf16_f32 v157, v170, v171
v_cvt_pk_bf16_f32 v158, v172, v173
v_cvt_pk_bf16_f32 v159, v174, v175
s_add_u32 s35, s55, s70
buffer_store_dwordx4 v[156:159], v218, s[28:31], s35 offen sc1
s_mov_b32 s79, 0
v_cmp_gt_u32 vcc, 16, v227
s_cbranch_vccz L_cleared
s_mov_b32 s63, 0
L_cnt:
buffer_load_dword v227, v228, s[44:47], 0 offen sc1
s_add_u32 s63, s63, 1
s_cmp_ge_u32 s63, 0x100000
s_cbranch_scc1 L_cnt_x
s_waitcnt vmcnt(0)
v_cmp_gt_u32 vcc, 16, v227
s_cbranch_vccnz L_cnt
L_cnt_x:
v_mov_b32 v221, 0
L_cleared:
s_mov_b32 s63, 0
s_waitcnt vmcnt(21)
buffer_store_dword v226, v222, s[40:43], s92 offen sc1
s_waitcnt vmcnt(15)
buffer_store_dword v226, v222, s[40:43], s93 offen sc1
s_waitcnt vmcnt(9)
buffer_store_dword v226, v222, s[40:43], s94 offen sc1
s_waitcnt vmcnt(3)
buffer_store_dword v226, v222, s[40:43], s95 offen sc1
L_q_poll:
buffer_load_dword v221, v223, s[40:43], 0 offen sc1
s_add_u32 s63, s63, 1
s_cmp_ge_u32 s63, 0x100000
s_cbranch_scc1 L_q_done
s_waitcnt vmcnt(0)
L_q_look:
v_cmp_ne_u32 vcc, 1, v221
s_or_b32 s35, vcc_lo, s79
s_and_b32 s34, s35, 15
s_cbranch_scc1 L_q_skip0
s_or_b32 s79, s79, 15
s_mov_b32 s34, 0
buffer_load_dwordx4 a[0:3], v224, s[36:39], s34 offen offset:0 sc1
buffer_load_dwordx4 a[16:19], v224, s[36:39], s34 offen offset:1024 sc1
buffer_load_dwordx4 a[32:35], v224, s[36:39], s34 offen offset:2048 sc1
buffer_load_dwordx4 a[48:51], v224, s[36:39], s34 offen offset:3072 sc1
s_add_u32 s34, s34, 4096
buffer_load_dwordx4 a[64:67], v224, s[36:39], s34 offen offset:0 sc1
buffer_load_dwordx4 a[80:83], v224, s[36:39], s34 offen offset:1024 sc1
buffer_load_dwordx4 a[96:99], v224, s[36:39], s34 offen offset:2048 sc1
L_q_skip0:
s_and_b32 s34, s35, 240
s_cbranch_scc1 L_q_skip1
s_or_b32 s79, s79, 240
s_mov_b32 s34, 28672
buffer_load_dwordx4 a[4:7], v224, s[36:39], s34 offen offset:0 sc1
buffer_load_dwordx4 a[20:23], v224, s[36:39], s34 offen offset:1024 sc1
buffer_load_dwordx4 a[36:39], v224, s[36:39], s34 offen offset:2048 sc1
buffer_load_dwordx4 a[52:55], v224, s[36:39], s34 offen offset:3072 sc1
s_add_u32 s34, s34, 4096
buffer_load_dwordx4 a[68:71], v224, s[36:39], s34 offen offset:0 sc1
buffer_load_dwordx4 a[84:87], v224, s[36:39], s34 offen offset:1024 sc1
buffer_load_dwordx4 a[100:103], v224, s[36:39], s34 offen offset:2048 sc1
L_q_skip1:
s_and_b32 s34, s35, 3840
s_cbranch_scc1 L_q_skip2
s_or_b32 s79, s79, 3840
s_mov_b32 s34, 57344
buffer_load_dwordx4 a[8:11], v224, s[36:39], s34 offen offset:0 sc1
buffer_load_dwordx4 a[24:27], v224, s[36:39], s34 offen offset:1024 sc1
buffer_load_dwordx4 a[40:43], v224, s[36:39], s34 offen offset:2048 sc1
buffer_load_dwordx4 a[56:59], v224, s[36:39], s34 offen offset:3072 sc1
s_add_u32 s34, s34, 4096
buffer_load_dwordx4 a[72:75], v224, s[36:39], s34 offen offset:0 sc1
buffer_load_dwordx4 a[88:91], v224, s[36:39], s34 offen offset:1024 sc1
buffer_load_dwordx4 a[104:107], v224, s[36:39], s34 offen offset:2048 sc1
L_q_skip2:
s_and_b32 s34, s35, 61440
s_cbranch_scc1 L_q_skip3
s_or_b32 s79, s79, 61440
s_mov_b32 s34, 86016
buffer_load_dwordx4 a[12:15], v224, s[36:39], s34 offen offset:0 sc1
buffer_load_dwordx4 a[28:31], v224, s[36:39], s34 offen offset:1024 sc1
buffer_load_dwordx4 a[44:47], v224, s[36:39], s34 offen offset:2048 sc1
buffer_load_dwordx4 a[60:63], v224, s[36:39], s34 offen offset:3072 sc1
s_add_u32 s34, s34, 4096
buffer_load_dwordx4 a[76:79], v224, s[36:39], s34 offen offset:0 sc1
buffer_load_dwordx4 a[92:95], v224, s[36:39], s34 offen offset:1024 sc1
buffer_load_dwordx4 a[108:111], v224, s[36:39], s34 offen offset:2048 sc1
L_q_skip3:
s_cmp_lg_u32 s79, 0xffff
s_cbranch_scc1 L_q_poll
L_q_done:
s_waitcnt vmcnt(6)
v_mfma_f32_16x16x32_bf16 v[0:3], v[204:207], a[0:3], 0
v_mfma_f32_16x16x32_bf16 v[0:3], v[204:207], a[4:7], v[0:3]
v_mfma_f32_16x16x32_bf16 v[0:3], v[204:207], a[8:11], v[0:3]
v_mfma_f32_16x16x32_bf16 v[0:3], v[204:207], a[12:15], v[0:3]
s_waitcnt vmcnt(5)
v_mfma_f32_16x16x32_bf16 v[4:7], v[204:207], a[16:19], 0
v_mfma_f32_16x16x32_bf16 v[4:7], v[204:207], a[20:23], v[4:7]
v_mfma_f32_16x16x32_bf16 v[4:7], v[204:207], a[24:27], v[4:7]
v_mfma_f32_16x16x32_bf16 v[4:7], v[204:207], a[28:31], v[4:7]
s_waitcnt vmcnt(4)
v_mfma_f32_16x16x32_bf16 v[8:11], v[204:207], a[32:35], 0
v_mfma_f32_16x16x32_bf16 v[8:11], v[204:207], a[36:39], v[8:11]
v_mfma_f32_16x16x32_bf16 v[8:11], v[204:207], a[40:43], v[8:11]
v_mfma_f32_16x16x32_bf16 v[8:11], v[204:207], a[44:47], v[8:11]
v_cvt_pk_bf16_f32 v32, v0, v1
v_cvt_pk_bf16_f32 v33, v2, v3
buffer_store_dwordx2 v[32:33], v225, s[48:51], 0 offen offset:0
s_waitcnt vmcnt(4)
v_mfma_f32_16x16x32_bf16 v[12:15], v[204:207], a[48:51], 0
v_mfma_f32_16x16x32_bf16 v[12:15], v[204:207], a[52:55], v[12:15]
v_mfma_f32_16x16x32_bf16 v[12:15], v[204:207], a[56:59], v[12:15]
v_mfma_f32_16x16x32_bf16 v[12:15], v[204:207], a[60:63], v[12:15]
v_cvt_pk_bf16_f32 v34, v4, v5
v_cvt_pk_bf16_f32 v35, v6, v7
buffer_store_dwordx2 v[34:35], v225, s[48:51], 0 offen offset:128
s_waitcnt vmcnt(4)
v_mfma_f32_16x16x32_bf16 v[16:19], v[204:207], a[64:67], 0
v_mfma_f32_16x16x32_bf16 v[16:19], v[204:207], a[68:71], v[16:19]
v_mfma_f32_16x16x32_bf16 v[16:19], v[204:207], a[72:75], v[16:19]
v_mfma_f32_16x16x32_bf16 v[16:19], v[204:207], a[76:79], v[16:19]
v_cvt_pk_bf16_f32 v36, v8, v9
v_cvt_pk_bf16_f32 v37, v10, v11
buffer_store_dwordx2 v[36:37], v225, s[48:51], 0 offen offset:256
s_waitcnt vmcnt(4)
v_mfma_f32_16x16x32_bf16 v[20:23], v[204:207], a[80:83], 0
v_mfma_f32_16x16x32_bf16 v[20:23], v[204:207], a[84:87], v[20:23]
v_mfma_f32_16x16x32_bf16 v[20:23], v[204:207], a[88:91], v[20:23]
v_mfma_f32_16x16x32_bf16 v[20:23], v[204:207], a[92:95], v[20:23]
v_cvt_pk_bf16_f32 v38, v12, v13
v_cvt_pk_bf16_f32 v39, v14, v15
buffer_store_dwordx2 v[38:39], v225, s[48:51], 0 offen offset:384
s_waitcnt vmcnt(4)
v_mfma_f32_16x16x32_bf16 v[24:27], v[204:207], a[96:99], 0
v_mfma_f32_16x16x32_bf16 v[24:27], v[204:207], a[100:103], v[24:27]
v_mfma_f32_16x16x32_bf16 v[24:27], v[204:207], a[104:107], v[24:27]
v_mfma_f32_16x16x32_bf16 v[24:27], v[204:207], a[108:111], v[24:27]
v_cvt_pk_bf16_f32 v40, v16, v17
v_cvt_pk_bf16_f32 v41, v18, v19
buffer_store_dwordx2 v[40:41], v225, s[48:51], 0 offen offset:512
s_nop 3
v_cvt_pk_bf16_f32 v42, v20, v21
v_cvt_pk_bf16_f32 v43, v22, v23
buffer_store_dwordx2 v[42:43], v225, s[48:51], 0 offen offset:640
s_nop 1
v_cvt_pk_bf16_f32 v44, v24, v25
v_cvt_pk_bf16_f32 v45, v26, v27
buffer_store_dwordx2 v[44:45], v225, s[48:51], 0 offen offset:768
L_end:
s_endpgm
L_rescale:
v_mov_b32 v212, v208
v_mov_b32 v213, v209
s_nop 1
v_permlane16_swap_b32 v208, v212
v_permlane16_swap_b32 v209, v213
v_max_f32 v208, v208, v212
v_max_f32 v209, v209, v213
v_mov_b32 v212, v208
v_mov_b32 v213, v209
s_nop 1
v_permlane32_swap_b32 v208, v212
v_permlane32_swap_b32 v209, v213
v_max_f32 v208, v208, v212
v_max_f32 v209, v209, v213
v_max_f32 v208, 0, v208
v_max_f32 v209, 0, v209
v_sub_f32 v210, 0, v208
v_sub_f32 v211, 0, v209
v_exp_f32 v210, v210
v_exp_f32 v211, v211
v_sub_f32 v168, v168, v208
v_sub_f32 v169, v169, v208
v_sub_f32 v170, v170, v208
v_sub_f32 v171, v171, v208
v_sub_f32 v172, v172, v209
v_sub_f32 v173, v173, v209
v_sub_f32 v174, v174, v209
v_sub_f32 v175, v175, v209
v_sub_f32 v128, v128, v208
v_sub_f32 v129, v129, v208
v_sub_f32 v130, v130, v208
v_sub_f32 v131, v131, v208
v_sub_f32 v132, v132, v208
v_sub_f32 v133, v133, v208
v_sub_f32 v134, v134, v208
v_sub_f32 v135, v135, v208
v_sub_f32 v136, v136, v209
v_sub_f32 v137, v137, v209
v_sub_f32 v138, v138, v209
v_sub_f32 v139, v139, v209
v_sub_f32 v140, v140, v209
v_sub_f32 v141, v141, v209
v_sub_f32 v142, v142, v209
v_sub_f32 v143, v143, v209
v_sub_f32 v144, v144, v208
v_sub_f32 v145, v145, v208
v_sub_f32 v146, v146, v208
v_sub_f32 v147, v147, v208
v_sub_f32 v148, v148, v208
v_sub_f32 v149, v149, v208
v_sub_f32 v150, v150, v208
v_sub_f32 v151, v151, v208
v_sub_f32 v152, v152, v209
v_sub_f32 v153, v153, v209
v_sub_f32 v154, v154, v209
v_sub_f32 v155, v155, v209
v_sub_f32 v156, v156, v209
v_sub_f32 v157, v157, v209
v_sub_f32 v158, v158, v209
v_sub_f32 v159, v159, v209
v_accvgpr_read_b32 v212, a224
v_mul_f32 v212, v210, v212
v_accvgpr_write_b32 a224, v212
v_accvgpr_read_b32 v212, a225
v_mul_f32 v212, v210, v212
v_accvgpr_write_b32 a225, v212
v_accvgpr_read_b32 v212, a226
v_mul_f32 v212, v210, v212
v_accvgpr_write_b32 a226, v212
v_accvgpr_read_b32 v212, a227
v_mul_f32 v212, v210, v212
v_accvgpr_write_b32 a227, v212
v_accvgpr_read_b32 v212, a228
v_mul_f32 v212, v211, v212
v_accvgpr_write_b32 a228, v212
v_accvgpr_read_b32 v212, a229
v_mul_f32 v212, v211, v212
v_accvgpr_write_b32 a229, v212
v_accvgpr_read_b32 v212, a230
v_mul_f32 v212, v211, v212
v_accvgpr_write_b32 a230, v212
v_accvgpr_read_b32 v212, a231
v_mul_f32 v212, v211, v212
v_accvgpr_write_b32 a231, v212
v_mul_f32 v0, v210, v0
v_mul_f32 v1, v210, v1
v_mul_f32 v2, v210, v2
v_mul_f32 v3, v210, v3
v_mul_f32 v4, v210, v4
v_mul_f32 v5, v210, v5
v_mul_f32 v6, v210, v6
v_mul_f32 v7, v210, v7
v_mul_f32 v8, v211, v8
v_mul_f32 v9, v211, v9
v_mul_f32 v10, v211, v10
v_mul_f32 v11, v211, v11
v_mul_f32 v12, v211, v12
v_mul_f32 v13, v211, v13
v_mul_f32 v14, v211, v14
v_mul_f32 v15, v211, v15
v_mul_f32 v16, v210, v16
v_mul_f32 v17, v210, v17
v_mul_f32 v18, v210, v18
v_mul_f32 v19, v210, v19
v_mul_f32 v20, v210, v20
v_mul_f32 v21, v210, v21
v_mul_f32 v22, v210, v22
v_mul_f32 v23, v210, v23
v_mul_f32 v24, v211, v24
v_mul_f32 v25, v211, v25
v_mul_f32 v26, v211, v26
v_mul_f32 v27, v211, v27
v_mul_f32 v28, v211, v28
v_mul_f32 v29, v211, v29
v_mul_f32 v30, v211, v30
v_mul_f32 v31, v211, v31
v_mul_f32 v32, v210, v32
v_mul_f32 v33, v210, v33
v_mul_f32 v34, v210, v34
v_mul_f32 v35, v210, v35
v_mul_f32 v36, v210, v36
v_mul_f32 v37, v210, v37
v_mul_f32 v38, v210, v38
v_mul_f32 v39, v210, v39
v_mul_f32 v40, v211, v40
v_mul_f32 v41, v211, v41
v_mul_f32 v42, v211, v42
v_mul_f32 v43, v211, v43
v_mul_f32 v44, v211, v44
v_mul_f32 v45, v211, v45
v_mul_f32 v46, v211, v46
v_mul_f32 v47, v211, v47
v_mul_f32 v48, v210, v48
v_mul_f32 v49, v210, v49
v_mul_f32 v50, v210, v50
v_mul_f32 v51, v210, v51
v_mul_f32 v52, v210, v52
v_mul_f32 v53, v210, v53
v_mul_f32 v54, v210, v54
v_mul_f32 v55, v210, v55
v_mul_f32 v56, v211, v56
v_mul_f32 v57, v211, v57
v_mul_f32 v58, v211, v58
v_mul_f32 v59, v211, v59
v_mul_f32 v60, v211, v60
v_mul_f32 v61, v211, v61
v_mul_f32 v62, v211, v62
v_mul_f32 v63, v211, v63
v_mul_f32 v64, v210, v64
v_mul_f32 v65, v210, v65
v_mul_f32 v66, v210, v66
v_mul_f32 v67, v210, v67
v_mul_f32 v68, v210, v68
v_mul_f32 v69, v210, v69
v_mul_f32 v70, v210, v70
v_mul_f32 v71, v210, v71
v_mul_f32 v72, v211, v72
v_mul_f32 v73, v211, v73
v_mul_f32 v74, v211, v74
v_mul_f32 v75, v211, v75
v_mul_f32 v76, v211, v76
v_mul_f32 v77, v211, v77
v_mul_f32 v78, v211, v78
v_mul_f32 v79, v211, v79
v_mul_f32 v80, v210, v80
v_mul_f32 v81, v210, v81
v_mul_f32 v82, v210, v82
v_mul_f32 v83, v210, v83
v_mul_f32 v84, v210, v84
v_mul_f32 v85, v210, v85
v_mul_f32 v86, v210, v86
v_mul_f32 v87, v210, v87
v_mul_f32 v88, v211, v88
v_mul_f32 v89, v211, v89
v_mul_f32 v90, v211, v90
v_mul_f32 v91, v211, v91
v_mul_f32 v92, v211, v92
v_mul_f32 v93, v211, v93
v_mul_f32 v94, v211, v94
v_mul_f32 v95, v211, v95
v_mul_f32 v96, v210, v96
v_mul_f32 v97, v210, v97
v_mul_f32 v98, v210, v98
v_mul_f32 v99, v210, v99
v_mul_f32 v100, v210, v100
v_mul_f32 v101, v210, v101
v_mul_f32 v102, v210, v102
v_mul_f32 v103, v210, v103
v_mul_f32 v104, v211, v104
v_mul_f32 v105, v211, v105
v_mul_f32 v106, v211, v106
v_mul_f32 v107, v211, v107
v_mul_f32 v108, v211, v108
v_mul_f32 v109, v211, v109
v_mul_f32 v110, v211, v110
v_mul_f32 v111, v211, v111
v_mul_f32 v112, v210, v112
v_mul_f32 v113, v210, v113
v_mul_f32 v114, v210, v114
v_mul_f32 v115, v210, v115
v_mul_f32 v116, v210, v116
v_mul_f32 v117, v210, v117
v_mul_f32 v118, v210, v118
v_mul_f32 v119, v210, v119
v_mul_f32 v120, v211, v120
v_mul_f32 v121, v211, v121
v_mul_f32 v122, v211, v122
v_mul_f32 v123, v211, v123
v_mul_f32 v124, v211, v124
v_mul_f32 v125, v211, v125
v_mul_f32 v126, v211, v126
v_mul_f32 v127, v211, v127
s_setpc_b64 s[82:83]
L_codeend:
.section .rodata,"a"
.p2align 6
.amdhsa_kernel concat_heads__mha_block_cached__mha_block_cached__near_ridge_kernel
  .amdhsa_next_free_vgpr 512
  .amdhsa_next_free_sgpr 102
  .amdhsa_accum_offset 256
  .amdhsa_group_segment_fixed_size 0
  .amdhsa_kernarg_size 104
  .amdhsa_user_sgpr_count 2
  .amdhsa_user_sgpr_kernarg_segment_ptr 1
  .amdhsa_system_sgpr_workgroup_id_x 1
.end_amdhsa_kernel
```
